```python
import torch

def _softmax(x, axis=-1):
    return torch.softmax(x, dim=axis)
def _gelu(x):
    return torch.nn.functional.gelu(x, approximate="tanh")
def _silu(x):
    return torch.nn.functional.silu(x)
def _sigmoid(x):
    return torch.sigmoid(x)
def _layernorm(x, axis=-1, eps=1e-5):
    m = x.mean(dim=axis, keepdim=True)
    v = x.var(dim=axis, keepdim=True, unbiased=False)
    return (x - m) / torch.sqrt(v + eps)
def _scatter_add(tgt, idx, src, axis=0):
    return tgt.clone().index_add_(axis, idx, src)
def _segment_sum(src, seg, n):
    out = torch.zeros((n,) + src.shape[1:], dtype=src.dtype)
    return out.index_add_(0, seg, src)
def _pad(x, pw):
    flat = tuple(v for pair in reversed(pw) for v in pair)
    return torch.nn.functional.pad(x, flat)

kernel_name = 'recurrent_scan__linear_attn_block__dense_activation_gelu__prompt'

def setup_inputs():

    _w = (lambda a: (lambda t: t.to(torch.bfloat16) if t.is_floating_point() else t)(torch.as_tensor(a)))
    def _A_setup():
        B, S, D = 1, 2048, 576
        return {
            "x": _w((lambda *s: torch.randn(*s, dtype=torch.bfloat16) * 0.05)(B, S, D)),
            "wqkv": _w((lambda *s: torch.randn(*s, dtype=torch.bfloat16) * 0.2)(D, 3 * D)),
            "wo": _w((lambda *s: torch.randn(*s, dtype=torch.bfloat16) * 0.2)(D, D)),
        }
    _A_in = _A_setup()

    def _B_setup():
        B, S, D, F = 1, 2048, 576, 4608
        return {
            "x": _w((lambda *s: torch.randn(*s, dtype=torch.bfloat16) * 0.05)(B, S, D)),
            "w1": _w((lambda *s: torch.randn(*s, dtype=torch.bfloat16) * 0.4)(D, F) * (D ** -0.5)),
            "b1": _w((lambda *s: torch.randn(*s, dtype=torch.bfloat16) * 12.8)(F) * 0.01),
            "w2": _w((lambda *s: torch.randn(*s, dtype=torch.bfloat16) * 0.2)(F, D) * (F ** -0.5)),
            "b2": _w((lambda *s: torch.randn(*s, dtype=torch.bfloat16) * 1.6)(D) * 0.01),
        }
    _B_in = _B_setup()

    return {
        "A_x": _A_in["x"],
        "A_wqkv": _A_in["wqkv"],
        "A_wo": _A_in["wo"],
        "B_x": _B_in["x"],
        "B_w1": _B_in["w1"],
        "B_b1": _B_in["b1"],
        "B_w2": _B_in["w2"],
        "B_b2": _B_in["b2"],
    }

def reference(A_x, A_wqkv, A_wo, B_x, B_w1, B_b1, B_w2, B_b2):
    def _A_ref(x, wqkv, wo):
        B, S, D = x.shape
        H = 32; Dh = D // H
        qkv = (lambda x, *d: x.permute(*d))((x @ wqkv).reshape(B, S, 3, H, Dh), 2, 0, 3, 1, 4)
        q, k, v = qkv[0], qkv[1], qkv[2]
        phi = lambda t: torch.where(t > 0, t + 1, torch.exp(t)) + 1e-6
        pq, pk = phi(q), phi(k)
        kv = torch.einsum("bhsd,bhse->bhde", pk, v)
        z = torch.einsum("bhsd->bhd", pk)
        num = torch.einsum("bhqd,bhde->bhqe", pq, kv)
        den = torch.einsum("bhqd,bhd->bhq", pq, z)[..., None] + 1e-6
        o = num / den
        return (lambda x, *d: x.permute(*d))(o, 0, 2, 1, 3).reshape(B, S, D) @ wo

    def _B_ref(x, w1, b1, w2, b2):
        h = torch.einsum("bsd,df->bsf", x, w1) + b1
        h = _gelu(h)
        return torch.einsum("bsf,fd->bsd", h, w2) + b2

    x = A_x
    xn = _layernorm(x, axis=-1)
    s = _A_ref(xn, A_wqkv, A_wo)
    g = _silu(_B_ref(xn, B_w1, B_b1, B_w2, B_b2))
    return x + s * g
```

```asm
; @launch grid=(256,1,1) block=(256,1,1) lds=163840
.amdgcn_target "amdgcn-amd-amdhsa--gfx950"
.text
.globl recurrent_scan__linear_attn_block__dense_activation_gelu__prompt_kernel
.p2align 8
.type recurrent_scan__linear_attn_block__dense_activation_gelu__prompt_kernel,@function
recurrent_scan__linear_attn_block__dense_activation_gelu__prompt_kernel:
    s_cmp_ge_u32 s2, 256
    s_cbranch_scc1 L_k1_end
    s_load_dwordx16 s[16:31], s[0:1], 0
    s_load_dwordx4 s[32:35], s[0:1], 64
    s_load_dwordx2 s[36:37], s[0:1], 80
    v_and_b32 v1, 63, v0
    v_lshrrev_b32 v4, 6, v0
    s_and_b32 s9, s2, 7
    v_readfirstlane_b32 s3, v4
    s_lshr_b32 s5, s2, 3
    s_and_b32 s4, s5, 7
    s_lshr_b32 s5, s5, 3
    s_lshr_b32 s6, s9, 1
    s_lshl_b32 s6, s6, 3
    s_add_u32 s4, s4, s6
    s_and_b32 s6, s9, 1
    s_mul_i32 s15, s6, 3
    s_add_u32 s15, s15, s5
    s_sub_u32 s15, s15, 1
    s_cmp_eq_u32 s5, 0
    s_cselect_b32 s6, s6, s15
    s_cmp_lg_u32 s3, 3
    s_cbranch_scc1 L_cpf0
    s_getpc_b64 s[72:73]
L_pc0:
    s_cmp_eq_u32 s5, 0
    s_cselect_b32 s71, L_attn-L_pc0-4096, 0
    s_add_u32 s72, s72, s71
    s_addc_u32 s73, s73, 0
    s_and_b32 s71, s4, 7
    s_mul_i32 s71, s71, 44
    v_min_u32 v176, 43, v1
    v_add_u32 v176, s71, v176
    v_lshlrev_b32 v176, 7, v176
    global_load_dword v176, v176, s[72:73]
L_cpf0:
    s_lshl_b32 s7, s3, 12
    v_lshrrev_b32 v4, 3, v1
    v_lshrrev_b32 v5, 1, v4
    v_xor_b32 v5, v5, v1
    v_and_b32 v5, 7, v5
    v_lshlrev_b32 v5, 4, v5
    v_mul_u32_u24 v4, 1152, v4
    v_add_u32 v4, v4, v5
    v_xor_b32 v5, 64, v4
    v_add_u32 v5, 9216, v5
    s_lshl_b32 s8, s4, 2
    s_add_u32 s8, s8, s3
    s_mul_i32 s8, s8, 18432
    s_waitcnt lgkmcnt(0)
    s_mov_b32 s40, s16
    s_and_b32 s41, s17, 0xffff
    s_mov_b32 s42, 2359296
    s_mov_b32 s43, 0x00020000
    s_mov_b32 s52, s36
    s_and_b32 s53, s37, 0xffff
    s_mov_b32 s54, 67108864
    s_mov_b32 s55, 0x00020000
    s_add_u32 s9, s2, s3
    s_cmp_lg_u32 s9, 0
    s_cbranch_scc1 L_noep1
    v_mov_b32 v15, 48300032
    buffer_load_dword v15, v15, s[52:55], 0 offen sc1
L_noep1:
    s_add_u32 m0, s7, 0
    s_nop 0
    buffer_load_dwordx4 v4, s[40:43], s8 offen offset:0 lds
    s_add_u32 m0, s7, 1024
    s_nop 0
    buffer_load_dwordx4 v5, s[40:43], s8 offen offset:0 lds
    s_add_u32 m0, s7, 1920
    s_nop 0
    buffer_load_dwordx4 v4, s[40:43], s8 offen offset:128 lds
    s_add_u32 m0, s7, 2944
    s_nop 0
    buffer_load_dwordx4 v5, s[40:43], s8 offen offset:128 lds
    s_add_u32 m0, s7, 16128
    s_nop 0
    buffer_load_dwordx4 v4, s[40:43], s8 offen offset:256 lds
    s_add_u32 m0, s7, 17152
    s_nop 0
    buffer_load_dwordx4 v5, s[40:43], s8 offen offset:256 lds
    s_add_u32 m0, s7, 18048
    s_nop 0
    buffer_load_dwordx4 v4, s[40:43], s8 offen offset:384 lds
    s_add_u32 m0, s7, 19072
    s_nop 0
    buffer_load_dwordx4 v5, s[40:43], s8 offen offset:384 lds
    s_add_u32 m0, s7, 32256
    s_nop 0
    buffer_load_dwordx4 v4, s[40:43], s8 offen offset:512 lds
    s_add_u32 m0, s7, 33280
    s_nop 0
    buffer_load_dwordx4 v5, s[40:43], s8 offen offset:512 lds
    s_add_u32 m0, s7, 34176
    s_nop 0
    buffer_load_dwordx4 v4, s[40:43], s8 offen offset:640 lds
    s_add_u32 m0, s7, 35200
    s_nop 0
    buffer_load_dwordx4 v5, s[40:43], s8 offen offset:640 lds
    s_add_u32 m0, s7, 48384
    s_nop 0
    buffer_load_dwordx4 v4, s[40:43], s8 offen offset:768 lds
    s_add_u32 m0, s7, 49408
    s_nop 0
    buffer_load_dwordx4 v5, s[40:43], s8 offen offset:768 lds
    s_add_u32 m0, s7, 50304
    s_nop 0
    buffer_load_dwordx4 v4, s[40:43], s8 offen offset:896 lds
    s_add_u32 m0, s7, 51328
    s_nop 0
    buffer_load_dwordx4 v5, s[40:43], s8 offen offset:896 lds
    s_add_u32 m0, s7, 64512
    s_nop 0
    buffer_load_dwordx4 v4, s[40:43], s8 offen offset:1024 lds
    s_add_u32 m0, s7, 65536
    s_nop 0
    buffer_load_dwordx4 v5, s[40:43], s8 offen offset:1024 lds
    s_mov_b32 s60, s34
    s_and_b32 s61, s35, 0xffff
    s_mov_b32 s62, 256
    s_mov_b32 s63, 0x00020000
    s_mov_b32 s13, 0xffff0000
    s_mov_b32 s14, 0x3f803f80
    v_lshlrev_b32 v2, 4, v1
    v_add_u32 v3, 0x10000, v2
    s_cmp_eq_u32 s5, 0
    s_cbranch_scc1 L_attn
    s_mul_i32 s67, s6, 1536
    s_lshl_b32 s9, s3, 7
    s_add_u32 s10, s67, s9
    s_mul_i32 s68, s6, 884736
    s_mov_b32 s66, 0xc09d30fc
    s_mov_b32 s44, s24
    s_and_b32 s45, s25, 0xffff
    s_mov_b32 s46, 5308416
    s_mov_b32 s47, 0x00020000
    s_mov_b32 s72, s4
    s_lshl_b32 s73, s3, 6
    s_cmp_ge_u32 s73, 36
    s_cbranch_scc1 L_pf0
    s_mul_i32 s72, s72, 165888
    s_add_u32 s72, s72, s67
    s_add_u32 s72, s72, 124
    v_add_u32 v178, s73, v1
    v_min_u32 v178, 35, v178
    v_mul_u32_u24 v179, 32768, v178
    v_lshrrev_b32 v179, 16, v179
    v_lshlrev_b32 v178, 8, v178
    v_mul_u32_u24 v179, 8704, v179
    v_add_u32 v178, v178, v179
    buffer_load_dwordx2 v[178:179], v178, s[44:47], s72 offen
L_pf0:
    v_lshrrev_b32 v216, 3, v1
    v_bfe_u32 v217, v1, 1, 2
    v_bfe_u32 v218, v1, 4, 2
    v_xor_b32 v217, v217, v218
    v_lshlrev_b32 v217, 5, v217
    v_and_b32 v218, 1, v1
    v_lshl_add_u32 v217, v218, 4, v217
    v_lshrrev_b32 v218, 2, v216
    v_and_b32 v216, 3, v216
    v_lshl_add_u32 v216, v218, 3, v216
    v_mul_u32_u24 v216, 9216, v216
    v_add_u32 v252, v216, v217
    v_add_u32 v253, 146432, v252
    v_add_u32 v254, 34816, v252
    v_add_u32 v255, 181248, v252
    s_mov_b32 s48, s28
    s_and_b32 s49, s29, 0xffff
    s_mov_b32 s50, 5308416
    s_mov_b32 s51, 0x00020000
    s_mov_b32 s56, s26
    s_and_b32 s57, s27, 0xffff
    s_mov_b32 s58, 9216
    s_mov_b32 s59, 0x00020000
    v_lshrrev_b32 v216, 5, v1
    v_lshlrev_b32 v216, 10, v216
    v_bfe_u32 v217, v1, 2, 3
    v_lshl_add_u32 v216, v217, 7, v216
    v_lshrrev_b32 v217, 1, v217
    v_lshl_add_u32 v216, v217, 5, v216
    v_and_b32 v217, 3, v1
    v_lshl_add_u32 v216, v217, 3, v216
    v_add_u32 v240, s7, v216
    v_xor_b32 v241, 32, v240
    v_xor_b32 v242, 64, v240
    v_xor_b32 v243, 96, v240
    v_add_u32 v244, 65536, v240
    v_add_u32 v245, 65536, v241
    v_add_u32 v246, 65536, v242
    v_add_u32 v247, 65536, v243
    v_add_u32 v248, 131072, v240
    v_add_u32 v249, 131072, v241
    v_add_u32 v250, 131072, v242
    v_add_u32 v251, 131072, v243
    s_add_u32 s71, s10, 0
    v_lshrrev_b32 v222, 4, v1
    v_lshlrev_b32 v222, 3, v222
    buffer_load_dwordx2 v[216:217], v222, s[56:59], s71 offen offset:0
    buffer_load_dwordx2 v[218:219], v222, s[56:59], s71 offen offset:32
    buffer_load_dwordx2 v[220:221], v222, s[56:59], s71 offen offset:64
    buffer_load_dwordx2 v[222:223], v222, s[56:59], s71 offen offset:96
    v_min_u32 v180, 2, v1
    v_lshlrev_b32 v180, 9, v180
    buffer_load_dword v180, v180, s[56:59], s10 offen
    s_add_u32 s9, s6, 1
    s_cmp_ge_u32 s9, 6
    s_cselect_b32 s15, 6, 0
    s_sub_u32 s9, s9, s15
    s_add_u32 s15, s3, 6
    s_cmp_lt_u32 s3, 3
    s_cselect_b32 s9, s15, s9
    s_lshl_b32 s15, s9, 7
    s_add_u32 s74, s68, s15
    s_mul_i32 s15, s4, 9
    s_add_u32 s9, s9, s15
    s_lshl_b32 s15, s9, 16
    s_lshl_b32 s76, s6, 10
    s_add_u32 s76, s76, s15
    s_lshl_b32 s15, s9, 6
    s_lshl_b32 s78, s6, 2
    s_add_u32 s78, s78, s15
    s_add_u32 s78, s78, 48238592
    s_add_u32 s9, s6, s3
    s_add_u32 s9, s9, 2
    s_cmp_ge_u32 s9, 6
    s_cselect_b32 s15, 6, 0
    s_sub_u32 s9, s9, s15
    s_lshl_b32 s15, s9, 7
    s_add_u32 s75, s68, s15
    s_mul_i32 s15, s4, 9
    s_add_u32 s9, s9, s15
    s_lshl_b32 s15, s9, 16
    s_lshl_b32 s77, s6, 10
    s_add_u32 s77, s77, s15
    s_lshl_b32 s15, s9, 6
    s_lshl_b32 s79, s6, 2
    s_add_u32 s79, s79, s15
    s_add_u32 s79, s79, 48238592
    s_mul_i32 s9, s3, 36864
    s_add_u32 s65, s68, s9
    s_lshl_b32 s9, s6, 7
    s_add_u32 s65, s65, s9
    s_mul_i32 s94, s4, 73728
    s_add_u32 s94, s94, s7
    s_add_u32 s94, s94, 37748736
    s_lshl_b32 s95, s4, 6
    s_add_u32 s95, s95, 48267264
    v_and_b32 v6, 15, v1
    v_lshrrev_b32 v7, 4, v1
    v_lshrrev_b32 v8, 1, v6
    v_xor_b32 v8, v8, v7
    v_lshlrev_b32 v8, 4, v8
    v_lshl_add_u32 v8, v6, 7, v8
    v_add_u32 v4, s7, v8
    v_xor_b32 v5, 64, v4
    v_add_u32 v6, 0x10000, v4
    v_add_u32 v7, 0x10000, v5
    v_mov_b32 v8, 0
    v_mov_b32 v9, 0
    v_mov_b32 v10, 0
    v_mov_b32 v14, 0
    s_waitcnt vmcnt(21)
    ds_read_b128 v[48:51], v4 offset:0
    ds_read_b128 v[52:55], v5 offset:0
    s_waitcnt vmcnt(19)
    ds_read_b128 v[56:59], v4 offset:2048
    ds_read_b128 v[60:63], v5 offset:2048
    s_add_u32 m0, s7, 81920
    s_add_u32 s64, s10, 0
    buffer_load_dwordx4 v252, s[44:47], s64 offen offset:0  lds
    buffer_load_dwordx4 v253, s[44:47], s64 offen offset:1024  lds
    s_waitcnt lgkmcnt(2)
    v_dot2c_f32_bf16 v8, s14, v48
    v_dot2c_f32_bf16 v10, v48, v48
    v_dot2c_f32_bf16 v9, s14, v49
    v_dot2c_f32_bf16 v14, v49, v49
    v_dot2c_f32_bf16 v8, s14, v50
    v_dot2c_f32_bf16 v10, v50, v50
    v_dot2c_f32_bf16 v9, s14, v51
    v_dot2c_f32_bf16 v14, v51, v51
    v_dot2c_f32_bf16 v8, s14, v52
    v_dot2c_f32_bf16 v10, v52, v52
    v_dot2c_f32_bf16 v9, s14, v53
    v_dot2c_f32_bf16 v14, v53, v53
    v_dot2c_f32_bf16 v8, s14, v54
    v_dot2c_f32_bf16 v10, v54, v54
    v_dot2c_f32_bf16 v9, s14, v55
    v_dot2c_f32_bf16 v14, v55, v55
    s_waitcnt vmcnt(19)
    ds_read_b128 v[64:67], v4 offset:16384
    ds_read_b128 v[68:71], v5 offset:16384
    buffer_load_dwordx4 v254, s[44:47], s64 offen offset:2048  lds
    buffer_load_dwordx4 v255, s[44:47], s64 offen offset:3072  lds
    s_waitcnt lgkmcnt(2)
    v_dot2c_f32_bf16 v8, s14, v56
    v_dot2c_f32_bf16 v10, v56, v56
    v_dot2c_f32_bf16 v9, s14, v57
    v_dot2c_f32_bf16 v14, v57, v57
    v_dot2c_f32_bf16 v8, s14, v58
    v_dot2c_f32_bf16 v10, v58, v58
    v_dot2c_f32_bf16 v9, s14, v59
    v_dot2c_f32_bf16 v14, v59, v59
    v_dot2c_f32_bf16 v8, s14, v60
    v_dot2c_f32_bf16 v10, v60, v60
    v_dot2c_f32_bf16 v9, s14, v61
    v_dot2c_f32_bf16 v14, v61, v61
    v_dot2c_f32_bf16 v8, s14, v62
    v_dot2c_f32_bf16 v10, v62, v62
    v_dot2c_f32_bf16 v9, s14, v63
    v_dot2c_f32_bf16 v14, v63, v63
    s_waitcnt vmcnt(19)
    ds_read_b128 v[72:75], v4 offset:18432
    ds_read_b128 v[76:79], v5 offset:18432
    s_add_u32 m0, s7, 98304
    s_add_u32 s64, s10, 294912
    buffer_load_dwordx4 v252, s[44:47], s64 offen offset:0  lds
    buffer_load_dwordx4 v253, s[44:47], s64 offen offset:1024  lds
    s_waitcnt lgkmcnt(2)
    v_dot2c_f32_bf16 v8, s14, v64
    v_dot2c_f32_bf16 v10, v64, v64
    v_dot2c_f32_bf16 v9, s14, v65
    v_dot2c_f32_bf16 v14, v65, v65
    v_dot2c_f32_bf16 v8, s14, v66
    v_dot2c_f32_bf16 v10, v66, v66
    v_dot2c_f32_bf16 v9, s14, v67
    v_dot2c_f32_bf16 v14, v67, v67
    v_dot2c_f32_bf16 v8, s14, v68
    v_dot2c_f32_bf16 v10, v68, v68
    v_dot2c_f32_bf16 v9, s14, v69
    v_dot2c_f32_bf16 v14, v69, v69
    v_dot2c_f32_bf16 v8, s14, v70
    v_dot2c_f32_bf16 v10, v70, v70
    v_dot2c_f32_bf16 v9, s14, v71
    v_dot2c_f32_bf16 v14, v71, v71
    s_waitcnt vmcnt(19)
    ds_read_b128 v[80:83], v4 offset:32768
    ds_read_b128 v[84:87], v5 offset:32768
    buffer_load_dwordx4 v254, s[44:47], s64 offen offset:2048  lds
    buffer_load_dwordx4 v255, s[44:47], s64 offen offset:3072  lds
    s_waitcnt lgkmcnt(2)
    v_dot2c_f32_bf16 v8, s14, v72
    v_dot2c_f32_bf16 v10, v72, v72
    v_dot2c_f32_bf16 v9, s14, v73
    v_dot2c_f32_bf16 v14, v73, v73
    v_dot2c_f32_bf16 v8, s14, v74
    v_dot2c_f32_bf16 v10, v74, v74
    v_dot2c_f32_bf16 v9, s14, v75
    v_dot2c_f32_bf16 v14, v75, v75
    v_dot2c_f32_bf16 v8, s14, v76
    v_dot2c_f32_bf16 v10, v76, v76
    v_dot2c_f32_bf16 v9, s14, v77
    v_dot2c_f32_bf16 v14, v77, v77
    v_dot2c_f32_bf16 v8, s14, v78
    v_dot2c_f32_bf16 v10, v78, v78
    v_dot2c_f32_bf16 v9, s14, v79
    v_dot2c_f32_bf16 v14, v79, v79
    s_waitcnt vmcnt(19)
    ds_read_b128 v[88:91], v4 offset:34816
    ds_read_b128 v[92:95], v5 offset:34816
    s_add_u32 m0, s7, 114688
    s_add_u32 s64, s10, 589824
    buffer_load_dwordx4 v252, s[44:47], s64 offen offset:0  lds
    buffer_load_dwordx4 v253, s[44:47], s64 offen offset:1024  lds
    s_waitcnt lgkmcnt(2)
    v_dot2c_f32_bf16 v8, s14, v80
    v_dot2c_f32_bf16 v10, v80, v80
    v_dot2c_f32_bf16 v9, s14, v81
    v_dot2c_f32_bf16 v14, v81, v81
    v_dot2c_f32_bf16 v8, s14, v82
    v_dot2c_f32_bf16 v10, v82, v82
    v_dot2c_f32_bf16 v9, s14, v83
    v_dot2c_f32_bf16 v14, v83, v83
    v_dot2c_f32_bf16 v8, s14, v84
    v_dot2c_f32_bf16 v10, v84, v84
    v_dot2c_f32_bf16 v9, s14, v85
    v_dot2c_f32_bf16 v14, v85, v85
    v_dot2c_f32_bf16 v8, s14, v86
    v_dot2c_f32_bf16 v10, v86, v86
    v_dot2c_f32_bf16 v9, s14, v87
    v_dot2c_f32_bf16 v14, v87, v87
    s_waitcnt vmcnt(19)
    ds_read_b128 v[96:99], v4 offset:49152
    ds_read_b128 v[100:103], v5 offset:49152
    buffer_load_dwordx4 v254, s[44:47], s64 offen offset:2048  lds
    buffer_load_dwordx4 v255, s[44:47], s64 offen offset:3072  lds
    s_waitcnt lgkmcnt(2)
    v_dot2c_f32_bf16 v8, s14, v88
    v_dot2c_f32_bf16 v10, v88, v88
    v_dot2c_f32_bf16 v9, s14, v89
    v_dot2c_f32_bf16 v14, v89, v89
    v_dot2c_f32_bf16 v8, s14, v90
    v_dot2c_f32_bf16 v10, v90, v90
    v_dot2c_f32_bf16 v9, s14, v91
    v_dot2c_f32_bf16 v14, v91, v91
    v_dot2c_f32_bf16 v8, s14, v92
    v_dot2c_f32_bf16 v10, v92, v92
    v_dot2c_f32_bf16 v9, s14, v93
    v_dot2c_f32_bf16 v14, v93, v93
    v_dot2c_f32_bf16 v8, s14, v94
    v_dot2c_f32_bf16 v10, v94, v94
    v_dot2c_f32_bf16 v9, s14, v95
    v_dot2c_f32_bf16 v14, v95, v95
    s_waitcnt vmcnt(19)
    ds_read_b128 v[104:107], v4 offset:51200
    ds_read_b128 v[108:111], v5 offset:51200
    s_add_u32 m0, s7, 131072
    s_add_u32 s64, s10, 884736
    buffer_load_dwordx4 v252, s[44:47], s64 offen offset:0  lds
    buffer_load_dwordx4 v253, s[44:47], s64 offen offset:1024  lds
    s_waitcnt lgkmcnt(2)
    v_dot2c_f32_bf16 v8, s14, v96
    v_dot2c_f32_bf16 v10, v96, v96
    v_dot2c_f32_bf16 v9, s14, v97
    v_dot2c_f32_bf16 v14, v97, v97
    v_dot2c_f32_bf16 v8, s14, v98
    v_dot2c_f32_bf16 v10, v98, v98
    v_dot2c_f32_bf16 v9, s14, v99
    v_dot2c_f32_bf16 v14, v99, v99
    v_dot2c_f32_bf16 v8, s14, v100
    v_dot2c_f32_bf16 v10, v100, v100
    v_dot2c_f32_bf16 v9, s14, v101
    v_dot2c_f32_bf16 v14, v101, v101
    v_dot2c_f32_bf16 v8, s14, v102
    v_dot2c_f32_bf16 v10, v102, v102
    v_dot2c_f32_bf16 v9, s14, v103
    v_dot2c_f32_bf16 v14, v103, v103
    s_waitcnt vmcnt(19)
    ds_read_b128 v[112:115], v6 offset:0
    ds_read_b128 v[116:119], v7 offset:0
    buffer_load_dwordx4 v254, s[44:47], s64 offen offset:2048  lds
    buffer_load_dwordx4 v255, s[44:47], s64 offen offset:3072  lds
    s_waitcnt lgkmcnt(2)
    v_dot2c_f32_bf16 v8, s14, v104
    v_dot2c_f32_bf16 v10, v104, v104
    v_dot2c_f32_bf16 v9, s14, v105
    v_dot2c_f32_bf16 v14, v105, v105
    v_dot2c_f32_bf16 v8, s14, v106
    v_dot2c_f32_bf16 v10, v106, v106
    v_dot2c_f32_bf16 v9, s14, v107
    v_dot2c_f32_bf16 v14, v107, v107
    v_dot2c_f32_bf16 v8, s14, v108
    v_dot2c_f32_bf16 v10, v108, v108
    v_dot2c_f32_bf16 v9, s14, v109
    v_dot2c_f32_bf16 v14, v109, v109
    v_dot2c_f32_bf16 v8, s14, v110
    v_dot2c_f32_bf16 v10, v110, v110
    v_dot2c_f32_bf16 v9, s14, v111
    v_dot2c_f32_bf16 v14, v111, v111
    s_add_u32 m0, s7, 147456
    s_add_u32 s64, s10, 1179648
    buffer_load_dwordx4 v252, s[44:47], s64 offen offset:0  lds
    buffer_load_dwordx4 v253, s[44:47], s64 offen offset:1024  lds
    s_waitcnt lgkmcnt(0)
    v_dot2c_f32_bf16 v8, s14, v112
    v_dot2c_f32_bf16 v10, v112, v112
    v_dot2c_f32_bf16 v9, s14, v113
    v_dot2c_f32_bf16 v14, v113, v113
    v_dot2c_f32_bf16 v8, s14, v114
    v_dot2c_f32_bf16 v10, v114, v114
    v_dot2c_f32_bf16 v9, s14, v115
    v_dot2c_f32_bf16 v14, v115, v115
    v_dot2c_f32_bf16 v8, s14, v116
    v_dot2c_f32_bf16 v10, v116, v116
    v_dot2c_f32_bf16 v9, s14, v117
    v_dot2c_f32_bf16 v14, v117, v117
    v_dot2c_f32_bf16 v8, s14, v118
    v_dot2c_f32_bf16 v10, v118, v118
    v_dot2c_f32_bf16 v9, s14, v119
    v_dot2c_f32_bf16 v14, v119, v119
    s_nop 1
    v_add_f32 v8, v8, v9
    v_add_f32 v9, v10, v14
    v_mov_b32 v12, v8
    v_mov_b32 v13, v9
    s_nop 0
    v_permlane16_swap_b32 v8, v12
    v_permlane16_swap_b32 v9, v13
    v_add_f32 v8, v8, v12
    v_add_f32 v9, v9, v13
    v_mov_b32 v12, v8
    v_mov_b32 v13, v9
    s_nop 0
    v_permlane32_swap_b32 v8, v12
    v_permlane32_swap_b32 v9, v13
    v_add_f32 v8, v8, v12
    v_add_f32 v9, v9, v13
    v_mul_f32 v10, 0xbae38e39, v8
    v_mul_f32 v9, 0x3ae38e39, v9
    v_fma_f32 v9, -v10, v10, v9
    v_max_f32 v9, 0, v9
    v_add_f32 v9, 0x3727c5ac, v9
    v_rsq_f32 v8, v9
    s_nop 0
    v_mul_f32 v8, 0x3eeff558, v8
    v_cvt_pk_bf16_f32 v8, v8, 0
    v_lshlrev_b32 v12, 16, v8
    v_mul_f32 v9, v10, v12
    v_mov_b32 v10, v12
    v_add_u32 v4, s7, v2
    v_add_u32 v5, 0x10000, v4
    s_add_u32 s9, s2, s3
    s_cmp_lg_u32 s9, 0
    s_cbranch_scc1 L_ep_m
    s_mov_b32 s9, 0x9e3779b1
    v_mul_lo_u32 v15, v15, s9
    v_add_u32 v15, 0x7f4a7c15, v15
    v_or_b32 v15, 1, v15
    v_mov_b32 v14, 0
    s_mov_b32 s9, 48300032
    s_mov_b64 exec, 1
    buffer_store_dword v15, v14, s[60:63], 0 offen sc1
    buffer_store_dword v15, v14, s[52:55], s9 offen sc1
    s_mov_b64 exec, -1
L_ep_m:
    v_lshrrev_b32 v232, 3, v1
    v_bfe_u32 v233, v1, 1, 2
    v_bfe_u32 v234, v1, 4, 2
    v_xor_b32 v233, v233, v234
    v_lshlrev_b32 v233, 5, v233
    v_and_b32 v234, 1, v1
    v_lshl_add_u32 v233, v234, 4, v233
    v_mul_u32_u24 v232, 1152, v232
    v_add_u32 v12, v232, v233
    v_add_u32 v13, 8192, v12
    v_add_u32 v14, 16384, v12
    v_add_u32 v15, 24576, v12
    v_dot2_f32_bf16 v200, v48, v8, v9
    v_dot2_f32_bf16 v201, v48, v10, v9
    v_dot2_f32_bf16 v202, v49, v8, v9
    v_dot2_f32_bf16 v203, v49, v10, v9
    v_dot2_f32_bf16 v204, v50, v8, v9
    v_dot2_f32_bf16 v205, v50, v10, v9
    v_dot2_f32_bf16 v206, v51, v8, v9
    v_dot2_f32_bf16 v207, v51, v10, v9
    v_dot2_f32_bf16 v208, v52, v8, v9
    v_dot2_f32_bf16 v209, v52, v10, v9
    v_dot2_f32_bf16 v210, v53, v8, v9
    v_dot2_f32_bf16 v211, v53, v10, v9
    v_dot2_f32_bf16 v212, v54, v8, v9
    v_dot2_f32_bf16 v213, v54, v10, v9
    v_dot2_f32_bf16 v214, v55, v8, v9
    v_dot2_f32_bf16 v215, v55, v10, v9
    v_cvt_pk_bf16_f32 v48, v200, v201
    v_cvt_pk_bf16_f32 v49, v202, v203
    v_cvt_pk_bf16_f32 v50, v204, v205
    v_cvt_pk_bf16_f32 v51, v206, v207
    ds_write_b128 v4, v[48:51] offset:0
    v_dot2_f32_bf16 v200, v56, v8, v9
    v_dot2_f32_bf16 v201, v56, v10, v9
    v_dot2_f32_bf16 v202, v57, v8, v9
    v_dot2_f32_bf16 v203, v57, v10, v9
    v_dot2_f32_bf16 v204, v58, v8, v9
    v_dot2_f32_bf16 v205, v58, v10, v9
    v_dot2_f32_bf16 v206, v59, v8, v9
    v_dot2_f32_bf16 v207, v59, v10, v9
    v_cvt_pk_bf16_f32 v52, v208, v209
    v_cvt_pk_bf16_f32 v53, v210, v211
    v_cvt_pk_bf16_f32 v54, v212, v213
    v_cvt_pk_bf16_f32 v55, v214, v215
    ds_write_b128 v4, v[52:55] offset:1024
    v_dot2_f32_bf16 v208, v60, v8, v9
    v_dot2_f32_bf16 v209, v60, v10, v9
    v_dot2_f32_bf16 v210, v61, v8, v9
    v_dot2_f32_bf16 v211, v61, v10, v9
    v_dot2_f32_bf16 v212, v62, v8, v9
    v_dot2_f32_bf16 v213, v62, v10, v9
    v_dot2_f32_bf16 v214, v63, v8, v9
    v_dot2_f32_bf16 v215, v63, v10, v9
    v_cvt_pk_bf16_f32 v56, v200, v201
    v_cvt_pk_bf16_f32 v57, v202, v203
    v_cvt_pk_bf16_f32 v58, v204, v205
    v_cvt_pk_bf16_f32 v59, v206, v207
    ds_write_b128 v4, v[56:59] offset:2048
    v_dot2_f32_bf16 v200, v64, v8, v9
    v_dot2_f32_bf16 v201, v64, v10, v9
    v_dot2_f32_bf16 v202, v65, v8, v9
    v_dot2_f32_bf16 v203, v65, v10, v9
    v_dot2_f32_bf16 v204, v66, v8, v9
    v_dot2_f32_bf16 v205, v66, v10, v9
    v_dot2_f32_bf16 v206, v67, v8, v9
    v_dot2_f32_bf16 v207, v67, v10, v9
    v_cvt_pk_bf16_f32 v60, v208, v209
    v_cvt_pk_bf16_f32 v61, v210, v211
    v_cvt_pk_bf16_f32 v62, v212, v213
    v_cvt_pk_bf16_f32 v63, v214, v215
    ds_write_b128 v4, v[60:63] offset:3072
    v_dot2_f32_bf16 v208, v68, v8, v9
    v_dot2_f32_bf16 v209, v68, v10, v9
    v_dot2_f32_bf16 v210, v69, v8, v9
    v_dot2_f32_bf16 v211, v69, v10, v9
    v_dot2_f32_bf16 v212, v70, v8, v9
    v_dot2_f32_bf16 v213, v70, v10, v9
    v_dot2_f32_bf16 v214, v71, v8, v9
    v_dot2_f32_bf16 v215, v71, v10, v9
    v_cvt_pk_bf16_f32 v64, v200, v201
    v_cvt_pk_bf16_f32 v65, v202, v203
    v_cvt_pk_bf16_f32 v66, v204, v205
    v_cvt_pk_bf16_f32 v67, v206, v207
    ds_write_b128 v4, v[64:67] offset:16384
    v_dot2_f32_bf16 v200, v72, v8, v9
    v_dot2_f32_bf16 v201, v72, v10, v9
    v_dot2_f32_bf16 v202, v73, v8, v9
    v_dot2_f32_bf16 v203, v73, v10, v9
    v_dot2_f32_bf16 v204, v74, v8, v9
    v_dot2_f32_bf16 v205, v74, v10, v9
    v_dot2_f32_bf16 v206, v75, v8, v9
    v_dot2_f32_bf16 v207, v75, v10, v9
    v_cvt_pk_bf16_f32 v68, v208, v209
    v_cvt_pk_bf16_f32 v69, v210, v211
    v_cvt_pk_bf16_f32 v70, v212, v213
    v_cvt_pk_bf16_f32 v71, v214, v215
    ds_write_b128 v4, v[68:71] offset:17408
    v_dot2_f32_bf16 v208, v76, v8, v9
    v_dot2_f32_bf16 v209, v76, v10, v9
    v_dot2_f32_bf16 v210, v77, v8, v9
    v_dot2_f32_bf16 v211, v77, v10, v9
    v_dot2_f32_bf16 v212, v78, v8, v9
    v_dot2_f32_bf16 v213, v78, v10, v9
    v_dot2_f32_bf16 v214, v79, v8, v9
    v_dot2_f32_bf16 v215, v79, v10, v9
    v_cvt_pk_bf16_f32 v72, v200, v201
    v_cvt_pk_bf16_f32 v73, v202, v203
    v_cvt_pk_bf16_f32 v74, v204, v205
    v_cvt_pk_bf16_f32 v75, v206, v207
    ds_write_b128 v4, v[72:75] offset:18432
    v_dot2_f32_bf16 v200, v80, v8, v9
    v_dot2_f32_bf16 v201, v80, v10, v9
    v_dot2_f32_bf16 v202, v81, v8, v9
    v_dot2_f32_bf16 v203, v81, v10, v9
    v_dot2_f32_bf16 v204, v82, v8, v9
    v_dot2_f32_bf16 v205, v82, v10, v9
    v_dot2_f32_bf16 v206, v83, v8, v9
    v_dot2_f32_bf16 v207, v83, v10, v9
    v_cvt_pk_bf16_f32 v76, v208, v209
    v_cvt_pk_bf16_f32 v77, v210, v211
    v_cvt_pk_bf16_f32 v78, v212, v213
    v_cvt_pk_bf16_f32 v79, v214, v215
    ds_write_b128 v4, v[76:79] offset:19456
    v_dot2_f32_bf16 v208, v84, v8, v9
    v_dot2_f32_bf16 v209, v84, v10, v9
    v_dot2_f32_bf16 v210, v85, v8, v9
    v_dot2_f32_bf16 v211, v85, v10, v9
    v_dot2_f32_bf16 v212, v86, v8, v9
    v_dot2_f32_bf16 v213, v86, v10, v9
    v_dot2_f32_bf16 v214, v87, v8, v9
    v_dot2_f32_bf16 v215, v87, v10, v9
    v_cvt_pk_bf16_f32 v80, v200, v201
    v_cvt_pk_bf16_f32 v81, v202, v203
    v_cvt_pk_bf16_f32 v82, v204, v205
    v_cvt_pk_bf16_f32 v83, v206, v207
    ds_write_b128 v4, v[80:83] offset:32768
    v_dot2_f32_bf16 v200, v88, v8, v9
    v_dot2_f32_bf16 v201, v88, v10, v9
    v_dot2_f32_bf16 v202, v89, v8, v9
    v_dot2_f32_bf16 v203, v89, v10, v9
    v_dot2_f32_bf16 v204, v90, v8, v9
    v_dot2_f32_bf16 v205, v90, v10, v9
    v_dot2_f32_bf16 v206, v91, v8, v9
    v_dot2_f32_bf16 v207, v91, v10, v9
    v_cvt_pk_bf16_f32 v84, v208, v209
    v_cvt_pk_bf16_f32 v85, v210, v211
    v_cvt_pk_bf16_f32 v86, v212, v213
    v_cvt_pk_bf16_f32 v87, v214, v215
    ds_write_b128 v4, v[84:87] offset:33792
    v_dot2_f32_bf16 v208, v92, v8, v9
    v_dot2_f32_bf16 v209, v92, v10, v9
    v_dot2_f32_bf16 v210, v93, v8, v9
    v_dot2_f32_bf16 v211, v93, v10, v9
    v_dot2_f32_bf16 v212, v94, v8, v9
    v_dot2_f32_bf16 v213, v94, v10, v9
    v_dot2_f32_bf16 v214, v95, v8, v9
    v_dot2_f32_bf16 v215, v95, v10, v9
    v_cvt_pk_bf16_f32 v88, v200, v201
    v_cvt_pk_bf16_f32 v89, v202, v203
    v_cvt_pk_bf16_f32 v90, v204, v205
    v_cvt_pk_bf16_f32 v91, v206, v207
    ds_write_b128 v4, v[88:91] offset:34816
    v_dot2_f32_bf16 v200, v96, v8, v9
    v_dot2_f32_bf16 v201, v96, v10, v9
    v_dot2_f32_bf16 v202, v97, v8, v9
    v_dot2_f32_bf16 v203, v97, v10, v9
    v_dot2_f32_bf16 v204, v98, v8, v9
    v_dot2_f32_bf16 v205, v98, v10, v9
    v_dot2_f32_bf16 v206, v99, v8, v9
    v_dot2_f32_bf16 v207, v99, v10, v9
    v_cvt_pk_bf16_f32 v92, v208, v209
    v_cvt_pk_bf16_f32 v93, v210, v211
    v_cvt_pk_bf16_f32 v94, v212, v213
    v_cvt_pk_bf16_f32 v95, v214, v215
    ds_write_b128 v4, v[92:95] offset:35840
    v_dot2_f32_bf16 v208, v100, v8, v9
    v_dot2_f32_bf16 v209, v100, v10, v9
    v_dot2_f32_bf16 v210, v101, v8, v9
    v_dot2_f32_bf16 v211, v101, v10, v9
    v_dot2_f32_bf16 v212, v102, v8, v9
    v_dot2_f32_bf16 v213, v102, v10, v9
    v_dot2_f32_bf16 v214, v103, v8, v9
    v_dot2_f32_bf16 v215, v103, v10, v9
    v_cvt_pk_bf16_f32 v96, v200, v201
    v_cvt_pk_bf16_f32 v97, v202, v203
    v_cvt_pk_bf16_f32 v98, v204, v205
    v_cvt_pk_bf16_f32 v99, v206, v207
    ds_write_b128 v4, v[96:99] offset:49152
    v_dot2_f32_bf16 v200, v104, v8, v9
    v_dot2_f32_bf16 v201, v104, v10, v9
    v_dot2_f32_bf16 v202, v105, v8, v9
    v_dot2_f32_bf16 v203, v105, v10, v9
    v_dot2_f32_bf16 v204, v106, v8, v9
    v_dot2_f32_bf16 v205, v106, v10, v9
    v_dot2_f32_bf16 v206, v107, v8, v9
    v_dot2_f32_bf16 v207, v107, v10, v9
    v_cvt_pk_bf16_f32 v100, v208, v209
    v_cvt_pk_bf16_f32 v101, v210, v211
    v_cvt_pk_bf16_f32 v102, v212, v213
    v_cvt_pk_bf16_f32 v103, v214, v215
    ds_write_b128 v4, v[100:103] offset:50176
    v_dot2_f32_bf16 v208, v108, v8, v9
    v_dot2_f32_bf16 v209, v108, v10, v9
    v_dot2_f32_bf16 v210, v109, v8, v9
    v_dot2_f32_bf16 v211, v109, v10, v9
    v_dot2_f32_bf16 v212, v110, v8, v9
    v_dot2_f32_bf16 v213, v110, v10, v9
    v_dot2_f32_bf16 v214, v111, v8, v9
    v_dot2_f32_bf16 v215, v111, v10, v9
    v_cvt_pk_bf16_f32 v104, v200, v201
    v_cvt_pk_bf16_f32 v105, v202, v203
    v_cvt_pk_bf16_f32 v106, v204, v205
    v_cvt_pk_bf16_f32 v107, v206, v207
    ds_write_b128 v4, v[104:107] offset:51200
    v_dot2_f32_bf16 v200, v112, v8, v9
    v_dot2_f32_bf16 v201, v112, v10, v9
    v_dot2_f32_bf16 v202, v113, v8, v9
    v_dot2_f32_bf16 v203, v113, v10, v9
    v_dot2_f32_bf16 v204, v114, v8, v9
    v_dot2_f32_bf16 v205, v114, v10, v9
    v_dot2_f32_bf16 v206, v115, v8, v9
    v_dot2_f32_bf16 v207, v115, v10, v9
    v_cvt_pk_bf16_f32 v108, v208, v209
    v_cvt_pk_bf16_f32 v109, v210, v211
    v_cvt_pk_bf16_f32 v110, v212, v213
    v_cvt_pk_bf16_f32 v111, v214, v215
    ds_write_b128 v4, v[108:111] offset:52224
    v_dot2_f32_bf16 v208, v116, v8, v9
    v_dot2_f32_bf16 v209, v116, v10, v9
    v_dot2_f32_bf16 v210, v117, v8, v9
    v_dot2_f32_bf16 v211, v117, v10, v9
    v_dot2_f32_bf16 v212, v118, v8, v9
    v_dot2_f32_bf16 v213, v118, v10, v9
    v_dot2_f32_bf16 v214, v119, v8, v9
    v_dot2_f32_bf16 v215, v119, v10, v9
    v_cvt_pk_bf16_f32 v112, v200, v201
    v_cvt_pk_bf16_f32 v113, v202, v203
    v_cvt_pk_bf16_f32 v114, v204, v205
    v_cvt_pk_bf16_f32 v115, v206, v207
    ds_write_b128 v5, v[112:115] offset:0
    v_cvt_pk_bf16_f32 v116, v208, v209
    v_cvt_pk_bf16_f32 v117, v210, v211
    v_cvt_pk_bf16_f32 v118, v212, v213
    v_cvt_pk_bf16_f32 v119, v214, v215
    ds_write_b128 v5, v[116:119] offset:1024
    s_waitcnt lgkmcnt(0)
    s_barrier
    ds_read_b128 a[0:3], v2 offset:0
    ds_read_b128 a[4:7], v2 offset:4096
    ds_read_b128 a[8:11], v2 offset:8192
    ds_read_b128 a[12:15], v2 offset:12288
    ds_read_b128 a[16:19], v2 offset:1024
    ds_read_b128 a[20:23], v2 offset:5120
    ds_read_b128 a[24:27], v2 offset:9216
    ds_read_b128 a[28:31], v2 offset:13312
    s_waitcnt vmcnt(19)
    v_lshlrev_b32 v224, 16, v216
    v_and_b32 v225, s13, v216
    v_lshlrev_b32 v226, 16, v217
    v_and_b32 v227, s13, v217
    v_lshlrev_b32 v228, 16, v218
    v_and_b32 v229, s13, v218
    v_lshlrev_b32 v230, 16, v219
    v_and_b32 v231, s13, v219
    v_lshlrev_b32 v232, 16, v220
    v_and_b32 v233, s13, v220
    v_lshlrev_b32 v234, 16, v221
    v_and_b32 v235, s13, v221
    v_lshlrev_b32 v236, 16, v222
    v_and_b32 v237, s13, v222
    v_lshlrev_b32 v238, 16, v223
    v_and_b32 v239, s13, v223
    v_mul_f32 v224, 0x3eeff558, v224
    v_mul_f32 v225, 0x3eeff558, v225
    v_mul_f32 v226, 0x3eeff558, v226
    v_mul_f32 v227, 0x3eeff558, v227
    v_mul_f32 v228, 0x3eeff558, v228
    v_mul_f32 v229, 0x3eeff558, v229
    v_mul_f32 v230, 0x3eeff558, v230
    v_mul_f32 v231, 0x3eeff558, v231
    v_mul_f32 v232, 0x3eeff558, v232
    v_mul_f32 v233, 0x3eeff558, v233
    v_mul_f32 v234, 0x3eeff558, v234
    v_mul_f32 v235, 0x3eeff558, v235
    v_mul_f32 v236, 0x3eeff558, v236
    v_mul_f32 v237, 0x3eeff558, v237
    v_mul_f32 v238, 0x3eeff558, v238
    v_mul_f32 v239, 0x3eeff558, v239
    s_waitcnt vmcnt(14)
    ds_read_b64_tr_b16 v[176:177], v244 offset:16384
    ds_read_b64_tr_b16 v[178:179], v244 offset:18432
    ds_read_b64_tr_b16 v[180:181], v245 offset:16384
    ds_read_b64_tr_b16 v[182:183], v245 offset:18432
    ds_read_b64_tr_b16 v[184:185], v246 offset:16384
    ds_read_b64_tr_b16 v[186:187], v246 offset:18432
    ds_read_b64_tr_b16 v[188:189], v247 offset:16384
    ds_read_b64_tr_b16 v[190:191], v247 offset:18432
    s_waitcnt lgkmcnt(12)
    ds_read_b128 a[32:35], v2 offset:2048
    ds_read_b128 a[48:51], v2 offset:3072
    s_waitcnt lgkmcnt(6)
    v_mfma_f32_16x16x32_bf16 v[48:51], v[176:179], a[0:3], v[224:227]
    s_waitcnt vmcnt(10)
    ds_read_b64_tr_b16 v[192:193], v244 offset:32768
    v_mfma_f32_16x16x32_bf16 v[52:55], v[176:179], a[4:7], v[224:227]
    ds_read_b64_tr_b16 v[194:195], v244 offset:34816
    v_mfma_f32_16x16x32_bf16 v[56:59], v[176:179], a[8:11], v[224:227]
    buffer_load_dwordx4 v254, s[44:47], s64 offen offset:2048  lds
    v_mfma_f32_16x16x32_bf16 v[60:63], v[176:179], a[12:15], v[224:227]
    buffer_load_dwordx4 v255, s[44:47], s64 offen offset:3072  lds
    ds_read_b128 a[36:39], v2 offset:6144
    ds_read_b128 a[52:55], v2 offset:7168
    v_mfma_f32_16x16x32_bf16 v[64:67], v[180:183], a[0:3], v[228:231]
    ds_read_b64_tr_b16 v[196:197], v245 offset:32768
    v_mfma_f32_16x16x32_bf16 v[68:71], v[180:183], a[4:7], v[228:231]
    ds_read_b64_tr_b16 v[198:199], v245 offset:34816
    v_mfma_f32_16x16x32_bf16 v[72:75], v[180:183], a[8:11], v[228:231]
    v_mfma_f32_16x16x32_bf16 v[76:79], v[180:183], a[12:15], v[228:231]
    ds_read_b128 a[40:43], v2 offset:10240
    ds_read_b128 a[56:59], v2 offset:11264
    s_waitcnt lgkmcnt(10)
    v_mfma_f32_16x16x32_bf16 v[80:83], v[184:187], a[0:3], v[232:235]
    ds_read_b64_tr_b16 v[176:177], v246 offset:32768
    v_mfma_f32_16x16x32_bf16 v[84:87], v[184:187], a[4:7], v[232:235]
    ds_read_b64_tr_b16 v[178:179], v246 offset:34816
    v_mfma_f32_16x16x32_bf16 v[88:91], v[184:187], a[8:11], v[232:235]
    s_add_u32 m0, s7, 81920
    s_add_u32 s64, s10, 1474560
    buffer_load_dwordx4 v252, s[44:47], s64 offen offset:0  lds
    v_mfma_f32_16x16x32_bf16 v[92:95], v[184:187], a[12:15], v[232:235]
    ds_read_b128 a[44:47], v2 offset:14336
    ds_read_b128 a[60:63], v2 offset:15360
    v_mfma_f32_16x16x32_bf16 v[96:99], v[188:191], a[0:3], v[236:239]
    ds_read_b64_tr_b16 v[180:181], v247 offset:32768
    v_mfma_f32_16x16x32_bf16 v[100:103], v[188:191], a[4:7], v[236:239]
    ds_read_b64_tr_b16 v[182:183], v247 offset:34816
    v_mfma_f32_16x16x32_bf16 v[104:107], v[188:191], a[8:11], v[236:239]
    buffer_load_dwordx4 v253, s[44:47], s64 offen offset:1024  lds
    v_mfma_f32_16x16x32_bf16 v[108:111], v[188:191], a[12:15], v[236:239]
    ds_read_b128 a[64:67], v2 offset:16384
    ds_read_b128 a[80:83], v2 offset:17408
    s_and_b32 s72, s4, 3
    s_cmp_lg_u32 s72, 0
    s_cbranch_scc1 L_pf1
    s_lshr_b32 s72, s4, 2
    s_lshl_b32 s73, s3, 6
    s_cmp_ge_u32 s73, 144
    s_cbranch_scc1 L_pf1
    s_mul_i32 s72, s72, 663552
    s_add_u32 s72, s72, s67
    s_add_u32 s72, s72, 636
    v_add_u32 v10, s73, v1
    v_min_u32 v10, 143, v10
    v_mul_u32_u24 v11, 32768, v10
    v_lshrrev_b32 v11, 16, v11
    v_lshlrev_b32 v10, 8, v10
    v_mul_u32_u24 v11, 8704, v11
    v_add_u32 v10, v10, v11
    buffer_load_dwordx2 v[10:11], v10, s[44:47], s72 offen
L_pf1:
    s_waitcnt lgkmcnt(10)
    v_mfma_f32_16x16x32_bf16 v[48:51], v[192:195], a[16:19], v[48:51]
    s_waitcnt vmcnt(10)
    ds_read_b64_tr_b16 v[184:185], v244 offset:49152
    v_mfma_f32_16x16x32_bf16 v[52:55], v[192:195], a[20:23], v[52:55]
    ds_read_b64_tr_b16 v[186:187], v244 offset:51200
    v_mfma_f32_16x16x32_bf16 v[56:59], v[192:195], a[24:27], v[56:59]
    buffer_load_dwordx4 v254, s[44:47], s64 offen offset:2048  lds
    v_mfma_f32_16x16x32_bf16 v[60:63], v[192:195], a[28:31], v[60:63]
    ds_read_b128 a[68:71], v2 offset:20480
    ds_read_b128 a[84:87], v2 offset:21504
    v_mfma_f32_16x16x32_bf16 v[64:67], v[196:199], a[16:19], v[64:67]
    ds_read_b64_tr_b16 v[188:189], v245 offset:49152
    v_mfma_f32_16x16x32_bf16 v[68:71], v[196:199], a[20:23], v[68:71]
    ds_read_b64_tr_b16 v[190:191], v245 offset:51200
    v_mfma_f32_16x16x32_bf16 v[72:75], v[196:199], a[24:27], v[72:75]
    buffer_load_dwordx4 v255, s[44:47], s64 offen offset:3072  lds
    v_mfma_f32_16x16x32_bf16 v[76:79], v[196:199], a[28:31], v[76:79]
    ds_read_b128 a[72:75], v2 offset:24576
    ds_read_b128 a[88:91], v2 offset:25600
    s_waitcnt lgkmcnt(10)
    v_mfma_f32_16x16x32_bf16 v[80:83], v[176:179], a[16:19], v[80:83]
    ds_read_b64_tr_b16 v[192:193], v246 offset:49152
    v_mfma_f32_16x16x32_bf16 v[84:87], v[176:179], a[20:23], v[84:87]
    ds_read_b64_tr_b16 v[194:195], v246 offset:51200
    v_mfma_f32_16x16x32_bf16 v[88:91], v[176:179], a[24:27], v[88:91]
    s_add_u32 m0, s7, 98304
    s_add_u32 s64, s10, 1769472
    buffer_load_dwordx4 v252, s[44:47], s64 offen offset:0  lds
    v_mfma_f32_16x16x32_bf16 v[92:95], v[176:179], a[28:31], v[92:95]
    buffer_load_dwordx4 v253, s[44:47], s64 offen offset:1024  lds
    ds_read_b128 a[76:79], v2 offset:28672
    ds_read_b128 a[92:95], v2 offset:29696
    v_mfma_f32_16x16x32_bf16 v[96:99], v[180:183], a[16:19], v[96:99]
    ds_read_b64_tr_b16 v[196:197], v247 offset:49152
    v_mfma_f32_16x16x32_bf16 v[100:103], v[180:183], a[20:23], v[100:103]
    ds_read_b64_tr_b16 v[198:199], v247 offset:51200
    v_mfma_f32_16x16x32_bf16 v[104:107], v[180:183], a[24:27], v[104:107]
    buffer_load_dwordx4 v254, s[44:47], s64 offen offset:2048  lds
    v_mfma_f32_16x16x32_bf16 v[108:111], v[180:183], a[28:31], v[108:111]
    ds_read_b128 a[96:99], v2 offset:18432
    ds_read_b128 a[112:115], v2 offset:19456
    s_waitcnt lgkmcnt(10)
    v_mfma_f32_16x16x32_bf16 v[48:51], v[184:187], a[32:35], v[48:51]
    s_waitcnt vmcnt(11)
    ds_read_b64_tr_b16 v[176:177], v248 offset:0
    v_mfma_f32_16x16x32_bf16 v[52:55], v[184:187], a[36:39], v[52:55]
    ds_read_b64_tr_b16 v[178:179], v248 offset:2048
    v_mfma_f32_16x16x32_bf16 v[56:59], v[184:187], a[40:43], v[56:59]
    buffer_load_dwordx4 v255, s[44:47], s64 offen offset:3072  lds
    v_mfma_f32_16x16x32_bf16 v[60:63], v[184:187], a[44:47], v[60:63]
    ds_read_b128 a[100:103], v2 offset:22528
    ds_read_b128 a[116:119], v2 offset:23552
    v_mfma_f32_16x16x32_bf16 v[64:67], v[188:191], a[32:35], v[64:67]
    ds_read_b64_tr_b16 v[180:181], v249 offset:0
    v_mfma_f32_16x16x32_bf16 v[68:71], v[188:191], a[36:39], v[68:71]
    ds_read_b64_tr_b16 v[182:183], v249 offset:2048
    v_mfma_f32_16x16x32_bf16 v[72:75], v[188:191], a[40:43], v[72:75]
    v_mfma_f32_16x16x32_bf16 v[76:79], v[188:191], a[44:47], v[76:79]
    ds_read_b128 a[104:107], v2 offset:26624
    ds_read_b128 a[120:123], v2 offset:27648
    s_waitcnt lgkmcnt(10)
    v_mfma_f32_16x16x32_bf16 v[80:83], v[192:195], a[32:35], v[80:83]
    ds_read_b64_tr_b16 v[184:185], v250 offset:0
    v_mfma_f32_16x16x32_bf16 v[84:87], v[192:195], a[36:39], v[84:87]
    ds_read_b64_tr_b16 v[186:187], v250 offset:2048
    v_mfma_f32_16x16x32_bf16 v[88:91], v[192:195], a[40:43], v[88:91]
    s_add_u32 m0, s7, 114688
    s_add_u32 s64, s10, 2064384
    buffer_load_dwordx4 v252, s[44:47], s64 offen offset:0  lds
    v_mfma_f32_16x16x32_bf16 v[92:95], v[192:195], a[44:47], v[92:95]
    ds_read_b128 a[108:111], v2 offset:30720
    ds_read_b128 a[124:127], v2 offset:31744
    v_mfma_f32_16x16x32_bf16 v[96:99], v[196:199], a[32:35], v[96:99]
    ds_read_b64_tr_b16 v[188:189], v251 offset:0
    v_mfma_f32_16x16x32_bf16 v[100:103], v[196:199], a[36:39], v[100:103]
    ds_read_b64_tr_b16 v[190:191], v251 offset:2048
    v_mfma_f32_16x16x32_bf16 v[104:107], v[196:199], a[40:43], v[104:107]
    buffer_load_dwordx4 v253, s[44:47], s64 offen offset:1024  lds
    v_mfma_f32_16x16x32_bf16 v[108:111], v[196:199], a[44:47], v[108:111]
    ds_read_b128 a[128:131], v2 offset:32768
    ds_read_b128 a[144:147], v2 offset:33792
    s_waitcnt lgkmcnt(10)
    v_mfma_f32_16x16x32_bf16 v[48:51], v[176:179], a[48:51], v[48:51]
    s_waitcnt vmcnt(10)
    ds_read_b64_tr_b16 v[192:193], v248 offset:16384
    v_mfma_f32_16x16x32_bf16 v[52:55], v[176:179], a[52:55], v[52:55]
    ds_read_b64_tr_b16 v[194:195], v248 offset:18432
    v_mfma_f32_16x16x32_bf16 v[56:59], v[176:179], a[56:59], v[56:59]
    buffer_load_dwordx4 v254, s[44:47], s64 offen offset:2048  lds
    v_mfma_f32_16x16x32_bf16 v[60:63], v[176:179], a[60:63], v[60:63]
    buffer_load_dwordx4 v255, s[44:47], s64 offen offset:3072  lds
    ds_read_b128 a[132:135], v2 offset:36864
    ds_read_b128 a[148:151], v2 offset:37888
    v_mfma_f32_16x16x32_bf16 v[64:67], v[180:183], a[48:51], v[64:67]
    ds_read_b64_tr_b16 v[196:197], v249 offset:16384
    v_mfma_f32_16x16x32_bf16 v[68:71], v[180:183], a[52:55], v[68:71]
    ds_read_b64_tr_b16 v[198:199], v249 offset:18432
    v_mfma_f32_16x16x32_bf16 v[72:75], v[180:183], a[56:59], v[72:75]
    v_mfma_f32_16x16x32_bf16 v[76:79], v[180:183], a[60:63], v[76:79]
    ds_read_b128 a[136:139], v2 offset:40960
    ds_read_b128 a[152:155], v2 offset:41984
    s_waitcnt lgkmcnt(10)
    v_mfma_f32_16x16x32_bf16 v[80:83], v[184:187], a[48:51], v[80:83]
    ds_read_b64_tr_b16 v[176:177], v250 offset:16384
    v_mfma_f32_16x16x32_bf16 v[84:87], v[184:187], a[52:55], v[84:87]
    ds_read_b64_tr_b16 v[178:179], v250 offset:18432
    v_mfma_f32_16x16x32_bf16 v[88:91], v[184:187], a[56:59], v[88:91]
    s_add_u32 m0, s7, 131072
    s_add_u32 s64, s10, 2359296
    buffer_load_dwordx4 v252, s[44:47], s64 offen offset:0  lds
    v_mfma_f32_16x16x32_bf16 v[92:95], v[184:187], a[60:63], v[92:95]
    ds_read_b128 a[140:143], v2 offset:45056
    ds_read_b128 a[156:159], v2 offset:46080
    v_mfma_f32_16x16x32_bf16 v[96:99], v[188:191], a[48:51], v[96:99]
    ds_read_b64_tr_b16 v[180:181], v251 offset:16384
    v_mfma_f32_16x16x32_bf16 v[100:103], v[188:191], a[52:55], v[100:103]
    ds_read_b64_tr_b16 v[182:183], v251 offset:18432
    v_mfma_f32_16x16x32_bf16 v[104:107], v[188:191], a[56:59], v[104:107]
    buffer_load_dwordx4 v253, s[44:47], s64 offen offset:1024  lds
    v_mfma_f32_16x16x32_bf16 v[108:111], v[188:191], a[60:63], v[108:111]
    ds_read_b128 a[160:163], v2 offset:34816
    ds_read_b128 a[176:179], v2 offset:35840
    s_waitcnt lgkmcnt(10)
    v_mfma_f32_16x16x32_bf16 v[48:51], v[192:195], a[64:67], v[48:51]
    s_waitcnt vmcnt(10)
    ds_read_b64_tr_b16 v[184:185], v244 offset:16384
    v_mfma_f32_16x16x32_bf16 v[52:55], v[192:195], a[68:71], v[52:55]
    ds_read_b64_tr_b16 v[186:187], v244 offset:18432
    v_mfma_f32_16x16x32_bf16 v[56:59], v[192:195], a[72:75], v[56:59]
    buffer_load_dwordx4 v254, s[44:47], s64 offen offset:2048  lds
    v_mfma_f32_16x16x32_bf16 v[60:63], v[192:195], a[76:79], v[60:63]
    ds_read_b128 a[164:167], v2 offset:38912
    ds_read_b128 a[180:183], v2 offset:39936
    v_mfma_f32_16x16x32_bf16 v[64:67], v[196:199], a[64:67], v[64:67]
    ds_read_b64_tr_b16 v[188:189], v245 offset:16384
    v_mfma_f32_16x16x32_bf16 v[68:71], v[196:199], a[68:71], v[68:71]
    ds_read_b64_tr_b16 v[190:191], v245 offset:18432
    v_mfma_f32_16x16x32_bf16 v[72:75], v[196:199], a[72:75], v[72:75]
    buffer_load_dwordx4 v255, s[44:47], s64 offen offset:3072  lds
    v_mfma_f32_16x16x32_bf16 v[76:79], v[196:199], a[76:79], v[76:79]
    ds_read_b128 a[168:171], v2 offset:43008
    ds_read_b128 a[184:187], v2 offset:44032
    s_waitcnt lgkmcnt(10)
    v_mfma_f32_16x16x32_bf16 v[80:83], v[176:179], a[64:67], v[80:83]
    ds_read_b64_tr_b16 v[192:193], v246 offset:16384
    v_mfma_f32_16x16x32_bf16 v[84:87], v[176:179], a[68:71], v[84:87]
    ds_read_b64_tr_b16 v[194:195], v246 offset:18432
    v_mfma_f32_16x16x32_bf16 v[88:91], v[176:179], a[72:75], v[88:91]
    s_add_u32 m0, s7, 147456
    s_add_u32 s64, s10, 2654208
    buffer_load_dwordx4 v252, s[44:47], s64 offen offset:0  lds
    v_mfma_f32_16x16x32_bf16 v[92:95], v[176:179], a[76:79], v[92:95]
    buffer_load_dwordx4 v253, s[44:47], s64 offen offset:1024  lds
    ds_read_b128 a[172:175], v2 offset:47104
    ds_read_b128 a[188:191], v2 offset:48128
    v_mfma_f32_16x16x32_bf16 v[96:99], v[180:183], a[64:67], v[96:99]
    ds_read_b64_tr_b16 v[196:197], v247 offset:16384
    v_mfma_f32_16x16x32_bf16 v[100:103], v[180:183], a[68:71], v[100:103]
    ds_read_b64_tr_b16 v[198:199], v247 offset:18432
    v_mfma_f32_16x16x32_bf16 v[104:107], v[180:183], a[72:75], v[104:107]
    buffer_load_dwordx4 v254, s[44:47], s64 offen offset:2048  lds
    v_mfma_f32_16x16x32_bf16 v[108:111], v[180:183], a[76:79], v[108:111]
    ds_read_b128 a[192:195], v2 offset:49152
    ds_read_b128 a[208:211], v2 offset:50176
    s_waitcnt lgkmcnt(10)
    v_mfma_f32_16x16x32_bf16 v[48:51], v[184:187], a[80:83], v[48:51]
    s_waitcnt vmcnt(11)
    ds_read_b64_tr_b16 v[176:177], v244 offset:32768
    v_mfma_f32_16x16x32_bf16 v[52:55], v[184:187], a[84:87], v[52:55]
    ds_read_b64_tr_b16 v[178:179], v244 offset:34816
    v_mfma_f32_16x16x32_bf16 v[56:59], v[184:187], a[88:91], v[56:59]
    buffer_load_dwordx4 v255, s[44:47], s64 offen offset:3072  lds
    v_mfma_f32_16x16x32_bf16 v[60:63], v[184:187], a[92:95], v[60:63]
    ds_read_b128 a[196:199], v2 offset:53248
    ds_read_b128 a[212:215], v2 offset:54272
    v_mfma_f32_16x16x32_bf16 v[64:67], v[188:191], a[80:83], v[64:67]
    ds_read_b64_tr_b16 v[180:181], v245 offset:32768
    v_mfma_f32_16x16x32_bf16 v[68:71], v[188:191], a[84:87], v[68:71]
    ds_read_b64_tr_b16 v[182:183], v245 offset:34816
    v_mfma_f32_16x16x32_bf16 v[72:75], v[188:191], a[88:91], v[72:75]
    v_mfma_f32_16x16x32_bf16 v[76:79], v[188:191], a[92:95], v[76:79]
    ds_read_b128 a[200:203], v2 offset:57344
    ds_read_b128 a[216:219], v2 offset:58368
    s_waitcnt lgkmcnt(10)
    v_mfma_f32_16x16x32_bf16 v[80:83], v[192:195], a[80:83], v[80:83]
    ds_read_b64_tr_b16 v[184:185], v246 offset:32768
    v_mfma_f32_16x16x32_bf16 v[84:87], v[192:195], a[84:87], v[84:87]
    ds_read_b64_tr_b16 v[186:187], v246 offset:34816
    v_mfma_f32_16x16x32_bf16 v[88:91], v[192:195], a[88:91], v[88:91]
    s_add_u32 m0, s7, 81920
    s_add_u32 s64, s10, 2949120
    buffer_load_dwordx4 v252, s[44:47], s64 offen offset:0  lds
    v_mfma_f32_16x16x32_bf16 v[92:95], v[192:195], a[92:95], v[92:95]
    ds_read_b128 a[204:207], v2 offset:61440
    ds_read_b128 a[220:223], v2 offset:62464
    v_mfma_f32_16x16x32_bf16 v[96:99], v[196:199], a[80:83], v[96:99]
    ds_read_b64_tr_b16 v[188:189], v247 offset:32768
    v_mfma_f32_16x16x32_bf16 v[100:103], v[196:199], a[84:87], v[100:103]
    ds_read_b64_tr_b16 v[190:191], v247 offset:34816
    v_mfma_f32_16x16x32_bf16 v[104:107], v[196:199], a[88:91], v[104:107]
    buffer_load_dwordx4 v253, s[44:47], s64 offen offset:1024  lds
    v_mfma_f32_16x16x32_bf16 v[108:111], v[196:199], a[92:95], v[108:111]
    ds_read_b128 a[224:227], v2 offset:51200
    ds_read_b128 a[240:243], v2 offset:52224
    s_and_b32 s72, s4, 3
    s_cmp_lg_u32 s72, 1
    s_cbranch_scc1 L_pf2
    s_lshr_b32 s72, s4, 2
    s_lshl_b32 s73, s3, 6
    s_cmp_ge_u32 s73, 144
    s_cbranch_scc1 L_pf2
    s_mul_i32 s72, s72, 663552
    s_add_u32 s72, s72, s67
    s_add_u32 s72, s72, 1148
    v_add_u32 v10, s73, v1
    v_min_u32 v10, 143, v10
    v_mul_u32_u24 v11, 32768, v10
    v_lshrrev_b32 v11, 16, v11
    v_lshlrev_b32 v10, 8, v10
    v_mul_u32_u24 v11, 8704, v11
    v_add_u32 v10, v10, v11
    buffer_load_dwordx2 v[10:11], v10, s[44:47], s72 offen
L_pf2:
    s_waitcnt lgkmcnt(10)
    v_mfma_f32_16x16x32_bf16 v[48:51], v[176:179], a[96:99], v[48:51]
    s_waitcnt vmcnt(10)
    ds_read_b64_tr_b16 v[192:193], v244 offset:49152
    v_mfma_f32_16x16x32_bf16 v[52:55], v[176:179], a[100:103], v[52:55]
    ds_read_b64_tr_b16 v[194:195], v244 offset:51200
    v_mfma_f32_16x16x32_bf16 v[56:59], v[176:179], a[104:107], v[56:59]
    buffer_load_dwordx4 v254, s[44:47], s64 offen offset:2048  lds
    v_mfma_f32_16x16x32_bf16 v[60:63], v[176:179], a[108:111], v[60:63]
    buffer_load_dwordx4 v255, s[44:47], s64 offen offset:3072  lds
    ds_read_b128 a[228:231], v2 offset:55296
    ds_read_b128 a[244:247], v2 offset:56320
    v_mfma_f32_16x16x32_bf16 v[64:67], v[180:183], a[96:99], v[64:67]
    ds_read_b64_tr_b16 v[196:197], v245 offset:49152
    v_mfma_f32_16x16x32_bf16 v[68:71], v[180:183], a[100:103], v[68:71]
    ds_read_b64_tr_b16 v[198:199], v245 offset:51200
    v_mfma_f32_16x16x32_bf16 v[72:75], v[180:183], a[104:107], v[72:75]
    v_mfma_f32_16x16x32_bf16 v[76:79], v[180:183], a[108:111], v[76:79]
    ds_read_b128 a[232:235], v2 offset:59392
    ds_read_b128 a[248:251], v2 offset:60416
    s_waitcnt lgkmcnt(10)
    v_mfma_f32_16x16x32_bf16 v[80:83], v[184:187], a[96:99], v[80:83]
    ds_read_b64_tr_b16 v[176:177], v246 offset:49152
    v_mfma_f32_16x16x32_bf16 v[84:87], v[184:187], a[100:103], v[84:87]
    ds_read_b64_tr_b16 v[178:179], v246 offset:51200
    v_mfma_f32_16x16x32_bf16 v[88:91], v[184:187], a[104:107], v[88:91]
    s_add_u32 m0, s7, 98304
    s_add_u32 s64, s10, 3244032
    buffer_load_dwordx4 v252, s[44:47], s64 offen offset:0  lds
    v_mfma_f32_16x16x32_bf16 v[92:95], v[184:187], a[108:111], v[92:95]
    ds_read_b128 a[236:239], v2 offset:63488
    ds_read_b128 a[252:255], v2 offset:64512
    v_mfma_f32_16x16x32_bf16 v[96:99], v[188:191], a[96:99], v[96:99]
    ds_read_b64_tr_b16 v[180:181], v247 offset:49152
    v_mfma_f32_16x16x32_bf16 v[100:103], v[188:191], a[100:103], v[100:103]
    ds_read_b64_tr_b16 v[182:183], v247 offset:51200
    v_mfma_f32_16x16x32_bf16 v[104:107], v[188:191], a[104:107], v[104:107]
    buffer_load_dwordx4 v253, s[44:47], s64 offen offset:1024  lds
    v_mfma_f32_16x16x32_bf16 v[108:111], v[188:191], a[108:111], v[108:111]
    ds_read_b128 v[16:19], v3 offset:0
    ds_read_b128 v[32:35], v3 offset:1024
    s_waitcnt lgkmcnt(10)
    v_mfma_f32_16x16x32_bf16 v[48:51], v[192:195], a[112:115], v[48:51]
    s_waitcnt vmcnt(10)
    ds_read_b64_tr_b16 v[184:185], v248 offset:0
    v_mfma_f32_16x16x32_bf16 v[52:55], v[192:195], a[116:119], v[52:55]
    ds_read_b64_tr_b16 v[186:187], v248 offset:2048
    v_mfma_f32_16x16x32_bf16 v[56:59], v[192:195], a[120:123], v[56:59]
    buffer_load_dwordx4 v254, s[44:47], s64 offen offset:2048  lds
    v_mfma_f32_16x16x32_bf16 v[60:63], v[192:195], a[124:127], v[60:63]
    ds_read_b128 v[20:23], v3 offset:4096
    ds_read_b128 v[36:39], v3 offset:5120
    v_mfma_f32_16x16x32_bf16 v[64:67], v[196:199], a[112:115], v[64:67]
    ds_read_b64_tr_b16 v[188:189], v249 offset:0
    v_mfma_f32_16x16x32_bf16 v[68:71], v[196:199], a[116:119], v[68:71]
    ds_read_b64_tr_b16 v[190:191], v249 offset:2048
    v_mfma_f32_16x16x32_bf16 v[72:75], v[196:199], a[120:123], v[72:75]
    buffer_load_dwordx4 v255, s[44:47], s64 offen offset:3072  lds
    v_mfma_f32_16x16x32_bf16 v[76:79], v[196:199], a[124:127], v[76:79]
    ds_read_b128 v[24:27], v3 offset:8192
    ds_read_b128 v[40:43], v3 offset:9216
    s_waitcnt lgkmcnt(10)
    v_mfma_f32_16x16x32_bf16 v[80:83], v[176:179], a[112:115], v[80:83]
    ds_read_b64_tr_b16 v[192:193], v250 offset:0
    v_mfma_f32_16x16x32_bf16 v[84:87], v[176:179], a[116:119], v[84:87]
    ds_read_b64_tr_b16 v[194:195], v250 offset:2048
    v_mfma_f32_16x16x32_bf16 v[88:91], v[176:179], a[120:123], v[88:91]
    s_add_u32 m0, s7, 114688
    s_add_u32 s64, s10, 3538944
    buffer_load_dwordx4 v252, s[44:47], s64 offen offset:0  lds
    v_mfma_f32_16x16x32_bf16 v[92:95], v[176:179], a[124:127], v[92:95]
    buffer_load_dwordx4 v253, s[44:47], s64 offen offset:1024  lds
    ds_read_b128 v[28:31], v3 offset:12288
    ds_read_b128 v[44:47], v3 offset:13312
    v_mfma_f32_16x16x32_bf16 v[96:99], v[180:183], a[112:115], v[96:99]
    ds_read_b64_tr_b16 v[196:197], v251 offset:0
    v_mfma_f32_16x16x32_bf16 v[100:103], v[180:183], a[116:119], v[100:103]
    ds_read_b64_tr_b16 v[198:199], v251 offset:2048
    v_mfma_f32_16x16x32_bf16 v[104:107], v[180:183], a[120:123], v[104:107]
    buffer_load_dwordx4 v254, s[44:47], s64 offen offset:2048  lds
    v_mfma_f32_16x16x32_bf16 v[108:111], v[180:183], a[124:127], v[108:111]
    s_waitcnt lgkmcnt(8)
    v_mfma_f32_16x16x32_bf16 v[48:51], v[184:187], a[128:131], v[48:51]
    s_waitcnt vmcnt(11)
    ds_read_b64_tr_b16 v[176:177], v248 offset:16384
    v_mfma_f32_16x16x32_bf16 v[52:55], v[184:187], a[132:135], v[52:55]
    ds_read_b64_tr_b16 v[178:179], v248 offset:18432
    v_mfma_f32_16x16x32_bf16 v[56:59], v[184:187], a[136:139], v[56:59]
    buffer_load_dwordx4 v255, s[44:47], s64 offen offset:3072  lds
    v_mfma_f32_16x16x32_bf16 v[60:63], v[184:187], a[140:143], v[60:63]
    v_mfma_f32_16x16x32_bf16 v[64:67], v[188:191], a[128:131], v[64:67]
    ds_read_b64_tr_b16 v[180:181], v249 offset:16384
    v_mfma_f32_16x16x32_bf16 v[68:71], v[188:191], a[132:135], v[68:71]
    ds_read_b64_tr_b16 v[182:183], v249 offset:18432
    v_mfma_f32_16x16x32_bf16 v[72:75], v[188:191], a[136:139], v[72:75]
    v_mfma_f32_16x16x32_bf16 v[76:79], v[188:191], a[140:143], v[76:79]
    s_waitcnt lgkmcnt(4)
    v_mfma_f32_16x16x32_bf16 v[80:83], v[192:195], a[128:131], v[80:83]
    ds_read_b64_tr_b16 v[184:185], v250 offset:16384
    v_mfma_f32_16x16x32_bf16 v[84:87], v[192:195], a[132:135], v[84:87]
    ds_read_b64_tr_b16 v[186:187], v250 offset:18432
    v_mfma_f32_16x16x32_bf16 v[88:91], v[192:195], a[136:139], v[88:91]
    s_add_u32 m0, s7, 131072
    s_add_u32 s64, s10, 3833856
    buffer_load_dwordx4 v252, s[44:47], s64 offen offset:0  lds
    v_mfma_f32_16x16x32_bf16 v[92:95], v[192:195], a[140:143], v[92:95]
    v_mfma_f32_16x16x32_bf16 v[96:99], v[196:199], a[128:131], v[96:99]
    ds_read_b64_tr_b16 v[188:189], v251 offset:16384
    v_mfma_f32_16x16x32_bf16 v[100:103], v[196:199], a[132:135], v[100:103]
    ds_read_b64_tr_b16 v[190:191], v251 offset:18432
    v_mfma_f32_16x16x32_bf16 v[104:107], v[196:199], a[136:139], v[104:107]
    buffer_load_dwordx4 v253, s[44:47], s64 offen offset:1024  lds
    v_mfma_f32_16x16x32_bf16 v[108:111], v[196:199], a[140:143], v[108:111]
    s_barrier
    s_waitcnt lgkmcnt(4)
    v_mfma_f32_16x16x32_bf16 v[48:51], v[176:179], a[144:147], v[48:51]
    s_waitcnt vmcnt(10)
    ds_read_b64_tr_b16 v[192:193], v244 offset:16384
    v_mfma_f32_16x16x32_bf16 v[52:55], v[176:179], a[148:151], v[52:55]
    ds_read_b64_tr_b16 v[194:195], v244 offset:18432
    v_mfma_f32_16x16x32_bf16 v[56:59], v[176:179], a[152:155], v[56:59]
    buffer_load_dwordx4 v254, s[44:47], s64 offen offset:2048  lds
    v_mfma_f32_16x16x32_bf16 v[60:63], v[176:179], a[156:159], v[60:63]
    buffer_load_dwordx4 v255, s[44:47], s64 offen offset:3072  lds
    v_mfma_f32_16x16x32_bf16 v[64:67], v[180:183], a[144:147], v[64:67]
    ds_read_b64_tr_b16 v[196:197], v245 offset:16384
    v_mfma_f32_16x16x32_bf16 v[68:71], v[180:183], a[148:151], v[68:71]
    ds_read_b64_tr_b16 v[198:199], v245 offset:18432
    v_mfma_f32_16x16x32_bf16 v[72:75], v[180:183], a[152:155], v[72:75]
    s_add_u32 m0, s7, 0
    s_add_u32 s64, s10, 4128768
    buffer_load_dwordx4 v252, s[44:47], s64 offen offset:0  lds
    v_mfma_f32_16x16x32_bf16 v[76:79], v[180:183], a[156:159], v[76:79]
    s_waitcnt lgkmcnt(4)
    v_mfma_f32_16x16x32_bf16 v[80:83], v[184:187], a[144:147], v[80:83]
    ds_read_b64_tr_b16 v[176:177], v246 offset:16384
    v_mfma_f32_16x16x32_bf16 v[84:87], v[184:187], a[148:151], v[84:87]
    ds_read_b64_tr_b16 v[178:179], v246 offset:18432
    v_mfma_f32_16x16x32_bf16 v[88:91], v[184:187], a[152:155], v[88:91]
    buffer_load_dwordx4 v253, s[44:47], s64 offen offset:1024  lds
    v_mfma_f32_16x16x32_bf16 v[92:95], v[184:187], a[156:159], v[92:95]
    v_mfma_f32_16x16x32_bf16 v[96:99], v[188:191], a[144:147], v[96:99]
    ds_read_b64_tr_b16 v[180:181], v247 offset:16384
    v_mfma_f32_16x16x32_bf16 v[100:103], v[188:191], a[148:151], v[100:103]
    ds_read_b64_tr_b16 v[182:183], v247 offset:18432
    v_mfma_f32_16x16x32_bf16 v[104:107], v[188:191], a[152:155], v[104:107]
    buffer_load_dwordx4 v254, s[44:47], s64 offen offset:2048  lds
    v_mfma_f32_16x16x32_bf16 v[108:111], v[188:191], a[156:159], v[108:111]
    s_waitcnt lgkmcnt(4)
    v_mfma_f32_16x16x32_bf16 v[48:51], v[192:195], a[160:163], v[48:51]
    s_waitcnt vmcnt(11)
    ds_read_b64_tr_b16 v[184:185], v244 offset:32768
    v_mfma_f32_16x16x32_bf16 v[52:55], v[192:195], a[164:167], v[52:55]
    ds_read_b64_tr_b16 v[186:187], v244 offset:34816
    v_mfma_f32_16x16x32_bf16 v[56:59], v[192:195], a[168:171], v[56:59]
    buffer_load_dwordx4 v255, s[44:47], s64 offen offset:3072  lds
    v_mfma_f32_16x16x32_bf16 v[60:63], v[192:195], a[172:175], v[60:63]
    v_mfma_f32_16x16x32_bf16 v[64:67], v[196:199], a[160:163], v[64:67]
    ds_read_b64_tr_b16 v[188:189], v245 offset:32768
    v_mfma_f32_16x16x32_bf16 v[68:71], v[196:199], a[164:167], v[68:71]
    ds_read_b64_tr_b16 v[190:191], v245 offset:34816
    v_mfma_f32_16x16x32_bf16 v[72:75], v[196:199], a[168:171], v[72:75]
    s_add_u32 m0, s7, 16384
    s_add_u32 s64, s10, 4423680
    buffer_load_dwordx4 v252, s[44:47], s64 offen offset:0  lds
    v_mfma_f32_16x16x32_bf16 v[76:79], v[196:199], a[172:175], v[76:79]
    s_waitcnt lgkmcnt(4)
    v_mfma_f32_16x16x32_bf16 v[80:83], v[176:179], a[160:163], v[80:83]
    ds_read_b64_tr_b16 v[192:193], v246 offset:32768
    v_mfma_f32_16x16x32_bf16 v[84:87], v[176:179], a[164:167], v[84:87]
    ds_read_b64_tr_b16 v[194:195], v246 offset:34816
    v_mfma_f32_16x16x32_bf16 v[88:91], v[176:179], a[168:171], v[88:91]
    buffer_load_dwordx4 v253, s[44:47], s64 offen offset:1024  lds
    v_mfma_f32_16x16x32_bf16 v[92:95], v[176:179], a[172:175], v[92:95]
    buffer_load_dwordx4 v254, s[44:47], s64 offen offset:2048  lds
    v_mfma_f32_16x16x32_bf16 v[96:99], v[180:183], a[160:163], v[96:99]
    ds_read_b64_tr_b16 v[196:197], v247 offset:32768
    v_mfma_f32_16x16x32_bf16 v[100:103], v[180:183], a[164:167], v[100:103]
    ds_read_b64_tr_b16 v[198:199], v247 offset:34816
    v_mfma_f32_16x16x32_bf16 v[104:107], v[180:183], a[168:171], v[104:107]
    buffer_load_dwordx4 v255, s[44:47], s64 offen offset:3072  lds
    v_mfma_f32_16x16x32_bf16 v[108:111], v[180:183], a[172:175], v[108:111]
    s_waitcnt lgkmcnt(4)
    v_mfma_f32_16x16x32_bf16 v[48:51], v[184:187], a[176:179], v[48:51]
    s_waitcnt vmcnt(12)
    ds_read_b64_tr_b16 v[176:177], v244 offset:49152
    v_mfma_f32_16x16x32_bf16 v[52:55], v[184:187], a[180:183], v[52:55]
    ds_read_b64_tr_b16 v[178:179], v244 offset:51200
    v_mfma_f32_16x16x32_bf16 v[56:59], v[184:187], a[184:187], v[56:59]
    s_add_u32 m0, s7, 32768
    s_add_u32 s64, s10, 4718592
    buffer_load_dwordx4 v252, s[44:47], s64 offen offset:0  lds
    v_mfma_f32_16x16x32_bf16 v[60:63], v[184:187], a[188:191], v[60:63]
    v_mfma_f32_16x16x32_bf16 v[64:67], v[188:191], a[176:179], v[64:67]
    ds_read_b64_tr_b16 v[180:181], v245 offset:49152
    v_mfma_f32_16x16x32_bf16 v[68:71], v[188:191], a[180:183], v[68:71]
    ds_read_b64_tr_b16 v[182:183], v245 offset:51200
    v_mfma_f32_16x16x32_bf16 v[72:75], v[188:191], a[184:187], v[72:75]
    buffer_load_dwordx4 v253, s[44:47], s64 offen offset:1024  lds
    v_mfma_f32_16x16x32_bf16 v[76:79], v[188:191], a[188:191], v[76:79]
    s_waitcnt lgkmcnt(4)
    v_mfma_f32_16x16x32_bf16 v[80:83], v[192:195], a[176:179], v[80:83]
    ds_read_b64_tr_b16 v[184:185], v246 offset:49152
    v_mfma_f32_16x16x32_bf16 v[84:87], v[192:195], a[180:183], v[84:87]
    ds_read_b64_tr_b16 v[186:187], v246 offset:51200
    v_mfma_f32_16x16x32_bf16 v[88:91], v[192:195], a[184:187], v[88:91]
    buffer_load_dwordx4 v254, s[44:47], s64 offen offset:2048  lds
    v_mfma_f32_16x16x32_bf16 v[92:95], v[192:195], a[188:191], v[92:95]
    v_mfma_f32_16x16x32_bf16 v[96:99], v[196:199], a[176:179], v[96:99]
    ds_read_b64_tr_b16 v[188:189], v247 offset:49152
    v_mfma_f32_16x16x32_bf16 v[100:103], v[196:199], a[180:183], v[100:103]
    ds_read_b64_tr_b16 v[190:191], v247 offset:51200
    v_mfma_f32_16x16x32_bf16 v[104:107], v[196:199], a[184:187], v[104:107]
    buffer_load_dwordx4 v255, s[44:47], s64 offen offset:3072  lds
    v_mfma_f32_16x16x32_bf16 v[108:111], v[196:199], a[188:191], v[108:111]
    s_and_b32 s72, s4, 3
    s_cmp_lg_u32 s72, 2
    s_cbranch_scc1 L_pf3
    s_lshr_b32 s72, s4, 2
    s_lshl_b32 s73, s3, 6
    s_cmp_ge_u32 s73, 216
    s_cbranch_scc1 L_pf3
    s_mul_i32 s72, s72, 55296
    s_add_u32 s72, s72, s68
    s_add_u32 s72, s72, 124
    v_add_u32 v10, s73, v1
    v_min_u32 v10, 215, v10
    v_mul_u32_u24 v10, 256, v10
    buffer_load_dwordx2 v[10:11], v10, s[48:51], s72 offen
L_pf3:
    s_add_u32 s71, s10, 512
    v_lshrrev_b32 v222, 4, v1
    v_lshlrev_b32 v222, 3, v222
    buffer_load_dwordx2 v[216:217], v222, s[56:59], s71 offen offset:0
    buffer_load_dwordx2 v[218:219], v222, s[56:59], s71 offen offset:32
    buffer_load_dwordx2 v[220:221], v222, s[56:59], s71 offen offset:64
    buffer_load_dwordx2 v[222:223], v222, s[56:59], s71 offen offset:96
    s_waitcnt lgkmcnt(4)
    v_mfma_f32_16x16x32_bf16 v[48:51], v[176:179], a[192:195], v[48:51]
    s_waitcnt vmcnt(16)
    ds_read_b64_tr_b16 v[192:193], v248 offset:0
    v_mfma_f32_16x16x32_bf16 v[52:55], v[176:179], a[196:199], v[52:55]
    ds_read_b64_tr_b16 v[194:195], v248 offset:2048
    v_mfma_f32_16x16x32_bf16 v[56:59], v[176:179], a[200:203], v[56:59]
    s_add_u32 m0, s7, 49152
    s_add_u32 s64, s10, 5013504
    buffer_load_dwordx4 v252, s[44:47], s64 offen offset:0  lds
    v_mfma_f32_16x16x32_bf16 v[60:63], v[176:179], a[204:207], v[60:63]
    buffer_load_dwordx4 v253, s[44:47], s64 offen offset:1024  lds
    v_mfma_f32_16x16x32_bf16 v[64:67], v[180:183], a[192:195], v[64:67]
    ds_read_b64_tr_b16 v[196:197], v249 offset:0
    v_mfma_f32_16x16x32_bf16 v[68:71], v[180:183], a[196:199], v[68:71]
    ds_read_b64_tr_b16 v[198:199], v249 offset:2048
    v_mfma_f32_16x16x32_bf16 v[72:75], v[180:183], a[200:203], v[72:75]
    buffer_load_dwordx4 v254, s[44:47], s64 offen offset:2048  lds
    v_mfma_f32_16x16x32_bf16 v[76:79], v[180:183], a[204:207], v[76:79]
    s_waitcnt lgkmcnt(4)
    v_mfma_f32_16x16x32_bf16 v[80:83], v[184:187], a[192:195], v[80:83]
    ds_read_b64_tr_b16 v[176:177], v250 offset:0
    v_mfma_f32_16x16x32_bf16 v[84:87], v[184:187], a[196:199], v[84:87]
    ds_read_b64_tr_b16 v[178:179], v250 offset:2048
    v_mfma_f32_16x16x32_bf16 v[88:91], v[184:187], a[200:203], v[88:91]
    buffer_load_dwordx4 v255, s[44:47], s64 offen offset:3072  lds
    v_mfma_f32_16x16x32_bf16 v[92:95], v[184:187], a[204:207], v[92:95]
    v_mfma_f32_16x16x32_bf16 v[96:99], v[188:191], a[192:195], v[96:99]
    ds_read_b64_tr_b16 v[180:181], v251 offset:0
    v_mfma_f32_16x16x32_bf16 v[100:103], v[188:191], a[196:199], v[100:103]
    ds_read_b64_tr_b16 v[182:183], v251 offset:2048
    v_mfma_f32_16x16x32_bf16 v[104:107], v[188:191], a[200:203], v[104:107]
    s_add_u32 m0, s7, 65536
    s_add_u32 s64, s10, 512
    buffer_load_dwordx4 v252, s[44:47], s64 offen offset:0  lds
    v_mfma_f32_16x16x32_bf16 v[108:111], v[188:191], a[204:207], v[108:111]
    s_waitcnt lgkmcnt(4)
    v_mfma_f32_16x16x32_bf16 v[48:51], v[192:195], a[208:211], v[48:51]
    s_waitcnt vmcnt(17)
    ds_read_b64_tr_b16 v[184:185], v240 offset:0
    v_mfma_f32_16x16x32_bf16 v[52:55], v[192:195], a[212:215], v[52:55]
    ds_read_b64_tr_b16 v[186:187], v240 offset:2048
    v_mfma_f32_16x16x32_bf16 v[56:59], v[192:195], a[216:219], v[56:59]
    buffer_load_dwordx4 v253, s[44:47], s64 offen offset:1024  lds
    v_mfma_f32_16x16x32_bf16 v[60:63], v[192:195], a[220:223], v[60:63]
    v_mfma_f32_16x16x32_bf16 v[64:67], v[196:199], a[208:211], v[64:67]
    ds_read_b64_tr_b16 v[188:189], v241 offset:0
    v_mfma_f32_16x16x32_bf16 v[68:71], v[196:199], a[212:215], v[68:71]
    ds_read_b64_tr_b16 v[190:191], v241 offset:2048
    v_mfma_f32_16x16x32_bf16 v[72:75], v[196:199], a[216:219], v[72:75]
    buffer_load_dwordx4 v254, s[44:47], s64 offen offset:2048  lds
    v_mfma_f32_16x16x32_bf16 v[76:79], v[196:199], a[220:223], v[76:79]
    s_waitcnt lgkmcnt(4)
    v_mfma_f32_16x16x32_bf16 v[80:83], v[176:179], a[208:211], v[80:83]
    ds_read_b64_tr_b16 v[192:193], v242 offset:0
    v_mfma_f32_16x16x32_bf16 v[84:87], v[176:179], a[212:215], v[84:87]
    ds_read_b64_tr_b16 v[194:195], v242 offset:2048
    v_mfma_f32_16x16x32_bf16 v[88:91], v[176:179], a[216:219], v[88:91]
    buffer_load_dwordx4 v255, s[44:47], s64 offen offset:3072  lds
    v_mfma_f32_16x16x32_bf16 v[92:95], v[176:179], a[220:223], v[92:95]
    s_add_u32 m0, s7, 147456
    s_add_u32 s64, s10, 295424
    buffer_load_dwordx4 v252, s[44:47], s64 offen offset:0  lds
    v_mfma_f32_16x16x32_bf16 v[96:99], v[180:183], a[208:211], v[96:99]
    ds_read_b64_tr_b16 v[196:197], v243 offset:0
    v_mfma_f32_16x16x32_bf16 v[100:103], v[180:183], a[212:215], v[100:103]
    ds_read_b64_tr_b16 v[198:199], v243 offset:2048
    v_mfma_f32_16x16x32_bf16 v[104:107], v[180:183], a[216:219], v[104:107]
    buffer_load_dwordx4 v253, s[44:47], s64 offen offset:1024  lds
    v_mfma_f32_16x16x32_bf16 v[108:111], v[180:183], a[220:223], v[108:111]
    s_waitcnt lgkmcnt(4)
    v_mfma_f32_16x16x32_bf16 v[48:51], v[184:187], a[224:227], v[48:51]
    s_waitcnt vmcnt(18)
    ds_read_b64_tr_b16 v[176:177], v240 offset:16384
    v_mfma_f32_16x16x32_bf16 v[52:55], v[184:187], a[228:231], v[52:55]
    ds_read_b64_tr_b16 v[178:179], v240 offset:18432
    v_mfma_f32_16x16x32_bf16 v[56:59], v[184:187], a[232:235], v[56:59]
    buffer_load_dwordx4 v254, s[44:47], s64 offen offset:2048  lds
    v_mfma_f32_16x16x32_bf16 v[60:63], v[184:187], a[236:239], v[60:63]
    v_mfma_f32_16x16x32_bf16 v[64:67], v[188:191], a[224:227], v[64:67]
    ds_read_b64_tr_b16 v[180:181], v241 offset:16384
    v_mfma_f32_16x16x32_bf16 v[68:71], v[188:191], a[228:231], v[68:71]
    ds_read_b64_tr_b16 v[182:183], v241 offset:18432
    v_mfma_f32_16x16x32_bf16 v[72:75], v[188:191], a[232:235], v[72:75]
    buffer_load_dwordx4 v255, s[44:47], s64 offen offset:3072  lds
    v_mfma_f32_16x16x32_bf16 v[76:79], v[188:191], a[236:239], v[76:79]
    s_waitcnt lgkmcnt(4)
    v_mfma_f32_16x16x32_bf16 v[80:83], v[192:195], a[224:227], v[80:83]
    ds_read_b64_tr_b16 v[184:185], v242 offset:16384
    v_mfma_f32_16x16x32_bf16 v[84:87], v[192:195], a[228:231], v[84:87]
    ds_read_b64_tr_b16 v[186:187], v242 offset:18432
    v_mfma_f32_16x16x32_bf16 v[88:91], v[192:195], a[232:235], v[88:91]
    s_add_u32 m0, s7, 81920
    s_add_u32 s64, s10, 590336
    buffer_load_dwordx4 v252, s[44:47], s64 offen offset:0  lds
    v_mfma_f32_16x16x32_bf16 v[92:95], v[192:195], a[236:239], v[92:95]
    v_mfma_f32_16x16x32_bf16 v[96:99], v[196:199], a[224:227], v[96:99]
    ds_read_b64_tr_b16 v[188:189], v243 offset:16384
    v_mfma_f32_16x16x32_bf16 v[100:103], v[196:199], a[228:231], v[100:103]
    ds_read_b64_tr_b16 v[190:191], v243 offset:18432
    v_mfma_f32_16x16x32_bf16 v[104:107], v[196:199], a[232:235], v[104:107]
    buffer_load_dwordx4 v253, s[44:47], s64 offen offset:1024  lds
    v_mfma_f32_16x16x32_bf16 v[108:111], v[196:199], a[236:239], v[108:111]
    s_waitcnt lgkmcnt(4)
    v_mfma_f32_16x16x32_bf16 v[48:51], v[176:179], a[240:243], v[48:51]
    s_waitcnt vmcnt(18)
    ds_read_b64_tr_b16 v[192:193], v240 offset:32768
    v_mfma_f32_16x16x32_bf16 v[52:55], v[176:179], a[244:247], v[52:55]
    ds_read_b64_tr_b16 v[194:195], v240 offset:34816
    v_mfma_f32_16x16x32_bf16 v[56:59], v[176:179], a[248:251], v[56:59]
    buffer_load_dwordx4 v254, s[44:47], s64 offen offset:2048  lds
    v_mfma_f32_16x16x32_bf16 v[60:63], v[176:179], a[252:255], v[60:63]
    buffer_load_dwordx4 v255, s[44:47], s64 offen offset:3072  lds
    v_mfma_f32_16x16x32_bf16 v[64:67], v[180:183], a[240:243], v[64:67]
    ds_read_b64_tr_b16 v[196:197], v241 offset:32768
    v_mfma_f32_16x16x32_bf16 v[68:71], v[180:183], a[244:247], v[68:71]
    ds_read_b64_tr_b16 v[198:199], v241 offset:34816
    v_mfma_f32_16x16x32_bf16 v[72:75], v[180:183], a[248:251], v[72:75]
    s_add_u32 m0, s7, 98304
    s_add_u32 s64, s10, 885248
    buffer_load_dwordx4 v252, s[44:47], s64 offen offset:0  lds
    v_mfma_f32_16x16x32_bf16 v[76:79], v[180:183], a[252:255], v[76:79]
    s_waitcnt lgkmcnt(4)
    v_mfma_f32_16x16x32_bf16 v[80:83], v[184:187], a[240:243], v[80:83]
    ds_read_b64_tr_b16 v[176:177], v242 offset:32768
    v_mfma_f32_16x16x32_bf16 v[84:87], v[184:187], a[244:247], v[84:87]
    ds_read_b64_tr_b16 v[178:179], v242 offset:34816
    v_mfma_f32_16x16x32_bf16 v[88:91], v[184:187], a[248:251], v[88:91]
    buffer_load_dwordx4 v253, s[44:47], s64 offen offset:1024  lds
    v_mfma_f32_16x16x32_bf16 v[92:95], v[184:187], a[252:255], v[92:95]
    v_mfma_f32_16x16x32_bf16 v[96:99], v[188:191], a[240:243], v[96:99]
    ds_read_b64_tr_b16 v[180:181], v243 offset:32768
    v_mfma_f32_16x16x32_bf16 v[100:103], v[188:191], a[244:247], v[100:103]
    ds_read_b64_tr_b16 v[182:183], v243 offset:34816
    v_mfma_f32_16x16x32_bf16 v[104:107], v[188:191], a[248:251], v[104:107]
    buffer_load_dwordx4 v254, s[44:47], s64 offen offset:2048  lds
    v_mfma_f32_16x16x32_bf16 v[108:111], v[188:191], a[252:255], v[108:111]
    s_waitcnt lgkmcnt(4)
    v_mfma_f32_16x16x32_bf16 v[48:51], v[192:195], v[16:19], v[48:51]
    s_waitcnt vmcnt(15)
    ds_read_b64_tr_b16 v[184:185], v240 offset:49152
    v_mfma_f32_16x16x32_bf16 v[52:55], v[192:195], v[20:23], v[52:55]
    ds_read_b64_tr_b16 v[186:187], v240 offset:51200
    v_lshlrev_b32 v224, 16, v216
    v_mfma_f32_16x16x32_bf16 v[56:59], v[192:195], v[24:27], v[56:59]
    buffer_load_dwordx4 v255, s[44:47], s64 offen offset:3072  lds
    v_and_b32 v225, s13, v216
    v_mfma_f32_16x16x32_bf16 v[60:63], v[192:195], v[28:31], v[60:63]
    v_lshlrev_b32 v226, 16, v217
    v_mfma_f32_16x16x32_bf16 v[64:67], v[196:199], v[16:19], v[64:67]
    ds_read_b64_tr_b16 v[188:189], v241 offset:49152
    v_and_b32 v227, s13, v217
    v_mfma_f32_16x16x32_bf16 v[68:71], v[196:199], v[20:23], v[68:71]
    ds_read_b64_tr_b16 v[190:191], v241 offset:51200
    v_lshlrev_b32 v228, 16, v218
    v_and_b32 v229, s13, v218
    v_mfma_f32_16x16x32_bf16 v[72:75], v[196:199], v[24:27], v[72:75]
    s_add_u32 m0, s7, 114688
    s_add_u32 s64, s10, 1180160
    buffer_load_dwordx4 v252, s[44:47], s64 offen offset:0  lds
    v_lshlrev_b32 v230, 16, v219
    v_mfma_f32_16x16x32_bf16 v[76:79], v[196:199], v[28:31], v[76:79]
    v_and_b32 v231, s13, v219
    s_waitcnt lgkmcnt(4)
    v_mfma_f32_16x16x32_bf16 v[80:83], v[176:179], v[16:19], v[80:83]
    ds_read_b64_tr_b16 v[192:193], v242 offset:49152
    v_lshlrev_b32 v232, 16, v220
    v_mfma_f32_16x16x32_bf16 v[84:87], v[176:179], v[20:23], v[84:87]
    ds_read_b64_tr_b16 v[194:195], v242 offset:51200
    v_and_b32 v233, s13, v220
    v_mfma_f32_16x16x32_bf16 v[88:91], v[176:179], v[24:27], v[88:91]
    buffer_load_dwordx4 v253, s[44:47], s64 offen offset:1024  lds
    v_lshlrev_b32 v234, 16, v221
    v_mfma_f32_16x16x32_bf16 v[92:95], v[176:179], v[28:31], v[92:95]
    buffer_load_dwordx4 v254, s[44:47], s64 offen offset:2048  lds
    v_and_b32 v235, s13, v221
    v_lshlrev_b32 v236, 16, v222
    v_mfma_f32_16x16x32_bf16 v[96:99], v[180:183], v[16:19], v[96:99]
    ds_read_b64_tr_b16 v[196:197], v243 offset:49152
    v_and_b32 v237, s13, v222
    v_mfma_f32_16x16x32_bf16 v[100:103], v[180:183], v[20:23], v[100:103]
    ds_read_b64_tr_b16 v[198:199], v243 offset:51200
    v_lshlrev_b32 v238, 16, v223
    v_mfma_f32_16x16x32_bf16 v[104:107], v[180:183], v[24:27], v[104:107]
    buffer_load_dwordx4 v255, s[44:47], s64 offen offset:3072  lds
    v_and_b32 v239, s13, v223
    v_mfma_f32_16x16x32_bf16 v[108:111], v[180:183], v[28:31], v[108:111]
    v_mul_f32 v224, 0x3eeff558, v224
    s_waitcnt lgkmcnt(4)
    v_mfma_f32_16x16x32_bf16 v[48:51], v[184:187], v[32:35], v[48:51]
    s_waitcnt vmcnt(16)
    ds_read_b64_tr_b16 v[176:177], v244 offset:0
    v_mul_f32 v225, 0x3eeff558, v225
    v_mul_f32 v226, 0x3eeff558, v226
    v_mfma_f32_16x16x32_bf16 v[52:55], v[184:187], v[36:39], v[52:55]
    ds_read_b64_tr_b16 v[178:179], v244 offset:2048
    v_mul_f32 v227, 0x3eeff558, v227
    v_mfma_f32_16x16x32_bf16 v[56:59], v[184:187], v[40:43], v[56:59]
    s_add_u32 m0, s7, 131072
    s_add_u32 s64, s10, 1475072
    buffer_load_dwordx4 v252, s[44:47], s64 offen offset:0  lds
    v_mul_f32 v228, 0x3eeff558, v228
    v_mfma_f32_16x16x32_bf16 v[60:63], v[184:187], v[44:47], v[60:63]
    v_mul_f32 v229, 0x3eeff558, v229
    v_mfma_f32_16x16x32_bf16 v[64:67], v[188:191], v[32:35], v[64:67]
    ds_read_b64_tr_b16 v[180:181], v245 offset:0
    v_mul_f32 v230, 0x3eeff558, v230
    v_mfma_f32_16x16x32_bf16 v[68:71], v[188:191], v[36:39], v[68:71]
    ds_read_b64_tr_b16 v[182:183], v245 offset:2048
    v_mul_f32 v231, 0x3eeff558, v231
    v_mfma_f32_16x16x32_bf16 v[72:75], v[188:191], v[40:43], v[72:75]
    buffer_load_dwordx4 v253, s[44:47], s64 offen offset:1024  lds
    v_mul_f32 v232, 0x3eeff558, v232
    v_mul_f32 v233, 0x3eeff558, v233
    v_mfma_f32_16x16x32_bf16 v[76:79], v[188:191], v[44:47], v[76:79]
    v_mul_f32 v234, 0x3eeff558, v234
    s_waitcnt lgkmcnt(4)
    v_mfma_f32_16x16x32_bf16 v[80:83], v[192:195], v[32:35], v[80:83]
    ds_read_b64_tr_b16 v[184:185], v246 offset:0
    v_mul_f32 v235, 0x3eeff558, v235
    v_mfma_f32_16x16x32_bf16 v[84:87], v[192:195], v[36:39], v[84:87]
    ds_read_b64_tr_b16 v[186:187], v246 offset:2048
    v_mul_f32 v236, 0x3eeff558, v236
    v_mfma_f32_16x16x32_bf16 v[88:91], v[192:195], v[40:43], v[88:91]
    buffer_load_dwordx4 v254, s[44:47], s64 offen offset:2048  lds
    v_mul_f32 v237, 0x3eeff558, v237
    v_mfma_f32_16x16x32_bf16 v[92:95], v[192:195], v[44:47], v[92:95]
    v_mul_f32 v238, 0x3eeff558, v238
    v_mul_f32 v239, 0x3eeff558, v239
    v_mfma_f32_16x16x32_bf16 v[96:99], v[196:199], v[32:35], v[96:99]
    ds_read_b64_tr_b16 v[188:189], v247 offset:0
    v_mfma_f32_16x16x32_bf16 v[100:103], v[196:199], v[36:39], v[100:103]
    ds_read_b64_tr_b16 v[190:191], v247 offset:2048
    v_mfma_f32_16x16x32_bf16 v[104:107], v[196:199], v[40:43], v[104:107]
    buffer_load_dwordx4 v255, s[44:47], s64 offen offset:3072  lds
    v_mfma_f32_16x16x32_bf16 v[108:111], v[196:199], v[44:47], v[108:111]
    s_and_b32 s72, s4, 3
    s_cmp_lg_u32 s72, 3
    s_cbranch_scc1 L_pf4
    s_lshr_b32 s72, s4, 2
    s_lshl_b32 s73, s3, 6
    s_cmp_ge_u32 s73, 216
    s_cbranch_scc1 L_pf4
    s_mul_i32 s72, s72, 55296
    s_add_u32 s72, s72, s68
    s_add_u32 s72, s72, 442492
    v_add_u32 v10, s73, v1
    v_min_u32 v10, 215, v10
    v_mul_u32_u24 v10, 256, v10
    buffer_load_dwordx2 v[10:11], v10, s[48:51], s72 offen
L_pf4:
    s_waitcnt lgkmcnt(4)
    v_mfma_f32_16x16x32_bf16 v[112:115], v[176:179], a[0:3], v[224:227]
    s_waitcnt vmcnt(16)
    ds_read_b64_tr_b16 v[192:193], v248 offset:16384
    v_mfma_f32_16x16x32_bf16 v[116:119], v[176:179], a[4:7], v[224:227]
    ds_read_b64_tr_b16 v[194:195], v248 offset:18432
    v_mfma_f32_16x16x32_bf16 v[120:123], v[176:179], a[8:11], v[224:227]
    s_add_u32 m0, s7, 32768
    s_add_u32 s64, s10, 1769984
    buffer_load_dwordx4 v252, s[44:47], s64 offen offset:0  lds
    v_mfma_f32_16x16x32_bf16 v[124:127], v[176:179], a[12:15], v[224:227]
    buffer_load_dwordx4 v253, s[44:47], s64 offen offset:1024  lds
    v_mfma_f32_16x16x32_bf16 v[128:131], v[180:183], a[0:3], v[228:231]
    ds_read_b64_tr_b16 v[196:197], v249 offset:16384
    v_fma_f32 v200, -v48, v48, s66
    v_mfma_f32_16x16x32_bf16 v[132:135], v[180:183], a[4:7], v[228:231]
    ds_read_b64_tr_b16 v[198:199], v249 offset:18432
    v_mul_f32 v200, v200, v48
    v_fma_f32 v201, -v49, v49, s66
    v_mfma_f32_16x16x32_bf16 v[136:139], v[180:183], a[8:11], v[228:231]
    buffer_load_dwordx4 v254, s[44:47], s64 offen offset:2048  lds
    v_exp_f32 v200, v200
    v_mul_f32 v201, v201, v49
    v_mfma_f32_16x16x32_bf16 v[140:143], v[180:183], a[12:15], v[228:231]
    v_fma_f32 v202, -v50, v50, s66
    s_waitcnt lgkmcnt(4)
    v_mfma_f32_16x16x32_bf16 v[144:147], v[184:187], a[0:3], v[232:235]
    ds_read_b64_tr_b16 v[176:177], v250 offset:16384
    v_add_f32 v200, 1.0, v200
    v_exp_f32 v201, v201
    v_mfma_f32_16x16x32_bf16 v[148:151], v[184:187], a[4:7], v[232:235]
    ds_read_b64_tr_b16 v[178:179], v250 offset:18432
    v_mul_f32 v202, v202, v50
    v_mfma_f32_16x16x32_bf16 v[152:155], v[184:187], a[8:11], v[232:235]
    buffer_load_dwordx4 v255, s[44:47], s64 offen offset:3072  lds
    v_fma_f32 v203, -v51, v51, s66
    v_rcp_f32 v200, v200
    v_mfma_f32_16x16x32_bf16 v[156:159], v[184:187], a[12:15], v[232:235]
    v_add_f32 v201, 1.0, v201
    v_exp_f32 v202, v202
    v_mfma_f32_16x16x32_bf16 v[160:163], v[188:191], a[0:3], v[236:239]
    ds_read_b64_tr_b16 v[180:181], v251 offset:16384
    v_mul_f32 v203, v203, v51
    v_mfma_f32_16x16x32_bf16 v[164:167], v[188:191], a[4:7], v[236:239]
    ds_read_b64_tr_b16 v[182:183], v251 offset:18432
    v_fma_f32 v204, -v64, v64, s66
    v_mul_f32 v48, v200, v48
    v_mfma_f32_16x16x32_bf16 v[168:171], v[188:191], a[8:11], v[236:239]
    s_add_u32 m0, s7, 49152
    s_add_u32 s64, s10, 2064896
    buffer_load_dwordx4 v252, s[44:47], s64 offen offset:0  lds
    v_rcp_f32 v201, v201
    v_mfma_f32_16x16x32_bf16 v[172:175], v[188:191], a[12:15], v[236:239]
    v_add_f32 v202, 1.0, v202
    v_exp_f32 v203, v203
    s_waitcnt lgkmcnt(4)
    v_mfma_f32_16x16x32_bf16 v[112:115], v[192:195], a[16:19], v[112:115]
    s_waitcnt vmcnt(17)
    ds_read_b64_tr_b16 v[184:185], v244 offset:16384
    v_mul_f32 v204, v204, v64
    v_fma_f32 v205, -v65, v65, s66
    v_mfma_f32_16x16x32_bf16 v[116:119], v[192:195], a[20:23], v[116:119]
    ds_read_b64_tr_b16 v[186:187], v244 offset:18432
    v_mul_f32 v49, v201, v49
    v_mfma_f32_16x16x32_bf16 v[120:123], v[192:195], a[24:27], v[120:123]
    buffer_load_dwordx4 v253, s[44:47], s64 offen offset:1024  lds
    v_rcp_f32 v202, v202
    v_add_f32 v203, 1.0, v203
    v_mfma_f32_16x16x32_bf16 v[124:127], v[192:195], a[28:31], v[124:127]
    v_exp_f32 v204, v204
    v_mfma_f32_16x16x32_bf16 v[128:131], v[196:199], a[16:19], v[128:131]
    ds_read_b64_tr_b16 v[188:189], v245 offset:16384
    v_mul_f32 v205, v205, v65
    v_fma_f32 v206, -v66, v66, s66
    v_mfma_f32_16x16x32_bf16 v[132:135], v[196:199], a[20:23], v[132:135]
    ds_read_b64_tr_b16 v[190:191], v245 offset:18432
    v_cvt_pk_bf16_f32 v208, v48, v49
    v_mul_f32 v50, v202, v50
    v_mfma_f32_16x16x32_bf16 v[136:139], v[196:199], a[24:27], v[136:139]
    buffer_load_dwordx4 v254, s[44:47], s64 offen offset:2048  lds
    v_rcp_f32 v203, v203
    v_mfma_f32_16x16x32_bf16 v[140:143], v[196:199], a[28:31], v[140:143]
    v_add_f32 v204, 1.0, v204
    v_exp_f32 v205, v205
    s_waitcnt lgkmcnt(4)
    v_mfma_f32_16x16x32_bf16 v[144:147], v[176:179], a[16:19], v[144:147]
    ds_read_b64_tr_b16 v[192:193], v246 offset:16384
    v_mul_f32 v206, v206, v66
    v_mfma_f32_16x16x32_bf16 v[148:151], v[176:179], a[20:23], v[148:151]
    ds_read_b64_tr_b16 v[194:195], v246 offset:18432
    v_fma_f32 v207, -v67, v67, s66
    v_mul_f32 v51, v203, v51
    v_mfma_f32_16x16x32_bf16 v[152:155], v[176:179], a[24:27], v[152:155]
    buffer_load_dwordx4 v255, s[44:47], s64 offen offset:3072  lds
    v_rcp_f32 v204, v204
    v_mfma_f32_16x16x32_bf16 v[156:159], v[176:179], a[28:31], v[156:159]
    s_add_u32 m0, s7, 65536
    s_add_u32 s64, s10, 2359808
    buffer_load_dwordx4 v252, s[44:47], s64 offen offset:0  lds
    v_add_f32 v205, 1.0, v205
    v_exp_f32 v206, v206
    v_mfma_f32_16x16x32_bf16 v[160:163], v[180:183], a[16:19], v[160:163]
    ds_read_b64_tr_b16 v[196:197], v247 offset:16384
    v_mul_f32 v207, v207, v67
    v_fma_f32 v200, -v52, v52, s66
    v_mfma_f32_16x16x32_bf16 v[164:167], v[180:183], a[20:23], v[164:167]
    ds_read_b64_tr_b16 v[198:199], v247 offset:18432
    v_cvt_pk_bf16_f32 v209, v50, v51
    v_mfma_f32_16x16x32_bf16 v[168:171], v[180:183], a[24:27], v[168:171]
    buffer_load_dwordx4 v253, s[44:47], s64 offen offset:1024  lds
    v_mul_f32 v64, v204, v64
    v_rcp_f32 v205, v205
    v_mfma_f32_16x16x32_bf16 v[172:175], v[180:183], a[28:31], v[172:175]
    v_add_f32 v206, 1.0, v206
    s_waitcnt lgkmcnt(4)
    v_mfma_f32_16x16x32_bf16 v[112:115], v[184:187], a[32:35], v[112:115]
    s_waitcnt vmcnt(18)
    ds_read_b64_tr_b16 v[176:177], v244 offset:32768
    v_exp_f32 v207, v207
    v_mul_f32 v200, v200, v52
    v_mfma_f32_16x16x32_bf16 v[116:119], v[184:187], a[36:39], v[116:119]
    ds_read_b64_tr_b16 v[178:179], v244 offset:34816
    v_fma_f32 v201, -v53, v53, s66
    v_mul_f32 v65, v205, v65
    v_mfma_f32_16x16x32_bf16 v[120:123], v[184:187], a[40:43], v[120:123]
    buffer_load_dwordx4 v254, s[44:47], s64 offen offset:2048  lds
    v_rcp_f32 v206, v206
    v_mfma_f32_16x16x32_bf16 v[124:127], v[184:187], a[44:47], v[124:127]
    v_add_f32 v207, 1.0, v207
    v_exp_f32 v200, v200
    v_mfma_f32_16x16x32_bf16 v[128:131], v[188:191], a[32:35], v[128:131]
    ds_read_b64_tr_b16 v[180:181], v245 offset:32768
    v_mul_f32 v201, v201, v53
    v_mfma_f32_16x16x32_bf16 v[132:135], v[188:191], a[36:39], v[132:135]
    ds_read_b64_tr_b16 v[182:183], v245 offset:34816
    v_fma_f32 v202, -v54, v54, s66
    v_cvt_pk_bf16_f32 v210, v64, v65
    v_mfma_f32_16x16x32_bf16 v[136:139], v[188:191], a[40:43], v[136:139]
    buffer_load_dwordx4 v255, s[44:47], s64 offen offset:3072  lds
    v_mul_f32 v66, v206, v66
    v_rcp_f32 v207, v207
    v_mfma_f32_16x16x32_bf16 v[140:143], v[188:191], a[44:47], v[140:143]
    v_add_f32 v200, 1.0, v200
    s_waitcnt lgkmcnt(4)
    v_mfma_f32_16x16x32_bf16 v[144:147], v[192:195], a[32:35], v[144:147]
    ds_read_b64_tr_b16 v[184:185], v246 offset:32768
    v_exp_f32 v201, v201
    v_mul_f32 v202, v202, v54
    v_mfma_f32_16x16x32_bf16 v[148:151], v[192:195], a[36:39], v[148:151]
    ds_read_b64_tr_b16 v[186:187], v246 offset:34816
    v_fma_f32 v203, -v55, v55, s66
    v_mfma_f32_16x16x32_bf16 v[152:155], v[192:195], a[40:43], v[152:155]
    s_add_u32 m0, s7, 147456
    s_add_u32 s64, s10, 2654720
    buffer_load_dwordx4 v252, s[44:47], s64 offen offset:0  lds
    v_mul_f32 v67, v207, v67
    v_rcp_f32 v200, v200
    v_mfma_f32_16x16x32_bf16 v[156:159], v[192:195], a[44:47], v[156:159]
    v_add_f32 v201, 1.0, v201
    v_exp_f32 v202, v202
    v_mfma_f32_16x16x32_bf16 v[160:163], v[196:199], a[32:35], v[160:163]
    ds_read_b64_tr_b16 v[188:189], v247 offset:32768
    v_mul_f32 v203, v203, v55
    v_mfma_f32_16x16x32_bf16 v[164:167], v[196:199], a[36:39], v[164:167]
    ds_read_b64_tr_b16 v[190:191], v247 offset:34816
    v_fma_f32 v204, -v68, v68, s66
    v_cvt_pk_bf16_f32 v211, v66, v67
    v_mfma_f32_16x16x32_bf16 v[168:171], v[196:199], a[40:43], v[168:171]
    buffer_load_dwordx4 v253, s[44:47], s64 offen offset:1024  lds
    v_mul_f32 v52, v200, v52
    v_mfma_f32_16x16x32_bf16 v[172:175], v[196:199], a[44:47], v[172:175]
    v_rcp_f32 v201, v201
    v_add_f32 v202, 1.0, v202
    s_waitcnt lgkmcnt(4)
    v_mfma_f32_16x16x32_bf16 v[112:115], v[176:179], a[48:51], v[112:115]
    s_waitcnt vmcnt(18)
    ds_read_b64_tr_b16 v[192:193], v244 offset:49152
    v_exp_f32 v203, v203
    v_mul_f32 v204, v204, v68
    v_mfma_f32_16x16x32_bf16 v[116:119], v[176:179], a[52:55], v[116:119]
    ds_read_b64_tr_b16 v[194:195], v244 offset:51200
    v_fma_f32 v205, -v69, v69, s66
    v_mfma_f32_16x16x32_bf16 v[120:123], v[176:179], a[56:59], v[120:123]
    buffer_load_dwordx4 v254, s[44:47], s64 offen offset:2048  lds
    ds_write_b128 v4, v[208:211] offset:0
    v_mul_f32 v53, v201, v53
    v_mfma_f32_16x16x32_bf16 v[124:127], v[176:179], a[60:63], v[124:127]
    buffer_load_dwordx4 v255, s[44:47], s64 offen offset:3072  lds
    v_rcp_f32 v202, v202
    v_mfma_f32_16x16x32_bf16 v[128:131], v[180:183], a[48:51], v[128:131]
    ds_read_b64_tr_b16 v[196:197], v245 offset:49152
    v_add_f32 v203, 1.0, v203
    v_exp_f32 v204, v204
    v_mfma_f32_16x16x32_bf16 v[132:135], v[180:183], a[52:55], v[132:135]
    ds_read_b64_tr_b16 v[198:199], v245 offset:51200
    v_mul_f32 v205, v205, v69
    v_mfma_f32_16x16x32_bf16 v[136:139], v[180:183], a[56:59], v[136:139]
    s_add_u32 m0, s7, 81920
    s_add_u32 s64, s10, 2949632
    buffer_load_dwordx4 v252, s[44:47], s64 offen offset:0  lds
    v_fma_f32 v206, -v70, v70, s66
    v_cvt_pk_bf16_f32 v212, v52, v53
    v_mfma_f32_16x16x32_bf16 v[140:143], v[180:183], a[60:63], v[140:143]
    v_mul_f32 v54, v202, v54
    v_rcp_f32 v203, v203
    s_waitcnt lgkmcnt(5)
    v_mfma_f32_16x16x32_bf16 v[144:147], v[184:187], a[48:51], v[144:147]
    ds_read_b64_tr_b16 v[176:177], v246 offset:49152
    v_add_f32 v204, 1.0, v204
    v_mfma_f32_16x16x32_bf16 v[148:151], v[184:187], a[52:55], v[148:151]
    ds_read_b64_tr_b16 v[178:179], v246 offset:51200
    v_exp_f32 v205, v205
    v_mul_f32 v206, v206, v70
    v_mfma_f32_16x16x32_bf16 v[152:155], v[184:187], a[56:59], v[152:155]
    buffer_load_dwordx4 v253, s[44:47], s64 offen offset:1024  lds
    v_fma_f32 v207, -v71, v71, s66
    v_mfma_f32_16x16x32_bf16 v[156:159], v[184:187], a[60:63], v[156:159]
    v_mul_f32 v55, v203, v55
    v_rcp_f32 v204, v204
    v_mfma_f32_16x16x32_bf16 v[160:163], v[188:191], a[48:51], v[160:163]
    ds_read_b64_tr_b16 v[180:181], v247 offset:49152
    v_add_f32 v205, 1.0, v205
    v_exp_f32 v206, v206
    v_mfma_f32_16x16x32_bf16 v[164:167], v[188:191], a[52:55], v[164:167]
    ds_read_b64_tr_b16 v[182:183], v247 offset:51200
    v_mul_f32 v207, v207, v71
    v_mfma_f32_16x16x32_bf16 v[168:171], v[188:191], a[56:59], v[168:171]
    buffer_load_dwordx4 v254, s[44:47], s64 offen offset:2048  lds
    v_fma_f32 v200, -v56, v56, s66
    v_cvt_pk_bf16_f32 v213, v54, v55
    v_mfma_f32_16x16x32_bf16 v[172:175], v[188:191], a[60:63], v[172:175]
    v_mul_f32 v68, v204, v68
    s_waitcnt lgkmcnt(4)
    v_mfma_f32_16x16x32_bf16 v[112:115], v[192:195], a[64:67], v[112:115]
    s_waitcnt vmcnt(19)
    ds_read_b64_tr_b16 v[184:185], v248 offset:0
    v_rcp_f32 v205, v205
    v_add_f32 v206, 1.0, v206
    v_mfma_f32_16x16x32_bf16 v[116:119], v[192:195], a[68:71], v[116:119]
    ds_read_b64_tr_b16 v[186:187], v248 offset:2048
    v_exp_f32 v207, v207
    v_mul_f32 v200, v200, v56
    v_mfma_f32_16x16x32_bf16 v[120:123], v[192:195], a[72:75], v[120:123]
    buffer_load_dwordx4 v255, s[44:47], s64 offen offset:3072  lds
    v_fma_f32 v201, -v57, v57, s66
    v_mfma_f32_16x16x32_bf16 v[124:127], v[192:195], a[76:79], v[124:127]
    v_mul_f32 v69, v205, v69
    v_rcp_f32 v206, v206
    v_mfma_f32_16x16x32_bf16 v[128:131], v[196:199], a[64:67], v[128:131]
    ds_read_b64_tr_b16 v[188:189], v249 offset:0
    v_add_f32 v207, 1.0, v207
    v_mfma_f32_16x16x32_bf16 v[132:135], v[196:199], a[68:71], v[132:135]
    ds_read_b64_tr_b16 v[190:191], v249 offset:2048
    v_exp_f32 v200, v200
    v_mul_f32 v201, v201, v57
    v_mfma_f32_16x16x32_bf16 v[136:139], v[196:199], a[72:75], v[136:139]
    s_add_u32 m0, s7, 98304
    s_add_u32 s64, s10, 3244544
    buffer_load_dwordx4 v252, s[44:47], s64 offen offset:0  lds
    v_fma_f32 v202, -v58, v58, s66
    v_cvt_pk_bf16_f32 v214, v68, v69
    v_mfma_f32_16x16x32_bf16 v[140:143], v[196:199], a[76:79], v[140:143]
    v_mul_f32 v70, v206, v70
    s_waitcnt lgkmcnt(4)
    v_mfma_f32_16x16x32_bf16 v[144:147], v[176:179], a[64:67], v[144:147]
    ds_read_b64_tr_b16 v[192:193], v250 offset:0
    v_rcp_f32 v207, v207
    v_add_f32 v200, 1.0, v200
    v_mfma_f32_16x16x32_bf16 v[148:151], v[176:179], a[68:71], v[148:151]
    ds_read_b64_tr_b16 v[194:195], v250 offset:2048
    v_exp_f32 v201, v201
    v_mfma_f32_16x16x32_bf16 v[152:155], v[176:179], a[72:75], v[152:155]
    buffer_load_dwordx4 v253, s[44:47], s64 offen offset:1024  lds
    v_mul_f32 v202, v202, v58
    v_fma_f32 v203, -v59, v59, s66
    v_mfma_f32_16x16x32_bf16 v[156:159], v[176:179], a[76:79], v[156:159]
    buffer_load_dwordx4 v254, s[44:47], s64 offen offset:2048  lds
    v_mul_f32 v71, v207, v71
    v_rcp_f32 v200, v200
    v_mfma_f32_16x16x32_bf16 v[160:163], v[180:183], a[64:67], v[160:163]
    ds_read_b64_tr_b16 v[196:197], v251 offset:0
    v_add_f32 v201, 1.0, v201
    v_mfma_f32_16x16x32_bf16 v[164:167], v[180:183], a[68:71], v[164:167]
    ds_read_b64_tr_b16 v[198:199], v251 offset:2048
    v_exp_f32 v202, v202
    v_mul_f32 v203, v203, v59
    v_mfma_f32_16x16x32_bf16 v[168:171], v[180:183], a[72:75], v[168:171]
    buffer_load_dwordx4 v255, s[44:47], s64 offen offset:3072  lds
    v_fma_f32 v204, -v72, v72, s66
    v_mfma_f32_16x16x32_bf16 v[172:175], v[180:183], a[76:79], v[172:175]
    v_cvt_pk_bf16_f32 v215, v70, v71
    v_mul_f32 v56, v200, v56
    s_waitcnt lgkmcnt(4)
    v_mfma_f32_16x16x32_bf16 v[112:115], v[184:187], a[80:83], v[112:115]
    s_waitcnt vmcnt(20)
    ds_read_b64_tr_b16 v[176:177], v240 offset:32768
    v_rcp_f32 v201, v201
    v_mfma_f32_16x16x32_bf16 v[116:119], v[184:187], a[84:87], v[116:119]
    ds_read_b64_tr_b16 v[178:179], v240 offset:34816
    v_add_f32 v202, 1.0, v202
    v_exp_f32 v203, v203
    v_mfma_f32_16x16x32_bf16 v[120:123], v[184:187], a[88:91], v[120:123]
    s_add_u32 m0, s7, 114688
    s_add_u32 s64, s10, 3539456
    buffer_load_dwordx4 v252, s[44:47], s64 offen offset:0  lds
    v_mul_f32 v204, v204, v72
    v_fma_f32 v205, -v73, v73, s66
    v_mfma_f32_16x16x32_bf16 v[124:127], v[184:187], a[92:95], v[124:127]
    ds_write_b128 v4, v[212:215] offset:1024
    v_mfma_f32_16x16x32_bf16 v[128:131], v[188:191], a[80:83], v[128:131]
    ds_read_b64_tr_b16 v[180:181], v241 offset:32768
    v_mul_f32 v57, v201, v57
    v_rcp_f32 v202, v202
    v_mfma_f32_16x16x32_bf16 v[132:135], v[188:191], a[84:87], v[132:135]
    ds_read_b64_tr_b16 v[182:183], v241 offset:34816
    v_add_f32 v203, 1.0, v203
    v_mfma_f32_16x16x32_bf16 v[136:139], v[188:191], a[88:91], v[136:139]
    buffer_load_dwordx4 v253, s[44:47], s64 offen offset:1024  lds
    v_exp_f32 v204, v204
    v_mul_f32 v205, v205, v73
    v_mfma_f32_16x16x32_bf16 v[140:143], v[188:191], a[92:95], v[140:143]
    v_fma_f32 v206, -v74, v74, s66
    v_cvt_pk_bf16_f32 v208, v56, v57
    s_waitcnt lgkmcnt(5)
    v_mfma_f32_16x16x32_bf16 v[144:147], v[192:195], a[80:83], v[144:147]
    ds_read_b64_tr_b16 v[184:185], v242 offset:32768
    v_mul_f32 v58, v202, v58
    v_mfma_f32_16x16x32_bf16 v[148:151], v[192:195], a[84:87], v[148:151]
    ds_read_b64_tr_b16 v[186:187], v242 offset:34816
    v_rcp_f32 v203, v203
    v_add_f32 v204, 1.0, v204
    v_mfma_f32_16x16x32_bf16 v[152:155], v[192:195], a[88:91], v[152:155]
    buffer_load_dwordx4 v254, s[44:47], s64 offen offset:2048  lds
    v_exp_f32 v205, v205
    v_mfma_f32_16x16x32_bf16 v[156:159], v[192:195], a[92:95], v[156:159]
    v_mul_f32 v206, v206, v74
    v_fma_f32 v207, -v75, v75, s66
    v_mfma_f32_16x16x32_bf16 v[160:163], v[196:199], a[80:83], v[160:163]
    ds_read_b64_tr_b16 v[188:189], v243 offset:32768
    v_mul_f32 v59, v203, v59
    v_rcp_f32 v204, v204
    v_mfma_f32_16x16x32_bf16 v[164:167], v[196:199], a[84:87], v[164:167]
    ds_read_b64_tr_b16 v[190:191], v243 offset:34816
    v_add_f32 v205, 1.0, v205
    v_mfma_f32_16x16x32_bf16 v[168:171], v[196:199], a[88:91], v[168:171]
    buffer_load_dwordx4 v255, s[44:47], s64 offen offset:3072  lds
    v_exp_f32 v206, v206
    v_mul_f32 v207, v207, v75
    v_mfma_f32_16x16x32_bf16 v[172:175], v[196:199], a[92:95], v[172:175]
    v_fma_f32 v200, -v60, v60, s66
    v_mov_b32 v6, 0
    buffer_load_dword v7, v6, s[60:63], 0 offen sc1
    s_waitcnt lgkmcnt(4)
    v_mfma_f32_16x16x32_bf16 v[112:115], v[176:179], a[96:99], v[112:115]
    s_waitcnt vmcnt(21)
    ds_read_b64_tr_b16 v[192:193], v240 offset:49152
    v_cvt_pk_bf16_f32 v209, v58, v59
    v_mul_f32 v72, v204, v72
    v_mfma_f32_16x16x32_bf16 v[116:119], v[176:179], a[100:103], v[116:119]
    ds_read_b64_tr_b16 v[194:195], v240 offset:51200
    v_rcp_f32 v205, v205
    v_add_f32 v206, 1.0, v206
    v_mfma_f32_16x16x32_bf16 v[120:123], v[176:179], a[104:107], v[120:123]
    s_add_u32 m0, s7, 131072
    s_add_u32 s64, s10, 3834368
    buffer_load_dwordx4 v252, s[44:47], s64 offen offset:0  lds
    v_exp_f32 v207, v207
    v_mfma_f32_16x16x32_bf16 v[124:127], v[176:179], a[108:111], v[124:127]
    buffer_load_dwordx4 v253, s[44:47], s64 offen offset:1024  lds
    v_mul_f32 v200, v200, v60
    v_fma_f32 v201, -v61, v61, s66
    v_mfma_f32_16x16x32_bf16 v[128:131], v[180:183], a[96:99], v[128:131]
    ds_read_b64_tr_b16 v[196:197], v241 offset:49152
    v_mul_f32 v73, v205, v73
    v_mfma_f32_16x16x32_bf16 v[132:135], v[180:183], a[100:103], v[132:135]
    ds_read_b64_tr_b16 v[198:199], v241 offset:51200
    v_rcp_f32 v206, v206
    v_add_f32 v207, 1.0, v207
    v_mfma_f32_16x16x32_bf16 v[136:139], v[180:183], a[104:107], v[136:139]
    buffer_load_dwordx4 v254, s[44:47], s64 offen offset:2048  lds
    v_exp_f32 v200, v200
    v_mul_f32 v201, v201, v61
    v_mfma_f32_16x16x32_bf16 v[140:143], v[180:183], a[108:111], v[140:143]
    v_fma_f32 v202, -v62, v62, s66
    s_waitcnt lgkmcnt(4)
    v_mfma_f32_16x16x32_bf16 v[144:147], v[184:187], a[96:99], v[144:147]
    ds_read_b64_tr_b16 v[176:177], v242 offset:49152
    v_cvt_pk_bf16_f32 v210, v72, v73
    v_mul_f32 v74, v206, v74
    v_mfma_f32_16x16x32_bf16 v[148:151], v[184:187], a[100:103], v[148:151]
    ds_read_b64_tr_b16 v[178:179], v242 offset:51200
    v_rcp_f32 v207, v207
    v_mfma_f32_16x16x32_bf16 v[152:155], v[184:187], a[104:107], v[152:155]
    buffer_load_dwordx4 v255, s[44:47], s64 offen offset:3072  lds
    v_add_f32 v200, 1.0, v200
    v_exp_f32 v201, v201
    v_mfma_f32_16x16x32_bf16 v[156:159], v[184:187], a[108:111], v[156:159]
    v_mul_f32 v202, v202, v62
    v_mfma_f32_16x16x32_bf16 v[160:163], v[188:191], a[96:99], v[160:163]
    ds_read_b64_tr_b16 v[180:181], v243 offset:49152
    v_fma_f32 v203, -v63, v63, s66
    v_mul_f32 v75, v207, v75
    v_mfma_f32_16x16x32_bf16 v[164:167], v[188:191], a[100:103], v[164:167]
    ds_read_b64_tr_b16 v[182:183], v243 offset:51200
    v_rcp_f32 v200, v200
    v_add_f32 v201, 1.0, v201
    v_mfma_f32_16x16x32_bf16 v[168:171], v[188:191], a[104:107], v[168:171]
    s_add_u32 m0, s7, 32768
    s_add_u32 s64, s10, 4129280
    buffer_load_dwordx4 v252, s[44:47], s64 offen offset:0  lds
    v_exp_f32 v202, v202
    v_mfma_f32_16x16x32_bf16 v[172:175], v[188:191], a[108:111], v[172:175]
    v_mul_f32 v203, v203, v63
    v_fma_f32 v204, -v76, v76, s66
    s_waitcnt lgkmcnt(4)
    v_mfma_f32_16x16x32_bf16 v[112:115], v[192:195], a[112:115], v[112:115]
    s_waitcnt vmcnt(22)
    ds_read_b64_tr_b16 v[184:185], v244 offset:0
    v_cvt_pk_bf16_f32 v211, v74, v75
    v_mfma_f32_16x16x32_bf16 v[116:119], v[192:195], a[116:119], v[116:119]
    ds_read_b64_tr_b16 v[186:187], v244 offset:2048
    v_mul_f32 v60, v200, v60
    v_rcp_f32 v201, v201
    v_mfma_f32_16x16x32_bf16 v[120:123], v[192:195], a[120:123], v[120:123]
    buffer_load_dwordx4 v253, s[44:47], s64 offen offset:1024  lds
    v_add_f32 v202, 1.0, v202
    v_exp_f32 v203, v203
    v_mfma_f32_16x16x32_bf16 v[124:127], v[192:195], a[124:127], v[124:127]
    v_mul_f32 v204, v204, v76
    v_mfma_f32_16x16x32_bf16 v[128:131], v[196:199], a[112:115], v[128:131]
    ds_read_b64_tr_b16 v[188:189], v245 offset:0
    v_fma_f32 v205, -v77, v77, s66
    ds_write_b128 v4, v[208:211] offset:2048
    v_mfma_f32_16x16x32_bf16 v[132:135], v[196:199], a[116:119], v[132:135]
    ds_read_b64_tr_b16 v[190:191], v245 offset:2048
    v_mul_f32 v61, v201, v61
    v_mfma_f32_16x16x32_bf16 v[136:139], v[196:199], a[120:123], v[136:139]
    buffer_load_dwordx4 v254, s[44:47], s64 offen offset:2048  lds
    v_rcp_f32 v202, v202
    v_add_f32 v203, 1.0, v203
    v_mfma_f32_16x16x32_bf16 v[140:143], v[196:199], a[124:127], v[140:143]
    v_exp_f32 v204, v204
    v_mul_f32 v205, v205, v77
    s_waitcnt lgkmcnt(5)
    v_mfma_f32_16x16x32_bf16 v[144:147], v[176:179], a[112:115], v[144:147]
    ds_read_b64_tr_b16 v[192:193], v246 offset:0
    v_fma_f32 v206, -v78, v78, s66
    v_mfma_f32_16x16x32_bf16 v[148:151], v[176:179], a[116:119], v[148:151]
    ds_read_b64_tr_b16 v[194:195], v246 offset:2048
    v_cvt_pk_bf16_f32 v212, v60, v61
    v_mul_f32 v62, v202, v62
    v_mfma_f32_16x16x32_bf16 v[152:155], v[176:179], a[120:123], v[152:155]
    buffer_load_dwordx4 v255, s[44:47], s64 offen offset:3072  lds
    v_rcp_f32 v203, v203
    v_mfma_f32_16x16x32_bf16 v[156:159], v[176:179], a[124:127], v[156:159]
    s_add_u32 m0, s7, 49152
    s_add_u32 s64, s10, 4424192
    buffer_load_dwordx4 v252, s[44:47], s64 offen offset:0  lds
    v_add_f32 v204, 1.0, v204
    v_exp_f32 v205, v205
    v_mfma_f32_16x16x32_bf16 v[160:163], v[180:183], a[112:115], v[160:163]
    ds_read_b64_tr_b16 v[196:197], v247 offset:0
    v_mul_f32 v206, v206, v78
    v_fma_f32 v207, -v79, v79, s66
    v_mfma_f32_16x16x32_bf16 v[164:167], v[180:183], a[116:119], v[164:167]
    ds_read_b64_tr_b16 v[198:199], v247 offset:2048
    v_mul_f32 v63, v203, v63
    v_mfma_f32_16x16x32_bf16 v[168:171], v[180:183], a[120:123], v[168:171]
    buffer_load_dwordx4 v253, s[44:47], s64 offen offset:1024  lds
    v_rcp_f32 v204, v204
    v_add_f32 v205, 1.0, v205
    v_mfma_f32_16x16x32_bf16 v[172:175], v[180:183], a[124:127], v[172:175]
    v_exp_f32 v206, v206
    s_waitcnt lgkmcnt(4)
    v_mfma_f32_16x16x32_bf16 v[112:115], v[184:187], a[128:131], v[112:115]
    s_waitcnt vmcnt(23)
    ds_read_b64_tr_b16 v[176:177], v248 offset:16384
    v_mul_f32 v207, v207, v79
    v_fma_f32 v200, -v80, v80, s66
    v_mfma_f32_16x16x32_bf16 v[116:119], v[184:187], a[132:135], v[116:119]
    ds_read_b64_tr_b16 v[178:179], v248 offset:18432
    v_cvt_pk_bf16_f32 v213, v62, v63
    v_mul_f32 v76, v204, v76
    v_mfma_f32_16x16x32_bf16 v[120:123], v[184:187], a[136:139], v[120:123]
    buffer_load_dwordx4 v254, s[44:47], s64 offen offset:2048  lds
    v_rcp_f32 v205, v205
    v_mfma_f32_16x16x32_bf16 v[124:127], v[184:187], a[140:143], v[124:127]
    v_add_f32 v206, 1.0, v206
    v_exp_f32 v207, v207
    v_mfma_f32_16x16x32_bf16 v[128:131], v[188:191], a[128:131], v[128:131]
    ds_read_b64_tr_b16 v[180:181], v249 offset:16384
    v_mul_f32 v200, v200, v80
    v_mfma_f32_16x16x32_bf16 v[132:135], v[188:191], a[132:135], v[132:135]
    ds_read_b64_tr_b16 v[182:183], v249 offset:18432
    v_fma_f32 v201, -v81, v81, s66
    v_mul_f32 v77, v205, v77
    v_mfma_f32_16x16x32_bf16 v[136:139], v[188:191], a[136:139], v[136:139]
    buffer_load_dwordx4 v255, s[44:47], s64 offen offset:3072  lds
    v_rcp_f32 v206, v206
    v_mfma_f32_16x16x32_bf16 v[140:143], v[188:191], a[140:143], v[140:143]
    v_add_f32 v207, 1.0, v207
    v_exp_f32 v200, v200
    s_waitcnt lgkmcnt(4)
    v_mfma_f32_16x16x32_bf16 v[144:147], v[192:195], a[128:131], v[144:147]
    ds_read_b64_tr_b16 v[184:185], v250 offset:16384
    v_mul_f32 v201, v201, v81
    v_fma_f32 v202, -v82, v82, s66
    v_mfma_f32_16x16x32_bf16 v[148:151], v[192:195], a[132:135], v[148:151]
    ds_read_b64_tr_b16 v[186:187], v250 offset:18432
    v_cvt_pk_bf16_f32 v214, v76, v77
    v_mfma_f32_16x16x32_bf16 v[152:155], v[192:195], a[136:139], v[152:155]
    s_add_u32 m0, s7, 65536
    s_add_u32 s64, s10, 4719104
    buffer_load_dwordx4 v252, s[44:47], s64 offen offset:0  lds
    v_mul_f32 v78, v206, v78
    v_rcp_f32 v207, v207
    v_mfma_f32_16x16x32_bf16 v[156:159], v[192:195], a[140:143], v[156:159]
    v_add_f32 v200, 1.0, v200
    v_mfma_f32_16x16x32_bf16 v[160:163], v[196:199], a[128:131], v[160:163]
    ds_read_b64_tr_b16 v[188:189], v251 offset:16384
    v_exp_f32 v201, v201
    v_mul_f32 v202, v202, v82
    v_mfma_f32_16x16x32_bf16 v[164:167], v[196:199], a[132:135], v[164:167]
    ds_read_b64_tr_b16 v[190:191], v251 offset:18432
    v_fma_f32 v203, -v83, v83, s66
    v_mul_f32 v79, v207, v79
    v_mfma_f32_16x16x32_bf16 v[168:171], v[196:199], a[136:139], v[168:171]
    buffer_load_dwordx4 v253, s[44:47], s64 offen offset:1024  lds
    v_rcp_f32 v200, v200
    v_mfma_f32_16x16x32_bf16 v[172:175], v[196:199], a[140:143], v[172:175]
    v_add_f32 v201, 1.0, v201
    v_exp_f32 v202, v202
    s_waitcnt lgkmcnt(4)
    v_mfma_f32_16x16x32_bf16 v[112:115], v[176:179], a[144:147], v[112:115]
    s_waitcnt vmcnt(23)
    ds_read_b64_tr_b16 v[192:193], v244 offset:16384
    v_mul_f32 v203, v203, v83
    v_mfma_f32_16x16x32_bf16 v[116:119], v[176:179], a[148:151], v[116:119]
    ds_read_b64_tr_b16 v[194:195], v244 offset:18432
    v_fma_f32 v204, -v96, v96, s66
    v_cvt_pk_bf16_f32 v215, v78, v79
    v_mfma_f32_16x16x32_bf16 v[120:123], v[176:179], a[152:155], v[120:123]
    buffer_load_dwordx4 v254, s[44:47], s64 offen offset:2048  lds
    v_mul_f32 v80, v200, v80
    v_rcp_f32 v201, v201
    v_mfma_f32_16x16x32_bf16 v[124:127], v[176:179], a[156:159], v[124:127]
    buffer_load_dwordx4 v255, s[44:47], s64 offen offset:3072  lds
    v_add_f32 v202, 1.0, v202
    v_mfma_f32_16x16x32_bf16 v[128:131], v[180:183], a[144:147], v[128:131]
    ds_read_b64_tr_b16 v[196:197], v245 offset:16384
    v_exp_f32 v203, v203
    v_mul_f32 v204, v204, v96
    v_mfma_f32_16x16x32_bf16 v[132:135], v[180:183], a[148:151], v[132:135]
    ds_read_b64_tr_b16 v[198:199], v245 offset:18432
    v_fma_f32 v205, -v97, v97, s66
    v_mfma_f32_16x16x32_bf16 v[136:139], v[180:183], a[152:155], v[136:139]
    ds_write_b128 v4, v[212:215] offset:3072
    v_mul_f32 v81, v201, v81
    v_mfma_f32_16x16x32_bf16 v[140:143], v[180:183], a[156:159], v[140:143]
    v_rcp_f32 v202, v202
    v_add_f32 v203, 1.0, v203
    s_waitcnt lgkmcnt(5)
    v_mfma_f32_16x16x32_bf16 v[144:147], v[184:187], a[144:147], v[144:147]
    ds_read_b64_tr_b16 v[176:177], v246 offset:16384
    v_exp_f32 v204, v204
    v_mfma_f32_16x16x32_bf16 v[148:151], v[184:187], a[148:151], v[148:151]
    ds_read_b64_tr_b16 v[178:179], v246 offset:18432
    v_mul_f32 v205, v205, v97
    v_fma_f32 v206, -v98, v98, s66
    v_mfma_f32_16x16x32_bf16 v[152:155], v[184:187], a[152:155], v[152:155]
    s_add_u32 m0, s7, 147456
    s_add_u32 s64, s10, 5014016
    buffer_load_dwordx4 v252, s[44:47], s64 offen offset:0  lds
    v_cvt_pk_bf16_f32 v208, v80, v81
    v_mfma_f32_16x16x32_bf16 v[156:159], v[184:187], a[156:159], v[156:159]
    v_mul_f32 v82, v202, v82
    v_rcp_f32 v203, v203
    v_mfma_f32_16x16x32_bf16 v[160:163], v[188:191], a[144:147], v[160:163]
    ds_read_b64_tr_b16 v[180:181], v247 offset:16384
    v_add_f32 v204, 1.0, v204
    v_exp_f32 v205, v205
    v_mfma_f32_16x16x32_bf16 v[164:167], v[188:191], a[148:151], v[164:167]
    ds_read_b64_tr_b16 v[182:183], v247 offset:18432
    v_mul_f32 v206, v206, v98
    v_mfma_f32_16x16x32_bf16 v[168:171], v[188:191], a[152:155], v[168:171]
    buffer_load_dwordx4 v253, s[44:47], s64 offen offset:1024  lds
    v_fma_f32 v207, -v99, v99, s66
    v_mul_f32 v83, v203, v83
    v_mfma_f32_16x16x32_bf16 v[172:175], v[188:191], a[156:159], v[172:175]
    v_rcp_f32 v204, v204
    s_waitcnt lgkmcnt(5)
    v_mfma_f32_16x16x32_bf16 v[112:115], v[192:195], a[160:163], v[112:115]
    s_waitcnt vmcnt(23)
    ds_read_b64_tr_b16 v[184:185], v244 offset:32768
    v_add_f32 v205, 1.0, v205
    v_exp_f32 v206, v206
    v_mfma_f32_16x16x32_bf16 v[116:119], v[192:195], a[164:167], v[116:119]
    ds_read_b64_tr_b16 v[186:187], v244 offset:34816
    v_mul_f32 v207, v207, v99
    v_mfma_f32_16x16x32_bf16 v[120:123], v[192:195], a[168:171], v[120:123]
    buffer_load_dwordx4 v254, s[44:47], s64 offen offset:2048  lds
    v_fma_f32 v200, -v84, v84, s66
    v_cvt_pk_bf16_f32 v209, v82, v83
    v_mfma_f32_16x16x32_bf16 v[124:127], v[192:195], a[172:175], v[124:127]
    v_mul_f32 v96, v204, v96
    v_rcp_f32 v205, v205
    v_mfma_f32_16x16x32_bf16 v[128:131], v[196:199], a[160:163], v[128:131]
    ds_read_b64_tr_b16 v[188:189], v245 offset:32768
    v_add_f32 v206, 1.0, v206
    v_mfma_f32_16x16x32_bf16 v[132:135], v[196:199], a[164:167], v[132:135]
    ds_read_b64_tr_b16 v[190:191], v245 offset:34816
    v_exp_f32 v207, v207
    v_mul_f32 v200, v200, v84
    v_mfma_f32_16x16x32_bf16 v[136:139], v[196:199], a[168:171], v[136:139]
    buffer_load_dwordx4 v255, s[44:47], s64 offen offset:3072  lds
    v_fma_f32 v201, -v85, v85, s66
    v_mfma_f32_16x16x32_bf16 v[140:143], v[196:199], a[172:175], v[140:143]
    v_mul_f32 v97, v205, v97
    v_rcp_f32 v206, v206
    s_waitcnt lgkmcnt(4)
    v_mfma_f32_16x16x32_bf16 v[144:147], v[176:179], a[160:163], v[144:147]
    ds_read_b64_tr_b16 v[192:193], v246 offset:32768
    v_add_f32 v207, 1.0, v207
    v_exp_f32 v200, v200
    v_mfma_f32_16x16x32_bf16 v[148:151], v[176:179], a[164:167], v[148:151]
    ds_read_b64_tr_b16 v[194:195], v246 offset:34816
    v_mul_f32 v201, v201, v85
    v_mfma_f32_16x16x32_bf16 v[152:155], v[176:179], a[168:171], v[152:155]
    s_add_u32 m0, s7, 81920
    s_add_u32 s64, s10, 1024
    buffer_load_dwordx4 v252, s[44:47], s64 offen offset:0  lds
    v_fma_f32 v202, -v86, v86, s66
    v_cvt_pk_bf16_f32 v210, v96, v97
    v_mfma_f32_16x16x32_bf16 v[156:159], v[176:179], a[172:175], v[156:159]
    buffer_load_dwordx4 v253, s[44:47], s64 offen offset:1024  lds
    v_mul_f32 v98, v206, v98
    v_mfma_f32_16x16x32_bf16 v[160:163], v[180:183], a[160:163], v[160:163]
    ds_read_b64_tr_b16 v[196:197], v247 offset:32768
    v_rcp_f32 v207, v207
    v_add_f32 v200, 1.0, v200
    v_mfma_f32_16x16x32_bf16 v[164:167], v[180:183], a[164:167], v[164:167]
    ds_read_b64_tr_b16 v[198:199], v247 offset:34816
    v_exp_f32 v201, v201
    v_mul_f32 v202, v202, v86
    v_mfma_f32_16x16x32_bf16 v[168:171], v[180:183], a[168:171], v[168:171]
    buffer_load_dwordx4 v254, s[44:47], s64 offen offset:2048  lds
    v_fma_f32 v203, -v87, v87, s66
    v_mfma_f32_16x16x32_bf16 v[172:175], v[180:183], a[172:175], v[172:175]
    v_mul_f32 v99, v207, v99
    v_rcp_f32 v200, v200
    s_waitcnt lgkmcnt(4)
    v_mfma_f32_16x16x32_bf16 v[112:115], v[184:187], a[176:179], v[112:115]
    s_waitcnt vmcnt(24)
    ds_read_b64_tr_b16 v[176:177], v244 offset:49152
    v_add_f32 v201, 1.0, v201
    v_mfma_f32_16x16x32_bf16 v[116:119], v[184:187], a[180:183], v[116:119]
    ds_read_b64_tr_b16 v[178:179], v244 offset:51200
    v_exp_f32 v202, v202
    v_mul_f32 v203, v203, v87
    v_mfma_f32_16x16x32_bf16 v[120:123], v[184:187], a[184:187], v[120:123]
    buffer_load_dwordx4 v255, s[44:47], s64 offen offset:3072  lds
    v_fma_f32 v204, -v100, v100, s66
    v_cvt_pk_bf16_f32 v211, v98, v99
    v_mfma_f32_16x16x32_bf16 v[124:127], v[184:187], a[188:191], v[124:127]
    v_mul_f32 v84, v200, v84
    v_mfma_f32_16x16x32_bf16 v[128:131], v[188:191], a[176:179], v[128:131]
    ds_read_b64_tr_b16 v[180:181], v245 offset:49152
    v_rcp_f32 v201, v201
    v_add_f32 v202, 1.0, v202
    v_mfma_f32_16x16x32_bf16 v[132:135], v[188:191], a[180:183], v[132:135]
    ds_read_b64_tr_b16 v[182:183], v245 offset:51200
    v_exp_f32 v203, v203
    v_mfma_f32_16x16x32_bf16 v[136:139], v[188:191], a[184:187], v[136:139]
    v_mul_f32 v204, v204, v100
    v_fma_f32 v205, -v101, v101, s66
    v_mfma_f32_16x16x32_bf16 v[140:143], v[188:191], a[188:191], v[140:143]
    ds_write_b128 v4, v[208:211] offset:16384
    v_mul_f32 v85, v201, v85
    s_waitcnt lgkmcnt(5)
    v_mfma_f32_16x16x32_bf16 v[144:147], v[192:195], a[176:179], v[144:147]
    ds_read_b64_tr_b16 v[184:185], v246 offset:49152
    v_rcp_f32 v202, v202
    v_mfma_f32_16x16x32_bf16 v[148:151], v[192:195], a[180:183], v[148:151]
    ds_read_b64_tr_b16 v[186:187], v246 offset:51200
    v_add_f32 v203, 1.0, v203
    v_exp_f32 v204, v204
    v_mfma_f32_16x16x32_bf16 v[152:155], v[192:195], a[184:187], v[152:155]
    s_add_u32 m0, s7, 98304
    s_add_u32 s64, s10, 295936
    buffer_load_dwordx4 v252, s[44:47], s64 offen offset:0  lds
    v_mul_f32 v205, v205, v101
    v_mfma_f32_16x16x32_bf16 v[156:159], v[192:195], a[188:191], v[156:159]
    v_fma_f32 v206, -v102, v102, s66
    v_cvt_pk_bf16_f32 v212, v84, v85
    v_mfma_f32_16x16x32_bf16 v[160:163], v[196:199], a[176:179], v[160:163]
    ds_read_b64_tr_b16 v[188:189], v247 offset:49152
    v_mul_f32 v86, v202, v86
    v_mfma_f32_16x16x32_bf16 v[164:167], v[196:199], a[180:183], v[164:167]
    ds_read_b64_tr_b16 v[190:191], v247 offset:51200
    v_rcp_f32 v203, v203
    v_add_f32 v204, 1.0, v204
    v_mfma_f32_16x16x32_bf16 v[168:171], v[196:199], a[184:187], v[168:171]
    buffer_load_dwordx4 v253, s[44:47], s64 offen offset:1024  lds
    v_exp_f32 v205, v205
    v_mul_f32 v206, v206, v102
    v_mfma_f32_16x16x32_bf16 v[172:175], v[196:199], a[188:191], v[172:175]
    v_fma_f32 v207, -v103, v103, s66
    s_add_u32 s71, s10, 1024
    v_lshrrev_b32 v222, 4, v1
    v_lshlrev_b32 v222, 3, v222
    buffer_load_dwordx2 v[216:217], v222, s[56:59], s71 offen offset:0
    buffer_load_dwordx2 v[218:219], v222, s[56:59], s71 offen offset:32
    buffer_load_dwordx2 v[220:221], v222, s[56:59], s71 offen offset:64
    buffer_load_dwordx2 v[222:223], v222, s[56:59], s71 offen offset:96
    s_waitcnt lgkmcnt(5)
    v_mfma_f32_16x16x32_bf16 v[112:115], v[176:179], a[192:195], v[112:115]
    s_waitcnt vmcnt(26)
    ds_read_b64_tr_b16 v[192:193], v248 offset:0
    v_mul_f32 v87, v203, v87
    v_rcp_f32 v204, v204
    v_mfma_f32_16x16x32_bf16 v[116:119], v[176:179], a[196:199], v[116:119]
    ds_read_b64_tr_b16 v[194:195], v248 offset:2048
    v_add_f32 v205, 1.0, v205
    v_mfma_f32_16x16x32_bf16 v[120:123], v[176:179], a[200:203], v[120:123]
    buffer_load_dwordx4 v254, s[44:47], s64 offen offset:2048  lds
    v_exp_f32 v206, v206
    v_mul_f32 v207, v207, v103
    v_mfma_f32_16x16x32_bf16 v[124:127], v[176:179], a[204:207], v[124:127]
    buffer_load_dwordx4 v255, s[44:47], s64 offen offset:3072  lds
    v_fma_f32 v200, -v88, v88, s66
    v_cvt_pk_bf16_f32 v213, v86, v87
    v_mfma_f32_16x16x32_bf16 v[128:131], v[180:183], a[192:195], v[128:131]
    ds_read_b64_tr_b16 v[196:197], v249 offset:0
    v_mul_f32 v100, v204, v100
    v_mfma_f32_16x16x32_bf16 v[132:135], v[180:183], a[196:199], v[132:135]
    ds_read_b64_tr_b16 v[198:199], v249 offset:2048
    v_rcp_f32 v205, v205
    v_add_f32 v206, 1.0, v206
    v_mfma_f32_16x16x32_bf16 v[136:139], v[180:183], a[200:203], v[136:139]
    v_exp_f32 v207, v207
    v_mfma_f32_16x16x32_bf16 v[140:143], v[180:183], a[204:207], v[140:143]
    v_mul_f32 v200, v200, v88
    v_fma_f32 v201, -v89, v89, s66
    s_waitcnt lgkmcnt(4)
    v_mfma_f32_16x16x32_bf16 v[144:147], v[184:187], a[192:195], v[144:147]
    ds_read_b64_tr_b16 v[176:177], v250 offset:0
    v_mul_f32 v101, v205, v101
    v_rcp_f32 v206, v206
    v_mfma_f32_16x16x32_bf16 v[148:151], v[184:187], a[196:199], v[148:151]
    ds_read_b64_tr_b16 v[178:179], v250 offset:2048
    v_add_f32 v207, 1.0, v207
    v_mfma_f32_16x16x32_bf16 v[152:155], v[184:187], a[200:203], v[152:155]
    s_add_u32 m0, s7, 114688
    s_add_u32 s64, s10, 590848
    buffer_load_dwordx4 v252, s[44:47], s64 offen offset:0  lds
    v_exp_f32 v200, v200
    v_mul_f32 v201, v201, v89
    v_mfma_f32_16x16x32_bf16 v[156:159], v[184:187], a[204:207], v[156:159]
    v_fma_f32 v202, -v90, v90, s66
    v_mfma_f32_16x16x32_bf16 v[160:163], v[188:191], a[192:195], v[160:163]
    ds_read_b64_tr_b16 v[180:181], v251 offset:0
    v_cvt_pk_bf16_f32 v214, v100, v101
    v_mul_f32 v102, v206, v102
    v_mfma_f32_16x16x32_bf16 v[164:167], v[188:191], a[196:199], v[164:167]
    ds_read_b64_tr_b16 v[182:183], v251 offset:2048
    v_rcp_f32 v207, v207
    v_add_f32 v200, 1.0, v200
    v_mfma_f32_16x16x32_bf16 v[168:171], v[188:191], a[200:203], v[168:171]
    buffer_load_dwordx4 v253, s[44:47], s64 offen offset:1024  lds
    v_exp_f32 v201, v201
    v_mfma_f32_16x16x32_bf16 v[172:175], v[188:191], a[204:207], v[172:175]
    v_mul_f32 v202, v202, v90
    v_fma_f32 v203, -v91, v91, s66
    s_waitcnt lgkmcnt(4)
    v_mfma_f32_16x16x32_bf16 v[112:115], v[192:195], a[208:211], v[112:115]
    s_waitcnt vmcnt(26)
    ds_read_b64_tr_b16 v[184:185], v240 offset:32768
    v_mul_f32 v103, v207, v103
    v_mfma_f32_16x16x32_bf16 v[116:119], v[192:195], a[212:215], v[116:119]
    ds_read_b64_tr_b16 v[186:187], v240 offset:34816
    v_rcp_f32 v200, v200
    v_add_f32 v201, 1.0, v201
    v_mfma_f32_16x16x32_bf16 v[120:123], v[192:195], a[216:219], v[120:123]
    buffer_load_dwordx4 v254, s[44:47], s64 offen offset:2048  lds
    v_exp_f32 v202, v202
    v_mul_f32 v203, v203, v91
    v_mfma_f32_16x16x32_bf16 v[124:127], v[192:195], a[220:223], v[124:127]
    v_fma_f32 v204, -v104, v104, s66
    v_mfma_f32_16x16x32_bf16 v[128:131], v[196:199], a[208:211], v[128:131]
    ds_read_b64_tr_b16 v[188:189], v241 offset:32768
    v_cvt_pk_bf16_f32 v215, v102, v103
    v_mul_f32 v88, v200, v88
    v_mfma_f32_16x16x32_bf16 v[132:135], v[196:199], a[212:215], v[132:135]
    ds_read_b64_tr_b16 v[190:191], v241 offset:34816
    v_rcp_f32 v201, v201
    v_mfma_f32_16x16x32_bf16 v[136:139], v[196:199], a[216:219], v[136:139]
    buffer_load_dwordx4 v255, s[44:47], s64 offen offset:3072  lds
    v_add_f32 v202, 1.0, v202
    v_exp_f32 v203, v203
    v_mfma_f32_16x16x32_bf16 v[140:143], v[196:199], a[220:223], v[140:143]
    v_mul_f32 v204, v204, v104
    s_waitcnt lgkmcnt(4)
    v_mfma_f32_16x16x32_bf16 v[144:147], v[176:179], a[208:211], v[144:147]
    ds_read_b64_tr_b16 v[192:193], v242 offset:32768
    v_fma_f32 v205, -v105, v105, s66
    ds_write_b128 v4, v[212:215] offset:17408
    v_mfma_f32_16x16x32_bf16 v[148:151], v[176:179], a[212:215], v[148:151]
    ds_read_b64_tr_b16 v[194:195], v242 offset:34816
    v_mul_f32 v89, v201, v89
    v_rcp_f32 v202, v202
    v_mfma_f32_16x16x32_bf16 v[152:155], v[176:179], a[216:219], v[152:155]
    s_add_u32 m0, s7, 131072
    s_add_u32 s64, s10, 885760
    buffer_load_dwordx4 v252, s[44:47], s64 offen offset:0  lds
    v_add_f32 v203, 1.0, v203
    v_mfma_f32_16x16x32_bf16 v[156:159], v[176:179], a[220:223], v[156:159]
    buffer_load_dwordx4 v253, s[44:47], s64 offen offset:1024  lds
    v_exp_f32 v204, v204
    v_mul_f32 v205, v205, v105
    v_mfma_f32_16x16x32_bf16 v[160:163], v[180:183], a[208:211], v[160:163]
    ds_read_b64_tr_b16 v[196:197], v243 offset:32768
    v_fma_f32 v206, -v106, v106, s66
    v_mfma_f32_16x16x32_bf16 v[164:167], v[180:183], a[212:215], v[164:167]
    ds_read_b64_tr_b16 v[198:199], v243 offset:34816
    v_cvt_pk_bf16_f32 v208, v88, v89
    v_mul_f32 v90, v202, v90
    v_mfma_f32_16x16x32_bf16 v[168:171], v[180:183], a[216:219], v[168:171]
    buffer_load_dwordx4 v254, s[44:47], s64 offen offset:2048  lds
    v_rcp_f32 v203, v203
    v_add_f32 v204, 1.0, v204
    v_mfma_f32_16x16x32_bf16 v[172:175], v[180:183], a[220:223], v[172:175]
    v_exp_f32 v205, v205
    s_waitcnt lgkmcnt(5)
    v_mfma_f32_16x16x32_bf16 v[112:115], v[184:187], a[224:227], v[112:115]
    s_waitcnt vmcnt(27)
    ds_read_b64_tr_b16 v[176:177], v240 offset:49152
    v_mul_f32 v206, v206, v106
    v_fma_f32 v207, -v107, v107, s66
    v_mfma_f32_16x16x32_bf16 v[116:119], v[184:187], a[228:231], v[116:119]
    ds_read_b64_tr_b16 v[178:179], v240 offset:51200
    v_mul_f32 v91, v203, v91
    v_mfma_f32_16x16x32_bf16 v[120:123], v[184:187], a[232:235], v[120:123]
    buffer_load_dwordx4 v255, s[44:47], s64 offen offset:3072  lds
    v_rcp_f32 v204, v204
    v_add_f32 v205, 1.0, v205
    v_mfma_f32_16x16x32_bf16 v[124:127], v[184:187], a[236:239], v[124:127]
    v_exp_f32 v206, v206
    v_mul_f32 v207, v207, v107
    v_mfma_f32_16x16x32_bf16 v[128:131], v[188:191], a[224:227], v[128:131]
    ds_read_b64_tr_b16 v[180:181], v241 offset:49152
    v_fma_f32 v200, -v92, v92, s66
    v_mfma_f32_16x16x32_bf16 v[132:135], v[188:191], a[228:231], v[132:135]
    ds_read_b64_tr_b16 v[182:183], v241 offset:51200
    v_cvt_pk_bf16_f32 v209, v90, v91
    v_mul_f32 v104, v204, v104
    v_mfma_f32_16x16x32_bf16 v[136:139], v[188:191], a[232:235], v[136:139]
    v_rcp_f32 v205, v205
    v_mfma_f32_16x16x32_bf16 v[140:143], v[188:191], a[236:239], v[140:143]
    v_add_f32 v206, 1.0, v206
    v_exp_f32 v207, v207
    s_waitcnt lgkmcnt(4)
    v_mfma_f32_16x16x32_bf16 v[144:147], v[192:195], a[224:227], v[144:147]
    ds_read_b64_tr_b16 v[184:185], v242 offset:49152
    v_mul_f32 v200, v200, v92
    v_fma_f32 v201, -v93, v93, s66
    v_mfma_f32_16x16x32_bf16 v[148:151], v[192:195], a[228:231], v[148:151]
    ds_read_b64_tr_b16 v[186:187], v242 offset:51200
    v_mul_f32 v105, v205, v105
    v_mfma_f32_16x16x32_bf16 v[152:155], v[192:195], a[232:235], v[152:155]
    v_rcp_f32 v206, v206
    v_add_f32 v207, 1.0, v207
    v_mfma_f32_16x16x32_bf16 v[156:159], v[192:195], a[236:239], v[156:159]
    v_exp_f32 v200, v200
    v_mfma_f32_16x16x32_bf16 v[160:163], v[196:199], a[224:227], v[160:163]
    ds_read_b64_tr_b16 v[188:189], v243 offset:49152
    v_mul_f32 v201, v201, v93
    v_fma_f32 v202, -v94, v94, s66
    v_mfma_f32_16x16x32_bf16 v[164:167], v[196:199], a[228:231], v[164:167]
    ds_read_b64_tr_b16 v[190:191], v243 offset:51200
    v_cvt_pk_bf16_f32 v210, v104, v105
    v_mul_f32 v106, v206, v106
    v_mfma_f32_16x16x32_bf16 v[168:171], v[196:199], a[232:235], v[168:171]
    v_rcp_f32 v207, v207
    v_mfma_f32_16x16x32_bf16 v[172:175], v[196:199], a[236:239], v[172:175]
    v_add_f32 v200, 1.0, v200
    v_exp_f32 v201, v201
    s_waitcnt lgkmcnt(4)
    v_mfma_f32_16x16x32_bf16 v[112:115], v[176:179], a[240:243], v[112:115]
    s_waitcnt vmcnt(24)
    ds_read_b64_tr_b16 v[192:193], v244 offset:0
    v_mul_f32 v202, v202, v94
    v_mfma_f32_16x16x32_bf16 v[116:119], v[176:179], a[244:247], v[116:119]
    ds_read_b64_tr_b16 v[194:195], v244 offset:2048
    v_fma_f32 v203, -v95, v95, s66
    v_mul_f32 v107, v207, v107
    v_mfma_f32_16x16x32_bf16 v[120:123], v[176:179], a[248:251], v[120:123]
    v_rcp_f32 v200, v200
    v_mfma_f32_16x16x32_bf16 v[124:127], v[176:179], a[252:255], v[124:127]
    v_add_f32 v201, 1.0, v201
    v_exp_f32 v202, v202
    v_mfma_f32_16x16x32_bf16 v[128:131], v[180:183], a[240:243], v[128:131]
    ds_read_b64_tr_b16 v[196:197], v245 offset:0
    v_mul_f32 v203, v203, v95
    v_fma_f32 v204, -v108, v108, s66
    v_mfma_f32_16x16x32_bf16 v[132:135], v[180:183], a[244:247], v[132:135]
    ds_read_b64_tr_b16 v[198:199], v245 offset:2048
    v_cvt_pk_bf16_f32 v211, v106, v107
    v_mfma_f32_16x16x32_bf16 v[136:139], v[180:183], a[248:251], v[136:139]
    v_mul_f32 v92, v200, v92
    v_rcp_f32 v201, v201
    v_mfma_f32_16x16x32_bf16 v[140:143], v[180:183], a[252:255], v[140:143]
    v_add_f32 v202, 1.0, v202
    s_waitcnt lgkmcnt(4)
    v_mfma_f32_16x16x32_bf16 v[144:147], v[184:187], a[240:243], v[144:147]
    ds_read_b64_tr_b16 v[176:177], v246 offset:0
    v_exp_f32 v203, v203
    v_mul_f32 v204, v204, v108
    v_mfma_f32_16x16x32_bf16 v[148:151], v[184:187], a[244:247], v[148:151]
    ds_read_b64_tr_b16 v[178:179], v246 offset:2048
    v_fma_f32 v205, -v109, v109, s66
    ds_write_b128 v4, v[208:211] offset:18432
    v_mfma_f32_16x16x32_bf16 v[152:155], v[184:187], a[248:251], v[152:155]
    s_add_u32 m0, s7, 49152
    s_add_u32 s64, s10, 1180672
    buffer_load_dwordx4 v252, s[44:47], s64 offen offset:0  lds
    v_mul_f32 v93, v201, v93
    v_mfma_f32_16x16x32_bf16 v[156:159], v[184:187], a[252:255], v[156:159]
    v_rcp_f32 v202, v202
    v_add_f32 v203, 1.0, v203
    v_mfma_f32_16x16x32_bf16 v[160:163], v[188:191], a[240:243], v[160:163]
    ds_read_b64_tr_b16 v[180:181], v247 offset:0
    v_exp_f32 v204, v204
    v_mfma_f32_16x16x32_bf16 v[164:167], v[188:191], a[244:247], v[164:167]
    ds_read_b64_tr_b16 v[182:183], v247 offset:2048
    v_mul_f32 v205, v205, v109
    v_fma_f32 v206, -v110, v110, s66
    v_mfma_f32_16x16x32_bf16 v[168:171], v[188:191], a[248:251], v[168:171]
    buffer_load_dwordx4 v253, s[44:47], s64 offen offset:1024  lds
    v_cvt_pk_bf16_f32 v212, v92, v93
    v_mul_f32 v94, v202, v94
    v_mfma_f32_16x16x32_bf16 v[172:175], v[188:191], a[252:255], v[172:175]
    v_rcp_f32 v203, v203
    s_mov_b32 s71, 0
L_epc_m:
    v_readfirstlane_b32 s86, v7
    s_add_u32 s71, s71, 1
    s_nop 1
    s_cmp_lg_u32 s86, 0
    s_cbranch_scc1 L_epc_m_ok
    s_sleep 8
    buffer_load_dword v7, v6, s[60:63], 0 offen sc1
    s_waitcnt vmcnt(0)
    s_cmp_lt_u32 s71, 0x20000
    s_cbranch_scc1 L_epc_m
L_epc_m_ok:
    s_waitcnt lgkmcnt(5)
    v_mfma_f32_16x16x32_bf16 v[112:115], v[192:195], v[16:19], v[112:115]
    s_waitcnt vmcnt(22)
    ds_read_b64_tr_b16 v[184:185], v248 offset:16384
    v_add_f32 v204, 1.0, v204
    v_exp_f32 v205, v205
    v_mfma_f32_16x16x32_bf16 v[116:119], v[192:195], v[20:23], v[116:119]
    ds_read_b64_tr_b16 v[186:187], v248 offset:18432
    v_mul_f32 v206, v206, v110
    v_fma_f32 v207, -v111, v111, s66
    v_mfma_f32_16x16x32_bf16 v[120:123], v[192:195], v[24:27], v[120:123]
    buffer_load_dwordx4 v254, s[44:47], s64 offen offset:2048  lds
    v_mul_f32 v95, v203, v95
    v_rcp_f32 v204, v204
    v_mfma_f32_16x16x32_bf16 v[124:127], v[192:195], v[28:31], v[124:127]
    v_add_f32 v205, 1.0, v205
    v_exp_f32 v206, v206
    v_mfma_f32_16x16x32_bf16 v[128:131], v[196:199], v[16:19], v[128:131]
    ds_read_b64_tr_b16 v[188:189], v249 offset:16384
    v_mul_f32 v207, v207, v111
    v_cvt_pk_bf16_f32 v213, v94, v95
    v_mfma_f32_16x16x32_bf16 v[132:135], v[196:199], v[20:23], v[132:135]
    ds_read_b64_tr_b16 v[190:191], v249 offset:18432
    v_mul_f32 v108, v204, v108
    v_rcp_f32 v205, v205
    v_mfma_f32_16x16x32_bf16 v[136:139], v[196:199], v[24:27], v[136:139]
    buffer_load_dwordx4 v255, s[44:47], s64 offen offset:3072  lds
    v_add_f32 v206, 1.0, v206
    v_exp_f32 v207, v207
    v_mfma_f32_16x16x32_bf16 v[140:143], v[196:199], v[28:31], v[140:143]
    v_mul_f32 v109, v205, v109
    v_rcp_f32 v206, v206
    s_waitcnt lgkmcnt(4)
    v_mfma_f32_16x16x32_bf16 v[144:147], v[176:179], v[16:19], v[144:147]
    ds_read_b64_tr_b16 v[192:193], v250 offset:16384
    v_add_f32 v207, 1.0, v207
    v_cvt_pk_bf16_f32 v214, v108, v109
    v_mfma_f32_16x16x32_bf16 v[148:151], v[176:179], v[20:23], v[148:151]
    ds_read_b64_tr_b16 v[194:195], v250 offset:18432
    v_mul_f32 v110, v206, v110
    v_rcp_f32 v207, v207
    v_mfma_f32_16x16x32_bf16 v[152:155], v[176:179], v[24:27], v[152:155]
    s_add_u32 m0, s7, 65536
    s_add_u32 s64, s10, 1475584
    buffer_load_dwordx4 v252, s[44:47], s64 offen offset:0  lds
    v_mul_f32 v111, v207, v111
    v_cvt_pk_bf16_f32 v215, v110, v111
    v_mfma_f32_16x16x32_bf16 v[156:159], v[176:179], v[28:31], v[156:159]
    buffer_load_dwordx4 v253, s[44:47], s64 offen offset:1024  lds
    ds_write_b128 v4, v[212:215] offset:19456
    s_waitcnt vmcnt(16)
    v_mfma_f32_16x16x32_bf16 v[160:163], v[180:183], v[16:19], v[160:163]
    ds_read_b64_tr_b16 v[196:197], v251 offset:16384
    v_lshlrev_b32 v224, 16, v216
    v_and_b32 v225, s13, v216
    v_mfma_f32_16x16x32_bf16 v[164:167], v[180:183], v[20:23], v[164:167]
    ds_read_b64_tr_b16 v[198:199], v251 offset:18432
    v_lshlrev_b32 v226, 16, v217
    v_and_b32 v227, s13, v217
    v_mfma_f32_16x16x32_bf16 v[168:171], v[180:183], v[24:27], v[168:171]
    buffer_load_dwordx4 v254, s[44:47], s64 offen offset:2048  lds
    v_lshlrev_b32 v228, 16, v218
    v_and_b32 v229, s13, v218
    v_mfma_f32_16x16x32_bf16 v[172:175], v[180:183], v[28:31], v[172:175]
    v_lshlrev_b32 v230, 16, v219
    v_and_b32 v231, s13, v219
    s_waitcnt lgkmcnt(5)
    v_mfma_f32_16x16x32_bf16 v[112:115], v[184:187], v[32:35], v[112:115]
    ds_read_b64_tr_b16 v[176:177], v244 offset:16384
    v_lshlrev_b32 v232, 16, v220
    v_and_b32 v233, s13, v220
    v_mfma_f32_16x16x32_bf16 v[116:119], v[184:187], v[36:39], v[116:119]
    ds_read_b64_tr_b16 v[178:179], v244 offset:18432
    v_lshlrev_b32 v234, 16, v221
    v_and_b32 v235, s13, v221
    v_mfma_f32_16x16x32_bf16 v[120:123], v[184:187], v[40:43], v[120:123]
    buffer_load_dwordx4 v255, s[44:47], s64 offen offset:3072  lds
    v_lshlrev_b32 v236, 16, v222
    v_and_b32 v237, s13, v222
    v_mfma_f32_16x16x32_bf16 v[124:127], v[184:187], v[44:47], v[124:127]
    v_lshlrev_b32 v238, 16, v223
    v_and_b32 v239, s13, v223
    v_mfma_f32_16x16x32_bf16 v[128:131], v[188:191], v[32:35], v[128:131]
    ds_read_b64_tr_b16 v[180:181], v245 offset:16384
    v_mul_f32 v224, 0x3eeff558, v224
    v_mul_f32 v225, 0x3eeff558, v225
    v_mfma_f32_16x16x32_bf16 v[132:135], v[188:191], v[36:39], v[132:135]
    ds_read_b64_tr_b16 v[182:183], v245 offset:18432
    v_mul_f32 v226, 0x3eeff558, v226
    v_mul_f32 v227, 0x3eeff558, v227
    v_mfma_f32_16x16x32_bf16 v[136:139], v[188:191], v[40:43], v[136:139]
    v_mul_f32 v228, 0x3eeff558, v228
    v_mul_f32 v229, 0x3eeff558, v229
    v_mfma_f32_16x16x32_bf16 v[140:143], v[188:191], v[44:47], v[140:143]
    v_mul_f32 v230, 0x3eeff558, v230
    v_mul_f32 v231, 0x3eeff558, v231
    s_waitcnt lgkmcnt(4)
    v_mfma_f32_16x16x32_bf16 v[144:147], v[192:195], v[32:35], v[144:147]
    ds_read_b64_tr_b16 v[184:185], v246 offset:16384
    v_mul_f32 v232, 0x3eeff558, v232
    v_mul_f32 v233, 0x3eeff558, v233
    v_mfma_f32_16x16x32_bf16 v[148:151], v[192:195], v[36:39], v[148:151]
    ds_read_b64_tr_b16 v[186:187], v246 offset:18432
    v_mul_f32 v234, 0x3eeff558, v234
    v_mul_f32 v235, 0x3eeff558, v235
    v_mfma_f32_16x16x32_bf16 v[152:155], v[192:195], v[40:43], v[152:155]
    s_add_u32 m0, s7, 147456
    s_add_u32 s64, s10, 1770496
    buffer_load_dwordx4 v252, s[44:47], s64 offen offset:0  lds
    v_mul_f32 v236, 0x3eeff558, v236
    v_mul_f32 v237, 0x3eeff558, v237
    v_mfma_f32_16x16x32_bf16 v[156:159], v[192:195], v[44:47], v[156:159]
    v_mul_f32 v238, 0x3eeff558, v238
    v_mul_f32 v239, 0x3eeff558, v239
    v_mfma_f32_16x16x32_bf16 v[160:163], v[196:199], v[32:35], v[160:163]
    ds_read_b64_tr_b16 v[188:189], v247 offset:16384
    v_mfma_f32_16x16x32_bf16 v[164:167], v[196:199], v[36:39], v[164:167]
    ds_read_b64_tr_b16 v[190:191], v247 offset:18432
    v_mfma_f32_16x16x32_bf16 v[168:171], v[196:199], v[40:43], v[168:171]
    buffer_load_dwordx4 v253, s[44:47], s64 offen offset:1024  lds
    v_mfma_f32_16x16x32_bf16 v[172:175], v[196:199], v[44:47], v[172:175]
    s_barrier
    s_waitcnt lgkmcnt(4)
    v_mfma_f32_16x16x32_bf16 v[48:51], v[176:179], a[0:3], v[224:227]
    s_waitcnt vmcnt(18)
    ds_read_b64_tr_b16 v[192:193], v244 offset:32768
    v_mfma_f32_16x16x32_bf16 v[52:55], v[176:179], a[4:7], v[224:227]
    ds_read_b64_tr_b16 v[194:195], v244 offset:34816
    v_mfma_f32_16x16x32_bf16 v[56:59], v[176:179], a[8:11], v[224:227]
    buffer_load_dwordx4 v254, s[44:47], s64 offen offset:2048  lds
    v_mfma_f32_16x16x32_bf16 v[60:63], v[176:179], a[12:15], v[224:227]
    buffer_load_dwordx4 v255, s[44:47], s64 offen offset:3072  lds
    v_mfma_f32_16x16x32_bf16 v[64:67], v[180:183], a[0:3], v[228:231]
    ds_read_b64_tr_b16 v[196:197], v245 offset:32768
    v_fma_f32 v200, -v112, v112, s66
    v_mfma_f32_16x16x32_bf16 v[68:71], v[180:183], a[4:7], v[228:231]
    ds_read_b64_tr_b16 v[198:199], v245 offset:34816
    v_mul_f32 v200, v200, v112
    v_fma_f32 v201, -v113, v113, s66
    v_mfma_f32_16x16x32_bf16 v[72:75], v[180:183], a[8:11], v[228:231]
    v_exp_f32 v200, v200
    v_mul_f32 v201, v201, v113
    v_mfma_f32_16x16x32_bf16 v[76:79], v[180:183], a[12:15], v[228:231]
    v_fma_f32 v202, -v114, v114, s66
    s_waitcnt lgkmcnt(4)
    v_mfma_f32_16x16x32_bf16 v[80:83], v[184:187], a[0:3], v[232:235]
    ds_read_b64_tr_b16 v[176:177], v246 offset:32768
    v_add_f32 v200, 1.0, v200
    v_exp_f32 v201, v201
    v_mfma_f32_16x16x32_bf16 v[84:87], v[184:187], a[4:7], v[232:235]
    ds_read_b64_tr_b16 v[178:179], v246 offset:34816
    v_mul_f32 v202, v202, v114
    v_mfma_f32_16x16x32_bf16 v[88:91], v[184:187], a[8:11], v[232:235]
    s_add_u32 m0, s7, 81920
    s_add_u32 s64, s10, 2065408
    buffer_load_dwordx4 v252, s[44:47], s64 offen offset:0  lds
    v_fma_f32 v203, -v115, v115, s66
    v_rcp_f32 v200, v200
    v_mfma_f32_16x16x32_bf16 v[92:95], v[184:187], a[12:15], v[232:235]
    v_add_f32 v201, 1.0, v201
    v_exp_f32 v202, v202
    v_mfma_f32_16x16x32_bf16 v[96:99], v[188:191], a[0:3], v[236:239]
    ds_read_b64_tr_b16 v[180:181], v247 offset:32768
    v_mul_f32 v203, v203, v115
    v_mfma_f32_16x16x32_bf16 v[100:103], v[188:191], a[4:7], v[236:239]
    ds_read_b64_tr_b16 v[182:183], v247 offset:34816
    v_fma_f32 v204, -v128, v128, s66
    v_mul_f32 v112, v200, v112
    v_mfma_f32_16x16x32_bf16 v[104:107], v[188:191], a[8:11], v[236:239]
    buffer_load_dwordx4 v253, s[44:47], s64 offen offset:1024  lds
    v_rcp_f32 v201, v201
    v_mfma_f32_16x16x32_bf16 v[108:111], v[188:191], a[12:15], v[236:239]
    v_add_f32 v202, 1.0, v202
    v_exp_f32 v203, v203
    s_waitcnt lgkmcnt(4)
    v_mfma_f32_16x16x32_bf16 v[48:51], v[192:195], a[16:19], v[48:51]
    s_waitcnt vmcnt(18)
    ds_read_b64_tr_b16 v[184:185], v244 offset:49152
    v_mul_f32 v204, v204, v128
    v_fma_f32 v205, -v129, v129, s66
    v_mfma_f32_16x16x32_bf16 v[52:55], v[192:195], a[20:23], v[52:55]
    ds_read_b64_tr_b16 v[186:187], v244 offset:51200
    v_mul_f32 v113, v201, v113
    v_mfma_f32_16x16x32_bf16 v[56:59], v[192:195], a[24:27], v[56:59]
    buffer_load_dwordx4 v254, s[44:47], s64 offen offset:2048  lds
    v_rcp_f32 v202, v202
    v_add_f32 v203, 1.0, v203
    v_mfma_f32_16x16x32_bf16 v[60:63], v[192:195], a[28:31], v[60:63]
    v_exp_f32 v204, v204
    v_mfma_f32_16x16x32_bf16 v[64:67], v[196:199], a[16:19], v[64:67]
    ds_read_b64_tr_b16 v[188:189], v245 offset:49152
    v_mul_f32 v205, v205, v129
    v_fma_f32 v206, -v130, v130, s66
    v_mfma_f32_16x16x32_bf16 v[68:71], v[196:199], a[20:23], v[68:71]
    ds_read_b64_tr_b16 v[190:191], v245 offset:51200
    v_cvt_pk_bf16_f32 v208, v112, v113
    v_mul_f32 v114, v202, v114
    v_mfma_f32_16x16x32_bf16 v[72:75], v[196:199], a[24:27], v[72:75]
    buffer_load_dwordx4 v255, s[44:47], s64 offen offset:3072  lds
    v_rcp_f32 v203, v203
    v_mfma_f32_16x16x32_bf16 v[76:79], v[196:199], a[28:31], v[76:79]
    v_add_f32 v204, 1.0, v204
    v_exp_f32 v205, v205
    s_waitcnt lgkmcnt(4)
    v_mfma_f32_16x16x32_bf16 v[80:83], v[176:179], a[16:19], v[80:83]
    ds_read_b64_tr_b16 v[192:193], v246 offset:49152
    v_mul_f32 v206, v206, v130
    v_mfma_f32_16x16x32_bf16 v[84:87], v[176:179], a[20:23], v[84:87]
    ds_read_b64_tr_b16 v[194:195], v246 offset:51200
    v_fma_f32 v207, -v131, v131, s66
    v_mul_f32 v115, v203, v115
    v_mfma_f32_16x16x32_bf16 v[88:91], v[176:179], a[24:27], v[88:91]
    s_add_u32 m0, s7, 98304
    s_add_u32 s64, s10, 2360320
    buffer_load_dwordx4 v252, s[44:47], s64 offen offset:0  lds
    v_rcp_f32 v204, v204
    v_mfma_f32_16x16x32_bf16 v[92:95], v[176:179], a[28:31], v[92:95]
    buffer_load_dwordx4 v253, s[44:47], s64 offen offset:1024  lds
    v_add_f32 v205, 1.0, v205
    v_exp_f32 v206, v206
    v_mfma_f32_16x16x32_bf16 v[96:99], v[180:183], a[16:19], v[96:99]
    ds_read_b64_tr_b16 v[196:197], v247 offset:49152
    v_mul_f32 v207, v207, v131
    v_fma_f32 v200, -v116, v116, s66
    v_mfma_f32_16x16x32_bf16 v[100:103], v[180:183], a[20:23], v[100:103]
    ds_read_b64_tr_b16 v[198:199], v247 offset:51200
    v_cvt_pk_bf16_f32 v209, v114, v115
    v_mfma_f32_16x16x32_bf16 v[104:107], v[180:183], a[24:27], v[104:107]
    buffer_load_dwordx4 v254, s[44:47], s64 offen offset:2048  lds
    v_mul_f32 v128, v204, v128
    v_rcp_f32 v205, v205
    v_mfma_f32_16x16x32_bf16 v[108:111], v[180:183], a[28:31], v[108:111]
    v_add_f32 v206, 1.0, v206
    ds_read_b128 a[0:3], v2 offset:0
    s_waitcnt lgkmcnt(5)
    v_mfma_f32_16x16x32_bf16 v[48:51], v[184:187], a[32:35], v[48:51]
    s_waitcnt vmcnt(19)
    ds_read_b64_tr_b16 v[176:177], v248 offset:0
    v_exp_f32 v207, v207
    v_mul_f32 v200, v200, v116
    v_mfma_f32_16x16x32_bf16 v[52:55], v[184:187], a[36:39], v[52:55]
    ds_read_b64_tr_b16 v[178:179], v248 offset:2048
    v_fma_f32 v201, -v117, v117, s66
    v_mul_f32 v129, v205, v129
    v_mfma_f32_16x16x32_bf16 v[56:59], v[184:187], a[40:43], v[56:59]
    buffer_load_dwordx4 v255, s[44:47], s64 offen offset:3072  lds
    v_rcp_f32 v206, v206
    v_mfma_f32_16x16x32_bf16 v[60:63], v[184:187], a[44:47], v[60:63]
    v_add_f32 v207, 1.0, v207
    v_exp_f32 v200, v200
    ds_read_b128 a[4:7], v2 offset:1024
    v_mfma_f32_16x16x32_bf16 v[64:67], v[188:191], a[32:35], v[64:67]
    ds_read_b64_tr_b16 v[180:181], v249 offset:0
    v_mul_f32 v201, v201, v117
    v_mfma_f32_16x16x32_bf16 v[68:71], v[188:191], a[36:39], v[68:71]
    ds_read_b64_tr_b16 v[182:183], v249 offset:2048
    v_fma_f32 v202, -v118, v118, s66
    v_cvt_pk_bf16_f32 v210, v128, v129
    v_mfma_f32_16x16x32_bf16 v[72:75], v[188:191], a[40:43], v[72:75]
    v_mul_f32 v130, v206, v130
    v_rcp_f32 v207, v207
    v_mfma_f32_16x16x32_bf16 v[76:79], v[188:191], a[44:47], v[76:79]
    v_add_f32 v200, 1.0, v200
    ds_read_b128 a[8:11], v2 offset:2048
    s_waitcnt lgkmcnt(7)
    v_mfma_f32_16x16x32_bf16 v[80:83], v[192:195], a[32:35], v[80:83]
    ds_read_b64_tr_b16 v[184:185], v250 offset:0
    v_exp_f32 v201, v201
    v_mul_f32 v202, v202, v118
    v_mfma_f32_16x16x32_bf16 v[84:87], v[192:195], a[36:39], v[84:87]
    ds_read_b64_tr_b16 v[186:187], v250 offset:2048
    v_fma_f32 v203, -v119, v119, s66
    v_mfma_f32_16x16x32_bf16 v[88:91], v[192:195], a[40:43], v[88:91]
    s_add_u32 m0, s7, 114688
    s_add_u32 s64, s10, 2655232
    buffer_load_dwordx4 v252, s[44:47], s64 offen offset:0  lds
    v_mul_f32 v131, v207, v131
    v_rcp_f32 v200, v200
    v_mfma_f32_16x16x32_bf16 v[92:95], v[192:195], a[44:47], v[92:95]
    v_add_f32 v201, 1.0, v201
    v_exp_f32 v202, v202
    ds_read_b128 a[12:15], v2 offset:3072
    v_mfma_f32_16x16x32_bf16 v[96:99], v[196:199], a[32:35], v[96:99]
    ds_read_b64_tr_b16 v[188:189], v251 offset:0
    v_mul_f32 v203, v203, v119
    v_mfma_f32_16x16x32_bf16 v[100:103], v[196:199], a[36:39], v[100:103]
    ds_read_b64_tr_b16 v[190:191], v251 offset:2048
    v_fma_f32 v204, -v132, v132, s66
    v_cvt_pk_bf16_f32 v211, v130, v131
    v_mfma_f32_16x16x32_bf16 v[104:107], v[196:199], a[40:43], v[104:107]
    buffer_load_dwordx4 v253, s[44:47], s64 offen offset:1024  lds
    v_mul_f32 v116, v200, v116
    v_mfma_f32_16x16x32_bf16 v[108:111], v[196:199], a[44:47], v[108:111]
    v_rcp_f32 v201, v201
    v_add_f32 v202, 1.0, v202
    ds_read_b128 a[16:19], v2 offset:16384
    s_waitcnt lgkmcnt(7)
    v_mfma_f32_16x16x32_bf16 v[48:51], v[176:179], a[48:51], v[48:51]
    s_waitcnt vmcnt(18)
    ds_read_b64_tr_b16 v[192:193], v240 offset:49152
    v_exp_f32 v203, v203
    v_mul_f32 v204, v204, v132
    v_mfma_f32_16x16x32_bf16 v[52:55], v[176:179], a[52:55], v[52:55]
    ds_read_b64_tr_b16 v[194:195], v240 offset:51200
    v_fma_f32 v205, -v133, v133, s66
    v_mfma_f32_16x16x32_bf16 v[56:59], v[176:179], a[56:59], v[56:59]
    buffer_load_dwordx4 v254, s[44:47], s64 offen offset:2048  lds
    ds_write_b128 v4, v[208:211] offset:32768
    v_mul_f32 v117, v201, v117
    v_mfma_f32_16x16x32_bf16 v[60:63], v[176:179], a[60:63], v[60:63]
    buffer_load_dwordx4 v255, s[44:47], s64 offen offset:3072  lds
    v_rcp_f32 v202, v202
    ds_read_b128 a[20:23], v2 offset:17408
    v_mfma_f32_16x16x32_bf16 v[64:67], v[180:183], a[48:51], v[64:67]
    ds_read_b64_tr_b16 v[196:197], v241 offset:49152
    v_add_f32 v203, 1.0, v203
    v_exp_f32 v204, v204
    v_mfma_f32_16x16x32_bf16 v[68:71], v[180:183], a[52:55], v[68:71]
    ds_read_b64_tr_b16 v[198:199], v241 offset:51200
    v_mul_f32 v205, v205, v133
    v_mfma_f32_16x16x32_bf16 v[72:75], v[180:183], a[56:59], v[72:75]
    v_fma_f32 v206, -v134, v134, s66
    v_cvt_pk_bf16_f32 v212, v116, v117
    v_mfma_f32_16x16x32_bf16 v[76:79], v[180:183], a[60:63], v[76:79]
    v_mul_f32 v118, v202, v118
    v_rcp_f32 v203, v203
    ds_read_b128 a[24:27], v2 offset:18432
    s_waitcnt lgkmcnt(8)
    v_mfma_f32_16x16x32_bf16 v[80:83], v[184:187], a[48:51], v[80:83]
    ds_read_b64_tr_b16 v[176:177], v242 offset:49152
    v_add_f32 v204, 1.0, v204
    v_mfma_f32_16x16x32_bf16 v[84:87], v[184:187], a[52:55], v[84:87]
    ds_read_b64_tr_b16 v[178:179], v242 offset:51200
    v_exp_f32 v205, v205
    v_mul_f32 v206, v206, v134
    v_mfma_f32_16x16x32_bf16 v[88:91], v[184:187], a[56:59], v[88:91]
    s_add_u32 m0, s7, 131072
    s_add_u32 s64, s10, 2950144
    buffer_load_dwordx4 v252, s[44:47], s64 offen offset:0  lds
    v_fma_f32 v207, -v135, v135, s66
    v_mfma_f32_16x16x32_bf16 v[92:95], v[184:187], a[60:63], v[92:95]
    v_mul_f32 v119, v203, v119
    v_rcp_f32 v204, v204
    ds_read_b128 a[28:31], v2 offset:19456
    v_mfma_f32_16x16x32_bf16 v[96:99], v[188:191], a[48:51], v[96:99]
    ds_read_b64_tr_b16 v[180:181], v243 offset:49152
    v_add_f32 v205, 1.0, v205
    v_exp_f32 v206, v206
    v_mfma_f32_16x16x32_bf16 v[100:103], v[188:191], a[52:55], v[100:103]
    ds_read_b64_tr_b16 v[182:183], v243 offset:51200
    v_mul_f32 v207, v207, v135
    v_mfma_f32_16x16x32_bf16 v[104:107], v[188:191], a[56:59], v[104:107]
    buffer_load_dwordx4 v253, s[44:47], s64 offen offset:1024  lds
    v_fma_f32 v200, -v120, v120, s66
    v_cvt_pk_bf16_f32 v213, v118, v119
    v_mfma_f32_16x16x32_bf16 v[108:111], v[188:191], a[60:63], v[108:111]
    v_mul_f32 v132, v204, v132
    ds_read_b128 a[32:35], v2 offset:4096
    s_waitcnt lgkmcnt(7)
    v_mfma_f32_16x16x32_bf16 v[48:51], v[192:195], a[64:67], v[48:51]
    s_waitcnt vmcnt(18)
    ds_read_b64_tr_b16 v[184:185], v244 offset:0
    v_rcp_f32 v205, v205
    v_add_f32 v206, 1.0, v206
    v_mfma_f32_16x16x32_bf16 v[52:55], v[192:195], a[68:71], v[52:55]
    ds_read_b64_tr_b16 v[186:187], v244 offset:2048
    v_exp_f32 v207, v207
    v_mul_f32 v200, v200, v120
    v_mfma_f32_16x16x32_bf16 v[56:59], v[192:195], a[72:75], v[56:59]
    buffer_load_dwordx4 v254, s[44:47], s64 offen offset:2048  lds
    v_fma_f32 v201, -v121, v121, s66
    v_mfma_f32_16x16x32_bf16 v[60:63], v[192:195], a[76:79], v[60:63]
    v_mul_f32 v133, v205, v133
    v_rcp_f32 v206, v206
    ds_read_b128 a[36:39], v2 offset:5120
    v_mfma_f32_16x16x32_bf16 v[64:67], v[196:199], a[64:67], v[64:67]
    ds_read_b64_tr_b16 v[188:189], v245 offset:0
    v_add_f32 v207, 1.0, v207
    v_mfma_f32_16x16x32_bf16 v[68:71], v[196:199], a[68:71], v[68:71]
    ds_read_b64_tr_b16 v[190:191], v245 offset:2048
    v_exp_f32 v200, v200
    v_mul_f32 v201, v201, v121
    v_mfma_f32_16x16x32_bf16 v[72:75], v[196:199], a[72:75], v[72:75]
    buffer_load_dwordx4 v255, s[44:47], s64 offen offset:3072  lds
    v_fma_f32 v202, -v122, v122, s66
    v_cvt_pk_bf16_f32 v214, v132, v133
    v_mfma_f32_16x16x32_bf16 v[76:79], v[196:199], a[76:79], v[76:79]
    v_mul_f32 v134, v206, v134
    ds_read_b128 a[40:43], v2 offset:6144
    s_waitcnt lgkmcnt(7)
    v_mfma_f32_16x16x32_bf16 v[80:83], v[176:179], a[64:67], v[80:83]
    ds_read_b64_tr_b16 v[192:193], v246 offset:0
    v_rcp_f32 v207, v207
    v_add_f32 v200, 1.0, v200
    v_mfma_f32_16x16x32_bf16 v[84:87], v[176:179], a[68:71], v[84:87]
    ds_read_b64_tr_b16 v[194:195], v246 offset:2048
    v_exp_f32 v201, v201
    v_mfma_f32_16x16x32_bf16 v[88:91], v[176:179], a[72:75], v[88:91]
    v_mul_f32 v202, v202, v122
    v_fma_f32 v203, -v123, v123, s66
    v_mfma_f32_16x16x32_bf16 v[92:95], v[176:179], a[76:79], v[92:95]
    v_mul_f32 v135, v207, v135
    v_rcp_f32 v200, v200
    ds_read_b128 a[44:47], v2 offset:7168
    v_mfma_f32_16x16x32_bf16 v[96:99], v[180:183], a[64:67], v[96:99]
    ds_read_b64_tr_b16 v[196:197], v247 offset:0
    v_add_f32 v201, 1.0, v201
    v_mfma_f32_16x16x32_bf16 v[100:103], v[180:183], a[68:71], v[100:103]
    ds_read_b64_tr_b16 v[198:199], v247 offset:2048
    v_exp_f32 v202, v202
    v_mul_f32 v203, v203, v123
    v_mfma_f32_16x16x32_bf16 v[104:107], v[180:183], a[72:75], v[104:107]
    v_fma_f32 v204, -v136, v136, s66
    v_mfma_f32_16x16x32_bf16 v[108:111], v[180:183], a[76:79], v[108:111]
    v_cvt_pk_bf16_f32 v215, v134, v135
    v_mul_f32 v120, v200, v120
    ds_read_b128 a[48:51], v2 offset:20480
    s_waitcnt lgkmcnt(7)
    v_mfma_f32_16x16x32_bf16 v[48:51], v[184:187], a[80:83], v[48:51]
    s_waitcnt vmcnt(16)
    ds_read_b64_tr_b16 v[176:177], v248 offset:16384
    v_rcp_f32 v201, v201
    v_mfma_f32_16x16x32_bf16 v[52:55], v[184:187], a[84:87], v[52:55]
    ds_read_b64_tr_b16 v[178:179], v248 offset:18432
    v_add_f32 v202, 1.0, v202
    v_exp_f32 v203, v203
    v_mfma_f32_16x16x32_bf16 v[56:59], v[184:187], a[88:91], v[56:59]
    v_mul_f32 v204, v204, v136
    v_fma_f32 v205, -v137, v137, s66
    v_mfma_f32_16x16x32_bf16 v[60:63], v[184:187], a[92:95], v[60:63]
    ds_write_b128 v4, v[212:215] offset:33792
    ds_read_b128 a[52:55], v2 offset:21504
    v_mfma_f32_16x16x32_bf16 v[64:67], v[188:191], a[80:83], v[64:67]
    ds_read_b64_tr_b16 v[180:181], v249 offset:16384
    v_mul_f32 v121, v201, v121
    v_rcp_f32 v202, v202
    v_mfma_f32_16x16x32_bf16 v[68:71], v[188:191], a[84:87], v[68:71]
    ds_read_b64_tr_b16 v[182:183], v249 offset:18432
    v_add_f32 v203, 1.0, v203
    v_mfma_f32_16x16x32_bf16 v[72:75], v[188:191], a[88:91], v[72:75]
    v_exp_f32 v204, v204
    v_mul_f32 v205, v205, v137
    v_mfma_f32_16x16x32_bf16 v[76:79], v[188:191], a[92:95], v[76:79]
    v_fma_f32 v206, -v138, v138, s66
    v_cvt_pk_bf16_f32 v208, v120, v121
    ds_read_b128 a[56:59], v2 offset:22528
    s_waitcnt lgkmcnt(8)
    v_mfma_f32_16x16x32_bf16 v[80:83], v[192:195], a[80:83], v[80:83]
    ds_read_b64_tr_b16 v[184:185], v250 offset:16384
    v_mul_f32 v122, v202, v122
    v_mfma_f32_16x16x32_bf16 v[84:87], v[192:195], a[84:87], v[84:87]
    ds_read_b64_tr_b16 v[186:187], v250 offset:18432
    v_rcp_f32 v203, v203
    v_add_f32 v204, 1.0, v204
    v_mfma_f32_16x16x32_bf16 v[88:91], v[192:195], a[88:91], v[88:91]
    s_add_u32 m0, s7, 65536
    s_add_u32 s64, s10, 3245056
    buffer_load_dwordx4 v252, s[44:47], s64 offen offset:0  lds
    v_exp_f32 v205, v205
    v_mfma_f32_16x16x32_bf16 v[92:95], v[192:195], a[92:95], v[92:95]
    v_mul_f32 v206, v206, v138
    v_fma_f32 v207, -v139, v139, s66
    ds_read_b128 a[60:63], v2 offset:23552
    v_mfma_f32_16x16x32_bf16 v[96:99], v[196:199], a[80:83], v[96:99]
    ds_read_b64_tr_b16 v[188:189], v251 offset:16384
    v_mul_f32 v123, v203, v123
    v_rcp_f32 v204, v204
    v_mfma_f32_16x16x32_bf16 v[100:103], v[196:199], a[84:87], v[100:103]
    ds_read_b64_tr_b16 v[190:191], v251 offset:18432
    v_add_f32 v205, 1.0, v205
    v_mfma_f32_16x16x32_bf16 v[104:107], v[196:199], a[88:91], v[104:107]
    buffer_load_dwordx4 v253, s[44:47], s64 offen offset:1024  lds
    v_exp_f32 v206, v206
    v_mul_f32 v207, v207, v139
    v_mfma_f32_16x16x32_bf16 v[108:111], v[196:199], a[92:95], v[108:111]
    v_fma_f32 v200, -v124, v124, s66
    ds_read_b128 a[64:67], v2 offset:8192
    s_waitcnt lgkmcnt(7)
    v_mfma_f32_16x16x32_bf16 v[48:51], v[176:179], a[96:99], v[48:51]
    s_waitcnt vmcnt(14)
    ds_read_b64_tr_b16 v[192:193], v244 offset:16384
    v_cvt_pk_bf16_f32 v209, v122, v123
    v_mul_f32 v136, v204, v136
    v_mfma_f32_16x16x32_bf16 v[52:55], v[176:179], a[100:103], v[52:55]
    ds_read_b64_tr_b16 v[194:195], v244 offset:18432
    v_rcp_f32 v205, v205
    v_add_f32 v206, 1.0, v206
    v_mfma_f32_16x16x32_bf16 v[56:59], v[176:179], a[104:107], v[56:59]
    buffer_load_dwordx4 v254, s[44:47], s64 offen offset:2048  lds
    v_exp_f32 v207, v207
    v_mfma_f32_16x16x32_bf16 v[60:63], v[176:179], a[108:111], v[60:63]
    buffer_load_dwordx4 v255, s[44:47], s64 offen offset:3072  lds
    v_mul_f32 v200, v200, v124
    v_fma_f32 v201, -v125, v125, s66
    ds_read_b128 a[68:71], v2 offset:9216
    v_mfma_f32_16x16x32_bf16 v[64:67], v[180:183], a[96:99], v[64:67]
    ds_read_b64_tr_b16 v[196:197], v245 offset:16384
    v_mul_f32 v137, v205, v137
    v_mfma_f32_16x16x32_bf16 v[68:71], v[180:183], a[100:103], v[68:71]
    ds_read_b64_tr_b16 v[198:199], v245 offset:18432
    v_rcp_f32 v206, v206
    v_add_f32 v207, 1.0, v207
    v_mfma_f32_16x16x32_bf16 v[72:75], v[180:183], a[104:107], v[72:75]
    v_exp_f32 v200, v200
    v_mul_f32 v201, v201, v125
    v_mfma_f32_16x16x32_bf16 v[76:79], v[180:183], a[108:111], v[76:79]
    v_fma_f32 v202, -v126, v126, s66
    ds_read_b128 a[72:75], v2 offset:10240
    s_waitcnt lgkmcnt(7)
    v_mfma_f32_16x16x32_bf16 v[80:83], v[184:187], a[96:99], v[80:83]
    ds_read_b64_tr_b16 v[176:177], v246 offset:16384
    v_cvt_pk_bf16_f32 v210, v136, v137
    v_mul_f32 v138, v206, v138
    v_mfma_f32_16x16x32_bf16 v[84:87], v[184:187], a[100:103], v[84:87]
    ds_read_b64_tr_b16 v[178:179], v246 offset:18432
    v_rcp_f32 v207, v207
    v_mfma_f32_16x16x32_bf16 v[88:91], v[184:187], a[104:107], v[88:91]
    s_add_u32 m0, s7, 147456
    s_add_u32 s64, s10, 3539968
    buffer_load_dwordx4 v252, s[44:47], s64 offen offset:0  lds
    v_add_f32 v200, 1.0, v200
    v_exp_f32 v201, v201
    v_mfma_f32_16x16x32_bf16 v[92:95], v[184:187], a[108:111], v[92:95]
    v_mul_f32 v202, v202, v126
    ds_read_b128 a[76:79], v2 offset:11264
    v_mfma_f32_16x16x32_bf16 v[96:99], v[188:191], a[96:99], v[96:99]
    ds_read_b64_tr_b16 v[180:181], v247 offset:16384
    v_fma_f32 v203, -v127, v127, s66
    v_mul_f32 v139, v207, v139
    v_mfma_f32_16x16x32_bf16 v[100:103], v[188:191], a[100:103], v[100:103]
    ds_read_b64_tr_b16 v[182:183], v247 offset:18432
    v_rcp_f32 v200, v200
    v_add_f32 v201, 1.0, v201
    v_mfma_f32_16x16x32_bf16 v[104:107], v[188:191], a[104:107], v[104:107]
    buffer_load_dwordx4 v253, s[44:47], s64 offen offset:1024  lds
    v_exp_f32 v202, v202
    v_mfma_f32_16x16x32_bf16 v[108:111], v[188:191], a[108:111], v[108:111]
    v_mul_f32 v203, v203, v127
    v_fma_f32 v204, -v140, v140, s66
    ds_read_b128 a[80:83], v2 offset:24576
    s_waitcnt lgkmcnt(7)
    v_mfma_f32_16x16x32_bf16 v[48:51], v[192:195], a[112:115], v[48:51]
    s_waitcnt vmcnt(14)
    ds_read_b64_tr_b16 v[184:185], v244 offset:32768
    v_cvt_pk_bf16_f32 v211, v138, v139
    v_mfma_f32_16x16x32_bf16 v[52:55], v[192:195], a[116:119], v[52:55]
    ds_read_b64_tr_b16 v[186:187], v244 offset:34816
    v_mul_f32 v124, v200, v124
    v_rcp_f32 v201, v201
    v_mfma_f32_16x16x32_bf16 v[56:59], v[192:195], a[120:123], v[56:59]
    buffer_load_dwordx4 v254, s[44:47], s64 offen offset:2048  lds
    v_add_f32 v202, 1.0, v202
    v_exp_f32 v203, v203
    v_mfma_f32_16x16x32_bf16 v[60:63], v[192:195], a[124:127], v[60:63]
    v_mul_f32 v204, v204, v140
    ds_read_b128 a[84:87], v2 offset:25600
    v_mfma_f32_16x16x32_bf16 v[64:67], v[196:199], a[112:115], v[64:67]
    ds_read_b64_tr_b16 v[188:189], v245 offset:32768
    v_fma_f32 v205, -v141, v141, s66
    ds_write_b128 v4, v[208:211] offset:34816
    v_mfma_f32_16x16x32_bf16 v[68:71], v[196:199], a[116:119], v[68:71]
    ds_read_b64_tr_b16 v[190:191], v245 offset:34816
    v_mul_f32 v125, v201, v125
    v_mfma_f32_16x16x32_bf16 v[72:75], v[196:199], a[120:123], v[72:75]
    buffer_load_dwordx4 v255, s[44:47], s64 offen offset:3072  lds
    v_rcp_f32 v202, v202
    v_add_f32 v203, 1.0, v203
    v_mfma_f32_16x16x32_bf16 v[76:79], v[196:199], a[124:127], v[76:79]
    v_exp_f32 v204, v204
    v_mul_f32 v205, v205, v141
    ds_read_b128 a[88:91], v2 offset:26624
    s_waitcnt lgkmcnt(8)
    v_mfma_f32_16x16x32_bf16 v[80:83], v[176:179], a[112:115], v[80:83]
    ds_read_b64_tr_b16 v[192:193], v246 offset:32768
    v_fma_f32 v206, -v142, v142, s66
    v_mfma_f32_16x16x32_bf16 v[84:87], v[176:179], a[116:119], v[84:87]
    ds_read_b64_tr_b16 v[194:195], v246 offset:34816
    v_cvt_pk_bf16_f32 v212, v124, v125
    v_mul_f32 v126, v202, v126
    v_mfma_f32_16x16x32_bf16 v[88:91], v[176:179], a[120:123], v[88:91]
    s_add_u32 m0, s7, 81920
    s_add_u32 s64, s10, 3834880
    buffer_load_dwordx4 v252, s[44:47], s64 offen offset:0  lds
    v_rcp_f32 v203, v203
    v_mfma_f32_16x16x32_bf16 v[92:95], v[176:179], a[124:127], v[92:95]
    buffer_load_dwordx4 v253, s[44:47], s64 offen offset:1024  lds
    v_add_f32 v204, 1.0, v204
    v_exp_f32 v205, v205
    ds_read_b128 a[92:95], v2 offset:27648
    v_mfma_f32_16x16x32_bf16 v[96:99], v[180:183], a[112:115], v[96:99]
    ds_read_b64_tr_b16 v[196:197], v247 offset:32768
    v_mul_f32 v206, v206, v142
    v_fma_f32 v207, -v143, v143, s66
    v_mfma_f32_16x16x32_bf16 v[100:103], v[180:183], a[116:119], v[100:103]
    ds_read_b64_tr_b16 v[198:199], v247 offset:34816
    v_mul_f32 v127, v203, v127
    v_mfma_f32_16x16x32_bf16 v[104:107], v[180:183], a[120:123], v[104:107]
    buffer_load_dwordx4 v254, s[44:47], s64 offen offset:2048  lds
    v_rcp_f32 v204, v204
    v_add_f32 v205, 1.0, v205
    v_mfma_f32_16x16x32_bf16 v[108:111], v[180:183], a[124:127], v[108:111]
    v_exp_f32 v206, v206
    ds_read_b128 a[96:99], v2 offset:12288
    s_waitcnt lgkmcnt(7)
    v_mfma_f32_16x16x32_bf16 v[48:51], v[184:187], a[128:131], v[48:51]
    s_waitcnt vmcnt(15)
    ds_read_b64_tr_b16 v[176:177], v244 offset:49152
    v_mul_f32 v207, v207, v143
    v_fma_f32 v200, -v144, v144, s66
    v_mfma_f32_16x16x32_bf16 v[52:55], v[184:187], a[132:135], v[52:55]
    ds_read_b64_tr_b16 v[178:179], v244 offset:51200
    v_cvt_pk_bf16_f32 v213, v126, v127
    v_mul_f32 v140, v204, v140
    v_mfma_f32_16x16x32_bf16 v[56:59], v[184:187], a[136:139], v[56:59]
    buffer_load_dwordx4 v255, s[44:47], s64 offen offset:3072  lds
    v_rcp_f32 v205, v205
    v_mfma_f32_16x16x32_bf16 v[60:63], v[184:187], a[140:143], v[60:63]
    v_add_f32 v206, 1.0, v206
    v_exp_f32 v207, v207
    ds_read_b128 a[100:103], v2 offset:13312
    v_mfma_f32_16x16x32_bf16 v[64:67], v[188:191], a[128:131], v[64:67]
    ds_read_b64_tr_b16 v[180:181], v245 offset:49152
    v_mul_f32 v200, v200, v144
    v_mfma_f32_16x16x32_bf16 v[68:71], v[188:191], a[132:135], v[68:71]
    ds_read_b64_tr_b16 v[182:183], v245 offset:51200
    v_fma_f32 v201, -v145, v145, s66
    v_mul_f32 v141, v205, v141
    v_mfma_f32_16x16x32_bf16 v[72:75], v[188:191], a[136:139], v[72:75]
    v_rcp_f32 v206, v206
    v_mfma_f32_16x16x32_bf16 v[76:79], v[188:191], a[140:143], v[76:79]
    v_add_f32 v207, 1.0, v207
    v_exp_f32 v200, v200
    ds_read_b128 a[104:107], v2 offset:14336
    s_waitcnt lgkmcnt(7)
    v_mfma_f32_16x16x32_bf16 v[80:83], v[192:195], a[128:131], v[80:83]
    ds_read_b64_tr_b16 v[184:185], v246 offset:49152
    v_mul_f32 v201, v201, v145
    v_fma_f32 v202, -v146, v146, s66
    v_mfma_f32_16x16x32_bf16 v[84:87], v[192:195], a[132:135], v[84:87]
    ds_read_b64_tr_b16 v[186:187], v246 offset:51200
    v_cvt_pk_bf16_f32 v214, v140, v141
    v_mfma_f32_16x16x32_bf16 v[88:91], v[192:195], a[136:139], v[88:91]
    s_add_u32 m0, s7, 98304
    s_add_u32 s64, s10, 4129792
    buffer_load_dwordx4 v252, s[44:47], s64 offen offset:0  lds
    v_mul_f32 v142, v206, v142
    v_rcp_f32 v207, v207
    v_mfma_f32_16x16x32_bf16 v[92:95], v[192:195], a[140:143], v[92:95]
    v_add_f32 v200, 1.0, v200
    ds_read_b128 a[108:111], v2 offset:15360
    v_mfma_f32_16x16x32_bf16 v[96:99], v[196:199], a[128:131], v[96:99]
    ds_read_b64_tr_b16 v[188:189], v247 offset:49152
    v_exp_f32 v201, v201
    v_mul_f32 v202, v202, v146
    v_mfma_f32_16x16x32_bf16 v[100:103], v[196:199], a[132:135], v[100:103]
    ds_read_b64_tr_b16 v[190:191], v247 offset:51200
    v_fma_f32 v203, -v147, v147, s66
    v_mul_f32 v143, v207, v143
    v_mfma_f32_16x16x32_bf16 v[104:107], v[196:199], a[136:139], v[104:107]
    buffer_load_dwordx4 v253, s[44:47], s64 offen offset:1024  lds
    v_rcp_f32 v200, v200
    v_mfma_f32_16x16x32_bf16 v[108:111], v[196:199], a[140:143], v[108:111]
    v_add_f32 v201, 1.0, v201
    v_exp_f32 v202, v202
    ds_read_b128 a[112:115], v2 offset:28672
    s_waitcnt lgkmcnt(7)
    v_mfma_f32_16x16x32_bf16 v[48:51], v[176:179], a[144:147], v[48:51]
    s_waitcnt vmcnt(14)
    ds_read_b64_tr_b16 v[192:193], v248 offset:0
    v_mul_f32 v203, v203, v147
    v_mfma_f32_16x16x32_bf16 v[52:55], v[176:179], a[148:151], v[52:55]
    ds_read_b64_tr_b16 v[194:195], v248 offset:2048
    v_fma_f32 v204, -v160, v160, s66
    v_cvt_pk_bf16_f32 v215, v142, v143
    v_mfma_f32_16x16x32_bf16 v[56:59], v[176:179], a[152:155], v[56:59]
    buffer_load_dwordx4 v254, s[44:47], s64 offen offset:2048  lds
    v_mul_f32 v144, v200, v144
    v_rcp_f32 v201, v201
    v_mfma_f32_16x16x32_bf16 v[60:63], v[176:179], a[156:159], v[60:63]
    buffer_load_dwordx4 v255, s[44:47], s64 offen offset:3072  lds
    v_add_f32 v202, 1.0, v202
    ds_read_b128 a[116:119], v2 offset:29696
    v_mfma_f32_16x16x32_bf16 v[64:67], v[180:183], a[144:147], v[64:67]
    ds_read_b64_tr_b16 v[196:197], v249 offset:0
    v_exp_f32 v203, v203
    v_mul_f32 v204, v204, v160
    v_mfma_f32_16x16x32_bf16 v[68:71], v[180:183], a[148:151], v[68:71]
    ds_read_b64_tr_b16 v[198:199], v249 offset:2048
    v_fma_f32 v205, -v161, v161, s66
    v_mfma_f32_16x16x32_bf16 v[72:75], v[180:183], a[152:155], v[72:75]
    ds_write_b128 v4, v[212:215] offset:35840
    v_mul_f32 v145, v201, v145
    v_mfma_f32_16x16x32_bf16 v[76:79], v[180:183], a[156:159], v[76:79]
    v_rcp_f32 v202, v202
    v_add_f32 v203, 1.0, v203
    ds_read_b128 a[120:123], v2 offset:30720
    s_waitcnt lgkmcnt(8)
    v_mfma_f32_16x16x32_bf16 v[80:83], v[184:187], a[144:147], v[80:83]
    ds_read_b64_tr_b16 v[176:177], v250 offset:0
    v_exp_f32 v204, v204
    v_mfma_f32_16x16x32_bf16 v[84:87], v[184:187], a[148:151], v[84:87]
    ds_read_b64_tr_b16 v[178:179], v250 offset:2048
    v_mul_f32 v205, v205, v161
    v_fma_f32 v206, -v162, v162, s66
    v_mfma_f32_16x16x32_bf16 v[88:91], v[184:187], a[152:155], v[88:91]
    s_add_u32 m0, s7, 114688
    s_add_u32 s64, s10, 4424704
    buffer_load_dwordx4 v252, s[44:47], s64 offen offset:0  lds
    v_cvt_pk_bf16_f32 v208, v144, v145
    v_mfma_f32_16x16x32_bf16 v[92:95], v[184:187], a[156:159], v[92:95]
    v_mul_f32 v146, v202, v146
    v_rcp_f32 v203, v203
    ds_read_b128 a[124:127], v2 offset:31744
    v_mfma_f32_16x16x32_bf16 v[96:99], v[188:191], a[144:147], v[96:99]
    ds_read_b64_tr_b16 v[180:181], v251 offset:0
    v_add_f32 v204, 1.0, v204
    v_exp_f32 v205, v205
    v_mfma_f32_16x16x32_bf16 v[100:103], v[188:191], a[148:151], v[100:103]
    ds_read_b64_tr_b16 v[182:183], v251 offset:2048
    v_mul_f32 v206, v206, v162
    v_mfma_f32_16x16x32_bf16 v[104:107], v[188:191], a[152:155], v[104:107]
    buffer_load_dwordx4 v253, s[44:47], s64 offen offset:1024  lds
    v_fma_f32 v207, -v163, v163, s66
    v_mul_f32 v147, v203, v147
    v_mfma_f32_16x16x32_bf16 v[108:111], v[188:191], a[156:159], v[108:111]
    v_rcp_f32 v204, v204
    s_waitcnt lgkmcnt(7)
    v_mfma_f32_16x16x32_bf16 v[48:51], v[192:195], a[160:163], v[48:51]
    s_waitcnt vmcnt(14)
    ds_read_b64_tr_b16 v[184:185], v244 offset:0
    v_add_f32 v205, 1.0, v205
    v_exp_f32 v206, v206
    v_mfma_f32_16x16x32_bf16 v[52:55], v[192:195], a[164:167], v[52:55]
    ds_read_b64_tr_b16 v[186:187], v244 offset:2048
    v_mul_f32 v207, v207, v163
    v_mfma_f32_16x16x32_bf16 v[56:59], v[192:195], a[168:171], v[56:59]
    buffer_load_dwordx4 v254, s[44:47], s64 offen offset:2048  lds
    v_fma_f32 v200, -v148, v148, s66
    v_cvt_pk_bf16_f32 v209, v146, v147
    v_mfma_f32_16x16x32_bf16 v[60:63], v[192:195], a[172:175], v[60:63]
    v_mul_f32 v160, v204, v160
    v_rcp_f32 v205, v205
    v_mfma_f32_16x16x32_bf16 v[64:67], v[196:199], a[160:163], v[64:67]
    ds_read_b64_tr_b16 v[188:189], v245 offset:0
    v_add_f32 v206, 1.0, v206
    v_mfma_f32_16x16x32_bf16 v[68:71], v[196:199], a[164:167], v[68:71]
    ds_read_b64_tr_b16 v[190:191], v245 offset:2048
    v_exp_f32 v207, v207
    v_mul_f32 v200, v200, v148
    v_mfma_f32_16x16x32_bf16 v[72:75], v[196:199], a[168:171], v[72:75]
    buffer_load_dwordx4 v255, s[44:47], s64 offen offset:3072  lds
    v_fma_f32 v201, -v149, v149, s66
    v_mfma_f32_16x16x32_bf16 v[76:79], v[196:199], a[172:175], v[76:79]
    v_mul_f32 v161, v205, v161
    v_rcp_f32 v206, v206
    s_waitcnt lgkmcnt(4)
    v_mfma_f32_16x16x32_bf16 v[80:83], v[176:179], a[160:163], v[80:83]
    ds_read_b64_tr_b16 v[192:193], v246 offset:0
    v_add_f32 v207, 1.0, v207
    v_exp_f32 v200, v200
    v_mfma_f32_16x16x32_bf16 v[84:87], v[176:179], a[164:167], v[84:87]
    ds_read_b64_tr_b16 v[194:195], v246 offset:2048
    v_mul_f32 v201, v201, v149
    v_mfma_f32_16x16x32_bf16 v[88:91], v[176:179], a[168:171], v[88:91]
    s_add_u32 m0, s7, 131072
    s_add_u32 s64, s10, 4719616
    buffer_load_dwordx4 v252, s[44:47], s64 offen offset:0  lds
    v_fma_f32 v202, -v150, v150, s66
    v_cvt_pk_bf16_f32 v210, v160, v161
    v_mfma_f32_16x16x32_bf16 v[92:95], v[176:179], a[172:175], v[92:95]
    buffer_load_dwordx4 v253, s[44:47], s64 offen offset:1024  lds
    v_mul_f32 v162, v206, v162
    v_mfma_f32_16x16x32_bf16 v[96:99], v[180:183], a[160:163], v[96:99]
    ds_read_b64_tr_b16 v[196:197], v247 offset:0
    v_rcp_f32 v207, v207
    v_add_f32 v200, 1.0, v200
    v_mfma_f32_16x16x32_bf16 v[100:103], v[180:183], a[164:167], v[100:103]
    ds_read_b64_tr_b16 v[198:199], v247 offset:2048
    v_exp_f32 v201, v201
    v_mul_f32 v202, v202, v150
    v_mfma_f32_16x16x32_bf16 v[104:107], v[180:183], a[168:171], v[104:107]
    buffer_load_dwordx4 v254, s[44:47], s64 offen offset:2048  lds
    v_fma_f32 v203, -v151, v151, s66
    v_mfma_f32_16x16x32_bf16 v[108:111], v[180:183], a[172:175], v[108:111]
    v_mul_f32 v163, v207, v163
    v_rcp_f32 v200, v200
    s_waitcnt lgkmcnt(4)
    v_mfma_f32_16x16x32_bf16 v[48:51], v[184:187], a[176:179], v[48:51]
    s_waitcnt vmcnt(15)
    ds_read_b64_tr_b16 v[176:177], v248 offset:16384
    v_add_f32 v201, 1.0, v201
    v_mfma_f32_16x16x32_bf16 v[52:55], v[184:187], a[180:183], v[52:55]
    ds_read_b64_tr_b16 v[178:179], v248 offset:18432
    v_exp_f32 v202, v202
    v_mul_f32 v203, v203, v151
    v_mfma_f32_16x16x32_bf16 v[56:59], v[184:187], a[184:187], v[56:59]
    buffer_load_dwordx4 v255, s[44:47], s64 offen offset:3072  lds
    v_fma_f32 v204, -v164, v164, s66
    v_cvt_pk_bf16_f32 v211, v162, v163
    v_mfma_f32_16x16x32_bf16 v[60:63], v[184:187], a[188:191], v[60:63]
    v_mul_f32 v148, v200, v148
    v_mfma_f32_16x16x32_bf16 v[64:67], v[188:191], a[176:179], v[64:67]
    ds_read_b64_tr_b16 v[180:181], v249 offset:16384
    v_rcp_f32 v201, v201
    v_add_f32 v202, 1.0, v202
    v_mfma_f32_16x16x32_bf16 v[68:71], v[188:191], a[180:183], v[68:71]
    ds_read_b64_tr_b16 v[182:183], v249 offset:18432
    v_exp_f32 v203, v203
    v_mfma_f32_16x16x32_bf16 v[72:75], v[188:191], a[184:187], v[72:75]
    v_mul_f32 v204, v204, v164
    v_fma_f32 v205, -v165, v165, s66
    v_mfma_f32_16x16x32_bf16 v[76:79], v[188:191], a[188:191], v[76:79]
    ds_write_b128 v4, v[208:211] offset:49152
    v_mul_f32 v149, v201, v149
    s_waitcnt lgkmcnt(5)
    v_mfma_f32_16x16x32_bf16 v[80:83], v[192:195], a[176:179], v[80:83]
    ds_read_b64_tr_b16 v[184:185], v250 offset:16384
    v_rcp_f32 v202, v202
    v_mfma_f32_16x16x32_bf16 v[84:87], v[192:195], a[180:183], v[84:87]
    ds_read_b64_tr_b16 v[186:187], v250 offset:18432
    v_add_f32 v203, 1.0, v203
    v_exp_f32 v204, v204
    v_mfma_f32_16x16x32_bf16 v[88:91], v[192:195], a[184:187], v[88:91]
    s_add_u32 m0, s7, 65536
    s_add_u32 s64, s10, 5014528
    buffer_load_dwordx4 v252, s[44:47], s64 offen offset:0  lds
    v_mul_f32 v205, v205, v165
    v_mfma_f32_16x16x32_bf16 v[92:95], v[192:195], a[188:191], v[92:95]
    v_fma_f32 v206, -v166, v166, s66
    v_cvt_pk_bf16_f32 v212, v148, v149
    v_mfma_f32_16x16x32_bf16 v[96:99], v[196:199], a[176:179], v[96:99]
    ds_read_b64_tr_b16 v[188:189], v251 offset:16384
    v_mul_f32 v150, v202, v150
    v_mfma_f32_16x16x32_bf16 v[100:103], v[196:199], a[180:183], v[100:103]
    ds_read_b64_tr_b16 v[190:191], v251 offset:18432
    v_rcp_f32 v203, v203
    v_add_f32 v204, 1.0, v204
    v_mfma_f32_16x16x32_bf16 v[104:107], v[196:199], a[184:187], v[104:107]
    buffer_load_dwordx4 v253, s[44:47], s64 offen offset:1024  lds
    v_exp_f32 v205, v205
    v_mul_f32 v206, v206, v166
    v_mfma_f32_16x16x32_bf16 v[108:111], v[196:199], a[188:191], v[108:111]
    v_fma_f32 v207, -v167, v167, s66
    s_waitcnt lgkmcnt(5)
    v_mfma_f32_16x16x32_bf16 v[48:51], v[176:179], a[192:195], v[48:51]
    s_waitcnt vmcnt(14)
    ds_read_b64_tr_b16 v[192:193], v244 offset:16384
    v_mul_f32 v151, v203, v151
    v_rcp_f32 v204, v204
    v_mfma_f32_16x16x32_bf16 v[52:55], v[176:179], a[196:199], v[52:55]
    ds_read_b64_tr_b16 v[194:195], v244 offset:18432
    v_add_f32 v205, 1.0, v205
    v_mfma_f32_16x16x32_bf16 v[56:59], v[176:179], a[200:203], v[56:59]
    buffer_load_dwordx4 v254, s[44:47], s64 offen offset:2048  lds
    v_exp_f32 v206, v206
    v_mul_f32 v207, v207, v167
    v_mfma_f32_16x16x32_bf16 v[60:63], v[176:179], a[204:207], v[60:63]
    buffer_load_dwordx4 v255, s[44:47], s64 offen offset:3072  lds
    v_fma_f32 v200, -v152, v152, s66
    v_cvt_pk_bf16_f32 v213, v150, v151
    v_mfma_f32_16x16x32_bf16 v[64:67], v[180:183], a[192:195], v[64:67]
    ds_read_b64_tr_b16 v[196:197], v245 offset:16384
    v_mul_f32 v164, v204, v164
    v_mfma_f32_16x16x32_bf16 v[68:71], v[180:183], a[196:199], v[68:71]
    ds_read_b64_tr_b16 v[198:199], v245 offset:18432
    v_rcp_f32 v205, v205
    v_add_f32 v206, 1.0, v206
    v_mfma_f32_16x16x32_bf16 v[72:75], v[180:183], a[200:203], v[72:75]
    v_exp_f32 v207, v207
    v_mfma_f32_16x16x32_bf16 v[76:79], v[180:183], a[204:207], v[76:79]
    v_mul_f32 v200, v200, v152
    v_fma_f32 v201, -v153, v153, s66
    s_waitcnt lgkmcnt(4)
    v_mfma_f32_16x16x32_bf16 v[80:83], v[184:187], a[192:195], v[80:83]
    ds_read_b64_tr_b16 v[176:177], v246 offset:16384
    v_mul_f32 v165, v205, v165
    v_rcp_f32 v206, v206
    v_mfma_f32_16x16x32_bf16 v[84:87], v[184:187], a[196:199], v[84:87]
    ds_read_b64_tr_b16 v[178:179], v246 offset:18432
    v_add_f32 v207, 1.0, v207
    v_mfma_f32_16x16x32_bf16 v[88:91], v[184:187], a[200:203], v[88:91]
    s_add_u32 m0, s7, 147456
    s_add_u32 s64, s74, 0
    buffer_load_dwordx4 v12, s[48:51], s64 offen offset:0  lds
    v_exp_f32 v200, v200
    v_mul_f32 v201, v201, v153
    v_mfma_f32_16x16x32_bf16 v[92:95], v[184:187], a[204:207], v[92:95]
    v_fma_f32 v202, -v154, v154, s66
    v_mfma_f32_16x16x32_bf16 v[96:99], v[188:191], a[192:195], v[96:99]
    ds_read_b64_tr_b16 v[180:181], v247 offset:16384
    v_cvt_pk_bf16_f32 v214, v164, v165
    v_mul_f32 v166, v206, v166
    v_mfma_f32_16x16x32_bf16 v[100:103], v[188:191], a[196:199], v[100:103]
    ds_read_b64_tr_b16 v[182:183], v247 offset:18432
    v_rcp_f32 v207, v207
    v_add_f32 v200, 1.0, v200
    v_mfma_f32_16x16x32_bf16 v[104:107], v[188:191], a[200:203], v[104:107]
    buffer_load_dwordx4 v13, s[48:51], s64 offen offset:1024  lds
    v_exp_f32 v201, v201
    v_mfma_f32_16x16x32_bf16 v[108:111], v[188:191], a[204:207], v[108:111]
    v_mul_f32 v202, v202, v154
    v_fma_f32 v203, -v155, v155, s66
    s_waitcnt lgkmcnt(4)
    v_mfma_f32_16x16x32_bf16 v[48:51], v[192:195], a[208:211], v[48:51]
    s_waitcnt vmcnt(14)
    ds_read_b64_tr_b16 v[184:185], v244 offset:32768
    v_mul_f32 v167, v207, v167
    v_mfma_f32_16x16x32_bf16 v[52:55], v[192:195], a[212:215], v[52:55]
    ds_read_b64_tr_b16 v[186:187], v244 offset:34816
    v_rcp_f32 v200, v200
    v_add_f32 v201, 1.0, v201
    v_mfma_f32_16x16x32_bf16 v[56:59], v[192:195], a[216:219], v[56:59]
    buffer_load_dwordx4 v14, s[48:51], s64 offen offset:2048  lds
    v_exp_f32 v202, v202
    v_mul_f32 v203, v203, v155
    v_mfma_f32_16x16x32_bf16 v[60:63], v[192:195], a[220:223], v[60:63]
    v_fma_f32 v204, -v168, v168, s66
    v_mfma_f32_16x16x32_bf16 v[64:67], v[196:199], a[208:211], v[64:67]
    ds_read_b64_tr_b16 v[188:189], v245 offset:32768
    v_cvt_pk_bf16_f32 v215, v166, v167
    v_mul_f32 v152, v200, v152
    v_mfma_f32_16x16x32_bf16 v[68:71], v[196:199], a[212:215], v[68:71]
    ds_read_b64_tr_b16 v[190:191], v245 offset:34816
    v_rcp_f32 v201, v201
    v_mfma_f32_16x16x32_bf16 v[72:75], v[196:199], a[216:219], v[72:75]
    buffer_load_dwordx4 v15, s[48:51], s64 offen offset:3072  lds
    v_add_f32 v202, 1.0, v202
    v_exp_f32 v203, v203
    v_mfma_f32_16x16x32_bf16 v[76:79], v[196:199], a[220:223], v[76:79]
    v_mul_f32 v204, v204, v168
    s_waitcnt lgkmcnt(4)
    v_mfma_f32_16x16x32_bf16 v[80:83], v[176:179], a[208:211], v[80:83]
    ds_read_b64_tr_b16 v[192:193], v246 offset:32768
    v_fma_f32 v205, -v169, v169, s66
    ds_write_b128 v4, v[212:215] offset:50176
    v_mfma_f32_16x16x32_bf16 v[84:87], v[176:179], a[212:215], v[84:87]
    ds_read_b64_tr_b16 v[194:195], v246 offset:34816
    v_mul_f32 v153, v201, v153
    v_rcp_f32 v202, v202
    v_mfma_f32_16x16x32_bf16 v[88:91], v[176:179], a[216:219], v[88:91]
    s_add_u32 m0, s7, 81920
    s_add_u32 s64, s74, 36864
    buffer_load_dwordx4 v12, s[48:51], s64 offen offset:0  lds
    v_add_f32 v203, 1.0, v203
    v_mfma_f32_16x16x32_bf16 v[92:95], v[176:179], a[220:223], v[92:95]
    buffer_load_dwordx4 v13, s[48:51], s64 offen offset:1024  lds
    v_exp_f32 v204, v204
    v_mul_f32 v205, v205, v169
    v_mfma_f32_16x16x32_bf16 v[96:99], v[180:183], a[208:211], v[96:99]
    ds_read_b64_tr_b16 v[196:197], v247 offset:32768
    v_fma_f32 v206, -v170, v170, s66
    v_mfma_f32_16x16x32_bf16 v[100:103], v[180:183], a[212:215], v[100:103]
    ds_read_b64_tr_b16 v[198:199], v247 offset:34816
    v_cvt_pk_bf16_f32 v208, v152, v153
    v_mul_f32 v154, v202, v154
    v_mfma_f32_16x16x32_bf16 v[104:107], v[180:183], a[216:219], v[104:107]
    buffer_load_dwordx4 v14, s[48:51], s64 offen offset:2048  lds
    v_rcp_f32 v203, v203
    v_add_f32 v204, 1.0, v204
    v_mfma_f32_16x16x32_bf16 v[108:111], v[180:183], a[220:223], v[108:111]
    v_exp_f32 v205, v205
    s_waitcnt lgkmcnt(5)
    v_mfma_f32_16x16x32_bf16 v[48:51], v[184:187], a[224:227], v[48:51]
    s_waitcnt vmcnt(15)
    ds_read_b64_tr_b16 v[176:177], v244 offset:49152
    v_mul_f32 v206, v206, v170
    v_fma_f32 v207, -v171, v171, s66
    v_mfma_f32_16x16x32_bf16 v[52:55], v[184:187], a[228:231], v[52:55]
    ds_read_b64_tr_b16 v[178:179], v244 offset:51200
    v_mul_f32 v155, v203, v155
    v_mfma_f32_16x16x32_bf16 v[56:59], v[184:187], a[232:235], v[56:59]
    buffer_load_dwordx4 v15, s[48:51], s64 offen offset:3072  lds
    v_rcp_f32 v204, v204
    v_add_f32 v205, 1.0, v205
    v_mfma_f32_16x16x32_bf16 v[60:63], v[184:187], a[236:239], v[60:63]
    v_exp_f32 v206, v206
    v_mul_f32 v207, v207, v171
    v_mfma_f32_16x16x32_bf16 v[64:67], v[188:191], a[224:227], v[64:67]
    ds_read_b64_tr_b16 v[180:181], v245 offset:49152
    v_fma_f32 v200, -v156, v156, s66
    v_mfma_f32_16x16x32_bf16 v[68:71], v[188:191], a[228:231], v[68:71]
    ds_read_b64_tr_b16 v[182:183], v245 offset:51200
    v_cvt_pk_bf16_f32 v209, v154, v155
    v_mul_f32 v168, v204, v168
    v_mfma_f32_16x16x32_bf16 v[72:75], v[188:191], a[232:235], v[72:75]
    v_rcp_f32 v205, v205
    v_mfma_f32_16x16x32_bf16 v[76:79], v[188:191], a[236:239], v[76:79]
    v_add_f32 v206, 1.0, v206
    v_exp_f32 v207, v207
    s_waitcnt lgkmcnt(4)
    v_mfma_f32_16x16x32_bf16 v[80:83], v[192:195], a[224:227], v[80:83]
    ds_read_b64_tr_b16 v[184:185], v246 offset:49152
    v_mul_f32 v200, v200, v156
    v_fma_f32 v201, -v157, v157, s66
    v_mfma_f32_16x16x32_bf16 v[84:87], v[192:195], a[228:231], v[84:87]
    ds_read_b64_tr_b16 v[186:187], v246 offset:51200
    v_mul_f32 v169, v205, v169
    v_mfma_f32_16x16x32_bf16 v[88:91], v[192:195], a[232:235], v[88:91]
    s_add_u32 m0, s7, 98304
    s_add_u32 s64, s74, 73728
    buffer_load_dwordx4 v12, s[48:51], s64 offen offset:0  lds
    v_rcp_f32 v206, v206
    v_add_f32 v207, 1.0, v207
    v_mfma_f32_16x16x32_bf16 v[92:95], v[192:195], a[236:239], v[92:95]
    v_exp_f32 v200, v200
    v_mfma_f32_16x16x32_bf16 v[96:99], v[196:199], a[224:227], v[96:99]
    ds_read_b64_tr_b16 v[188:189], v247 offset:49152
    v_mul_f32 v201, v201, v157
    v_fma_f32 v202, -v158, v158, s66
    v_mfma_f32_16x16x32_bf16 v[100:103], v[196:199], a[228:231], v[100:103]
    ds_read_b64_tr_b16 v[190:191], v247 offset:51200
    v_cvt_pk_bf16_f32 v210, v168, v169
    v_mul_f32 v170, v206, v170
    v_mfma_f32_16x16x32_bf16 v[104:107], v[196:199], a[232:235], v[104:107]
    buffer_load_dwordx4 v13, s[48:51], s64 offen offset:1024  lds
    v_rcp_f32 v207, v207
    v_mfma_f32_16x16x32_bf16 v[108:111], v[196:199], a[236:239], v[108:111]
    v_add_f32 v200, 1.0, v200
    v_exp_f32 v201, v201
    s_waitcnt lgkmcnt(4)
    v_mfma_f32_16x16x32_bf16 v[48:51], v[176:179], a[240:243], v[48:51]
    s_waitcnt vmcnt(14)
    ds_read_b64_tr_b16 v[192:193], v248 offset:0
    v_mul_f32 v202, v202, v158
    v_mfma_f32_16x16x32_bf16 v[52:55], v[176:179], a[244:247], v[52:55]
    ds_read_b64_tr_b16 v[194:195], v248 offset:2048
    v_fma_f32 v203, -v159, v159, s66
    v_mul_f32 v171, v207, v171
    v_mfma_f32_16x16x32_bf16 v[56:59], v[176:179], a[248:251], v[56:59]
    buffer_load_dwordx4 v14, s[48:51], s64 offen offset:2048  lds
    v_rcp_f32 v200, v200
    v_mfma_f32_16x16x32_bf16 v[60:63], v[176:179], a[252:255], v[60:63]
    buffer_load_dwordx4 v15, s[48:51], s64 offen offset:3072  lds
    v_add_f32 v201, 1.0, v201
    v_exp_f32 v202, v202
    v_mfma_f32_16x16x32_bf16 v[64:67], v[180:183], a[240:243], v[64:67]
    ds_read_b64_tr_b16 v[196:197], v249 offset:0
    v_mul_f32 v203, v203, v159
    v_fma_f32 v204, -v172, v172, s66
    v_mfma_f32_16x16x32_bf16 v[68:71], v[180:183], a[244:247], v[68:71]
    ds_read_b64_tr_b16 v[198:199], v249 offset:2048
    v_cvt_pk_bf16_f32 v211, v170, v171
    v_mfma_f32_16x16x32_bf16 v[72:75], v[180:183], a[248:251], v[72:75]
    v_mul_f32 v156, v200, v156
    v_rcp_f32 v201, v201
    v_mfma_f32_16x16x32_bf16 v[76:79], v[180:183], a[252:255], v[76:79]
    v_add_f32 v202, 1.0, v202
    s_waitcnt lgkmcnt(4)
    v_mfma_f32_16x16x32_bf16 v[80:83], v[184:187], a[240:243], v[80:83]
    ds_read_b64_tr_b16 v[176:177], v250 offset:0
    v_exp_f32 v203, v203
    v_mul_f32 v204, v204, v172
    v_mfma_f32_16x16x32_bf16 v[84:87], v[184:187], a[244:247], v[84:87]
    ds_read_b64_tr_b16 v[178:179], v250 offset:2048
    v_fma_f32 v205, -v173, v173, s66
    ds_write_b128 v4, v[208:211] offset:51200
    v_mfma_f32_16x16x32_bf16 v[88:91], v[184:187], a[248:251], v[88:91]
    s_add_u32 m0, s7, 114688
    s_add_u32 s64, s74, 110592
    buffer_load_dwordx4 v12, s[48:51], s64 offen offset:0  lds
    v_mul_f32 v157, v201, v157
    v_mfma_f32_16x16x32_bf16 v[92:95], v[184:187], a[252:255], v[92:95]
    v_rcp_f32 v202, v202
    v_add_f32 v203, 1.0, v203
    v_mfma_f32_16x16x32_bf16 v[96:99], v[188:191], a[240:243], v[96:99]
    ds_read_b64_tr_b16 v[180:181], v251 offset:0
    v_exp_f32 v204, v204
    v_mfma_f32_16x16x32_bf16 v[100:103], v[188:191], a[244:247], v[100:103]
    ds_read_b64_tr_b16 v[182:183], v251 offset:2048
    v_mul_f32 v205, v205, v173
    v_fma_f32 v206, -v174, v174, s66
    v_mfma_f32_16x16x32_bf16 v[104:107], v[188:191], a[248:251], v[104:107]
    buffer_load_dwordx4 v13, s[48:51], s64 offen offset:1024  lds
    v_cvt_pk_bf16_f32 v212, v156, v157
    v_mul_f32 v158, v202, v158
    v_mfma_f32_16x16x32_bf16 v[108:111], v[188:191], a[252:255], v[108:111]
    v_rcp_f32 v203, v203
    s_waitcnt lgkmcnt(5)
    v_mfma_f32_16x16x32_bf16 v[48:51], v[192:195], v[16:19], v[48:51]
    s_waitcnt vmcnt(14)
    ds_read_b64_tr_b16 v[184:185], v244 offset:0
    v_add_f32 v204, 1.0, v204
    v_exp_f32 v205, v205
    v_mfma_f32_16x16x32_bf16 v[52:55], v[192:195], v[20:23], v[52:55]
    ds_read_b64_tr_b16 v[186:187], v244 offset:2048
    v_mul_f32 v206, v206, v174
    v_mfma_f32_16x16x32_bf16 v[56:59], v[192:195], v[24:27], v[56:59]
    buffer_load_dwordx4 v14, s[48:51], s64 offen offset:2048  lds
    v_fma_f32 v207, -v175, v175, s66
    v_mul_f32 v159, v203, v159
    v_mfma_f32_16x16x32_bf16 v[60:63], v[192:195], v[28:31], v[60:63]
    v_rcp_f32 v204, v204
    v_add_f32 v205, 1.0, v205
    v_mfma_f32_16x16x32_bf16 v[64:67], v[196:199], v[16:19], v[64:67]
    ds_read_b64_tr_b16 v[188:189], v245 offset:0
    v_exp_f32 v206, v206
    v_mfma_f32_16x16x32_bf16 v[68:71], v[196:199], v[20:23], v[68:71]
    ds_read_b64_tr_b16 v[190:191], v245 offset:2048
    v_mul_f32 v207, v207, v175
    v_cvt_pk_bf16_f32 v213, v158, v159
    v_mfma_f32_16x16x32_bf16 v[72:75], v[196:199], v[24:27], v[72:75]
    buffer_load_dwordx4 v15, s[48:51], s64 offen offset:3072  lds
    v_mul_f32 v172, v204, v172
    v_mfma_f32_16x16x32_bf16 v[76:79], v[196:199], v[28:31], v[76:79]
    v_rcp_f32 v205, v205
    v_add_f32 v206, 1.0, v206
    s_waitcnt lgkmcnt(4)
    v_mfma_f32_16x16x32_bf16 v[80:83], v[176:179], v[16:19], v[80:83]
    ds_read_b64_tr_b16 v[192:193], v246 offset:0
    v_exp_f32 v207, v207
    v_mul_f32 v173, v205, v173
    v_mfma_f32_16x16x32_bf16 v[84:87], v[176:179], v[20:23], v[84:87]
    ds_read_b64_tr_b16 v[194:195], v246 offset:2048
    v_rcp_f32 v206, v206
    v_mfma_f32_16x16x32_bf16 v[88:91], v[176:179], v[24:27], v[88:91]
    s_add_u32 m0, s7, 131072
    s_add_u32 s64, s74, 147456
    buffer_load_dwordx4 v12, s[48:51], s64 offen offset:0  lds
    v_add_f32 v207, 1.0, v207
    v_cvt_pk_bf16_f32 v214, v172, v173
    v_mfma_f32_16x16x32_bf16 v[92:95], v[176:179], v[28:31], v[92:95]
    buffer_load_dwordx4 v13, s[48:51], s64 offen offset:1024  lds
    v_mul_f32 v174, v206, v174
    v_mfma_f32_16x16x32_bf16 v[96:99], v[180:183], v[16:19], v[96:99]
    ds_read_b64_tr_b16 v[196:197], v247 offset:0
    v_rcp_f32 v207, v207
    s_nop 0
    v_mul_f32 v175, v207, v175
    v_mfma_f32_16x16x32_bf16 v[100:103], v[180:183], v[20:23], v[100:103]
    ds_read_b64_tr_b16 v[198:199], v247 offset:2048
    v_cvt_pk_bf16_f32 v215, v174, v175
    v_mfma_f32_16x16x32_bf16 v[104:107], v[180:183], v[24:27], v[104:107]
    buffer_load_dwordx4 v14, s[48:51], s64 offen offset:2048  lds
    ds_write_b128 v4, v[212:215] offset:52224
    v_mfma_f32_16x16x32_bf16 v[108:111], v[180:183], v[28:31], v[108:111]
    s_waitcnt lgkmcnt(5)
    v_mfma_f32_16x16x32_bf16 v[48:51], v[184:187], v[32:35], v[48:51]
    s_waitcnt vmcnt(15)
    ds_read_b64_tr_b16 v[176:177], v248 offset:16384
    v_mfma_f32_16x16x32_bf16 v[52:55], v[184:187], v[36:39], v[52:55]
    ds_read_b64_tr_b16 v[178:179], v248 offset:18432
    v_mfma_f32_16x16x32_bf16 v[56:59], v[184:187], v[40:43], v[56:59]
    buffer_load_dwordx4 v15, s[48:51], s64 offen offset:3072  lds
    v_mfma_f32_16x16x32_bf16 v[60:63], v[184:187], v[44:47], v[60:63]
    v_mfma_f32_16x16x32_bf16 v[64:67], v[188:191], v[32:35], v[64:67]
    ds_read_b64_tr_b16 v[180:181], v249 offset:16384
    v_mfma_f32_16x16x32_bf16 v[68:71], v[188:191], v[36:39], v[68:71]
    ds_read_b64_tr_b16 v[182:183], v249 offset:18432
    v_mfma_f32_16x16x32_bf16 v[72:75], v[188:191], v[40:43], v[72:75]
    v_mfma_f32_16x16x32_bf16 v[76:79], v[188:191], v[44:47], v[76:79]
    s_waitcnt lgkmcnt(5)
    v_mfma_f32_16x16x32_bf16 v[80:83], v[192:195], v[32:35], v[80:83]
    ds_read_b64_tr_b16 v[184:185], v250 offset:16384
    v_mfma_f32_16x16x32_bf16 v[84:87], v[192:195], v[36:39], v[84:87]
    ds_read_b64_tr_b16 v[186:187], v250 offset:18432
    v_mfma_f32_16x16x32_bf16 v[88:91], v[192:195], v[40:43], v[88:91]
    v_mfma_f32_16x16x32_bf16 v[92:95], v[192:195], v[44:47], v[92:95]
    v_mfma_f32_16x16x32_bf16 v[96:99], v[196:199], v[32:35], v[96:99]
    ds_read_b64_tr_b16 v[188:189], v251 offset:16384
    v_mfma_f32_16x16x32_bf16 v[100:103], v[196:199], v[36:39], v[100:103]
    ds_read_b64_tr_b16 v[190:191], v251 offset:18432
    v_mfma_f32_16x16x32_bf16 v[104:107], v[196:199], v[40:43], v[104:107]
    v_mfma_f32_16x16x32_bf16 v[108:111], v[196:199], v[44:47], v[108:111]
    s_waitcnt lgkmcnt(8)
    s_barrier
    ds_read_b128 a[128:131], v2 offset:32768
    s_waitcnt lgkmcnt(5)
    v_mfma_f32_16x16x32_bf16 v[112:115], v[176:179], a[0:3], 0
    s_waitcnt vmcnt(12)
    ds_read_b64_tr_b16 v[192:193], v244 offset:16384
    v_mfma_f32_16x16x32_bf16 v[116:119], v[176:179], a[4:7], 0
    ds_read_b64_tr_b16 v[194:195], v244 offset:18432
    v_mfma_f32_16x16x32_bf16 v[120:123], v[176:179], a[8:11], 0
    s_add_u32 m0, s7, 0
    s_add_u32 s64, s74, 184320
    buffer_load_dwordx4 v12, s[48:51], s64 offen offset:0  lds
    v_mfma_f32_16x16x32_bf16 v[124:127], v[176:179], a[12:15], 0
    buffer_load_dwordx4 v13, s[48:51], s64 offen offset:1024  lds
    v_fma_f32 v200, -v48, v48, s66
    v_mul_f32 v200, v200, v48
    ds_read_b128 a[132:135], v2 offset:33792
    v_mfma_f32_16x16x32_bf16 v[128:131], v[180:183], a[0:3], 0
    ds_read_b64_tr_b16 v[196:197], v245 offset:16384
    v_fma_f32 v201, -v49, v49, s66
    v_exp_f32 v200, v200
    v_mfma_f32_16x16x32_bf16 v[132:135], v[180:183], a[4:7], 0
    ds_read_b64_tr_b16 v[198:199], v245 offset:18432
    v_mul_f32 v201, v201, v49
    v_fma_f32 v202, -v50, v50, s66
    v_mfma_f32_16x16x32_bf16 v[136:139], v[180:183], a[8:11], 0
    buffer_load_dwordx4 v14, s[48:51], s64 offen offset:2048  lds
    v_add_f32 v200, 1.0, v200
    v_exp_f32 v201, v201
    v_mul_f32 v202, v202, v50
    v_mfma_f32_16x16x32_bf16 v[140:143], v[180:183], a[12:15], 0
    v_fma_f32 v203, -v51, v51, s66
    v_rcp_f32 v200, v200
    ds_read_b128 a[136:139], v2 offset:34816
    s_waitcnt lgkmcnt(7)
    v_mfma_f32_16x16x32_bf16 v[144:147], v[184:187], a[0:3], 0
    ds_read_b64_tr_b16 v[176:177], v246 offset:16384
    v_add_f32 v201, 1.0, v201
    v_exp_f32 v202, v202
    v_mfma_f32_16x16x32_bf16 v[148:151], v[184:187], a[4:7], 0
    ds_read_b64_tr_b16 v[178:179], v246 offset:18432
    v_mul_f32 v203, v203, v51
    v_fma_f32 v204, -v64, v64, s66
    v_mfma_f32_16x16x32_bf16 v[152:155], v[184:187], a[8:11], 0
    buffer_load_dwordx4 v15, s[48:51], s64 offen offset:3072  lds
    v_mul_f32 v48, v200, v48
    v_rcp_f32 v201, v201
    v_mfma_f32_16x16x32_bf16 v[156:159], v[184:187], a[12:15], 0
    v_add_f32 v202, 1.0, v202
    v_exp_f32 v203, v203
    ds_read_b128 a[140:143], v2 offset:35840
    v_mfma_f32_16x16x32_bf16 v[160:163], v[188:191], a[0:3], 0
    ds_read_b64_tr_b16 v[180:181], v247 offset:16384
    v_mul_f32 v204, v204, v64
    v_fma_f32 v205, -v65, v65, s66
    v_mfma_f32_16x16x32_bf16 v[164:167], v[188:191], a[4:7], 0
    ds_read_b64_tr_b16 v[182:183], v247 offset:18432
    v_mul_f32 v49, v201, v49
    v_rcp_f32 v202, v202
    v_add_f32 v203, 1.0, v203
    v_mfma_f32_16x16x32_bf16 v[168:171], v[188:191], a[8:11], 0
    s_add_u32 m0, s7, 16384
    s_add_u32 s64, s74, 221184
    buffer_load_dwordx4 v12, s[48:51], s64 offen offset:0  lds
    v_exp_f32 v204, v204
    v_mul_f32 v205, v205, v65
    v_mfma_f32_16x16x32_bf16 v[172:175], v[188:191], a[12:15], 0
    v_fma_f32 v206, -v66, v66, s66
    v_cvt_pk_bf16_f32 v208, v48, v49
    ds_read_b128 a[144:147], v2 offset:49152
    s_waitcnt lgkmcnt(7)
    v_mfma_f32_16x16x32_bf16 v[112:115], v[192:195], a[16:19], v[112:115]
    s_waitcnt vmcnt(13)
    ds_read_b64_tr_b16 v[184:185], v244 offset:32768
    v_mul_f32 v50, v202, v50
    v_rcp_f32 v203, v203
    v_mfma_f32_16x16x32_bf16 v[116:119], v[192:195], a[20:23], v[116:119]
    ds_read_b64_tr_b16 v[186:187], v244 offset:34816
    v_add_f32 v204, 1.0, v204
    v_exp_f32 v205, v205
    v_mfma_f32_16x16x32_bf16 v[120:123], v[192:195], a[24:27], v[120:123]
    buffer_load_dwordx4 v13, s[48:51], s64 offen offset:1024  lds
    v_mul_f32 v206, v206, v66
    v_fma_f32 v207, -v67, v67, s66
    v_mfma_f32_16x16x32_bf16 v[124:127], v[192:195], a[28:31], v[124:127]
    v_mul_f32 v51, v203, v51
    v_rcp_f32 v204, v204
    ds_read_b128 a[148:151], v2 offset:50176
    v_mfma_f32_16x16x32_bf16 v[128:131], v[196:199], a[16:19], v[128:131]
    ds_read_b64_tr_b16 v[188:189], v245 offset:32768
    v_add_f32 v205, 1.0, v205
    v_exp_f32 v206, v206
    v_mul_f32 v207, v207, v67
    v_mfma_f32_16x16x32_bf16 v[132:135], v[196:199], a[20:23], v[132:135]
    ds_read_b64_tr_b16 v[190:191], v245 offset:34816
    v_fma_f32 v200, -v52, v52, s66
    v_cvt_pk_bf16_f32 v209, v50, v51
    v_mfma_f32_16x16x32_bf16 v[136:139], v[196:199], a[24:27], v[136:139]
    buffer_load_dwordx4 v14, s[48:51], s64 offen offset:2048  lds
    v_mul_f32 v64, v204, v64
    v_rcp_f32 v205, v205
    v_mfma_f32_16x16x32_bf16 v[140:143], v[196:199], a[28:31], v[140:143]
    v_add_f32 v206, 1.0, v206
    v_exp_f32 v207, v207
    ds_read_b128 a[152:155], v2 offset:51200
    s_waitcnt lgkmcnt(7)
    v_mfma_f32_16x16x32_bf16 v[144:147], v[176:179], a[16:19], v[144:147]
    ds_read_b64_tr_b16 v[192:193], v246 offset:32768
    v_mul_f32 v200, v200, v52
    v_fma_f32 v201, -v53, v53, s66
    v_mfma_f32_16x16x32_bf16 v[148:151], v[176:179], a[20:23], v[148:151]
    ds_read_b64_tr_b16 v[194:195], v246 offset:34816
    v_mul_f32 v65, v205, v65
    v_rcp_f32 v206, v206
    v_mfma_f32_16x16x32_bf16 v[152:155], v[176:179], a[24:27], v[152:155]
    buffer_load_dwordx4 v15, s[48:51], s64 offen offset:3072  lds
    v_add_f32 v207, 1.0, v207
    v_exp_f32 v200, v200
    v_mul_f32 v201, v201, v53
    v_mfma_f32_16x16x32_bf16 v[156:159], v[176:179], a[28:31], v[156:159]
    s_add_u32 m0, s7, 147456
    s_add_u32 s64, s74, 258048
    buffer_load_dwordx4 v12, s[48:51], s64 offen offset:0  lds
    v_fma_f32 v202, -v54, v54, s66
    v_cvt_pk_bf16_f32 v210, v64, v65
    ds_read_b128 a[156:159], v2 offset:52224
    v_mfma_f32_16x16x32_bf16 v[160:163], v[180:183], a[16:19], v[160:163]
    ds_read_b64_tr_b16 v[196:197], v247 offset:32768
    v_mul_f32 v66, v206, v66
    v_rcp_f32 v207, v207
    v_mfma_f32_16x16x32_bf16 v[164:167], v[180:183], a[20:23], v[164:167]
    ds_read_b64_tr_b16 v[198:199], v247 offset:34816
    v_add_f32 v200, 1.0, v200
    v_exp_f32 v201, v201
    v_mfma_f32_16x16x32_bf16 v[168:171], v[180:183], a[24:27], v[168:171]
    buffer_load_dwordx4 v13, s[48:51], s64 offen offset:1024  lds
    v_mul_f32 v202, v202, v54
    v_fma_f32 v203, -v55, v55, s66
    v_mfma_f32_16x16x32_bf16 v[172:175], v[180:183], a[28:31], v[172:175]
    v_mul_f32 v67, v207, v67
    v_rcp_f32 v200, v200
    ds_read_b128 a[160:163], v2 offset:36864
    s_waitcnt lgkmcnt(7)
    v_mfma_f32_16x16x32_bf16 v[112:115], v[184:187], a[32:35], v[112:115]
    s_waitcnt vmcnt(14)
    ds_read_b64_tr_b16 v[176:177], v244 offset:49152
    v_add_f32 v201, 1.0, v201
    v_exp_f32 v202, v202
    v_mfma_f32_16x16x32_bf16 v[116:119], v[184:187], a[36:39], v[116:119]
    ds_read_b64_tr_b16 v[178:179], v244 offset:51200
    v_mul_f32 v203, v203, v55
    v_fma_f32 v204, -v68, v68, s66
    v_cvt_pk_bf16_f32 v211, v66, v67
    v_mfma_f32_16x16x32_bf16 v[120:123], v[184:187], a[40:43], v[120:123]
    buffer_load_dwordx4 v14, s[48:51], s64 offen offset:2048  lds
    v_mul_f32 v52, v200, v52
    v_rcp_f32 v201, v201
    v_mfma_f32_16x16x32_bf16 v[124:127], v[184:187], a[44:47], v[124:127]
    v_add_f32 v202, 1.0, v202
    v_exp_f32 v203, v203
    ds_read_b128 a[164:167], v2 offset:37888
    v_mfma_f32_16x16x32_bf16 v[128:131], v[188:191], a[32:35], v[128:131]
    ds_read_b64_tr_b16 v[180:181], v245 offset:49152
    v_mul_f32 v204, v204, v68
    v_fma_f32 v205, -v69, v69, s66
    v_mfma_f32_16x16x32_bf16 v[132:135], v[188:191], a[36:39], v[132:135]
    ds_read_b64_tr_b16 v[182:183], v245 offset:51200
    ds_write_b128 v5, v[208:211] offset:0
    v_mul_f32 v53, v201, v53
    v_mfma_f32_16x16x32_bf16 v[136:139], v[188:191], a[40:43], v[136:139]
    buffer_load_dwordx4 v15, s[48:51], s64 offen offset:3072  lds
    v_rcp_f32 v202, v202
    v_add_f32 v203, 1.0, v203
    v_mfma_f32_16x16x32_bf16 v[140:143], v[188:191], a[44:47], v[140:143]
    v_exp_f32 v204, v204
    v_mul_f32 v205, v205, v69
    ds_read_b128 a[168:171], v2 offset:38912
    s_waitcnt lgkmcnt(8)
    v_mfma_f32_16x16x32_bf16 v[144:147], v[192:195], a[32:35], v[144:147]
    ds_read_b64_tr_b16 v[184:185], v246 offset:49152
    v_fma_f32 v206, -v70, v70, s66
    v_cvt_pk_bf16_f32 v212, v52, v53
    v_mul_f32 v54, v202, v54
    v_mfma_f32_16x16x32_bf16 v[148:151], v[192:195], a[36:39], v[148:151]
    ds_read_b64_tr_b16 v[186:187], v246 offset:51200
    v_rcp_f32 v203, v203
    v_add_f32 v204, 1.0, v204
    v_mfma_f32_16x16x32_bf16 v[152:155], v[192:195], a[40:43], v[152:155]
    s_add_u32 m0, s7, 98304
    s_add_u32 s64, s74, 294912
    buffer_load_dwordx4 v12, s[48:51], s64 offen offset:0  lds
    v_exp_f32 v205, v205
    v_mul_f32 v206, v206, v70
    v_mfma_f32_16x16x32_bf16 v[156:159], v[192:195], a[44:47], v[156:159]
    v_fma_f32 v207, -v71, v71, s66
    v_mul_f32 v55, v203, v55
    ds_read_b128 a[172:175], v2 offset:39936
    v_mfma_f32_16x16x32_bf16 v[160:163], v[196:199], a[32:35], v[160:163]
    ds_read_b64_tr_b16 v[188:189], v247 offset:49152
    v_rcp_f32 v204, v204
    v_add_f32 v205, 1.0, v205
    v_mfma_f32_16x16x32_bf16 v[164:167], v[196:199], a[36:39], v[164:167]
    ds_read_b64_tr_b16 v[190:191], v247 offset:51200
    v_exp_f32 v206, v206
    v_mul_f32 v207, v207, v71
    v_mfma_f32_16x16x32_bf16 v[168:171], v[196:199], a[40:43], v[168:171]
    buffer_load_dwordx4 v13, s[48:51], s64 offen offset:1024  lds
    v_fma_f32 v200, -v56, v56, s66
    v_cvt_pk_bf16_f32 v213, v54, v55
    v_mul_f32 v68, v204, v68
    v_mfma_f32_16x16x32_bf16 v[172:175], v[196:199], a[44:47], v[172:175]
    v_rcp_f32 v205, v205
    v_add_f32 v206, 1.0, v206
    ds_read_b128 a[176:179], v2 offset:53248
    s_waitcnt lgkmcnt(8)
    v_mfma_f32_16x16x32_bf16 v[112:115], v[176:179], a[48:51], v[112:115]
    s_waitcnt vmcnt(14)
    ds_read_b64_tr_b16 v[192:193], v248 offset:0
    v_exp_f32 v207, v207
    v_mul_f32 v200, v200, v56
    v_mfma_f32_16x16x32_bf16 v[116:119], v[176:179], a[52:55], v[116:119]
    ds_read_b64_tr_b16 v[194:195], v248 offset:2048
    v_fma_f32 v201, -v57, v57, s66
    v_mul_f32 v69, v205, v69
    v_mfma_f32_16x16x32_bf16 v[120:123], v[176:179], a[56:59], v[120:123]
    buffer_load_dwordx4 v14, s[48:51], s64 offen offset:2048  lds
    v_rcp_f32 v206, v206
    v_add_f32 v207, 1.0, v207
    v_mfma_f32_16x16x32_bf16 v[124:127], v[176:179], a[60:63], v[124:127]
    buffer_load_dwordx4 v15, s[48:51], s64 offen offset:3072  lds
    v_exp_f32 v200, v200
    v_mul_f32 v201, v201, v57
    ds_read_b128 a[180:183], v2 offset:54272
    v_mfma_f32_16x16x32_bf16 v[128:131], v[180:183], a[48:51], v[128:131]
    ds_read_b64_tr_b16 v[196:197], v249 offset:0
    v_fma_f32 v202, -v58, v58, s66
    v_cvt_pk_bf16_f32 v214, v68, v69
    v_mfma_f32_16x16x32_bf16 v[132:135], v[180:183], a[52:55], v[132:135]
    ds_read_b64_tr_b16 v[198:199], v249 offset:2048
    v_mul_f32 v70, v206, v70
    v_rcp_f32 v207, v207
    v_add_f32 v200, 1.0, v200
    v_mfma_f32_16x16x32_bf16 v[136:139], v[180:183], a[56:59], v[136:139]
    v_exp_f32 v201, v201
    v_mul_f32 v202, v202, v58
    v_mfma_f32_16x16x32_bf16 v[140:143], v[180:183], a[60:63], v[140:143]
    v_fma_f32 v203, -v59, v59, s66
    v_mul_f32 v71, v207, v71
    ds_read_b128 a[184:187], v2 offset:55296
    s_waitcnt lgkmcnt(7)
    v_mfma_f32_16x16x32_bf16 v[144:147], v[184:187], a[48:51], v[144:147]
    ds_read_b64_tr_b16 v[176:177], v250 offset:0
    v_rcp_f32 v200, v200
    v_add_f32 v201, 1.0, v201
    v_mfma_f32_16x16x32_bf16 v[148:151], v[184:187], a[52:55], v[148:151]
    ds_read_b64_tr_b16 v[178:179], v250 offset:2048
    v_exp_f32 v202, v202
    v_mul_f32 v203, v203, v59
    v_mfma_f32_16x16x32_bf16 v[152:155], v[184:187], a[56:59], v[152:155]
    s_add_u32 m0, s7, 114688
    s_add_u32 s64, s74, 331776
    buffer_load_dwordx4 v12, s[48:51], s64 offen offset:0  lds
    v_fma_f32 v204, -v72, v72, s66
    v_cvt_pk_bf16_f32 v215, v70, v71
    v_mfma_f32_16x16x32_bf16 v[156:159], v[184:187], a[60:63], v[156:159]
    v_mul_f32 v56, v200, v56
    v_rcp_f32 v201, v201
    ds_read_b128 a[188:191], v2 offset:56320
    v_mfma_f32_16x16x32_bf16 v[160:163], v[188:191], a[48:51], v[160:163]
    ds_read_b64_tr_b16 v[180:181], v251 offset:0
    v_add_f32 v202, 1.0, v202
    v_exp_f32 v203, v203
    v_mul_f32 v204, v204, v72
    v_mfma_f32_16x16x32_bf16 v[164:167], v[188:191], a[52:55], v[164:167]
    ds_read_b64_tr_b16 v[182:183], v251 offset:2048
    v_fma_f32 v205, -v73, v73, s66
    ds_write_b128 v5, v[212:215] offset:1024
    v_mfma_f32_16x16x32_bf16 v[168:171], v[188:191], a[56:59], v[168:171]
    buffer_load_dwordx4 v13, s[48:51], s64 offen offset:1024  lds
    v_mul_f32 v57, v201, v57
    v_rcp_f32 v202, v202
    v_mfma_f32_16x16x32_bf16 v[172:175], v[188:191], a[60:63], v[172:175]
    v_add_f32 v203, 1.0, v203
    v_exp_f32 v204, v204
    ds_read_b128 a[192:195], v2 offset:40960
    s_waitcnt lgkmcnt(8)
    v_mfma_f32_16x16x32_bf16 v[112:115], v[192:195], a[64:67], v[112:115]
    s_waitcnt vmcnt(14)
    ds_read_b64_tr_b16 v[184:185], v240 offset:0
    v_mul_f32 v205, v205, v73
    v_fma_f32 v206, -v74, v74, s66
    v_mfma_f32_16x16x32_bf16 v[116:119], v[192:195], a[68:71], v[116:119]
    ds_read_b64_tr_b16 v[186:187], v240 offset:2048
    v_cvt_pk_bf16_f32 v208, v56, v57
    v_mul_f32 v58, v202, v58
    v_mfma_f32_16x16x32_bf16 v[120:123], v[192:195], a[72:75], v[120:123]
    buffer_load_dwordx4 v14, s[48:51], s64 offen offset:2048  lds
    v_rcp_f32 v203, v203
    v_add_f32 v204, 1.0, v204
    v_exp_f32 v205, v205
    v_mfma_f32_16x16x32_bf16 v[124:127], v[192:195], a[76:79], v[124:127]
    v_mul_f32 v206, v206, v74
    v_fma_f32 v207, -v75, v75, s66
    ds_read_b128 a[196:199], v2 offset:41984
    v_mfma_f32_16x16x32_bf16 v[128:131], v[196:199], a[64:67], v[128:131]
    ds_read_b64_tr_b16 v[188:189], v241 offset:0
    v_mul_f32 v59, v203, v59
    v_rcp_f32 v204, v204
    v_mfma_f32_16x16x32_bf16 v[132:135], v[196:199], a[68:71], v[132:135]
    ds_read_b64_tr_b16 v[190:191], v241 offset:2048
    v_add_f32 v205, 1.0, v205
    v_exp_f32 v206, v206
    v_mfma_f32_16x16x32_bf16 v[136:139], v[196:199], a[72:75], v[136:139]
    buffer_load_dwordx4 v15, s[48:51], s64 offen offset:3072  lds
    v_mul_f32 v207, v207, v75
    v_fma_f32 v200, -v60, v60, s66
    v_mfma_f32_16x16x32_bf16 v[140:143], v[196:199], a[76:79], v[140:143]
    v_cvt_pk_bf16_f32 v209, v58, v59
    v_mul_f32 v72, v204, v72
    ds_read_b128 a[200:203], v2 offset:43008
    s_waitcnt lgkmcnt(8)
    v_mfma_f32_16x16x32_bf16 v[144:147], v[176:179], a[64:67], v[144:147]
    ds_read_b64_tr_b16 v[192:193], v242 offset:0
    v_rcp_f32 v205, v205
    v_add_f32 v206, 1.0, v206
    v_mfma_f32_16x16x32_bf16 v[148:151], v[176:179], a[68:71], v[148:151]
    ds_read_b64_tr_b16 v[194:195], v242 offset:2048
    v_exp_f32 v207, v207
    v_mul_f32 v200, v200, v60
    v_fma_f32 v201, -v61, v61, s66
    v_mfma_f32_16x16x32_bf16 v[152:155], v[176:179], a[72:75], v[152:155]
    s_add_u32 m0, s7, 131072
    s_add_u32 s64, s74, 368640
    buffer_load_dwordx4 v12, s[48:51], s64 offen offset:0  lds
    v_mul_f32 v73, v205, v73
    v_rcp_f32 v206, v206
    v_mfma_f32_16x16x32_bf16 v[156:159], v[176:179], a[76:79], v[156:159]
    buffer_load_dwordx4 v13, s[48:51], s64 offen offset:1024  lds
    v_add_f32 v207, 1.0, v207
    v_exp_f32 v200, v200
    ds_read_b128 a[204:207], v2 offset:44032
    v_mfma_f32_16x16x32_bf16 v[160:163], v[180:183], a[64:67], v[160:163]
    ds_read_b64_tr_b16 v[196:197], v243 offset:0
    v_mul_f32 v201, v201, v61
    v_fma_f32 v202, -v62, v62, s66
    v_mfma_f32_16x16x32_bf16 v[164:167], v[180:183], a[68:71], v[164:167]
    ds_read_b64_tr_b16 v[198:199], v243 offset:2048
    v_cvt_pk_bf16_f32 v210, v72, v73
    v_mul_f32 v74, v206, v74
    v_mfma_f32_16x16x32_bf16 v[168:171], v[180:183], a[72:75], v[168:171]
    buffer_load_dwordx4 v14, s[48:51], s64 offen offset:2048  lds
    v_rcp_f32 v207, v207
    v_add_f32 v200, 1.0, v200
    v_mfma_f32_16x16x32_bf16 v[172:175], v[180:183], a[76:79], v[172:175]
    v_exp_f32 v201, v201
    v_mul_f32 v202, v202, v62
    ds_read_b128 a[208:211], v2 offset:57344
    s_waitcnt lgkmcnt(7)
    v_mfma_f32_16x16x32_bf16 v[112:115], v[184:187], a[80:83], v[112:115]
    s_waitcnt vmcnt(15)
    ds_read_b64_tr_b16 v[176:177], v240 offset:16384
    v_fma_f32 v203, -v63, v63, s66
    v_mul_f32 v75, v207, v75
    v_rcp_f32 v200, v200
    v_mfma_f32_16x16x32_bf16 v[116:119], v[184:187], a[84:87], v[116:119]
    ds_read_b64_tr_b16 v[178:179], v240 offset:18432
    v_add_f32 v201, 1.0, v201
    v_exp_f32 v202, v202
    v_mfma_f32_16x16x32_bf16 v[120:123], v[184:187], a[88:91], v[120:123]
    buffer_load_dwordx4 v15, s[48:51], s64 offen offset:3072  lds
    v_mul_f32 v203, v203, v63
    v_fma_f32 v204, -v76, v76, s66
    v_mfma_f32_16x16x32_bf16 v[124:127], v[184:187], a[92:95], v[124:127]
    v_cvt_pk_bf16_f32 v211, v74, v75
    v_mul_f32 v60, v200, v60
    ds_read_b128 a[212:215], v2 offset:58368
    v_mfma_f32_16x16x32_bf16 v[128:131], v[188:191], a[80:83], v[128:131]
    ds_read_b64_tr_b16 v[180:181], v241 offset:16384
    v_rcp_f32 v201, v201
    v_add_f32 v202, 1.0, v202
    v_mfma_f32_16x16x32_bf16 v[132:135], v[188:191], a[84:87], v[132:135]
    ds_read_b64_tr_b16 v[182:183], v241 offset:18432
    v_exp_f32 v203, v203
    v_mul_f32 v204, v204, v76
    v_mfma_f32_16x16x32_bf16 v[136:139], v[188:191], a[88:91], v[136:139]
    v_fma_f32 v205, -v77, v77, s66
    ds_write_b128 v5, v[208:211] offset:2048
    v_mul_f32 v61, v201, v61
    v_mfma_f32_16x16x32_bf16 v[140:143], v[188:191], a[92:95], v[140:143]
    v_rcp_f32 v202, v202
    v_add_f32 v203, 1.0, v203
    ds_read_b128 a[216:219], v2 offset:59392
    s_waitcnt lgkmcnt(8)
    v_mfma_f32_16x16x32_bf16 v[144:147], v[192:195], a[80:83], v[144:147]
    ds_read_b64_tr_b16 v[184:185], v242 offset:16384
    v_exp_f32 v204, v204
    v_mul_f32 v205, v205, v77
    v_mfma_f32_16x16x32_bf16 v[148:151], v[192:195], a[84:87], v[148:151]
    ds_read_b64_tr_b16 v[186:187], v242 offset:18432
    v_fma_f32 v206, -v78, v78, s66
    v_cvt_pk_bf16_f32 v212, v60, v61
    v_mfma_f32_16x16x32_bf16 v[152:155], v[192:195], a[88:91], v[152:155]
    s_add_u32 m0, s7, 0
    s_add_u32 s64, s74, 405504
    buffer_load_dwordx4 v12, s[48:51], s64 offen offset:0  lds
    v_mul_f32 v62, v202, v62
    v_rcp_f32 v203, v203
    v_mfma_f32_16x16x32_bf16 v[156:159], v[192:195], a[92:95], v[156:159]
    v_add_f32 v204, 1.0, v204
    v_exp_f32 v205, v205
    ds_read_b128 a[220:223], v2 offset:60416
    v_mfma_f32_16x16x32_bf16 v[160:163], v[196:199], a[80:83], v[160:163]
    ds_read_b64_tr_b16 v[188:189], v243 offset:16384
    v_mul_f32 v206, v206, v78
    v_fma_f32 v207, -v79, v79, s66
    v_mfma_f32_16x16x32_bf16 v[164:167], v[196:199], a[84:87], v[164:167]
    ds_read_b64_tr_b16 v[190:191], v243 offset:18432
    v_mul_f32 v63, v203, v63
    v_rcp_f32 v204, v204
    v_add_f32 v205, 1.0, v205
    v_mfma_f32_16x16x32_bf16 v[168:171], v[196:199], a[88:91], v[168:171]
    buffer_load_dwordx4 v13, s[48:51], s64 offen offset:1024  lds
    v_exp_f32 v206, v206
    v_mul_f32 v207, v207, v79
    v_mfma_f32_16x16x32_bf16 v[172:175], v[196:199], a[92:95], v[172:175]
    v_fma_f32 v200, -v80, v80, s66
    v_cvt_pk_bf16_f32 v213, v62, v63
    ds_read_b128 a[224:227], v2 offset:45056
    s_waitcnt lgkmcnt(8)
    v_mfma_f32_16x16x32_bf16 v[112:115], v[176:179], a[96:99], v[112:115]
    s_waitcnt vmcnt(14)
    ds_read_b64_tr_b16 v[192:193], v248 offset:16384
    v_mul_f32 v76, v204, v76
    v_rcp_f32 v205, v205
    v_mfma_f32_16x16x32_bf16 v[116:119], v[176:179], a[100:103], v[116:119]
    ds_read_b64_tr_b16 v[194:195], v248 offset:18432
    v_add_f32 v206, 1.0, v206
    v_exp_f32 v207, v207
    v_mfma_f32_16x16x32_bf16 v[120:123], v[176:179], a[104:107], v[120:123]
    buffer_load_dwordx4 v14, s[48:51], s64 offen offset:2048  lds
    v_mul_f32 v200, v200, v80
    v_fma_f32 v201, -v81, v81, s66
    v_mfma_f32_16x16x32_bf16 v[124:127], v[176:179], a[108:111], v[124:127]
    buffer_load_dwordx4 v15, s[48:51], s64 offen offset:3072  lds
    v_mul_f32 v77, v205, v77
    v_rcp_f32 v206, v206
    ds_read_b128 a[228:231], v2 offset:46080
    v_mfma_f32_16x16x32_bf16 v[128:131], v[180:183], a[96:99], v[128:131]
    ds_read_b64_tr_b16 v[196:197], v249 offset:16384
    v_add_f32 v207, 1.0, v207
    v_exp_f32 v200, v200
    v_mul_f32 v201, v201, v81
    v_mfma_f32_16x16x32_bf16 v[132:135], v[180:183], a[100:103], v[132:135]
    ds_read_b64_tr_b16 v[198:199], v249 offset:18432
    v_fma_f32 v202, -v82, v82, s66
    v_cvt_pk_bf16_f32 v214, v76, v77
    v_mfma_f32_16x16x32_bf16 v[136:139], v[180:183], a[104:107], v[136:139]
    v_mul_f32 v78, v206, v78
    v_rcp_f32 v207, v207
    v_mfma_f32_16x16x32_bf16 v[140:143], v[180:183], a[108:111], v[140:143]
    v_add_f32 v200, 1.0, v200
    v_exp_f32 v201, v201
    ds_read_b128 a[232:235], v2 offset:47104
    s_waitcnt lgkmcnt(7)
    v_mfma_f32_16x16x32_bf16 v[144:147], v[184:187], a[96:99], v[144:147]
    ds_read_b64_tr_b16 v[176:177], v250 offset:16384
    v_mul_f32 v202, v202, v82
    v_fma_f32 v203, -v83, v83, s66
    v_mfma_f32_16x16x32_bf16 v[148:151], v[184:187], a[100:103], v[148:151]
    ds_read_b64_tr_b16 v[178:179], v250 offset:18432
    v_mul_f32 v79, v207, v79
    v_rcp_f32 v200, v200
    v_mfma_f32_16x16x32_bf16 v[152:155], v[184:187], a[104:107], v[152:155]
    s_add_u32 m0, s7, 16384
    s_add_u32 s64, s74, 442368
    buffer_load_dwordx4 v12, s[48:51], s64 offen offset:0  lds
    v_add_f32 v201, 1.0, v201
    v_exp_f32 v202, v202
    v_mul_f32 v203, v203, v83
    v_mfma_f32_16x16x32_bf16 v[156:159], v[184:187], a[108:111], v[156:159]
    v_fma_f32 v204, -v96, v96, s66
    v_cvt_pk_bf16_f32 v215, v78, v79
    ds_read_b128 a[236:239], v2 offset:48128
    v_mfma_f32_16x16x32_bf16 v[160:163], v[188:191], a[96:99], v[160:163]
    ds_read_b64_tr_b16 v[180:181], v251 offset:16384
    v_mul_f32 v80, v200, v80
    v_rcp_f32 v201, v201
    v_mfma_f32_16x16x32_bf16 v[164:167], v[188:191], a[100:103], v[164:167]
    ds_read_b64_tr_b16 v[182:183], v251 offset:18432
    v_add_f32 v202, 1.0, v202
    v_exp_f32 v203, v203
    v_mfma_f32_16x16x32_bf16 v[168:171], v[188:191], a[104:107], v[168:171]
    buffer_load_dwordx4 v13, s[48:51], s64 offen offset:1024  lds
    v_mul_f32 v204, v204, v96
    v_fma_f32 v205, -v97, v97, s66
    v_mfma_f32_16x16x32_bf16 v[172:175], v[188:191], a[108:111], v[172:175]
    ds_write_b128 v5, v[212:215] offset:3072
    v_mul_f32 v81, v201, v81
    ds_read_b128 a[240:243], v2 offset:61440
    s_waitcnt lgkmcnt(8)
    v_mfma_f32_16x16x32_bf16 v[112:115], v[192:195], a[112:115], v[112:115]
    s_waitcnt vmcnt(14)
    ds_read_b64_tr_b16 v[184:185], v244 offset:32768
    v_rcp_f32 v202, v202
    v_add_f32 v203, 1.0, v203
    v_mfma_f32_16x16x32_bf16 v[116:119], v[192:195], a[116:119], v[116:119]
    ds_read_b64_tr_b16 v[186:187], v244 offset:34816
    v_exp_f32 v204, v204
    v_mul_f32 v205, v205, v97
    v_fma_f32 v206, -v98, v98, s66
    v_mfma_f32_16x16x32_bf16 v[120:123], v[192:195], a[120:123], v[120:123]
    buffer_load_dwordx4 v14, s[48:51], s64 offen offset:2048  lds
    v_cvt_pk_bf16_f32 v208, v80, v81
    v_mul_f32 v82, v202, v82
    v_mfma_f32_16x16x32_bf16 v[124:127], v[192:195], a[124:127], v[124:127]
    v_rcp_f32 v203, v203
    v_add_f32 v204, 1.0, v204
    ds_read_b128 a[244:247], v2 offset:62464
    v_mfma_f32_16x16x32_bf16 v[128:131], v[196:199], a[112:115], v[128:131]
    ds_read_b64_tr_b16 v[188:189], v245 offset:32768
    v_exp_f32 v205, v205
    v_mul_f32 v206, v206, v98
    v_mfma_f32_16x16x32_bf16 v[132:135], v[196:199], a[116:119], v[132:135]
    ds_read_b64_tr_b16 v[190:191], v245 offset:34816
    v_fma_f32 v207, -v99, v99, s66
    v_mul_f32 v83, v203, v83
    v_mfma_f32_16x16x32_bf16 v[136:139], v[196:199], a[120:123], v[136:139]
    buffer_load_dwordx4 v15, s[48:51], s64 offen offset:3072  lds
    v_rcp_f32 v204, v204
    v_add_f32 v205, 1.0, v205
    v_mfma_f32_16x16x32_bf16 v[140:143], v[196:199], a[124:127], v[140:143]
    v_exp_f32 v206, v206
    v_mul_f32 v207, v207, v99
    ds_read_b128 a[248:251], v2 offset:63488
    s_waitcnt lgkmcnt(8)
    v_mfma_f32_16x16x32_bf16 v[144:147], v[176:179], a[112:115], v[144:147]
    ds_read_b64_tr_b16 v[192:193], v246 offset:32768
    v_fma_f32 v200, -v84, v84, s66
    v_cvt_pk_bf16_f32 v209, v82, v83
    v_mul_f32 v96, v204, v96
    v_mfma_f32_16x16x32_bf16 v[148:151], v[176:179], a[116:119], v[148:151]
    ds_read_b64_tr_b16 v[194:195], v246 offset:34816
    v_rcp_f32 v205, v205
    v_add_f32 v206, 1.0, v206
    v_mfma_f32_16x16x32_bf16 v[152:155], v[176:179], a[120:123], v[152:155]
    s_add_u32 m0, s7, 147456
    s_add_u32 s64, s74, 479232
    buffer_load_dwordx4 v12, s[48:51], s64 offen offset:0  lds
    v_exp_f32 v207, v207
    v_mul_f32 v200, v200, v84
    v_mfma_f32_16x16x32_bf16 v[156:159], v[176:179], a[124:127], v[156:159]
    buffer_load_dwordx4 v13, s[48:51], s64 offen offset:1024  lds
    v_fma_f32 v201, -v85, v85, s66
    v_mul_f32 v97, v205, v97
    ds_read_b128 a[252:255], v2 offset:64512
    v_mfma_f32_16x16x32_bf16 v[160:163], v[180:183], a[112:115], v[160:163]
    ds_read_b64_tr_b16 v[196:197], v247 offset:32768
    v_rcp_f32 v206, v206
    v_add_f32 v207, 1.0, v207
    v_mfma_f32_16x16x32_bf16 v[164:167], v[180:183], a[116:119], v[164:167]
    ds_read_b64_tr_b16 v[198:199], v247 offset:34816
    v_exp_f32 v200, v200
    v_mul_f32 v201, v201, v85
    v_mfma_f32_16x16x32_bf16 v[168:171], v[180:183], a[120:123], v[168:171]
    buffer_load_dwordx4 v14, s[48:51], s64 offen offset:2048  lds
    v_fma_f32 v202, -v86, v86, s66
    v_cvt_pk_bf16_f32 v210, v96, v97
    v_mul_f32 v98, v206, v98
    v_mfma_f32_16x16x32_bf16 v[172:175], v[180:183], a[124:127], v[172:175]
    v_rcp_f32 v207, v207
    v_add_f32 v200, 1.0, v200
    s_waitcnt lgkmcnt(6)
    v_mfma_f32_16x16x32_bf16 v[112:115], v[184:187], a[128:131], v[112:115]
    s_waitcnt vmcnt(15)
    ds_read_b64_tr_b16 v[176:177], v244 offset:49152
    v_exp_f32 v201, v201
    v_mul_f32 v202, v202, v86
    v_mfma_f32_16x16x32_bf16 v[116:119], v[184:187], a[132:135], v[116:119]
    ds_read_b64_tr_b16 v[178:179], v244 offset:51200
    v_fma_f32 v203, -v87, v87, s66
    v_mul_f32 v99, v207, v99
    v_mfma_f32_16x16x32_bf16 v[120:123], v[184:187], a[136:139], v[120:123]
    buffer_load_dwordx4 v15, s[48:51], s64 offen offset:3072  lds
    v_rcp_f32 v200, v200
    v_add_f32 v201, 1.0, v201
    v_mfma_f32_16x16x32_bf16 v[124:127], v[184:187], a[140:143], v[124:127]
    v_exp_f32 v202, v202
    v_mul_f32 v203, v203, v87
    v_mfma_f32_16x16x32_bf16 v[128:131], v[188:191], a[128:131], v[128:131]
    ds_read_b64_tr_b16 v[180:181], v245 offset:49152
    v_fma_f32 v204, -v100, v100, s66
    v_cvt_pk_bf16_f32 v211, v98, v99
    v_mfma_f32_16x16x32_bf16 v[132:135], v[188:191], a[132:135], v[132:135]
    ds_read_b64_tr_b16 v[182:183], v245 offset:51200
    v_mul_f32 v84, v200, v84
    v_rcp_f32 v201, v201
    v_add_f32 v202, 1.0, v202
    v_mfma_f32_16x16x32_bf16 v[136:139], v[188:191], a[136:139], v[136:139]
    v_exp_f32 v203, v203
    v_mul_f32 v204, v204, v100
    v_mfma_f32_16x16x32_bf16 v[140:143], v[188:191], a[140:143], v[140:143]
    v_fma_f32 v205, -v101, v101, s66
    ds_write_b128 v5, v[208:211] offset:16384
    s_waitcnt lgkmcnt(5)
    v_mfma_f32_16x16x32_bf16 v[144:147], v[192:195], a[128:131], v[144:147]
    ds_read_b64_tr_b16 v[184:185], v246 offset:49152
    v_mul_f32 v85, v201, v85
    v_rcp_f32 v202, v202
    v_mfma_f32_16x16x32_bf16 v[148:151], v[192:195], a[132:135], v[148:151]
    ds_read_b64_tr_b16 v[186:187], v246 offset:51200
    v_add_f32 v203, 1.0, v203
    v_exp_f32 v204, v204
    v_mfma_f32_16x16x32_bf16 v[152:155], v[192:195], a[136:139], v[152:155]
    s_add_u32 m0, s7, 98304
    s_add_u32 s64, s74, 516096
    buffer_load_dwordx4 v12, s[48:51], s64 offen offset:0  lds
    v_mul_f32 v205, v205, v101
    v_fma_f32 v206, -v102, v102, s66
    v_mfma_f32_16x16x32_bf16 v[156:159], v[192:195], a[140:143], v[156:159]
    v_cvt_pk_bf16_f32 v212, v84, v85
    v_mul_f32 v86, v202, v86
    v_mfma_f32_16x16x32_bf16 v[160:163], v[196:199], a[128:131], v[160:163]
    ds_read_b64_tr_b16 v[188:189], v247 offset:49152
    v_rcp_f32 v203, v203
    v_add_f32 v204, 1.0, v204
    v_exp_f32 v205, v205
    v_mfma_f32_16x16x32_bf16 v[164:167], v[196:199], a[132:135], v[164:167]
    ds_read_b64_tr_b16 v[190:191], v247 offset:51200
    v_mul_f32 v206, v206, v102
    v_fma_f32 v207, -v103, v103, s66
    v_mfma_f32_16x16x32_bf16 v[168:171], v[196:199], a[136:139], v[168:171]
    buffer_load_dwordx4 v13, s[48:51], s64 offen offset:1024  lds
    v_mul_f32 v87, v203, v87
    v_rcp_f32 v204, v204
    v_mfma_f32_16x16x32_bf16 v[172:175], v[196:199], a[140:143], v[172:175]
    v_add_f32 v205, 1.0, v205
    v_exp_f32 v206, v206
    s_waitcnt lgkmcnt(5)
    v_mfma_f32_16x16x32_bf16 v[112:115], v[176:179], a[144:147], v[112:115]
    s_waitcnt vmcnt(14)
    ds_read_b64_tr_b16 v[192:193], v248 offset:0
    v_mul_f32 v207, v207, v103
    v_fma_f32 v200, -v88, v88, s66
    v_mfma_f32_16x16x32_bf16 v[116:119], v[176:179], a[148:151], v[116:119]
    ds_read_b64_tr_b16 v[194:195], v248 offset:2048
    v_cvt_pk_bf16_f32 v213, v86, v87
    v_mul_f32 v100, v204, v100
    v_mfma_f32_16x16x32_bf16 v[120:123], v[176:179], a[152:155], v[120:123]
    buffer_load_dwordx4 v14, s[48:51], s64 offen offset:2048  lds
    v_rcp_f32 v205, v205
    v_add_f32 v206, 1.0, v206
    v_exp_f32 v207, v207
    v_mfma_f32_16x16x32_bf16 v[124:127], v[176:179], a[156:159], v[124:127]
    buffer_load_dwordx4 v15, s[48:51], s64 offen offset:3072  lds
    v_mul_f32 v200, v200, v88
    v_fma_f32 v201, -v89, v89, s66
    v_mfma_f32_16x16x32_bf16 v[128:131], v[180:183], a[144:147], v[128:131]
    ds_read_b64_tr_b16 v[196:197], v249 offset:0
    v_mul_f32 v101, v205, v101
    v_rcp_f32 v206, v206
    v_mfma_f32_16x16x32_bf16 v[132:135], v[180:183], a[148:151], v[132:135]
    ds_read_b64_tr_b16 v[198:199], v249 offset:2048
    v_add_f32 v207, 1.0, v207
    v_exp_f32 v200, v200
    v_mfma_f32_16x16x32_bf16 v[136:139], v[180:183], a[152:155], v[136:139]
    v_mul_f32 v201, v201, v89
    v_fma_f32 v202, -v90, v90, s66
    v_mfma_f32_16x16x32_bf16 v[140:143], v[180:183], a[156:159], v[140:143]
    v_cvt_pk_bf16_f32 v214, v100, v101
    v_mul_f32 v102, v206, v102
    s_waitcnt lgkmcnt(4)
    v_mfma_f32_16x16x32_bf16 v[144:147], v[184:187], a[144:147], v[144:147]
    ds_read_b64_tr_b16 v[176:177], v250 offset:0
    v_rcp_f32 v207, v207
    v_add_f32 v200, 1.0, v200
    v_mfma_f32_16x16x32_bf16 v[148:151], v[184:187], a[148:151], v[148:151]
    ds_read_b64_tr_b16 v[178:179], v250 offset:2048
    v_exp_f32 v201, v201
    v_mul_f32 v202, v202, v90
    v_fma_f32 v203, -v91, v91, s66
    v_mfma_f32_16x16x32_bf16 v[152:155], v[184:187], a[152:155], v[152:155]
    s_add_u32 m0, s7, 114688
    s_add_u32 s64, s74, 552960
    buffer_load_dwordx4 v12, s[48:51], s64 offen offset:0  lds
    v_mul_f32 v103, v207, v103
    v_rcp_f32 v200, v200
    v_mfma_f32_16x16x32_bf16 v[156:159], v[184:187], a[156:159], v[156:159]
    v_add_f32 v201, 1.0, v201
    v_exp_f32 v202, v202
    v_mfma_f32_16x16x32_bf16 v[160:163], v[188:191], a[144:147], v[160:163]
    ds_read_b64_tr_b16 v[180:181], v251 offset:0
    v_mul_f32 v203, v203, v91
    v_fma_f32 v204, -v104, v104, s66
    v_mfma_f32_16x16x32_bf16 v[164:167], v[188:191], a[148:151], v[164:167]
    ds_read_b64_tr_b16 v[182:183], v251 offset:2048
    v_cvt_pk_bf16_f32 v215, v102, v103
    v_mul_f32 v88, v200, v88
    v_mfma_f32_16x16x32_bf16 v[168:171], v[188:191], a[152:155], v[168:171]
    buffer_load_dwordx4 v13, s[48:51], s64 offen offset:1024  lds
    v_rcp_f32 v201, v201
    v_add_f32 v202, 1.0, v202
    v_mfma_f32_16x16x32_bf16 v[172:175], v[188:191], a[156:159], v[172:175]
    v_exp_f32 v203, v203
    v_mul_f32 v204, v204, v104
    s_waitcnt lgkmcnt(4)
    v_mfma_f32_16x16x32_bf16 v[112:115], v[192:195], a[160:163], v[112:115]
    s_waitcnt vmcnt(14)
    ds_read_b64_tr_b16 v[184:185], v240 offset:0
    v_fma_f32 v205, -v105, v105, s66
    ds_write_b128 v5, v[212:215] offset:17408
    v_mul_f32 v89, v201, v89
    v_mfma_f32_16x16x32_bf16 v[116:119], v[192:195], a[164:167], v[116:119]
    ds_read_b64_tr_b16 v[186:187], v240 offset:2048
    v_rcp_f32 v202, v202
    v_add_f32 v203, 1.0, v203
    v_mfma_f32_16x16x32_bf16 v[120:123], v[192:195], a[168:171], v[120:123]
    buffer_load_dwordx4 v14, s[48:51], s64 offen offset:2048  lds
    v_exp_f32 v204, v204
    v_mul_f32 v205, v205, v105
    v_mfma_f32_16x16x32_bf16 v[124:127], v[192:195], a[172:175], v[124:127]
    v_fma_f32 v206, -v106, v106, s66
    v_cvt_pk_bf16_f32 v208, v88, v89
    v_mfma_f32_16x16x32_bf16 v[128:131], v[196:199], a[160:163], v[128:131]
    ds_read_b64_tr_b16 v[188:189], v241 offset:0
    v_mul_f32 v90, v202, v90
    v_rcp_f32 v203, v203
    v_mfma_f32_16x16x32_bf16 v[132:135], v[196:199], a[164:167], v[132:135]
    ds_read_b64_tr_b16 v[190:191], v241 offset:2048
    v_add_f32 v204, 1.0, v204
    v_exp_f32 v205, v205
    v_mfma_f32_16x16x32_bf16 v[136:139], v[196:199], a[168:171], v[136:139]
    buffer_load_dwordx4 v15, s[48:51], s64 offen offset:3072  lds
    v_mul_f32 v206, v206, v106
    v_fma_f32 v207, -v107, v107, s66
    v_mul_f32 v91, v203, v91
    v_mfma_f32_16x16x32_bf16 v[140:143], v[196:199], a[172:175], v[140:143]
    v_rcp_f32 v204, v204
    v_add_f32 v205, 1.0, v205
    s_waitcnt lgkmcnt(5)
    v_mfma_f32_16x16x32_bf16 v[144:147], v[176:179], a[160:163], v[144:147]
    ds_read_b64_tr_b16 v[192:193], v242 offset:0
    v_exp_f32 v206, v206
    v_mul_f32 v207, v207, v107
    v_mfma_f32_16x16x32_bf16 v[148:151], v[176:179], a[164:167], v[148:151]
    ds_read_b64_tr_b16 v[194:195], v242 offset:2048
    v_fma_f32 v200, -v92, v92, s66
    v_cvt_pk_bf16_f32 v209, v90, v91
    v_mfma_f32_16x16x32_bf16 v[152:155], v[176:179], a[168:171], v[152:155]
    s_add_u32 m0, s7, 131072
    s_add_u32 s64, s74, 589824
    buffer_load_dwordx4 v12, s[48:51], s64 offen offset:0  lds
    v_mul_f32 v104, v204, v104
    v_rcp_f32 v205, v205
    v_mfma_f32_16x16x32_bf16 v[156:159], v[176:179], a[172:175], v[156:159]
    buffer_load_dwordx4 v13, s[48:51], s64 offen offset:1024  lds
    v_add_f32 v206, 1.0, v206
    v_exp_f32 v207, v207
    v_mfma_f32_16x16x32_bf16 v[160:163], v[180:183], a[160:163], v[160:163]
    ds_read_b64_tr_b16 v[196:197], v243 offset:0
    v_mul_f32 v200, v200, v92
    v_fma_f32 v201, -v93, v93, s66
    v_mfma_f32_16x16x32_bf16 v[164:167], v[180:183], a[164:167], v[164:167]
    ds_read_b64_tr_b16 v[198:199], v243 offset:2048
    v_mul_f32 v105, v205, v105
    v_rcp_f32 v206, v206
    v_add_f32 v207, 1.0, v207
    v_mfma_f32_16x16x32_bf16 v[168:171], v[180:183], a[168:171], v[168:171]
    buffer_load_dwordx4 v14, s[48:51], s64 offen offset:2048  lds
    v_exp_f32 v200, v200
    v_mul_f32 v201, v201, v93
    v_mfma_f32_16x16x32_bf16 v[172:175], v[180:183], a[172:175], v[172:175]
    v_fma_f32 v202, -v94, v94, s66
    v_cvt_pk_bf16_f32 v210, v104, v105
    s_waitcnt lgkmcnt(4)
    v_mfma_f32_16x16x32_bf16 v[112:115], v[184:187], a[176:179], v[112:115]
    s_waitcnt vmcnt(15)
    ds_read_b64_tr_b16 v[176:177], v240 offset:16384
    v_mul_f32 v106, v206, v106
    v_rcp_f32 v207, v207
    v_mfma_f32_16x16x32_bf16 v[116:119], v[184:187], a[180:183], v[116:119]
    ds_read_b64_tr_b16 v[178:179], v240 offset:18432
    v_add_f32 v200, 1.0, v200
    v_exp_f32 v201, v201
    v_mfma_f32_16x16x32_bf16 v[120:123], v[184:187], a[184:187], v[120:123]
    buffer_load_dwordx4 v15, s[48:51], s64 offen offset:3072  lds
    v_mul_f32 v202, v202, v94
    v_fma_f32 v203, -v95, v95, s66
    v_mfma_f32_16x16x32_bf16 v[124:127], v[184:187], a[188:191], v[124:127]
    v_mul_f32 v107, v207, v107
    v_rcp_f32 v200, v200
    v_mfma_f32_16x16x32_bf16 v[128:131], v[188:191], a[176:179], v[128:131]
    ds_read_b64_tr_b16 v[180:181], v241 offset:16384
    v_add_f32 v201, 1.0, v201
    v_exp_f32 v202, v202
    v_mul_f32 v203, v203, v95
    v_mfma_f32_16x16x32_bf16 v[132:135], v[188:191], a[180:183], v[132:135]
    ds_read_b64_tr_b16 v[182:183], v241 offset:18432
    v_fma_f32 v204, -v108, v108, s66
    v_cvt_pk_bf16_f32 v211, v106, v107
    v_mfma_f32_16x16x32_bf16 v[136:139], v[188:191], a[184:187], v[136:139]
    v_mul_f32 v92, v200, v92
    v_rcp_f32 v201, v201
    v_mfma_f32_16x16x32_bf16 v[140:143], v[188:191], a[188:191], v[140:143]
    v_add_f32 v202, 1.0, v202
    v_exp_f32 v203, v203
    s_waitcnt lgkmcnt(4)
    v_mfma_f32_16x16x32_bf16 v[144:147], v[192:195], a[176:179], v[144:147]
    ds_read_b64_tr_b16 v[184:185], v242 offset:16384
    v_mul_f32 v204, v204, v108
    v_fma_f32 v205, -v109, v109, s66
    v_mfma_f32_16x16x32_bf16 v[148:151], v[192:195], a[180:183], v[148:151]
    ds_read_b64_tr_b16 v[186:187], v242 offset:18432
    ds_write_b128 v5, v[208:211] offset:18432
    v_mul_f32 v93, v201, v93
    v_mfma_f32_16x16x32_bf16 v[152:155], v[192:195], a[184:187], v[152:155]
    s_add_u32 m0, s7, 0
    s_add_u32 s64, s74, 626688
    buffer_load_dwordx4 v12, s[48:51], s64 offen offset:0  lds
    v_rcp_f32 v202, v202
    v_add_f32 v203, 1.0, v203
    v_exp_f32 v204, v204
    v_mfma_f32_16x16x32_bf16 v[156:159], v[192:195], a[188:191], v[156:159]
    v_mul_f32 v205, v205, v109
    v_fma_f32 v206, -v110, v110, s66
    v_mfma_f32_16x16x32_bf16 v[160:163], v[196:199], a[176:179], v[160:163]
    ds_read_b64_tr_b16 v[188:189], v243 offset:16384
    v_cvt_pk_bf16_f32 v212, v92, v93
    v_mul_f32 v94, v202, v94
    v_mfma_f32_16x16x32_bf16 v[164:167], v[196:199], a[180:183], v[164:167]
    ds_read_b64_tr_b16 v[190:191], v243 offset:18432
    v_rcp_f32 v203, v203
    v_add_f32 v204, 1.0, v204
    v_mfma_f32_16x16x32_bf16 v[168:171], v[196:199], a[184:187], v[168:171]
    buffer_load_dwordx4 v13, s[48:51], s64 offen offset:1024  lds
    v_exp_f32 v205, v205
    v_mul_f32 v206, v206, v110
    v_mfma_f32_16x16x32_bf16 v[172:175], v[196:199], a[188:191], v[172:175]
    v_fma_f32 v207, -v111, v111, s66
    v_mul_f32 v95, v203, v95
    s_lshl_b32 s9, s3, 5
    v_subrev_u32 v252, s7, v240
    v_xor_b32 v252, s9, v252
    v_add_u32 v253, 0x10000, v252
    v_add_u32 v254, 0x20000, v252
    s_waitcnt lgkmcnt(5)
    v_mfma_f32_16x16x32_bf16 v[112:115], v[176:179], a[192:195], v[112:115]
    s_waitcnt vmcnt(14)
    ds_read_b64_tr_b16 v[192:193], v248 offset:16384
    v_rcp_f32 v204, v204
    v_add_f32 v205, 1.0, v205
    v_mfma_f32_16x16x32_bf16 v[116:119], v[176:179], a[196:199], v[116:119]
    ds_read_b64_tr_b16 v[194:195], v248 offset:18432
    v_exp_f32 v206, v206
    v_mul_f32 v207, v207, v111
    v_cvt_pk_bf16_f32 v213, v94, v95
    v_mfma_f32_16x16x32_bf16 v[120:123], v[176:179], a[200:203], v[120:123]
    buffer_load_dwordx4 v14, s[48:51], s64 offen offset:2048  lds
    v_mul_f32 v108, v204, v108
    v_rcp_f32 v205, v205
    v_mfma_f32_16x16x32_bf16 v[124:127], v[176:179], a[204:207], v[124:127]
    buffer_load_dwordx4 v15, s[48:51], s64 offen offset:3072  lds
    v_add_f32 v206, 1.0, v206
    v_exp_f32 v207, v207
    v_mfma_f32_16x16x32_bf16 v[128:131], v[180:183], a[192:195], v[128:131]
    ds_read_b64_tr_b16 v[196:197], v249 offset:16384
    v_mul_f32 v109, v205, v109
    v_rcp_f32 v206, v206
    v_mfma_f32_16x16x32_bf16 v[132:135], v[180:183], a[196:199], v[132:135]
    ds_read_b64_tr_b16 v[198:199], v249 offset:18432
    v_add_f32 v207, 1.0, v207
    v_cvt_pk_bf16_f32 v214, v108, v109
    v_mfma_f32_16x16x32_bf16 v[136:139], v[180:183], a[200:203], v[136:139]
    v_mul_f32 v110, v206, v110
    v_rcp_f32 v207, v207
    v_mfma_f32_16x16x32_bf16 v[140:143], v[180:183], a[204:207], v[140:143]
    v_mul_f32 v111, v207, v111
    v_cvt_pk_bf16_f32 v215, v110, v111
    s_waitcnt lgkmcnt(4)
    v_mfma_f32_16x16x32_bf16 v[144:147], v[184:187], a[192:195], v[144:147]
    ds_read_b64_tr_b16 v[176:177], v250 offset:16384
    ds_write_b128 v5, v[212:215] offset:19456
    v_mfma_f32_16x16x32_bf16 v[148:151], v[184:187], a[196:199], v[148:151]
    ds_read_b64_tr_b16 v[178:179], v250 offset:18432
    v_mfma_f32_16x16x32_bf16 v[152:155], v[184:187], a[200:203], v[152:155]
    s_add_u32 m0, s7, 16384
    s_add_u32 s64, s74, 663552
    buffer_load_dwordx4 v12, s[48:51], s64 offen offset:0  lds
    v_mfma_f32_16x16x32_bf16 v[156:159], v[184:187], a[204:207], v[156:159]
    v_mfma_f32_16x16x32_bf16 v[160:163], v[188:191], a[192:195], v[160:163]
    ds_read_b64_tr_b16 v[180:181], v251 offset:16384
    v_mfma_f32_16x16x32_bf16 v[164:167], v[188:191], a[196:199], v[164:167]
    ds_read_b64_tr_b16 v[182:183], v251 offset:18432
    v_mfma_f32_16x16x32_bf16 v[168:171], v[188:191], a[200:203], v[168:171]
    buffer_load_dwordx4 v13, s[48:51], s64 offen offset:1024  lds
    v_mfma_f32_16x16x32_bf16 v[172:175], v[188:191], a[204:207], v[172:175]
    s_waitcnt lgkmcnt(3)
    s_barrier
    ds_read_b128 v[16:19], v3 offset:0
    ds_read_b128 v[32:35], v3 offset:16384
    v_mfma_f32_16x16x32_bf16 v[112:115], v[192:195], a[208:211], v[112:115]
    s_waitcnt vmcnt(14)
    ds_read_b64_tr_b16 v[184:185], v244 offset:32768
    v_mfma_f32_16x16x32_bf16 v[116:119], v[192:195], a[212:215], v[116:119]
    ds_read_b64_tr_b16 v[186:187], v244 offset:34816
    v_mfma_f32_16x16x32_bf16 v[120:123], v[192:195], a[216:219], v[120:123]
    buffer_load_dwordx4 v14, s[48:51], s64 offen offset:2048  lds
    v_mfma_f32_16x16x32_bf16 v[124:127], v[192:195], a[220:223], v[124:127]
    ds_read_b128 v[20:23], v3 offset:1024
    ds_read_b128 v[36:39], v3 offset:17408
    v_mfma_f32_16x16x32_bf16 v[128:131], v[196:199], a[208:211], v[128:131]
    ds_read_b64_tr_b16 v[188:189], v245 offset:32768
    v_mfma_f32_16x16x32_bf16 v[132:135], v[196:199], a[212:215], v[132:135]
    ds_read_b64_tr_b16 v[190:191], v245 offset:34816
    v_mfma_f32_16x16x32_bf16 v[136:139], v[196:199], a[216:219], v[136:139]
    buffer_load_dwordx4 v15, s[48:51], s64 offen offset:3072  lds
    v_mfma_f32_16x16x32_bf16 v[140:143], v[196:199], a[220:223], v[140:143]
    ds_read_b128 v[24:27], v3 offset:2048
    ds_read_b128 v[40:43], v3 offset:18432
    s_waitcnt lgkmcnt(10)
    v_mfma_f32_16x16x32_bf16 v[144:147], v[176:179], a[208:211], v[144:147]
    ds_read_b64_tr_b16 v[192:193], v246 offset:32768
    v_mfma_f32_16x16x32_bf16 v[148:151], v[176:179], a[212:215], v[148:151]
    ds_read_b64_tr_b16 v[194:195], v246 offset:34816
    v_mfma_f32_16x16x32_bf16 v[152:155], v[176:179], a[216:219], v[152:155]
    s_add_u32 m0, s7, 32768
    s_add_u32 s64, s74, 700416
    buffer_load_dwordx4 v12, s[48:51], s64 offen offset:0  lds
    v_mfma_f32_16x16x32_bf16 v[156:159], v[176:179], a[220:223], v[156:159]
    buffer_load_dwordx4 v13, s[48:51], s64 offen offset:1024  lds
    ds_read_b128 v[28:31], v3 offset:3072
    ds_read_b128 v[44:47], v3 offset:19456
    v_mfma_f32_16x16x32_bf16 v[160:163], v[180:183], a[208:211], v[160:163]
    ds_read_b64_tr_b16 v[196:197], v247 offset:32768
    v_mfma_f32_16x16x32_bf16 v[164:167], v[180:183], a[212:215], v[164:167]
    ds_read_b64_tr_b16 v[198:199], v247 offset:34816
    v_mfma_f32_16x16x32_bf16 v[168:171], v[180:183], a[216:219], v[168:171]
    buffer_load_dwordx4 v14, s[48:51], s64 offen offset:2048  lds
    v_mfma_f32_16x16x32_bf16 v[172:175], v[180:183], a[220:223], v[172:175]
    ds_read_b128 v[48:51], v3 offset:4096
    ds_read_b128 v[64:67], v3 offset:20480
    s_waitcnt lgkmcnt(10)
    v_mfma_f32_16x16x32_bf16 v[112:115], v[184:187], a[224:227], v[112:115]
    s_waitcnt vmcnt(15)
    ds_read_b64_tr_b16 v[176:177], v244 offset:49152
    v_mfma_f32_16x16x32_bf16 v[116:119], v[184:187], a[228:231], v[116:119]
    ds_read_b64_tr_b16 v[178:179], v244 offset:51200
    v_mfma_f32_16x16x32_bf16 v[120:123], v[184:187], a[232:235], v[120:123]
    buffer_load_dwordx4 v15, s[48:51], s64 offen offset:3072  lds
    v_mfma_f32_16x16x32_bf16 v[124:127], v[184:187], a[236:239], v[124:127]
    ds_read_b128 v[52:55], v3 offset:5120
    ds_read_b128 v[68:71], v3 offset:21504
    v_mfma_f32_16x16x32_bf16 v[128:131], v[188:191], a[224:227], v[128:131]
    ds_read_b64_tr_b16 v[180:181], v245 offset:49152
    v_mfma_f32_16x16x32_bf16 v[132:135], v[188:191], a[228:231], v[132:135]
    ds_read_b64_tr_b16 v[182:183], v245 offset:51200
    v_mfma_f32_16x16x32_bf16 v[136:139], v[188:191], a[232:235], v[136:139]
    s_add_u32 m0, s7, 49152
    s_add_u32 s64, s74, 737280
    buffer_load_dwordx4 v12, s[48:51], s64 offen offset:0  lds
    v_mfma_f32_16x16x32_bf16 v[140:143], v[188:191], a[236:239], v[140:143]
    ds_read_b128 v[56:59], v3 offset:6144
    ds_read_b128 v[72:75], v3 offset:22528
    s_waitcnt lgkmcnt(10)
    v_mfma_f32_16x16x32_bf16 v[144:147], v[192:195], a[224:227], v[144:147]
    ds_read_b64_tr_b16 v[184:185], v246 offset:49152
    v_mfma_f32_16x16x32_bf16 v[148:151], v[192:195], a[228:231], v[148:151]
    ds_read_b64_tr_b16 v[186:187], v246 offset:51200
    v_mfma_f32_16x16x32_bf16 v[152:155], v[192:195], a[232:235], v[152:155]
    buffer_load_dwordx4 v13, s[48:51], s64 offen offset:1024  lds
    v_mfma_f32_16x16x32_bf16 v[156:159], v[192:195], a[236:239], v[156:159]
    ds_read_b128 v[60:63], v3 offset:7168
    ds_read_b128 v[76:79], v3 offset:23552
    v_mfma_f32_16x16x32_bf16 v[160:163], v[196:199], a[224:227], v[160:163]
    ds_read_b64_tr_b16 v[188:189], v247 offset:49152
    v_mfma_f32_16x16x32_bf16 v[164:167], v[196:199], a[228:231], v[164:167]
    ds_read_b64_tr_b16 v[190:191], v247 offset:51200
    v_mfma_f32_16x16x32_bf16 v[168:171], v[196:199], a[232:235], v[168:171]
    buffer_load_dwordx4 v14, s[48:51], s64 offen offset:2048  lds
    v_mfma_f32_16x16x32_bf16 v[172:175], v[196:199], a[236:239], v[172:175]
    ds_read_b128 v[80:83], v3 offset:8192
    ds_read_b128 v[96:99], v3 offset:24576
    s_waitcnt lgkmcnt(10)
    v_mfma_f32_16x16x32_bf16 v[112:115], v[176:179], a[240:243], v[112:115]
    s_waitcnt vmcnt(15)
    ds_read_b64_tr_b16 v[192:193], v248 offset:0
    v_mfma_f32_16x16x32_bf16 v[116:119], v[176:179], a[244:247], v[116:119]
    ds_read_b64_tr_b16 v[194:195], v248 offset:2048
    v_mfma_f32_16x16x32_bf16 v[120:123], v[176:179], a[248:251], v[120:123]
    buffer_load_dwordx4 v15, s[48:51], s64 offen offset:3072  lds
    v_mfma_f32_16x16x32_bf16 v[124:127], v[176:179], a[252:255], v[124:127]
    s_add_u32 m0, s7, 147456
    s_add_u32 s64, s74, 774144
    buffer_load_dwordx4 v12, s[48:51], s64 offen offset:0  lds
    ds_read_b128 v[84:87], v3 offset:9216
    ds_read_b128 v[100:103], v3 offset:25600
    v_mfma_f32_16x16x32_bf16 v[128:131], v[180:183], a[240:243], v[128:131]
    ds_read_b64_tr_b16 v[196:197], v249 offset:0
    v_mfma_f32_16x16x32_bf16 v[132:135], v[180:183], a[244:247], v[132:135]
    ds_read_b64_tr_b16 v[198:199], v249 offset:2048
    v_mfma_f32_16x16x32_bf16 v[136:139], v[180:183], a[248:251], v[136:139]
    buffer_load_dwordx4 v13, s[48:51], s64 offen offset:1024  lds
    v_mfma_f32_16x16x32_bf16 v[140:143], v[180:183], a[252:255], v[140:143]
    ds_read_b128 v[88:91], v3 offset:10240
    ds_read_b128 v[104:107], v3 offset:26624
    s_waitcnt lgkmcnt(10)
    v_mfma_f32_16x16x32_bf16 v[144:147], v[184:187], a[240:243], v[144:147]
    ds_read_b64_tr_b16 v[176:177], v250 offset:0
    v_mfma_f32_16x16x32_bf16 v[148:151], v[184:187], a[244:247], v[148:151]
    ds_read_b64_tr_b16 v[178:179], v250 offset:2048
    v_mfma_f32_16x16x32_bf16 v[152:155], v[184:187], a[248:251], v[152:155]
    buffer_load_dwordx4 v14, s[48:51], s64 offen offset:2048  lds
    v_mfma_f32_16x16x32_bf16 v[156:159], v[184:187], a[252:255], v[156:159]
    ds_read_b128 v[92:95], v3 offset:11264
    ds_read_b128 v[108:111], v3 offset:27648
    v_mfma_f32_16x16x32_bf16 v[160:163], v[188:191], a[240:243], v[160:163]
    ds_read_b64_tr_b16 v[180:181], v251 offset:0
    v_mfma_f32_16x16x32_bf16 v[164:167], v[188:191], a[244:247], v[164:167]
    ds_read_b64_tr_b16 v[182:183], v251 offset:2048
    v_mfma_f32_16x16x32_bf16 v[168:171], v[188:191], a[248:251], v[168:171]
    buffer_load_dwordx4 v15, s[48:51], s64 offen offset:3072  lds
    v_mfma_f32_16x16x32_bf16 v[172:175], v[188:191], a[252:255], v[172:175]
    ds_read_b128 v[200:203], v3 offset:12288
    ds_read_b128 v[224:227], v3 offset:28672
    s_waitcnt lgkmcnt(10)
    v_mfma_f32_16x16x32_bf16 v[112:115], v[192:195], v[16:19], v[112:115]
    s_waitcnt vmcnt(16)
    ds_read_b64_tr_b16 v[184:185], v240 offset:0
    v_mfma_f32_16x16x32_bf16 v[116:119], v[192:195], v[20:23], v[116:119]
    ds_read_b64_tr_b16 v[186:187], v240 offset:2048
    v_mfma_f32_16x16x32_bf16 v[120:123], v[192:195], v[24:27], v[120:123]
    s_add_u32 m0, s7, 98304
    s_add_u32 s64, s74, 811008
    buffer_load_dwordx4 v12, s[48:51], s64 offen offset:0  lds
    v_mfma_f32_16x16x32_bf16 v[124:127], v[192:195], v[28:31], v[124:127]
    ds_read_b128 v[204:207], v3 offset:13312
    ds_read_b128 v[228:231], v3 offset:29696
    v_mfma_f32_16x16x32_bf16 v[128:131], v[196:199], v[16:19], v[128:131]
    ds_read_b64_tr_b16 v[188:189], v241 offset:0
    v_mfma_f32_16x16x32_bf16 v[132:135], v[196:199], v[20:23], v[132:135]
    ds_read_b64_tr_b16 v[190:191], v241 offset:2048
    v_mfma_f32_16x16x32_bf16 v[136:139], v[196:199], v[24:27], v[136:139]
    buffer_load_dwordx4 v13, s[48:51], s64 offen offset:1024  lds
    v_mfma_f32_16x16x32_bf16 v[140:143], v[196:199], v[28:31], v[140:143]
    ds_read_b128 v[216:219], v3 offset:14336
    ds_read_b128 v[232:235], v3 offset:30720
    s_waitcnt lgkmcnt(10)
    v_mfma_f32_16x16x32_bf16 v[144:147], v[176:179], v[16:19], v[144:147]
    ds_read_b64_tr_b16 v[192:193], v242 offset:0
    v_mfma_f32_16x16x32_bf16 v[148:151], v[176:179], v[20:23], v[148:151]
    ds_read_b64_tr_b16 v[194:195], v242 offset:2048
    v_mfma_f32_16x16x32_bf16 v[152:155], v[176:179], v[24:27], v[152:155]
    buffer_load_dwordx4 v14, s[48:51], s64 offen offset:2048  lds
    v_mfma_f32_16x16x32_bf16 v[156:159], v[176:179], v[28:31], v[156:159]
    buffer_load_dwordx4 v15, s[48:51], s64 offen offset:3072  lds
    ds_read_b128 v[220:223], v3 offset:15360
    ds_read_b128 v[236:239], v3 offset:31744
    v_mfma_f32_16x16x32_bf16 v[160:163], v[180:183], v[16:19], v[160:163]
    ds_read_b64_tr_b16 v[196:197], v243 offset:0
    v_mfma_f32_16x16x32_bf16 v[164:167], v[180:183], v[20:23], v[164:167]
    ds_read_b64_tr_b16 v[198:199], v243 offset:2048
    v_mfma_f32_16x16x32_bf16 v[168:171], v[180:183], v[24:27], v[168:171]
    s_add_u32 m0, s7, 114688
    s_add_u32 s64, s74, 847872
    buffer_load_dwordx4 v12, s[48:51], s64 offen offset:0  lds
    v_mfma_f32_16x16x32_bf16 v[172:175], v[180:183], v[28:31], v[172:175]
    s_waitcnt lgkmcnt(8)
    v_mfma_f32_16x16x32_bf16 v[112:115], v[184:187], v[32:35], v[112:115]
    s_waitcnt vmcnt(17)
    ds_read_b64_tr_b16 v[176:177], v240 offset:16384
    v_mfma_f32_16x16x32_bf16 v[116:119], v[184:187], v[36:39], v[116:119]
    ds_read_b64_tr_b16 v[178:179], v240 offset:18432
    v_mfma_f32_16x16x32_bf16 v[120:123], v[184:187], v[40:43], v[120:123]
    buffer_load_dwordx4 v13, s[48:51], s64 offen offset:1024  lds
    v_mfma_f32_16x16x32_bf16 v[124:127], v[184:187], v[44:47], v[124:127]
    v_mfma_f32_16x16x32_bf16 v[128:131], v[188:191], v[32:35], v[128:131]
    ds_read_b64_tr_b16 v[180:181], v241 offset:16384
    v_mfma_f32_16x16x32_bf16 v[132:135], v[188:191], v[36:39], v[132:135]
    ds_read_b64_tr_b16 v[182:183], v241 offset:18432
    v_mfma_f32_16x16x32_bf16 v[136:139], v[188:191], v[40:43], v[136:139]
    buffer_load_dwordx4 v14, s[48:51], s64 offen offset:2048  lds
    v_mfma_f32_16x16x32_bf16 v[140:143], v[188:191], v[44:47], v[140:143]
    s_waitcnt lgkmcnt(4)
    v_mfma_f32_16x16x32_bf16 v[144:147], v[192:195], v[32:35], v[144:147]
    ds_read_b64_tr_b16 v[184:185], v242 offset:16384
    v_mfma_f32_16x16x32_bf16 v[148:151], v[192:195], v[36:39], v[148:151]
    ds_read_b64_tr_b16 v[186:187], v242 offset:18432
    v_mfma_f32_16x16x32_bf16 v[152:155], v[192:195], v[40:43], v[152:155]
    buffer_load_dwordx4 v15, s[48:51], s64 offen offset:3072  lds
    v_mfma_f32_16x16x32_bf16 v[156:159], v[192:195], v[44:47], v[156:159]
    v_mfma_f32_16x16x32_bf16 v[160:163], v[196:199], v[32:35], v[160:163]
    ds_read_b64_tr_b16 v[188:189], v243 offset:16384
    v_mfma_f32_16x16x32_bf16 v[164:167], v[196:199], v[36:39], v[164:167]
    ds_read_b64_tr_b16 v[190:191], v243 offset:18432
    v_mfma_f32_16x16x32_bf16 v[168:171], v[196:199], v[40:43], v[168:171]
    s_add_u32 m0, s7, 131072
    s_add_u32 s64, s75, 0
    buffer_load_dwordx4 v12, s[48:51], s64 offen offset:0  lds
    v_mfma_f32_16x16x32_bf16 v[172:175], v[196:199], v[44:47], v[172:175]
    s_waitcnt lgkmcnt(4)
    v_mfma_f32_16x16x32_bf16 v[112:115], v[176:179], v[48:51], v[112:115]
    s_waitcnt vmcnt(17)
    ds_read_b64_tr_b16 v[192:193], v240 offset:32768
    v_mfma_f32_16x16x32_bf16 v[116:119], v[176:179], v[52:55], v[116:119]
    ds_read_b64_tr_b16 v[194:195], v240 offset:34816
    v_mfma_f32_16x16x32_bf16 v[120:123], v[176:179], v[56:59], v[120:123]
    buffer_load_dwordx4 v13, s[48:51], s64 offen offset:1024  lds
    v_mfma_f32_16x16x32_bf16 v[124:127], v[176:179], v[60:63], v[124:127]
    buffer_load_dwordx4 v14, s[48:51], s64 offen offset:2048  lds
    v_mfma_f32_16x16x32_bf16 v[128:131], v[180:183], v[48:51], v[128:131]
    ds_read_b64_tr_b16 v[196:197], v241 offset:32768
    v_mfma_f32_16x16x32_bf16 v[132:135], v[180:183], v[52:55], v[132:135]
    ds_read_b64_tr_b16 v[198:199], v241 offset:34816
    v_mfma_f32_16x16x32_bf16 v[136:139], v[180:183], v[56:59], v[136:139]
    buffer_load_dwordx4 v15, s[48:51], s64 offen offset:3072  lds
    v_mfma_f32_16x16x32_bf16 v[140:143], v[180:183], v[60:63], v[140:143]
    s_waitcnt lgkmcnt(4)
    v_mfma_f32_16x16x32_bf16 v[144:147], v[184:187], v[48:51], v[144:147]
    ds_read_b64_tr_b16 v[176:177], v242 offset:32768
    v_mfma_f32_16x16x32_bf16 v[148:151], v[184:187], v[52:55], v[148:151]
    ds_read_b64_tr_b16 v[178:179], v242 offset:34816
    v_mfma_f32_16x16x32_bf16 v[152:155], v[184:187], v[56:59], v[152:155]
    s_add_u32 m0, s7, 0
    s_add_u32 s64, s75, 36864
    buffer_load_dwordx4 v12, s[48:51], s64 offen offset:0  lds
    v_mfma_f32_16x16x32_bf16 v[156:159], v[184:187], v[60:63], v[156:159]
    v_mfma_f32_16x16x32_bf16 v[160:163], v[188:191], v[48:51], v[160:163]
    ds_read_b64_tr_b16 v[180:181], v243 offset:32768
    v_mfma_f32_16x16x32_bf16 v[164:167], v[188:191], v[52:55], v[164:167]
    ds_read_b64_tr_b16 v[182:183], v243 offset:34816
    v_mfma_f32_16x16x32_bf16 v[168:171], v[188:191], v[56:59], v[168:171]
    buffer_load_dwordx4 v13, s[48:51], s64 offen offset:1024  lds
    v_mfma_f32_16x16x32_bf16 v[172:175], v[188:191], v[60:63], v[172:175]
    s_barrier
    s_waitcnt lgkmcnt(4)
    v_mfma_f32_16x16x32_bf16 v[112:115], v[192:195], v[64:67], v[112:115]
    s_waitcnt vmcnt(18)
    ds_read_b64_tr_b16 v[184:185], v240 offset:49152
    v_mfma_f32_16x16x32_bf16 v[116:119], v[192:195], v[68:71], v[116:119]
    ds_read_b64_tr_b16 v[186:187], v240 offset:51200
    v_mfma_f32_16x16x32_bf16 v[120:123], v[192:195], v[72:75], v[120:123]
    buffer_load_dwordx4 v14, s[48:51], s64 offen offset:2048  lds
    v_mfma_f32_16x16x32_bf16 v[124:127], v[192:195], v[76:79], v[124:127]
    v_mfma_f32_16x16x32_bf16 v[128:131], v[196:199], v[64:67], v[128:131]
    ds_read_b64_tr_b16 v[188:189], v241 offset:49152
    v_mfma_f32_16x16x32_bf16 v[132:135], v[196:199], v[68:71], v[132:135]
    ds_read_b64_tr_b16 v[190:191], v241 offset:51200
    v_mfma_f32_16x16x32_bf16 v[136:139], v[196:199], v[72:75], v[136:139]
    buffer_load_dwordx4 v15, s[48:51], s64 offen offset:3072  lds
    v_mfma_f32_16x16x32_bf16 v[140:143], v[196:199], v[76:79], v[140:143]
    s_waitcnt lgkmcnt(4)
    v_mfma_f32_16x16x32_bf16 v[144:147], v[176:179], v[64:67], v[144:147]
    ds_read_b64_tr_b16 v[192:193], v242 offset:49152
    v_mfma_f32_16x16x32_bf16 v[148:151], v[176:179], v[68:71], v[148:151]
    ds_read_b64_tr_b16 v[194:195], v242 offset:51200
    v_mfma_f32_16x16x32_bf16 v[152:155], v[176:179], v[72:75], v[152:155]
    s_add_u32 m0, s7, 16384
    s_add_u32 s64, s75, 73728
    buffer_load_dwordx4 v12, s[48:51], s64 offen offset:0  lds
    v_mfma_f32_16x16x32_bf16 v[156:159], v[176:179], v[76:79], v[156:159]
    buffer_load_dwordx4 v13, s[48:51], s64 offen offset:1024  lds
    v_mfma_f32_16x16x32_bf16 v[160:163], v[180:183], v[64:67], v[160:163]
    ds_read_b64_tr_b16 v[196:197], v243 offset:49152
    v_mfma_f32_16x16x32_bf16 v[164:167], v[180:183], v[68:71], v[164:167]
    ds_read_b64_tr_b16 v[198:199], v243 offset:51200
    v_mfma_f32_16x16x32_bf16 v[168:171], v[180:183], v[72:75], v[168:171]
    buffer_load_dwordx4 v14, s[48:51], s64 offen offset:2048  lds
    v_mfma_f32_16x16x32_bf16 v[172:175], v[180:183], v[76:79], v[172:175]
    s_waitcnt lgkmcnt(4)
    v_mfma_f32_16x16x32_bf16 v[112:115], v[184:187], v[80:83], v[112:115]
    s_waitcnt vmcnt(19)
    ds_read_b64_tr_b16 v[176:177], v248 offset:16384
    v_mfma_f32_16x16x32_bf16 v[116:119], v[184:187], v[84:87], v[116:119]
    ds_read_b64_tr_b16 v[178:179], v248 offset:18432
    v_mfma_f32_16x16x32_bf16 v[120:123], v[184:187], v[88:91], v[120:123]
    buffer_load_dwordx4 v15, s[48:51], s64 offen offset:3072  lds
    v_mfma_f32_16x16x32_bf16 v[124:127], v[184:187], v[92:95], v[124:127]
    v_mfma_f32_16x16x32_bf16 v[128:131], v[188:191], v[80:83], v[128:131]
    ds_read_b64_tr_b16 v[180:181], v249 offset:16384
    v_mfma_f32_16x16x32_bf16 v[132:135], v[188:191], v[84:87], v[132:135]
    ds_read_b64_tr_b16 v[182:183], v249 offset:18432
    v_mfma_f32_16x16x32_bf16 v[136:139], v[188:191], v[88:91], v[136:139]
    s_add_u32 m0, s7, 65536
    s_add_u32 s64, s75, 110592
    buffer_load_dwordx4 v12, s[48:51], s64 offen offset:0  lds
    v_mfma_f32_16x16x32_bf16 v[140:143], v[188:191], v[92:95], v[140:143]
    s_waitcnt lgkmcnt(4)
    v_mfma_f32_16x16x32_bf16 v[144:147], v[192:195], v[80:83], v[144:147]
    ds_read_b64_tr_b16 v[184:185], v250 offset:16384
    v_mfma_f32_16x16x32_bf16 v[148:151], v[192:195], v[84:87], v[148:151]
    ds_read_b64_tr_b16 v[186:187], v250 offset:18432
    v_mfma_f32_16x16x32_bf16 v[152:155], v[192:195], v[88:91], v[152:155]
    buffer_load_dwordx4 v13, s[48:51], s64 offen offset:1024  lds
    v_mfma_f32_16x16x32_bf16 v[156:159], v[192:195], v[92:95], v[156:159]
    v_mfma_f32_16x16x32_bf16 v[160:163], v[196:199], v[80:83], v[160:163]
    ds_read_b64_tr_b16 v[188:189], v251 offset:16384
    v_mfma_f32_16x16x32_bf16 v[164:167], v[196:199], v[84:87], v[164:167]
    ds_read_b64_tr_b16 v[190:191], v251 offset:18432
    v_mfma_f32_16x16x32_bf16 v[168:171], v[196:199], v[88:91], v[168:171]
    buffer_load_dwordx4 v14, s[48:51], s64 offen offset:2048  lds
    v_mfma_f32_16x16x32_bf16 v[172:175], v[196:199], v[92:95], v[172:175]
    s_waitcnt lgkmcnt(4)
    v_mfma_f32_16x16x32_bf16 v[112:115], v[176:179], v[96:99], v[112:115]
    s_waitcnt vmcnt(19)
    ds_read_b64_tr_b16 v[192:193], v244 offset:32768
    v_mfma_f32_16x16x32_bf16 v[116:119], v[176:179], v[100:103], v[116:119]
    ds_read_b64_tr_b16 v[194:195], v244 offset:34816
    v_mfma_f32_16x16x32_bf16 v[120:123], v[176:179], v[104:107], v[120:123]
    buffer_load_dwordx4 v15, s[48:51], s64 offen offset:3072  lds
    v_mfma_f32_16x16x32_bf16 v[124:127], v[176:179], v[108:111], v[124:127]
    s_add_u32 m0, s7, 81920
    s_add_u32 s64, s75, 147456
    buffer_load_dwordx4 v12, s[48:51], s64 offen offset:0  lds
    v_mfma_f32_16x16x32_bf16 v[128:131], v[180:183], v[96:99], v[128:131]
    ds_read_b64_tr_b16 v[196:197], v245 offset:32768
    v_mfma_f32_16x16x32_bf16 v[132:135], v[180:183], v[100:103], v[132:135]
    ds_read_b64_tr_b16 v[198:199], v245 offset:34816
    v_mfma_f32_16x16x32_bf16 v[136:139], v[180:183], v[104:107], v[136:139]
    buffer_load_dwordx4 v13, s[48:51], s64 offen offset:1024  lds
    v_mfma_f32_16x16x32_bf16 v[140:143], v[180:183], v[108:111], v[140:143]
    s_waitcnt lgkmcnt(4)
    v_mfma_f32_16x16x32_bf16 v[144:147], v[184:187], v[96:99], v[144:147]
    ds_read_b64_tr_b16 v[176:177], v246 offset:32768
    v_mfma_f32_16x16x32_bf16 v[148:151], v[184:187], v[100:103], v[148:151]
    ds_read_b64_tr_b16 v[178:179], v246 offset:34816
    v_mfma_f32_16x16x32_bf16 v[152:155], v[184:187], v[104:107], v[152:155]
    buffer_load_dwordx4 v14, s[48:51], s64 offen offset:2048  lds
    v_mfma_f32_16x16x32_bf16 v[156:159], v[184:187], v[108:111], v[156:159]
    v_mfma_f32_16x16x32_bf16 v[160:163], v[188:191], v[96:99], v[160:163]
    ds_read_b64_tr_b16 v[180:181], v247 offset:32768
    v_mfma_f32_16x16x32_bf16 v[164:167], v[188:191], v[100:103], v[164:167]
    ds_read_b64_tr_b16 v[182:183], v247 offset:34816
    v_mfma_f32_16x16x32_bf16 v[168:171], v[188:191], v[104:107], v[168:171]
    buffer_load_dwordx4 v15, s[48:51], s64 offen offset:3072  lds
    v_mfma_f32_16x16x32_bf16 v[172:175], v[188:191], v[108:111], v[172:175]
    s_waitcnt lgkmcnt(4)
    v_mfma_f32_16x16x32_bf16 v[112:115], v[192:195], v[200:203], v[112:115]
    s_waitcnt vmcnt(20)
    ds_read_b64_tr_b16 v[184:185], v244 offset:49152
    v_mfma_f32_16x16x32_bf16 v[116:119], v[192:195], v[204:207], v[116:119]
    ds_read_b64_tr_b16 v[186:187], v244 offset:51200
    v_mfma_f32_16x16x32_bf16 v[120:123], v[192:195], v[216:219], v[120:123]
    s_add_u32 m0, s7, 32768
    s_add_u32 s64, s75, 184320
    buffer_load_dwordx4 v12, s[48:51], s64 offen offset:0  lds
    v_mfma_f32_16x16x32_bf16 v[124:127], v[192:195], v[220:223], v[124:127]
    v_mfma_f32_16x16x32_bf16 v[128:131], v[196:199], v[200:203], v[128:131]
    ds_read_b64_tr_b16 v[188:189], v245 offset:49152
    v_mfma_f32_16x16x32_bf16 v[132:135], v[196:199], v[204:207], v[132:135]
    ds_read_b64_tr_b16 v[190:191], v245 offset:51200
    v_mfma_f32_16x16x32_bf16 v[136:139], v[196:199], v[216:219], v[136:139]
    buffer_load_dwordx4 v13, s[48:51], s64 offen offset:1024  lds
    v_mfma_f32_16x16x32_bf16 v[140:143], v[196:199], v[220:223], v[140:143]
    s_waitcnt lgkmcnt(4)
    v_mfma_f32_16x16x32_bf16 v[144:147], v[176:179], v[200:203], v[144:147]
    ds_read_b64_tr_b16 v[192:193], v246 offset:49152
    v_mfma_f32_16x16x32_bf16 v[148:151], v[176:179], v[204:207], v[148:151]
    ds_read_b64_tr_b16 v[194:195], v246 offset:51200
    v_mfma_f32_16x16x32_bf16 v[152:155], v[176:179], v[216:219], v[152:155]
    buffer_load_dwordx4 v14, s[48:51], s64 offen offset:2048  lds
    v_mfma_f32_16x16x32_bf16 v[156:159], v[176:179], v[220:223], v[156:159]
    buffer_load_dwordx4 v15, s[48:51], s64 offen offset:3072  lds
    v_mfma_f32_16x16x32_bf16 v[160:163], v[180:183], v[200:203], v[160:163]
    ds_read_b64_tr_b16 v[196:197], v247 offset:49152
    v_mfma_f32_16x16x32_bf16 v[164:167], v[180:183], v[204:207], v[164:167]
    ds_read_b64_tr_b16 v[198:199], v247 offset:51200
    v_mfma_f32_16x16x32_bf16 v[168:171], v[180:183], v[216:219], v[168:171]
    s_add_u32 m0, s7, 49152
    s_add_u32 s64, s75, 221184
    buffer_load_dwordx4 v12, s[48:51], s64 offen offset:0  lds
    v_mfma_f32_16x16x32_bf16 v[172:175], v[180:183], v[220:223], v[172:175]
    s_waitcnt lgkmcnt(4)
    v_mfma_f32_16x16x32_bf16 v[112:115], v[184:187], v[224:227], v[112:115]
    s_waitcnt vmcnt(21)
    ds_read_b64_tr_b16 v[176:177], v248 offset:0
    v_mfma_f32_16x16x32_bf16 v[116:119], v[184:187], v[228:231], v[116:119]
    ds_read_b64_tr_b16 v[178:179], v248 offset:2048
    v_mfma_f32_16x16x32_bf16 v[120:123], v[184:187], v[232:235], v[120:123]
    buffer_load_dwordx4 v13, s[48:51], s64 offen offset:1024  lds
    v_mfma_f32_16x16x32_bf16 v[124:127], v[184:187], v[236:239], v[124:127]
    v_mfma_f32_16x16x32_bf16 v[128:131], v[188:191], v[224:227], v[128:131]
    ds_read_b64_tr_b16 v[180:181], v249 offset:0
    v_mfma_f32_16x16x32_bf16 v[132:135], v[188:191], v[228:231], v[132:135]
    ds_read_b64_tr_b16 v[182:183], v249 offset:2048
    v_mfma_f32_16x16x32_bf16 v[136:139], v[188:191], v[232:235], v[136:139]
    buffer_load_dwordx4 v14, s[48:51], s64 offen offset:2048  lds
    v_cvt_pk_bf16_f32 v112, v112, v113
    v_cvt_pk_bf16_f32 v113, v114, v115
    v_mfma_f32_16x16x32_bf16 v[140:143], v[188:191], v[236:239], v[140:143]
    v_cvt_pk_bf16_f32 v114, v116, v117
    v_cvt_pk_bf16_f32 v115, v118, v119
    s_waitcnt lgkmcnt(4)
    v_mfma_f32_16x16x32_bf16 v[144:147], v[192:195], v[224:227], v[144:147]
    ds_read_b64_tr_b16 v[184:185], v250 offset:0
    s_add_u32 s70, s76, 0
    buffer_store_dwordx4 v[112:115], v2, s[52:55], s70 offen sc1
    v_cvt_pk_bf16_f32 v120, v120, v121
    v_mfma_f32_16x16x32_bf16 v[148:151], v[192:195], v[228:231], v[148:151]
    ds_read_b64_tr_b16 v[186:187], v250 offset:2048
    v_cvt_pk_bf16_f32 v121, v122, v123
    v_cvt_pk_bf16_f32 v122, v124, v125
    v_cvt_pk_bf16_f32 v123, v126, v127
    v_mfma_f32_16x16x32_bf16 v[152:155], v[192:195], v[232:235], v[152:155]
    buffer_load_dwordx4 v15, s[48:51], s64 offen offset:3072  lds
    s_add_u32 s70, s76, 8192
    buffer_store_dwordx4 v[120:123], v2, s[52:55], s70 offen sc1
    v_mfma_f32_16x16x32_bf16 v[156:159], v[192:195], v[236:239], v[156:159]
    v_cvt_pk_bf16_f32 v128, v128, v129
    v_mfma_f32_16x16x32_bf16 v[160:163], v[196:199], v[224:227], v[160:163]
    ds_read_b64_tr_b16 v[188:189], v251 offset:0
    v_cvt_pk_bf16_f32 v129, v130, v131
    v_cvt_pk_bf16_f32 v130, v132, v133
    v_cvt_pk_bf16_f32 v131, v134, v135
    v_mfma_f32_16x16x32_bf16 v[164:167], v[196:199], v[228:231], v[164:167]
    ds_read_b64_tr_b16 v[190:191], v251 offset:2048
    s_add_u32 s70, s76, 16384
    buffer_store_dwordx4 v[128:131], v2, s[52:55], s70 offen sc1
    v_cvt_pk_bf16_f32 v136, v136, v137
    v_mfma_f32_16x16x32_bf16 v[168:171], v[196:199], v[232:235], v[168:171]
    s_add_u32 m0, s7, 147456
    s_add_u32 s64, s75, 258048
    buffer_load_dwordx4 v12, s[48:51], s64 offen offset:0  lds
    v_cvt_pk_bf16_f32 v137, v138, v139
    v_cvt_pk_bf16_f32 v138, v140, v141
    v_cvt_pk_bf16_f32 v139, v142, v143
    v_mfma_f32_16x16x32_bf16 v[172:175], v[196:199], v[236:239], v[172:175]
    s_add_u32 s70, s76, 24576
    buffer_store_dwordx4 v[136:139], v2, s[52:55], s70 offen sc1
    s_waitcnt lgkmcnt(4)
    v_mfma_f32_16x16x32_bf16 v[112:115], v[176:179], a[0:3], 0
    s_waitcnt vmcnt(25)
    ds_read_b64_tr_b16 v[192:193], v240 offset:0
    v_cvt_pk_bf16_f32 v144, v144, v145
    v_cvt_pk_bf16_f32 v145, v146, v147
    v_mfma_f32_16x16x32_bf16 v[116:119], v[176:179], a[4:7], 0
    ds_read_b64_tr_b16 v[194:195], v240 offset:2048
    v_cvt_pk_bf16_f32 v146, v148, v149
    v_cvt_pk_bf16_f32 v147, v150, v151
    s_add_u32 s70, s76, 32768
    buffer_store_dwordx4 v[144:147], v2, s[52:55], s70 offen sc1
    v_mfma_f32_16x16x32_bf16 v[120:123], v[176:179], a[8:11], 0
    buffer_load_dwordx4 v13, s[48:51], s64 offen offset:1024  lds
    v_cvt_pk_bf16_f32 v152, v152, v153
    v_cvt_pk_bf16_f32 v153, v154, v155
    v_cvt_pk_bf16_f32 v154, v156, v157
    v_mfma_f32_16x16x32_bf16 v[124:127], v[176:179], a[12:15], 0
    buffer_load_dwordx4 v14, s[48:51], s64 offen offset:2048  lds
    v_cvt_pk_bf16_f32 v155, v158, v159
    s_add_u32 s70, s76, 40960
    buffer_store_dwordx4 v[152:155], v2, s[52:55], s70 offen sc1
    v_mfma_f32_16x16x32_bf16 v[128:131], v[180:183], a[0:3], 0
    ds_read_b64_tr_b16 v[196:197], v241 offset:0
    v_cvt_pk_bf16_f32 v160, v160, v161
    v_mfma_f32_16x16x32_bf16 v[132:135], v[180:183], a[4:7], 0
    ds_read_b64_tr_b16 v[198:199], v241 offset:2048
    v_cvt_pk_bf16_f32 v161, v162, v163
    v_cvt_pk_bf16_f32 v162, v164, v165
    v_cvt_pk_bf16_f32 v163, v166, v167
    s_add_u32 s70, s76, 49152
    v_mfma_f32_16x16x32_bf16 v[136:139], v[180:183], a[8:11], 0
    buffer_load_dwordx4 v15, s[48:51], s64 offen offset:3072  lds
    buffer_store_dwordx4 v[160:163], v2, s[52:55], s70 offen sc1
    v_cvt_pk_bf16_f32 v168, v168, v169
    v_cvt_pk_bf16_f32 v169, v170, v171
    v_mfma_f32_16x16x32_bf16 v[140:143], v[180:183], a[12:15], 0
    v_cvt_pk_bf16_f32 v170, v172, v173
    v_cvt_pk_bf16_f32 v171, v174, v175
    s_add_u32 s70, s76, 57344
    buffer_store_dwordx4 v[168:171], v2, s[52:55], s70 offen sc1
    s_waitcnt lgkmcnt(4)
    v_mfma_f32_16x16x32_bf16 v[144:147], v[184:187], a[0:3], 0
    ds_read_b64_tr_b16 v[176:177], v242 offset:0
    v_mfma_f32_16x16x32_bf16 v[148:151], v[184:187], a[4:7], 0
    ds_read_b64_tr_b16 v[178:179], v242 offset:2048
    v_mfma_f32_16x16x32_bf16 v[152:155], v[184:187], a[8:11], 0
    s_add_u32 m0, s7, 98304
    s_add_u32 s64, s75, 294912
    buffer_load_dwordx4 v12, s[48:51], s64 offen offset:0  lds
    v_mfma_f32_16x16x32_bf16 v[156:159], v[184:187], a[12:15], 0
    v_mfma_f32_16x16x32_bf16 v[160:163], v[188:191], a[0:3], 0
    ds_read_b64_tr_b16 v[180:181], v243 offset:0
    v_mfma_f32_16x16x32_bf16 v[164:167], v[188:191], a[4:7], 0
    ds_read_b64_tr_b16 v[182:183], v243 offset:2048
    v_mfma_f32_16x16x32_bf16 v[168:171], v[188:191], a[8:11], 0
    buffer_load_dwordx4 v13, s[48:51], s64 offen offset:1024  lds
    v_mfma_f32_16x16x32_bf16 v[172:175], v[188:191], a[12:15], 0
    s_waitcnt lgkmcnt(4)
    v_mfma_f32_16x16x32_bf16 v[112:115], v[192:195], a[16:19], v[112:115]
    s_waitcnt vmcnt(30)
    ds_read_b64_tr_b16 v[184:185], v240 offset:16384
    v_mfma_f32_16x16x32_bf16 v[116:119], v[192:195], a[20:23], v[116:119]
    ds_read_b64_tr_b16 v[186:187], v240 offset:18432
    v_mfma_f32_16x16x32_bf16 v[120:123], v[192:195], a[24:27], v[120:123]
    buffer_load_dwordx4 v14, s[48:51], s64 offen offset:2048  lds
    v_mfma_f32_16x16x32_bf16 v[124:127], v[192:195], a[28:31], v[124:127]
    v_mfma_f32_16x16x32_bf16 v[128:131], v[196:199], a[16:19], v[128:131]
    ds_read_b64_tr_b16 v[188:189], v241 offset:16384
    v_mfma_f32_16x16x32_bf16 v[132:135], v[196:199], a[20:23], v[132:135]
    ds_read_b64_tr_b16 v[190:191], v241 offset:18432
    v_mfma_f32_16x16x32_bf16 v[136:139], v[196:199], a[24:27], v[136:139]
    buffer_load_dwordx4 v15, s[48:51], s64 offen offset:3072  lds
    v_mfma_f32_16x16x32_bf16 v[140:143], v[196:199], a[28:31], v[140:143]
    s_waitcnt lgkmcnt(4)
    v_mfma_f32_16x16x32_bf16 v[144:147], v[176:179], a[16:19], v[144:147]
    ds_read_b64_tr_b16 v[192:193], v242 offset:16384
    v_mfma_f32_16x16x32_bf16 v[148:151], v[176:179], a[20:23], v[148:151]
    ds_read_b64_tr_b16 v[194:195], v242 offset:18432
    v_mfma_f32_16x16x32_bf16 v[152:155], v[176:179], a[24:27], v[152:155]
    s_add_u32 m0, s7, 114688
    s_add_u32 s64, s75, 331776
    buffer_load_dwordx4 v12, s[48:51], s64 offen offset:0  lds
    v_mfma_f32_16x16x32_bf16 v[156:159], v[176:179], a[28:31], v[156:159]
    buffer_load_dwordx4 v13, s[48:51], s64 offen offset:1024  lds
    v_mfma_f32_16x16x32_bf16 v[160:163], v[180:183], a[16:19], v[160:163]
    ds_read_b64_tr_b16 v[196:197], v243 offset:16384
    v_mfma_f32_16x16x32_bf16 v[164:167], v[180:183], a[20:23], v[164:167]
    ds_read_b64_tr_b16 v[198:199], v243 offset:18432
    v_mfma_f32_16x16x32_bf16 v[168:171], v[180:183], a[24:27], v[168:171]
    buffer_load_dwordx4 v14, s[48:51], s64 offen offset:2048  lds
    v_mfma_f32_16x16x32_bf16 v[172:175], v[180:183], a[28:31], v[172:175]
    s_waitcnt lgkmcnt(4)
    v_mfma_f32_16x16x32_bf16 v[112:115], v[184:187], a[32:35], v[112:115]
    s_waitcnt vmcnt(31)
    ds_read_b64_tr_b16 v[176:177], v244 offset:0
    v_mfma_f32_16x16x32_bf16 v[116:119], v[184:187], a[36:39], v[116:119]
    ds_read_b64_tr_b16 v[178:179], v244 offset:2048
    v_mfma_f32_16x16x32_bf16 v[120:123], v[184:187], a[40:43], v[120:123]
    buffer_load_dwordx4 v15, s[48:51], s64 offen offset:3072  lds
    v_mfma_f32_16x16x32_bf16 v[124:127], v[184:187], a[44:47], v[124:127]
    v_mfma_f32_16x16x32_bf16 v[128:131], v[188:191], a[32:35], v[128:131]
    ds_read_b64_tr_b16 v[180:181], v245 offset:0
    v_mfma_f32_16x16x32_bf16 v[132:135], v[188:191], a[36:39], v[132:135]
    ds_read_b64_tr_b16 v[182:183], v245 offset:2048
    v_mfma_f32_16x16x32_bf16 v[136:139], v[188:191], a[40:43], v[136:139]
    s_add_u32 m0, s7, 131072
    s_add_u32 s64, s75, 368640
    buffer_load_dwordx4 v12, s[48:51], s64 offen offset:0  lds
    v_mfma_f32_16x16x32_bf16 v[140:143], v[188:191], a[44:47], v[140:143]
    s_waitcnt lgkmcnt(4)
    v_mfma_f32_16x16x32_bf16 v[144:147], v[192:195], a[32:35], v[144:147]
    ds_read_b64_tr_b16 v[184:185], v246 offset:0
    v_mfma_f32_16x16x32_bf16 v[148:151], v[192:195], a[36:39], v[148:151]
    ds_read_b64_tr_b16 v[186:187], v246 offset:2048
    v_mfma_f32_16x16x32_bf16 v[152:155], v[192:195], a[40:43], v[152:155]
    buffer_load_dwordx4 v13, s[48:51], s64 offen offset:1024  lds
    v_mfma_f32_16x16x32_bf16 v[156:159], v[192:195], a[44:47], v[156:159]
    v_mfma_f32_16x16x32_bf16 v[160:163], v[196:199], a[32:35], v[160:163]
    ds_read_b64_tr_b16 v[188:189], v247 offset:0
    v_mfma_f32_16x16x32_bf16 v[164:167], v[196:199], a[36:39], v[164:167]
    ds_read_b64_tr_b16 v[190:191], v247 offset:2048
    v_mfma_f32_16x16x32_bf16 v[168:171], v[196:199], a[40:43], v[168:171]
    buffer_load_dwordx4 v14, s[48:51], s64 offen offset:2048  lds
    v_mfma_f32_16x16x32_bf16 v[172:175], v[196:199], a[44:47], v[172:175]
    s_waitcnt lgkmcnt(4)
    v_mfma_f32_16x16x32_bf16 v[112:115], v[176:179], a[48:51], v[112:115]
    s_waitcnt vmcnt(31)
    ds_read_b64_tr_b16 v[192:193], v244 offset:16384
    v_mfma_f32_16x16x32_bf16 v[116:119], v[176:179], a[52:55], v[116:119]
    ds_read_b64_tr_b16 v[194:195], v244 offset:18432
    v_mfma_f32_16x16x32_bf16 v[120:123], v[176:179], a[56:59], v[120:123]
    buffer_load_dwordx4 v15, s[48:51], s64 offen offset:3072  lds
    v_mfma_f32_16x16x32_bf16 v[124:127], v[176:179], a[60:63], v[124:127]
    s_add_u32 m0, s7, 0
    s_add_u32 s64, s75, 405504
    buffer_load_dwordx4 v12, s[48:51], s64 offen offset:0  lds
    v_mfma_f32_16x16x32_bf16 v[128:131], v[180:183], a[48:51], v[128:131]
    ds_read_b64_tr_b16 v[196:197], v245 offset:16384
    v_mfma_f32_16x16x32_bf16 v[132:135], v[180:183], a[52:55], v[132:135]
    ds_read_b64_tr_b16 v[198:199], v245 offset:18432
    v_mfma_f32_16x16x32_bf16 v[136:139], v[180:183], a[56:59], v[136:139]
    buffer_load_dwordx4 v13, s[48:51], s64 offen offset:1024  lds
    v_mfma_f32_16x16x32_bf16 v[140:143], v[180:183], a[60:63], v[140:143]
    s_waitcnt lgkmcnt(4)
    v_mfma_f32_16x16x32_bf16 v[144:147], v[184:187], a[48:51], v[144:147]
    ds_read_b64_tr_b16 v[176:177], v246 offset:16384
    v_mfma_f32_16x16x32_bf16 v[148:151], v[184:187], a[52:55], v[148:151]
    ds_read_b64_tr_b16 v[178:179], v246 offset:18432
    v_mfma_f32_16x16x32_bf16 v[152:155], v[184:187], a[56:59], v[152:155]
    buffer_load_dwordx4 v14, s[48:51], s64 offen offset:2048  lds
    v_mfma_f32_16x16x32_bf16 v[156:159], v[184:187], a[60:63], v[156:159]
    v_mfma_f32_16x16x32_bf16 v[160:163], v[188:191], a[48:51], v[160:163]
    ds_read_b64_tr_b16 v[180:181], v247 offset:16384
    v_mfma_f32_16x16x32_bf16 v[164:167], v[188:191], a[52:55], v[164:167]
    ds_read_b64_tr_b16 v[182:183], v247 offset:18432
    v_mfma_f32_16x16x32_bf16 v[168:171], v[188:191], a[56:59], v[168:171]
    buffer_load_dwordx4 v15, s[48:51], s64 offen offset:3072  lds
    v_mfma_f32_16x16x32_bf16 v[172:175], v[188:191], a[60:63], v[172:175]
    s_waitcnt lgkmcnt(4)
    v_mfma_f32_16x16x32_bf16 v[112:115], v[192:195], a[64:67], v[112:115]
    s_waitcnt vmcnt(32)
    ds_read_b64_tr_b16 v[184:185], v240 offset:32768
    v_mfma_f32_16x16x32_bf16 v[116:119], v[192:195], a[68:71], v[116:119]
    ds_read_b64_tr_b16 v[186:187], v240 offset:34816
    v_mfma_f32_16x16x32_bf16 v[120:123], v[192:195], a[72:75], v[120:123]
    s_add_u32 m0, s7, 16384
    s_add_u32 s64, s75, 442368
    buffer_load_dwordx4 v12, s[48:51], s64 offen offset:0  lds
    v_mfma_f32_16x16x32_bf16 v[124:127], v[192:195], a[76:79], v[124:127]
    v_mfma_f32_16x16x32_bf16 v[128:131], v[196:199], a[64:67], v[128:131]
    ds_read_b64_tr_b16 v[188:189], v241 offset:32768
    v_mfma_f32_16x16x32_bf16 v[132:135], v[196:199], a[68:71], v[132:135]
    ds_read_b64_tr_b16 v[190:191], v241 offset:34816
    v_mfma_f32_16x16x32_bf16 v[136:139], v[196:199], a[72:75], v[136:139]
    buffer_load_dwordx4 v13, s[48:51], s64 offen offset:1024  lds
    v_mfma_f32_16x16x32_bf16 v[140:143], v[196:199], a[76:79], v[140:143]
    s_waitcnt lgkmcnt(4)
    v_mfma_f32_16x16x32_bf16 v[144:147], v[176:179], a[64:67], v[144:147]
    ds_read_b64_tr_b16 v[192:193], v242 offset:32768
    v_mfma_f32_16x16x32_bf16 v[148:151], v[176:179], a[68:71], v[148:151]
    ds_read_b64_tr_b16 v[194:195], v242 offset:34816
    v_mfma_f32_16x16x32_bf16 v[152:155], v[176:179], a[72:75], v[152:155]
    buffer_load_dwordx4 v14, s[48:51], s64 offen offset:2048  lds
    v_mfma_f32_16x16x32_bf16 v[156:159], v[176:179], a[76:79], v[156:159]
    buffer_load_dwordx4 v15, s[48:51], s64 offen offset:3072  lds
    v_mfma_f32_16x16x32_bf16 v[160:163], v[180:183], a[64:67], v[160:163]
    ds_read_b64_tr_b16 v[196:197], v243 offset:32768
    v_mfma_f32_16x16x32_bf16 v[164:167], v[180:183], a[68:71], v[164:167]
    ds_read_b64_tr_b16 v[198:199], v243 offset:34816
    v_mfma_f32_16x16x32_bf16 v[168:171], v[180:183], a[72:75], v[168:171]
    s_add_u32 m0, s7, 65536
    s_add_u32 s64, s75, 479232
    buffer_load_dwordx4 v12, s[48:51], s64 offen offset:0  lds
    v_mfma_f32_16x16x32_bf16 v[172:175], v[180:183], a[76:79], v[172:175]
    s_waitcnt lgkmcnt(4)
    v_mfma_f32_16x16x32_bf16 v[112:115], v[184:187], a[80:83], v[112:115]
    s_waitcnt vmcnt(32)
    ds_read_b64_tr_b16 v[176:177], v240 offset:49152
    v_mfma_f32_16x16x32_bf16 v[116:119], v[184:187], a[84:87], v[116:119]
    ds_read_b64_tr_b16 v[178:179], v240 offset:51200
    v_mfma_f32_16x16x32_bf16 v[120:123], v[184:187], a[88:91], v[120:123]
    buffer_load_dwordx4 v13, s[48:51], s64 offen offset:1024  lds
    v_mfma_f32_16x16x32_bf16 v[124:127], v[184:187], a[92:95], v[124:127]
    v_mfma_f32_16x16x32_bf16 v[128:131], v[188:191], a[80:83], v[128:131]
    ds_read_b64_tr_b16 v[180:181], v241 offset:49152
    v_mfma_f32_16x16x32_bf16 v[132:135], v[188:191], a[84:87], v[132:135]
    ds_read_b64_tr_b16 v[182:183], v241 offset:51200
    v_mfma_f32_16x16x32_bf16 v[136:139], v[188:191], a[88:91], v[136:139]
    buffer_load_dwordx4 v14, s[48:51], s64 offen offset:2048  lds
    v_mfma_f32_16x16x32_bf16 v[140:143], v[188:191], a[92:95], v[140:143]
    s_waitcnt lgkmcnt(4)
    v_mfma_f32_16x16x32_bf16 v[144:147], v[192:195], a[80:83], v[144:147]
    ds_read_b64_tr_b16 v[184:185], v242 offset:49152
    v_mfma_f32_16x16x32_bf16 v[148:151], v[192:195], a[84:87], v[148:151]
    ds_read_b64_tr_b16 v[186:187], v242 offset:51200
    v_mfma_f32_16x16x32_bf16 v[152:155], v[192:195], a[88:91], v[152:155]
    buffer_load_dwordx4 v15, s[48:51], s64 offen offset:3072  lds
    v_mfma_f32_16x16x32_bf16 v[156:159], v[192:195], a[92:95], v[156:159]
    v_mfma_f32_16x16x32_bf16 v[160:163], v[196:199], a[80:83], v[160:163]
    ds_read_b64_tr_b16 v[188:189], v243 offset:49152
    v_mfma_f32_16x16x32_bf16 v[164:167], v[196:199], a[84:87], v[164:167]
    ds_read_b64_tr_b16 v[190:191], v243 offset:51200
    v_mfma_f32_16x16x32_bf16 v[168:171], v[196:199], a[88:91], v[168:171]
    s_add_u32 m0, s7, 81920
    s_add_u32 s64, s75, 516096
    buffer_load_dwordx4 v12, s[48:51], s64 offen offset:0  lds
    v_mfma_f32_16x16x32_bf16 v[172:175], v[196:199], a[92:95], v[172:175]
    s_waitcnt lgkmcnt(4)
    v_mfma_f32_16x16x32_bf16 v[112:115], v[176:179], a[96:99], v[112:115]
    s_waitcnt vmcnt(27)
    ds_read_b64_tr_b16 v[192:193], v248 offset:16384
    v_mfma_f32_16x16x32_bf16 v[116:119], v[176:179], a[100:103], v[116:119]
    ds_read_b64_tr_b16 v[194:195], v248 offset:18432
    v_mfma_f32_16x16x32_bf16 v[120:123], v[176:179], a[104:107], v[120:123]
    buffer_load_dwordx4 v13, s[48:51], s64 offen offset:1024  lds
    v_mfma_f32_16x16x32_bf16 v[124:127], v[176:179], a[108:111], v[124:127]
    buffer_load_dwordx4 v14, s[48:51], s64 offen offset:2048  lds
    v_mfma_f32_16x16x32_bf16 v[128:131], v[180:183], a[96:99], v[128:131]
    ds_read_b64_tr_b16 v[196:197], v249 offset:16384
    v_mfma_f32_16x16x32_bf16 v[132:135], v[180:183], a[100:103], v[132:135]
    ds_read_b64_tr_b16 v[198:199], v249 offset:18432
    v_mfma_f32_16x16x32_bf16 v[136:139], v[180:183], a[104:107], v[136:139]
    buffer_load_dwordx4 v15, s[48:51], s64 offen offset:3072  lds
    v_mfma_f32_16x16x32_bf16 v[140:143], v[180:183], a[108:111], v[140:143]
    s_waitcnt lgkmcnt(4)
    v_mfma_f32_16x16x32_bf16 v[144:147], v[184:187], a[96:99], v[144:147]
    ds_read_b64_tr_b16 v[176:177], v250 offset:16384
    v_mfma_f32_16x16x32_bf16 v[148:151], v[184:187], a[100:103], v[148:151]
    ds_read_b64_tr_b16 v[178:179], v250 offset:18432
    v_mfma_f32_16x16x32_bf16 v[152:155], v[184:187], a[104:107], v[152:155]
    s_add_u32 m0, s7, 32768
    s_add_u32 s64, s75, 552960
    buffer_load_dwordx4 v12, s[48:51], s64 offen offset:0  lds
    v_mfma_f32_16x16x32_bf16 v[156:159], v[184:187], a[108:111], v[156:159]
    v_mfma_f32_16x16x32_bf16 v[160:163], v[188:191], a[96:99], v[160:163]
    ds_read_b64_tr_b16 v[180:181], v251 offset:16384
    v_mfma_f32_16x16x32_bf16 v[164:167], v[188:191], a[100:103], v[164:167]
    ds_read_b64_tr_b16 v[182:183], v251 offset:18432
    v_mfma_f32_16x16x32_bf16 v[168:171], v[188:191], a[104:107], v[168:171]
    buffer_load_dwordx4 v13, s[48:51], s64 offen offset:1024  lds
    v_mfma_f32_16x16x32_bf16 v[172:175], v[188:191], a[108:111], v[172:175]
    s_waitcnt lgkmcnt(4)
    v_mfma_f32_16x16x32_bf16 v[112:115], v[192:195], a[112:115], v[112:115]
    s_waitcnt vmcnt(26)
    ds_read_b64_tr_b16 v[184:185], v244 offset:32768
    v_mfma_f32_16x16x32_bf16 v[116:119], v[192:195], a[116:119], v[116:119]
    ds_read_b64_tr_b16 v[186:187], v244 offset:34816
    v_mfma_f32_16x16x32_bf16 v[120:123], v[192:195], a[120:123], v[120:123]
    buffer_load_dwordx4 v14, s[48:51], s64 offen offset:2048  lds
    v_mfma_f32_16x16x32_bf16 v[124:127], v[192:195], a[124:127], v[124:127]
    v_mfma_f32_16x16x32_bf16 v[128:131], v[196:199], a[112:115], v[128:131]
    ds_read_b64_tr_b16 v[188:189], v245 offset:32768
    v_mfma_f32_16x16x32_bf16 v[132:135], v[196:199], a[116:119], v[132:135]
    ds_read_b64_tr_b16 v[190:191], v245 offset:34816
    v_mfma_f32_16x16x32_bf16 v[136:139], v[196:199], a[120:123], v[136:139]
    buffer_load_dwordx4 v15, s[48:51], s64 offen offset:3072  lds
    v_mfma_f32_16x16x32_bf16 v[140:143], v[196:199], a[124:127], v[140:143]
    s_waitcnt lgkmcnt(4)
    v_mfma_f32_16x16x32_bf16 v[144:147], v[176:179], a[112:115], v[144:147]
    ds_read_b64_tr_b16 v[192:193], v246 offset:32768
    v_mfma_f32_16x16x32_bf16 v[148:151], v[176:179], a[116:119], v[148:151]
    ds_read_b64_tr_b16 v[194:195], v246 offset:34816
    v_mfma_f32_16x16x32_bf16 v[152:155], v[176:179], a[120:123], v[152:155]
    s_add_u32 m0, s7, 49152
    s_add_u32 s64, s75, 589824
    buffer_load_dwordx4 v12, s[48:51], s64 offen offset:0  lds
    v_mfma_f32_16x16x32_bf16 v[156:159], v[176:179], a[124:127], v[156:159]
    buffer_load_dwordx4 v13, s[48:51], s64 offen offset:1024  lds
    v_mfma_f32_16x16x32_bf16 v[160:163], v[180:183], a[112:115], v[160:163]
    ds_read_b64_tr_b16 v[196:197], v247 offset:32768
    v_mfma_f32_16x16x32_bf16 v[164:167], v[180:183], a[116:119], v[164:167]
    ds_read_b64_tr_b16 v[198:199], v247 offset:34816
    v_mfma_f32_16x16x32_bf16 v[168:171], v[180:183], a[120:123], v[168:171]
    buffer_load_dwordx4 v14, s[48:51], s64 offen offset:2048  lds
    v_mfma_f32_16x16x32_bf16 v[172:175], v[180:183], a[124:127], v[172:175]
    v_mov_b32 v6, 0
    v_mov_b32 v7, s86
    s_mov_b64 exec, 1
    buffer_store_dword v7, v6, s[52:55], s78 offen sc1
    s_mov_b64 exec, -1
    s_waitcnt lgkmcnt(4)
    v_mfma_f32_16x16x32_bf16 v[112:115], v[184:187], a[128:131], v[112:115]
    s_waitcnt vmcnt(28)
    ds_read_b64_tr_b16 v[176:177], v244 offset:49152
    v_mfma_f32_16x16x32_bf16 v[116:119], v[184:187], a[132:135], v[116:119]
    ds_read_b64_tr_b16 v[178:179], v244 offset:51200
    v_mfma_f32_16x16x32_bf16 v[120:123], v[184:187], a[136:139], v[120:123]
    buffer_load_dwordx4 v15, s[48:51], s64 offen offset:3072  lds
    v_mfma_f32_16x16x32_bf16 v[124:127], v[184:187], a[140:143], v[124:127]
    v_mfma_f32_16x16x32_bf16 v[128:131], v[188:191], a[128:131], v[128:131]
    ds_read_b64_tr_b16 v[180:181], v245 offset:49152
    v_mfma_f32_16x16x32_bf16 v[132:135], v[188:191], a[132:135], v[132:135]
    ds_read_b64_tr_b16 v[182:183], v245 offset:51200
    v_mfma_f32_16x16x32_bf16 v[136:139], v[188:191], a[136:139], v[136:139]
    s_add_u32 m0, s7, 147456
    s_add_u32 s64, s75, 626688
    buffer_load_dwordx4 v12, s[48:51], s64 offen offset:0  lds
    v_mfma_f32_16x16x32_bf16 v[140:143], v[188:191], a[140:143], v[140:143]
    buffer_load_dwordx4 v13, s[48:51], s64 offen offset:1024  lds
    s_waitcnt lgkmcnt(4)
    v_mfma_f32_16x16x32_bf16 v[144:147], v[192:195], a[128:131], v[144:147]
    ds_read_b64_tr_b16 v[184:185], v246 offset:49152
    v_mfma_f32_16x16x32_bf16 v[148:151], v[192:195], a[132:135], v[148:151]
    ds_read_b64_tr_b16 v[186:187], v246 offset:51200
    v_mfma_f32_16x16x32_bf16 v[152:155], v[192:195], a[136:139], v[152:155]
    buffer_load_dwordx4 v14, s[48:51], s64 offen offset:2048  lds
    v_mfma_f32_16x16x32_bf16 v[156:159], v[192:195], a[140:143], v[156:159]
    v_mfma_f32_16x16x32_bf16 v[160:163], v[196:199], a[128:131], v[160:163]
    ds_read_b64_tr_b16 v[188:189], v247 offset:49152
    v_mfma_f32_16x16x32_bf16 v[164:167], v[196:199], a[132:135], v[164:167]
    ds_read_b64_tr_b16 v[190:191], v247 offset:51200
    v_mfma_f32_16x16x32_bf16 v[168:171], v[196:199], a[136:139], v[168:171]
    buffer_load_dwordx4 v15, s[48:51], s64 offen offset:3072  lds
    v_mfma_f32_16x16x32_bf16 v[172:175], v[196:199], a[140:143], v[172:175]
    s_waitcnt lgkmcnt(4)
    v_mfma_f32_16x16x32_bf16 v[112:115], v[176:179], a[144:147], v[112:115]
    s_waitcnt vmcnt(29)
    ds_read_b64_tr_b16 v[192:193], v248 offset:0
    v_mfma_f32_16x16x32_bf16 v[116:119], v[176:179], a[148:151], v[116:119]
    ds_read_b64_tr_b16 v[194:195], v248 offset:2048
    v_mfma_f32_16x16x32_bf16 v[120:123], v[176:179], a[152:155], v[120:123]
    s_add_u32 m0, s7, 98304
    s_add_u32 s64, s75, 663552
    buffer_load_dwordx4 v12, s[48:51], s64 offen offset:0  lds
    v_mfma_f32_16x16x32_bf16 v[124:127], v[176:179], a[156:159], v[124:127]
    buffer_load_dwordx4 v13, s[48:51], s64 offen offset:1024  lds
    v_mfma_f32_16x16x32_bf16 v[128:131], v[180:183], a[144:147], v[128:131]
    ds_read_b64_tr_b16 v[196:197], v249 offset:0
    v_mfma_f32_16x16x32_bf16 v[132:135], v[180:183], a[148:151], v[132:135]
    ds_read_b64_tr_b16 v[198:199], v249 offset:2048
    v_mfma_f32_16x16x32_bf16 v[136:139], v[180:183], a[152:155], v[136:139]
    buffer_load_dwordx4 v14, s[48:51], s64 offen offset:2048  lds
    v_mfma_f32_16x16x32_bf16 v[140:143], v[180:183], a[156:159], v[140:143]
    s_waitcnt lgkmcnt(4)
    v_mfma_f32_16x16x32_bf16 v[144:147], v[184:187], a[144:147], v[144:147]
    ds_read_b64_tr_b16 v[176:177], v250 offset:0
    v_mfma_f32_16x16x32_bf16 v[148:151], v[184:187], a[148:151], v[148:151]
    ds_read_b64_tr_b16 v[178:179], v250 offset:2048
    v_mfma_f32_16x16x32_bf16 v[152:155], v[184:187], a[152:155], v[152:155]
    buffer_load_dwordx4 v15, s[48:51], s64 offen offset:3072  lds
    v_mfma_f32_16x16x32_bf16 v[156:159], v[184:187], a[156:159], v[156:159]
    v_mfma_f32_16x16x32_bf16 v[160:163], v[188:191], a[144:147], v[160:163]
    ds_read_b64_tr_b16 v[180:181], v251 offset:0
    v_mfma_f32_16x16x32_bf16 v[164:167], v[188:191], a[148:151], v[164:167]
    ds_read_b64_tr_b16 v[182:183], v251 offset:2048
    v_mfma_f32_16x16x32_bf16 v[168:171], v[188:191], a[152:155], v[168:171]
    s_add_u32 m0, s7, 114688
    s_add_u32 s64, s75, 700416
    buffer_load_dwordx4 v12, s[48:51], s64 offen offset:0  lds
    v_mfma_f32_16x16x32_bf16 v[172:175], v[188:191], a[156:159], v[172:175]
    buffer_load_dwordx4 v13, s[48:51], s64 offen offset:1024  lds
    v_and_b32 v208, 15, v1
    v_bfe_u32 v209, v1, 4, 1
    v_lshl_add_u32 v208, v209, 4, v208
    v_mul_u32_u24 v208, 1152, v208
    v_lshrrev_b32 v209, 5, v1
    v_lshl_add_u32 v208, v209, 4, v208
    v_lshrrev_b32 v209, 4, v1
    v_lshlrev_b32 v209, 3, v209
    s_mov_b32 s87, 0x40088e99
    s_mov_b32 s92, 0x00003f80
    s_mov_b32 s93, 0x3f800000
    s_mul_i32 s9, s4, 9
    s_add_u32 s9, s9, s6
    s_lshl_b32 s83, s9, 6
    s_add_u32 s83, s83, 48238592
    s_lshl_b32 s80, s9, 2
    s_add_u32 s80, s80, s3
    s_lshl_b32 s80, s80, 14
    s_lshl_b32 s81, s6, 2
    s_add_u32 s81, s81, s3
    s_lshl_b32 s81, s81, 5
    s_mul_i32 s82, s4, 73728
    s_add_u32 s82, s82, s81
    s_mov_b32 s56, s20
    s_and_b32 s57, s21, 0xffff
    s_mov_b32 s58, 663552
    s_mov_b32 s59, 0x00020000
    s_mov_b32 s44, s30
    s_and_b32 s45, s31, 0xffff
    s_mov_b32 s46, 1152
    s_mov_b32 s47, 0x00020000
    s_sub_u32 s88, s65, s68
    v_add_u32 v9, 0x20000, v2
    v_and_b32 v210, 7, v1
    v_lshlrev_b32 v210, 2, v210
    v_min_u32 v212, 4, v1
    s_add_u32 s9, s6, 5
    v_sub_u32 v212, s9, v212
    v_subrev_u32 v213, 6, v212
    v_min_u32 v212, v212, v213
    v_lshlrev_b32 v212, 2, v212
    s_waitcnt lgkmcnt(4)
    v_mfma_f32_16x16x32_bf16 v[112:115], v[192:195], a[160:163], v[112:115]
    s_waitcnt vmcnt(31)
    ds_read_b64_tr_b16 v[184:185], v240 offset:0
    v_mfma_f32_16x16x32_bf16 v[116:119], v[192:195], a[164:167], v[116:119]
    ds_read_b64_tr_b16 v[186:187], v240 offset:2048
    v_mfma_f32_16x16x32_bf16 v[120:123], v[192:195], a[168:171], v[120:123]
    buffer_load_dwordx4 v14, s[48:51], s64 offen offset:2048  lds
    v_mfma_f32_16x16x32_bf16 v[124:127], v[192:195], a[172:175], v[124:127]
    v_mfma_f32_16x16x32_bf16 v[128:131], v[196:199], a[160:163], v[128:131]
    ds_read_b64_tr_b16 v[188:189], v241 offset:0
    v_mfma_f32_16x16x32_bf16 v[132:135], v[196:199], a[164:167], v[132:135]
    ds_read_b64_tr_b16 v[190:191], v241 offset:2048
    v_mfma_f32_16x16x32_bf16 v[136:139], v[196:199], a[168:171], v[136:139]
    buffer_load_dwordx4 v15, s[48:51], s64 offen offset:3072  lds
    v_mfma_f32_16x16x32_bf16 v[140:143], v[196:199], a[172:175], v[140:143]
    s_waitcnt lgkmcnt(4)
    v_mfma_f32_16x16x32_bf16 v[144:147], v[176:179], a[160:163], v[144:147]
    ds_read_b64_tr_b16 v[192:193], v242 offset:0
    v_mfma_f32_16x16x32_bf16 v[148:151], v[176:179], a[164:167], v[148:151]
    ds_read_b64_tr_b16 v[194:195], v242 offset:2048
    v_mfma_f32_16x16x32_bf16 v[152:155], v[176:179], a[168:171], v[152:155]
    s_add_u32 m0, s7, 131072
    s_add_u32 s64, s75, 737280
    buffer_load_dwordx4 v12, s[48:51], s64 offen offset:0  lds
    v_mfma_f32_16x16x32_bf16 v[156:159], v[176:179], a[172:175], v[156:159]
    buffer_load_dwordx4 v13, s[48:51], s64 offen offset:1024  lds
    v_mfma_f32_16x16x32_bf16 v[160:163], v[180:183], a[160:163], v[160:163]
    ds_read_b64_tr_b16 v[196:197], v243 offset:0
    v_mfma_f32_16x16x32_bf16 v[164:167], v[180:183], a[164:167], v[164:167]
    ds_read_b64_tr_b16 v[198:199], v243 offset:2048
    v_mfma_f32_16x16x32_bf16 v[168:171], v[180:183], a[168:171], v[168:171]
    buffer_load_dwordx4 v14, s[48:51], s64 offen offset:2048  lds
    v_mfma_f32_16x16x32_bf16 v[172:175], v[180:183], a[172:175], v[172:175]
    s_waitcnt lgkmcnt(4)
    v_mfma_f32_16x16x32_bf16 v[112:115], v[184:187], a[176:179], v[112:115]
    s_waitcnt vmcnt(32)
    ds_read_b64_tr_b16 v[176:177], v240 offset:16384
    v_mfma_f32_16x16x32_bf16 v[116:119], v[184:187], a[180:183], v[116:119]
    ds_read_b64_tr_b16 v[178:179], v240 offset:18432
    v_mfma_f32_16x16x32_bf16 v[120:123], v[184:187], a[184:187], v[120:123]
    buffer_load_dwordx4 v15, s[48:51], s64 offen offset:3072  lds
    v_mfma_f32_16x16x32_bf16 v[124:127], v[184:187], a[188:191], v[124:127]
    v_mfma_f32_16x16x32_bf16 v[128:131], v[188:191], a[176:179], v[128:131]
    ds_read_b64_tr_b16 v[180:181], v241 offset:16384
    v_mfma_f32_16x16x32_bf16 v[132:135], v[188:191], a[180:183], v[132:135]
    ds_read_b64_tr_b16 v[182:183], v241 offset:18432
    v_mfma_f32_16x16x32_bf16 v[136:139], v[188:191], a[184:187], v[136:139]
    v_mfma_f32_16x16x32_bf16 v[140:143], v[188:191], a[188:191], v[140:143]
    s_waitcnt lgkmcnt(4)
    v_mfma_f32_16x16x32_bf16 v[144:147], v[192:195], a[176:179], v[144:147]
    ds_read_b64_tr_b16 v[184:185], v242 offset:16384
    v_mfma_f32_16x16x32_bf16 v[148:151], v[192:195], a[180:183], v[148:151]
    ds_read_b64_tr_b16 v[186:187], v242 offset:18432
    v_mfma_f32_16x16x32_bf16 v[152:155], v[192:195], a[184:187], v[152:155]
    s_add_u32 m0, s7, 0
    s_add_u32 s64, s75, 774144
    buffer_load_dwordx4 v12, s[48:51], s64 offen offset:0  lds
    v_mfma_f32_16x16x32_bf16 v[156:159], v[192:195], a[188:191], v[156:159]
    v_mfma_f32_16x16x32_bf16 v[160:163], v[196:199], a[176:179], v[160:163]
    ds_read_b64_tr_b16 v[188:189], v243 offset:16384
    v_mfma_f32_16x16x32_bf16 v[164:167], v[196:199], a[180:183], v[164:167]
    ds_read_b64_tr_b16 v[190:191], v243 offset:18432
    v_mfma_f32_16x16x32_bf16 v[168:171], v[196:199], a[184:187], v[168:171]
    buffer_load_dwordx4 v13, s[48:51], s64 offen offset:1024  lds
    v_mfma_f32_16x16x32_bf16 v[172:175], v[196:199], a[188:191], v[172:175]
    s_waitcnt lgkmcnt(4)
    v_mfma_f32_16x16x32_bf16 v[112:115], v[176:179], a[192:195], v[112:115]
    s_waitcnt vmcnt(31)
    ds_read_b64_tr_b16 v[192:193], v244 offset:0
    v_mfma_f32_16x16x32_bf16 v[116:119], v[176:179], a[196:199], v[116:119]
    ds_read_b64_tr_b16 v[194:195], v244 offset:2048
    v_mfma_f32_16x16x32_bf16 v[120:123], v[176:179], a[200:203], v[120:123]
    buffer_load_dwordx4 v14, s[48:51], s64 offen offset:2048  lds
    v_mfma_f32_16x16x32_bf16 v[124:127], v[176:179], a[204:207], v[124:127]
    buffer_load_dwordx4 v15, s[48:51], s64 offen offset:3072  lds
    v_mfma_f32_16x16x32_bf16 v[128:131], v[180:183], a[192:195], v[128:131]
    ds_read_b64_tr_b16 v[196:197], v245 offset:0
    v_mfma_f32_16x16x32_bf16 v[132:135], v[180:183], a[196:199], v[132:135]
    ds_read_b64_tr_b16 v[198:199], v245 offset:2048
    v_mfma_f32_16x16x32_bf16 v[136:139], v[180:183], a[200:203], v[136:139]
    v_mfma_f32_16x16x32_bf16 v[140:143], v[180:183], a[204:207], v[140:143]
    s_waitcnt lgkmcnt(4)
    v_mfma_f32_16x16x32_bf16 v[144:147], v[184:187], a[192:195], v[144:147]
    ds_read_b64_tr_b16 v[176:177], v246 offset:0
    v_mfma_f32_16x16x32_bf16 v[148:151], v[184:187], a[196:199], v[148:151]
    ds_read_b64_tr_b16 v[178:179], v246 offset:2048
    v_mfma_f32_16x16x32_bf16 v[152:155], v[184:187], a[200:203], v[152:155]
    s_add_u32 m0, s7, 16384
    s_add_u32 s64, s75, 811008
    buffer_load_dwordx4 v12, s[48:51], s64 offen offset:0  lds
    v_mfma_f32_16x16x32_bf16 v[156:159], v[184:187], a[204:207], v[156:159]
    v_mfma_f32_16x16x32_bf16 v[160:163], v[188:191], a[192:195], v[160:163]
    ds_read_b64_tr_b16 v[180:181], v247 offset:0
    v_mfma_f32_16x16x32_bf16 v[164:167], v[188:191], a[196:199], v[164:167]
    ds_read_b64_tr_b16 v[182:183], v247 offset:2048
    v_mfma_f32_16x16x32_bf16 v[168:171], v[188:191], a[200:203], v[168:171]
    buffer_load_dwordx4 v13, s[48:51], s64 offen offset:1024  lds
    v_mfma_f32_16x16x32_bf16 v[172:175], v[188:191], a[204:207], v[172:175]
    buffer_load_dwordx4 v14, s[48:51], s64 offen offset:2048  lds
    s_waitcnt lgkmcnt(4)
    v_mfma_f32_16x16x32_bf16 v[112:115], v[192:195], a[208:211], v[112:115]
    s_waitcnt vmcnt(32)
    ds_read_b64_tr_b16 v[184:185], v244 offset:16384
    v_mfma_f32_16x16x32_bf16 v[116:119], v[192:195], a[212:215], v[116:119]
    ds_read_b64_tr_b16 v[186:187], v244 offset:18432
    v_mfma_f32_16x16x32_bf16 v[120:123], v[192:195], a[216:219], v[120:123]
    buffer_load_dwordx4 v15, s[48:51], s64 offen offset:3072  lds
    v_mfma_f32_16x16x32_bf16 v[124:127], v[192:195], a[220:223], v[124:127]
    v_mfma_f32_16x16x32_bf16 v[128:131], v[196:199], a[208:211], v[128:131]
    ds_read_b64_tr_b16 v[188:189], v245 offset:16384
    v_mfma_f32_16x16x32_bf16 v[132:135], v[196:199], a[212:215], v[132:135]
    ds_read_b64_tr_b16 v[190:191], v245 offset:18432
    v_mfma_f32_16x16x32_bf16 v[136:139], v[196:199], a[216:219], v[136:139]
    v_mfma_f32_16x16x32_bf16 v[140:143], v[196:199], a[220:223], v[140:143]
    s_waitcnt lgkmcnt(4)
    v_mfma_f32_16x16x32_bf16 v[144:147], v[176:179], a[208:211], v[144:147]
    ds_read_b64_tr_b16 v[192:193], v246 offset:16384
    v_mfma_f32_16x16x32_bf16 v[148:151], v[176:179], a[212:215], v[148:151]
    ds_read_b64_tr_b16 v[194:195], v246 offset:18432
    v_mfma_f32_16x16x32_bf16 v[152:155], v[176:179], a[216:219], v[152:155]
    s_add_u32 m0, s7, 65536
    s_add_u32 s64, s75, 847872
    buffer_load_dwordx4 v12, s[48:51], s64 offen offset:0  lds
    v_mfma_f32_16x16x32_bf16 v[156:159], v[176:179], a[220:223], v[156:159]
    buffer_load_dwordx4 v13, s[48:51], s64 offen offset:1024  lds
    v_mfma_f32_16x16x32_bf16 v[160:163], v[180:183], a[208:211], v[160:163]
    ds_read_b64_tr_b16 v[196:197], v247 offset:16384
    v_mfma_f32_16x16x32_bf16 v[164:167], v[180:183], a[212:215], v[164:167]
    ds_read_b64_tr_b16 v[198:199], v247 offset:18432
    v_mfma_f32_16x16x32_bf16 v[168:171], v[180:183], a[216:219], v[168:171]
    buffer_load_dwordx4 v14, s[48:51], s64 offen offset:2048  lds
    v_mfma_f32_16x16x32_bf16 v[172:175], v[180:183], a[220:223], v[172:175]
    s_waitcnt lgkmcnt(4)
    v_mfma_f32_16x16x32_bf16 v[112:115], v[184:187], a[224:227], v[112:115]
    s_waitcnt vmcnt(32)
    ds_read_b64_tr_b16 v[176:177], v240 offset:32768
    v_mfma_f32_16x16x32_bf16 v[116:119], v[184:187], a[228:231], v[116:119]
    ds_read_b64_tr_b16 v[178:179], v240 offset:34816
    v_mfma_f32_16x16x32_bf16 v[120:123], v[184:187], a[232:235], v[120:123]
    buffer_load_dwordx4 v15, s[48:51], s64 offen offset:3072  lds
    v_mfma_f32_16x16x32_bf16 v[124:127], v[184:187], a[236:239], v[124:127]
    v_mfma_f32_16x16x32_bf16 v[128:131], v[188:191], a[224:227], v[128:131]
    ds_read_b64_tr_b16 v[180:181], v241 offset:32768
    v_mfma_f32_16x16x32_bf16 v[132:135], v[188:191], a[228:231], v[132:135]
    ds_read_b64_tr_b16 v[182:183], v241 offset:34816
    v_mfma_f32_16x16x32_bf16 v[136:139], v[188:191], a[232:235], v[136:139]
    v_mfma_f32_16x16x32_bf16 v[140:143], v[188:191], a[236:239], v[140:143]
    s_waitcnt lgkmcnt(4)
    v_mfma_f32_16x16x32_bf16 v[144:147], v[192:195], a[224:227], v[144:147]
    ds_read_b64_tr_b16 v[184:185], v242 offset:32768
    v_mfma_f32_16x16x32_bf16 v[148:151], v[192:195], a[228:231], v[148:151]
    ds_read_b64_tr_b16 v[186:187], v242 offset:34816
    v_mfma_f32_16x16x32_bf16 v[152:155], v[192:195], a[232:235], v[152:155]
    s_add_u32 m0, s7, 81920
    s_add_u32 s64, s65, 589824
    buffer_load_dwordx4 v12, s[48:51], s64 offen offset:0  lds
    v_mfma_f32_16x16x32_bf16 v[156:159], v[192:195], a[236:239], v[156:159]
    v_mfma_f32_16x16x32_bf16 v[160:163], v[196:199], a[224:227], v[160:163]
    ds_read_b64_tr_b16 v[188:189], v243 offset:32768
    v_mfma_f32_16x16x32_bf16 v[164:167], v[196:199], a[228:231], v[164:167]
    ds_read_b64_tr_b16 v[190:191], v243 offset:34816
    v_mfma_f32_16x16x32_bf16 v[168:171], v[196:199], a[232:235], v[168:171]
    buffer_load_dwordx4 v13, s[48:51], s64 offen offset:1024  lds
    v_mfma_f32_16x16x32_bf16 v[172:175], v[196:199], a[236:239], v[172:175]
    s_waitcnt lgkmcnt(4)
    v_mfma_f32_16x16x32_bf16 v[112:115], v[176:179], a[240:243], v[112:115]
    s_waitcnt vmcnt(30)
    ds_read_b64_tr_b16 v[192:193], v240 offset:49152
    v_mfma_f32_16x16x32_bf16 v[116:119], v[176:179], a[244:247], v[116:119]
    ds_read_b64_tr_b16 v[194:195], v240 offset:51200
    v_mfma_f32_16x16x32_bf16 v[120:123], v[176:179], a[248:251], v[120:123]
    buffer_load_dwordx4 v14, s[48:51], s64 offen offset:2048  lds
    v_mfma_f32_16x16x32_bf16 v[124:127], v[176:179], a[252:255], v[124:127]
    buffer_load_dwordx4 v15, s[48:51], s64 offen offset:3072  lds
    v_mfma_f32_16x16x32_bf16 v[128:131], v[180:183], a[240:243], v[128:131]
    ds_read_b64_tr_b16 v[196:197], v241 offset:49152
    v_mfma_f32_16x16x32_bf16 v[132:135], v[180:183], a[244:247], v[132:135]
    ds_read_b64_tr_b16 v[198:199], v241 offset:51200
    v_mfma_f32_16x16x32_bf16 v[136:139], v[180:183], a[248:251], v[136:139]
    v_mfma_f32_16x16x32_bf16 v[140:143], v[180:183], a[252:255], v[140:143]
    s_waitcnt lgkmcnt(4)
    v_mfma_f32_16x16x32_bf16 v[144:147], v[184:187], a[240:243], v[144:147]
    ds_read_b64_tr_b16 v[176:177], v242 offset:49152
    v_mfma_f32_16x16x32_bf16 v[148:151], v[184:187], a[244:247], v[148:151]
    ds_read_b64_tr_b16 v[178:179], v242 offset:51200
    v_mfma_f32_16x16x32_bf16 v[152:155], v[184:187], a[248:251], v[152:155]
    s_add_u32 m0, s7, 32768
    s_add_u32 s64, s65, 737280
    buffer_load_dwordx4 v12, s[48:51], s64 offen offset:0  lds
    v_mfma_f32_16x16x32_bf16 v[156:159], v[184:187], a[252:255], v[156:159]
    v_mfma_f32_16x16x32_bf16 v[160:163], v[188:191], a[240:243], v[160:163]
    ds_read_b64_tr_b16 v[180:181], v243 offset:49152
    v_mfma_f32_16x16x32_bf16 v[164:167], v[188:191], a[244:247], v[164:167]
    ds_read_b64_tr_b16 v[182:183], v243 offset:51200
    v_mfma_f32_16x16x32_bf16 v[168:171], v[188:191], a[248:251], v[168:171]
    buffer_load_dwordx4 v13, s[48:51], s64 offen offset:1024  lds
    v_mfma_f32_16x16x32_bf16 v[172:175], v[188:191], a[252:255], v[172:175]
    buffer_load_dwordx4 v14, s[48:51], s64 offen offset:2048  lds
    s_waitcnt lgkmcnt(4)
    v_mfma_f32_16x16x32_bf16 v[112:115], v[192:195], v[16:19], v[112:115]
    s_waitcnt vmcnt(31)
    ds_read_b64_tr_b16 v[184:185], v248 offset:16384
    v_mfma_f32_16x16x32_bf16 v[116:119], v[192:195], v[20:23], v[116:119]
    ds_read_b64_tr_b16 v[186:187], v248 offset:18432
    v_mfma_f32_16x16x32_bf16 v[120:123], v[192:195], v[24:27], v[120:123]
    buffer_load_dwordx4 v15, s[48:51], s64 offen offset:3072  lds
    v_mfma_f32_16x16x32_bf16 v[124:127], v[192:195], v[28:31], v[124:127]
    v_mfma_f32_16x16x32_bf16 v[128:131], v[196:199], v[16:19], v[128:131]
    ds_read_b64_tr_b16 v[188:189], v249 offset:16384
    v_mfma_f32_16x16x32_bf16 v[132:135], v[196:199], v[20:23], v[132:135]
    ds_read_b64_tr_b16 v[190:191], v249 offset:18432
    v_mfma_f32_16x16x32_bf16 v[136:139], v[196:199], v[24:27], v[136:139]
    v_mfma_f32_16x16x32_bf16 v[140:143], v[196:199], v[28:31], v[140:143]
    s_waitcnt lgkmcnt(4)
    v_mfma_f32_16x16x32_bf16 v[144:147], v[176:179], v[16:19], v[144:147]
    ds_read_b64_tr_b16 v[192:193], v250 offset:16384
    v_mfma_f32_16x16x32_bf16 v[148:151], v[176:179], v[20:23], v[148:151]
    ds_read_b64_tr_b16 v[194:195], v250 offset:18432
    v_mfma_f32_16x16x32_bf16 v[152:155], v[176:179], v[24:27], v[152:155]
    s_add_u32 m0, s7, 49152
    s_add_u32 s64, s65, 0
    buffer_load_dwordx4 v12, s[48:51], s64 offen offset:0  lds
    v_mfma_f32_16x16x32_bf16 v[156:159], v[176:179], v[28:31], v[156:159]
    buffer_load_dwordx4 v13, s[48:51], s64 offen offset:1024  lds
    v_mfma_f32_16x16x32_bf16 v[160:163], v[180:183], v[16:19], v[160:163]
    ds_read_b64_tr_b16 v[196:197], v251 offset:16384
    v_mfma_f32_16x16x32_bf16 v[164:167], v[180:183], v[20:23], v[164:167]
    ds_read_b64_tr_b16 v[198:199], v251 offset:18432
    v_mfma_f32_16x16x32_bf16 v[168:171], v[180:183], v[24:27], v[168:171]
    buffer_load_dwordx4 v14, s[48:51], s64 offen offset:2048  lds
    v_mfma_f32_16x16x32_bf16 v[172:175], v[180:183], v[28:31], v[172:175]
    s_waitcnt lgkmcnt(4)
    v_mfma_f32_16x16x32_bf16 v[112:115], v[184:187], v[32:35], v[112:115]
    s_waitcnt vmcnt(31)
    ds_read_b64_tr_b16 v[176:177], v244 offset:32768
    v_mfma_f32_16x16x32_bf16 v[116:119], v[184:187], v[36:39], v[116:119]
    ds_read_b64_tr_b16 v[178:179], v244 offset:34816
    v_mfma_f32_16x16x32_bf16 v[120:123], v[184:187], v[40:43], v[120:123]
    buffer_load_dwordx4 v15, s[48:51], s64 offen offset:3072  lds
    v_mfma_f32_16x16x32_bf16 v[124:127], v[184:187], v[44:47], v[124:127]
    v_mfma_f32_16x16x32_bf16 v[128:131], v[188:191], v[32:35], v[128:131]
    ds_read_b64_tr_b16 v[180:181], v245 offset:32768
    v_mfma_f32_16x16x32_bf16 v[132:135], v[188:191], v[36:39], v[132:135]
    ds_read_b64_tr_b16 v[182:183], v245 offset:34816
    v_mfma_f32_16x16x32_bf16 v[136:139], v[188:191], v[40:43], v[136:139]
    v_mfma_f32_16x16x32_bf16 v[140:143], v[188:191], v[44:47], v[140:143]
    s_waitcnt lgkmcnt(4)
    v_mfma_f32_16x16x32_bf16 v[144:147], v[192:195], v[32:35], v[144:147]
    ds_read_b64_tr_b16 v[184:185], v246 offset:32768
    v_mfma_f32_16x16x32_bf16 v[148:151], v[192:195], v[36:39], v[148:151]
    ds_read_b64_tr_b16 v[186:187], v246 offset:34816
    v_mfma_f32_16x16x32_bf16 v[152:155], v[192:195], v[40:43], v[152:155]
    s_add_u32 m0, s7, 147456
    s_add_u32 s64, s65, 147456
    buffer_load_dwordx4 v12, s[48:51], s64 offen offset:0  lds
    v_mfma_f32_16x16x32_bf16 v[156:159], v[192:195], v[44:47], v[156:159]
    v_mfma_f32_16x16x32_bf16 v[160:163], v[196:199], v[32:35], v[160:163]
    ds_read_b64_tr_b16 v[188:189], v247 offset:32768
    v_mfma_f32_16x16x32_bf16 v[164:167], v[196:199], v[36:39], v[164:167]
    ds_read_b64_tr_b16 v[190:191], v247 offset:34816
    v_mfma_f32_16x16x32_bf16 v[168:171], v[196:199], v[40:43], v[168:171]
    buffer_load_dwordx4 v13, s[48:51], s64 offen offset:1024  lds
    v_mfma_f32_16x16x32_bf16 v[172:175], v[196:199], v[44:47], v[172:175]
    buffer_load_dword v211, v210, s[52:55], s95 offen sc1
    s_waitcnt lgkmcnt(4)
    v_mfma_f32_16x16x32_bf16 v[112:115], v[176:179], v[48:51], v[112:115]
    s_waitcnt vmcnt(31)
    ds_read_b64_tr_b16 v[192:193], v244 offset:49152
    v_mfma_f32_16x16x32_bf16 v[116:119], v[176:179], v[52:55], v[116:119]
    ds_read_b64_tr_b16 v[194:195], v244 offset:51200
    v_mfma_f32_16x16x32_bf16 v[120:123], v[176:179], v[56:59], v[120:123]
    buffer_load_dwordx4 v14, s[48:51], s64 offen offset:2048  lds
    v_mfma_f32_16x16x32_bf16 v[124:127], v[176:179], v[60:63], v[124:127]
    buffer_load_dwordx4 v15, s[48:51], s64 offen offset:3072  lds
    v_mfma_f32_16x16x32_bf16 v[128:131], v[180:183], v[48:51], v[128:131]
    ds_read_b64_tr_b16 v[196:197], v245 offset:49152
    v_mfma_f32_16x16x32_bf16 v[132:135], v[180:183], v[52:55], v[132:135]
    ds_read_b64_tr_b16 v[198:199], v245 offset:51200
    v_mfma_f32_16x16x32_bf16 v[136:139], v[180:183], v[56:59], v[136:139]
    v_mfma_f32_16x16x32_bf16 v[140:143], v[180:183], v[60:63], v[140:143]
    s_waitcnt lgkmcnt(4)
    v_mfma_f32_16x16x32_bf16 v[144:147], v[184:187], v[48:51], v[144:147]
    ds_read_b64_tr_b16 v[176:177], v246 offset:49152
    v_mfma_f32_16x16x32_bf16 v[148:151], v[184:187], v[52:55], v[148:151]
    ds_read_b64_tr_b16 v[178:179], v246 offset:51200
    v_mfma_f32_16x16x32_bf16 v[152:155], v[184:187], v[56:59], v[152:155]
    s_add_u32 m0, s7, 98304
    s_add_u32 s64, s65, 294912
    buffer_load_dwordx4 v12, s[48:51], s64 offen offset:0  lds
    v_mfma_f32_16x16x32_bf16 v[156:159], v[184:187], v[60:63], v[156:159]
    v_mfma_f32_16x16x32_bf16 v[160:163], v[188:191], v[48:51], v[160:163]
    ds_read_b64_tr_b16 v[180:181], v247 offset:49152
    v_mfma_f32_16x16x32_bf16 v[164:167], v[188:191], v[52:55], v[164:167]
    ds_read_b64_tr_b16 v[182:183], v247 offset:51200
    v_mfma_f32_16x16x32_bf16 v[168:171], v[188:191], v[56:59], v[168:171]
    buffer_load_dwordx4 v13, s[48:51], s64 offen offset:1024  lds
    v_mfma_f32_16x16x32_bf16 v[172:175], v[188:191], v[60:63], v[172:175]
    buffer_load_dwordx4 v14, s[48:51], s64 offen offset:2048  lds
    s_waitcnt lgkmcnt(4)
    v_mfma_f32_16x16x32_bf16 v[112:115], v[192:195], v[64:67], v[112:115]
    s_waitcnt vmcnt(32)
    ds_read_b64_tr_b16 v[184:185], v248 offset:0
    v_mfma_f32_16x16x32_bf16 v[116:119], v[192:195], v[68:71], v[116:119]
    ds_read_b64_tr_b16 v[186:187], v248 offset:2048
    v_mfma_f32_16x16x32_bf16 v[120:123], v[192:195], v[72:75], v[120:123]
    buffer_load_dwordx4 v15, s[48:51], s64 offen offset:3072  lds
    v_mfma_f32_16x16x32_bf16 v[124:127], v[192:195], v[76:79], v[124:127]
    v_mfma_f32_16x16x32_bf16 v[128:131], v[196:199], v[64:67], v[128:131]
    ds_read_b64_tr_b16 v[188:189], v249 offset:0
    v_mfma_f32_16x16x32_bf16 v[132:135], v[196:199], v[68:71], v[132:135]
    ds_read_b64_tr_b16 v[190:191], v249 offset:2048
    v_mfma_f32_16x16x32_bf16 v[136:139], v[196:199], v[72:75], v[136:139]
    v_mfma_f32_16x16x32_bf16 v[140:143], v[196:199], v[76:79], v[140:143]
    s_waitcnt lgkmcnt(4)
    v_mfma_f32_16x16x32_bf16 v[144:147], v[176:179], v[64:67], v[144:147]
    ds_read_b64_tr_b16 v[192:193], v250 offset:0
    v_mfma_f32_16x16x32_bf16 v[148:151], v[176:179], v[68:71], v[148:151]
    ds_read_b64_tr_b16 v[194:195], v250 offset:2048
    v_mfma_f32_16x16x32_bf16 v[152:155], v[176:179], v[72:75], v[152:155]
    s_add_u32 m0, s7, 114688
    s_add_u32 s64, s65, 442368
    buffer_load_dwordx4 v12, s[48:51], s64 offen offset:0  lds
    v_mfma_f32_16x16x32_bf16 v[156:159], v[176:179], v[76:79], v[156:159]
    buffer_load_dwordx4 v13, s[48:51], s64 offen offset:1024  lds
    v_mfma_f32_16x16x32_bf16 v[160:163], v[180:183], v[64:67], v[160:163]
    ds_read_b64_tr_b16 v[196:197], v251 offset:0
    v_mfma_f32_16x16x32_bf16 v[164:167], v[180:183], v[68:71], v[164:167]
    ds_read_b64_tr_b16 v[198:199], v251 offset:2048
    v_mfma_f32_16x16x32_bf16 v[168:171], v[180:183], v[72:75], v[168:171]
    buffer_load_dwordx4 v14, s[48:51], s64 offen offset:2048  lds
    v_mfma_f32_16x16x32_bf16 v[172:175], v[180:183], v[76:79], v[172:175]
    s_waitcnt lgkmcnt(4)
    v_mfma_f32_16x16x32_bf16 v[112:115], v[184:187], v[80:83], v[112:115]
    s_waitcnt vmcnt(32)
    ds_read_b64_tr_b16 v[176:177], v240 offset:0
    v_mfma_f32_16x16x32_bf16 v[116:119], v[184:187], v[84:87], v[116:119]
    ds_read_b64_tr_b16 v[178:179], v240 offset:2048
    v_mfma_f32_16x16x32_bf16 v[120:123], v[184:187], v[88:91], v[120:123]
    buffer_load_dwordx4 v15, s[48:51], s64 offen offset:3072  lds
    v_mfma_f32_16x16x32_bf16 v[124:127], v[184:187], v[92:95], v[124:127]
    v_mfma_f32_16x16x32_bf16 v[128:131], v[188:191], v[80:83], v[128:131]
    ds_read_b64_tr_b16 v[180:181], v241 offset:0
    v_mfma_f32_16x16x32_bf16 v[132:135], v[188:191], v[84:87], v[132:135]
    ds_read_b64_tr_b16 v[182:183], v241 offset:2048
    v_mfma_f32_16x16x32_bf16 v[136:139], v[188:191], v[88:91], v[136:139]
    v_mfma_f32_16x16x32_bf16 v[140:143], v[188:191], v[92:95], v[140:143]
    s_waitcnt lgkmcnt(4)
    v_mfma_f32_16x16x32_bf16 v[144:147], v[192:195], v[80:83], v[144:147]
    ds_read_b64_tr_b16 v[184:185], v242 offset:0
    v_mfma_f32_16x16x32_bf16 v[148:151], v[192:195], v[84:87], v[148:151]
    ds_read_b64_tr_b16 v[186:187], v242 offset:2048
    v_mfma_f32_16x16x32_bf16 v[152:155], v[192:195], v[88:91], v[152:155]
    v_mfma_f32_16x16x32_bf16 v[156:159], v[192:195], v[92:95], v[156:159]
    v_mfma_f32_16x16x32_bf16 v[160:163], v[196:199], v[80:83], v[160:163]
    ds_read_b64_tr_b16 v[188:189], v243 offset:0
    v_mfma_f32_16x16x32_bf16 v[164:167], v[196:199], v[84:87], v[164:167]
    ds_read_b64_tr_b16 v[190:191], v243 offset:2048
    v_mfma_f32_16x16x32_bf16 v[168:171], v[196:199], v[88:91], v[168:171]
    v_mfma_f32_16x16x32_bf16 v[172:175], v[196:199], v[92:95], v[172:175]
    s_waitcnt lgkmcnt(4)
    v_mfma_f32_16x16x32_bf16 v[112:115], v[176:179], v[96:99], v[112:115]
    s_waitcnt vmcnt(29)
    ds_read_b64_tr_b16 v[192:193], v240 offset:16384
    v_mfma_f32_16x16x32_bf16 v[116:119], v[176:179], v[100:103], v[116:119]
    ds_read_b64_tr_b16 v[194:195], v240 offset:18432
    v_mfma_f32_16x16x32_bf16 v[120:123], v[176:179], v[104:107], v[120:123]
    v_mfma_f32_16x16x32_bf16 v[124:127], v[176:179], v[108:111], v[124:127]
    v_mfma_f32_16x16x32_bf16 v[128:131], v[180:183], v[96:99], v[128:131]
    ds_read_b64_tr_b16 v[196:197], v241 offset:16384
    v_mfma_f32_16x16x32_bf16 v[132:135], v[180:183], v[100:103], v[132:135]
    ds_read_b64_tr_b16 v[198:199], v241 offset:18432
    v_mfma_f32_16x16x32_bf16 v[136:139], v[180:183], v[104:107], v[136:139]
    v_mfma_f32_16x16x32_bf16 v[140:143], v[180:183], v[108:111], v[140:143]
    s_waitcnt lgkmcnt(4)
    v_mfma_f32_16x16x32_bf16 v[144:147], v[184:187], v[96:99], v[144:147]
    ds_read_b64_tr_b16 v[176:177], v242 offset:16384
    v_mfma_f32_16x16x32_bf16 v[148:151], v[184:187], v[100:103], v[148:151]
    ds_read_b64_tr_b16 v[178:179], v242 offset:18432
    v_mfma_f32_16x16x32_bf16 v[152:155], v[184:187], v[104:107], v[152:155]
    v_mfma_f32_16x16x32_bf16 v[156:159], v[184:187], v[108:111], v[156:159]
    v_mfma_f32_16x16x32_bf16 v[160:163], v[188:191], v[96:99], v[160:163]
    ds_read_b64_tr_b16 v[180:181], v243 offset:16384
    v_mfma_f32_16x16x32_bf16 v[164:167], v[188:191], v[100:103], v[164:167]
    ds_read_b64_tr_b16 v[182:183], v243 offset:18432
    v_mfma_f32_16x16x32_bf16 v[168:171], v[188:191], v[104:107], v[168:171]
    v_mfma_f32_16x16x32_bf16 v[172:175], v[188:191], v[108:111], v[172:175]
    s_waitcnt vmcnt(10)
    s_mov_b32 s71, 0
L_poll_om:
    v_cmp_eq_u32 vcc, s86, v211
    s_add_u32 s71, s71, 1
    s_nop 2
    s_cmp_eq_u64 vcc, -1
    s_cbranch_scc1 L_polled_om
    s_sleep 2
    buffer_load_dword v211, v210, s[52:55], s95 offen sc1
    s_waitcnt vmcnt(0)
    s_cmp_lt_u32 s71, 0x20000
    s_cbranch_scc1 L_poll_om
L_polled_om:
    s_waitcnt lgkmcnt(4)
    v_mfma_f32_16x16x32_bf16 v[112:115], v[192:195], v[200:203], v[112:115]
    ds_read_b64_tr_b16 v[184:185], v244 offset:0
    v_mfma_f32_16x16x32_bf16 v[116:119], v[192:195], v[204:207], v[116:119]
    ds_read_b64_tr_b16 v[186:187], v244 offset:2048
    v_mfma_f32_16x16x32_bf16 v[120:123], v[192:195], v[216:219], v[120:123]
    s_add_u32 m0, s7, 131072
    s_add_u32 s64, s94, 0
    buffer_load_dwordx4 v2, s[52:55], s64 offen offset:0 sc1 lds
    v_mfma_f32_16x16x32_bf16 v[124:127], v[192:195], v[220:223], v[124:127]
    v_mfma_f32_16x16x32_bf16 v[128:131], v[196:199], v[200:203], v[128:131]
    ds_read_b64_tr_b16 v[188:189], v245 offset:0
    v_mfma_f32_16x16x32_bf16 v[132:135], v[196:199], v[204:207], v[132:135]
    ds_read_b64_tr_b16 v[190:191], v245 offset:2048
    v_mfma_f32_16x16x32_bf16 v[136:139], v[196:199], v[216:219], v[136:139]
    buffer_load_dwordx4 v2, s[52:55], s64 offen offset:1024 sc1 lds
    v_mfma_f32_16x16x32_bf16 v[140:143], v[196:199], v[220:223], v[140:143]
    s_waitcnt lgkmcnt(4)
    v_mfma_f32_16x16x32_bf16 v[144:147], v[176:179], v[200:203], v[144:147]
    ds_read_b64_tr_b16 v[192:193], v246 offset:0
    v_mfma_f32_16x16x32_bf16 v[148:151], v[176:179], v[204:207], v[148:151]
    ds_read_b64_tr_b16 v[194:195], v246 offset:2048
    v_mfma_f32_16x16x32_bf16 v[152:155], v[176:179], v[216:219], v[152:155]
    buffer_load_dwordx4 v2, s[52:55], s64 offen offset:2048 sc1 lds
    v_mfma_f32_16x16x32_bf16 v[156:159], v[176:179], v[220:223], v[156:159]
    buffer_load_dwordx4 v2, s[52:55], s64 offen offset:3072 sc1 lds
    v_mfma_f32_16x16x32_bf16 v[160:163], v[180:183], v[200:203], v[160:163]
    ds_read_b64_tr_b16 v[196:197], v247 offset:0
    v_mfma_f32_16x16x32_bf16 v[164:167], v[180:183], v[204:207], v[164:167]
    ds_read_b64_tr_b16 v[198:199], v247 offset:2048
    v_mfma_f32_16x16x32_bf16 v[168:171], v[180:183], v[216:219], v[168:171]
    s_add_u32 m0, s7, 0
    s_add_u32 s64, s88, 0
    buffer_load_dwordx4 v12, s[56:59], s64 offen offset:0  lds
    v_mfma_f32_16x16x32_bf16 v[172:175], v[180:183], v[220:223], v[172:175]
    s_waitcnt lgkmcnt(4)
    v_mfma_f32_16x16x32_bf16 v[112:115], v[184:187], v[224:227], v[112:115]
    s_waitcnt vmcnt(13)
    s_barrier
    ds_read_b64_tr_b16 v[176:177], v253 offset:16384
    v_mfma_f32_16x16x32_bf16 v[116:119], v[184:187], v[228:231], v[116:119]
    ds_read_b64_tr_b16 v[178:179], v253 offset:18432
    v_mfma_f32_16x16x32_bf16 v[120:123], v[184:187], v[232:235], v[120:123]
    buffer_load_dwordx4 v13, s[56:59], s64 offen offset:1024  lds
    v_mfma_f32_16x16x32_bf16 v[124:127], v[184:187], v[236:239], v[124:127]
    v_mfma_f32_16x16x32_bf16 v[128:131], v[188:191], v[224:227], v[128:131]
    ds_read_b64_tr_b16 v[180:181], v253 offset:20480
    v_mfma_f32_16x16x32_bf16 v[132:135], v[188:191], v[228:231], v[132:135]
    ds_read_b64_tr_b16 v[182:183], v253 offset:22528
    v_mfma_f32_16x16x32_bf16 v[136:139], v[188:191], v[232:235], v[136:139]
    buffer_load_dwordx4 v14, s[56:59], s64 offen offset:2048  lds
    v_cvt_pk_bf16_f32 v112, v112, v113
    v_cvt_pk_bf16_f32 v113, v114, v115
    v_mfma_f32_16x16x32_bf16 v[140:143], v[188:191], v[236:239], v[140:143]
    buffer_load_dwordx4 v15, s[56:59], s64 offen offset:3072  lds
    v_cvt_pk_bf16_f32 v114, v116, v117
    v_cvt_pk_bf16_f32 v115, v118, v119
    s_waitcnt lgkmcnt(4)
    v_mfma_f32_16x16x32_bf16 v[144:147], v[192:195], v[224:227], v[144:147]
    ds_read_b64_tr_b16 v[184:185], v253 offset:24576
    s_add_u32 s70, s77, 0
    buffer_store_dwordx4 v[112:115], v2, s[52:55], s70 offen sc1
    v_cvt_pk_bf16_f32 v120, v120, v121
    v_mfma_f32_16x16x32_bf16 v[148:151], v[192:195], v[228:231], v[148:151]
    ds_read_b64_tr_b16 v[186:187], v253 offset:26624
    v_cvt_pk_bf16_f32 v121, v122, v123
    v_cvt_pk_bf16_f32 v122, v124, v125
    v_cvt_pk_bf16_f32 v123, v126, v127
    v_mfma_f32_16x16x32_bf16 v[152:155], v[192:195], v[232:235], v[152:155]
    s_add_u32 m0, s7, 16384
    s_add_u32 s64, s94, 16384
    buffer_load_dwordx4 v2, s[52:55], s64 offen offset:0 sc1 lds
    s_add_u32 s70, s77, 8192
    buffer_store_dwordx4 v[120:123], v2, s[52:55], s70 offen sc1
    v_mfma_f32_16x16x32_bf16 v[156:159], v[192:195], v[236:239], v[156:159]
    v_cvt_pk_bf16_f32 v128, v128, v129
    v_mfma_f32_16x16x32_bf16 v[160:163], v[196:199], v[224:227], v[160:163]
    ds_read_b64_tr_b16 v[188:189], v253 offset:28672
    v_cvt_pk_bf16_f32 v129, v130, v131
    v_cvt_pk_bf16_f32 v130, v132, v133
    v_cvt_pk_bf16_f32 v131, v134, v135
    v_mfma_f32_16x16x32_bf16 v[164:167], v[196:199], v[228:231], v[164:167]
    ds_read_b64_tr_b16 v[190:191], v253 offset:30720
    s_add_u32 s70, s77, 16384
    buffer_store_dwordx4 v[128:131], v2, s[52:55], s70 offen sc1
    v_cvt_pk_bf16_f32 v136, v136, v137
    v_mfma_f32_16x16x32_bf16 v[168:171], v[196:199], v[232:235], v[168:171]
    buffer_load_dwordx4 v2, s[52:55], s64 offen offset:1024 sc1 lds
    v_cvt_pk_bf16_f32 v137, v138, v139
    v_cvt_pk_bf16_f32 v138, v140, v141
    v_cvt_pk_bf16_f32 v139, v142, v143
    v_mfma_f32_16x16x32_bf16 v[172:175], v[196:199], v[236:239], v[172:175]
    s_add_u32 s70, s77, 24576
    buffer_store_dwordx4 v[136:139], v2, s[52:55], s70 offen sc1
    s_waitcnt lgkmcnt(4)
    v_mfma_f32_16x16x32_bf16 v[112:115], v[176:179], v[16:19], 0
    ds_read_b64_tr_b16 v[192:193], v252 offset:32768
    v_cvt_pk_bf16_f32 v144, v144, v145
    v_cvt_pk_bf16_f32 v145, v146, v147
    v_mfma_f32_16x16x32_bf16 v[116:119], v[176:179], v[20:23], 0
    ds_read_b64_tr_b16 v[194:195], v252 offset:34816
    v_cvt_pk_bf16_f32 v146, v148, v149
    v_cvt_pk_bf16_f32 v147, v150, v151
    s_add_u32 s70, s77, 32768
    buffer_store_dwordx4 v[144:147], v2, s[52:55], s70 offen sc1
    v_mfma_f32_16x16x32_bf16 v[120:123], v[176:179], v[24:27], 0
    buffer_load_dwordx4 v2, s[52:55], s64 offen offset:2048 sc1 lds
    v_cvt_pk_bf16_f32 v152, v152, v153
    v_cvt_pk_bf16_f32 v153, v154, v155
    v_cvt_pk_bf16_f32 v154, v156, v157
    v_mfma_f32_16x16x32_bf16 v[124:127], v[176:179], v[28:31], 0
    buffer_load_dwordx4 v2, s[52:55], s64 offen offset:3072 sc1 lds
    v_cvt_pk_bf16_f32 v155, v158, v159
    s_add_u32 s70, s77, 40960
    buffer_store_dwordx4 v[152:155], v2, s[52:55], s70 offen sc1
    v_mfma_f32_16x16x32_bf16 v[112:115], v[180:183], v[32:35], v[112:115]
    ds_read_b64_tr_b16 v[196:197], v252 offset:36864
    v_cvt_pk_bf16_f32 v160, v160, v161
    v_mfma_f32_16x16x32_bf16 v[116:119], v[180:183], v[36:39], v[116:119]
    ds_read_b64_tr_b16 v[198:199], v252 offset:38912
    v_cvt_pk_bf16_f32 v161, v162, v163
    v_cvt_pk_bf16_f32 v162, v164, v165
    v_cvt_pk_bf16_f32 v163, v166, v167
    s_add_u32 s70, s77, 49152
    v_mfma_f32_16x16x32_bf16 v[120:123], v[180:183], v[40:43], v[120:123]
    s_add_u32 m0, s7, 65536
    s_add_u32 s64, s88, 147456
    buffer_load_dwordx4 v12, s[56:59], s64 offen offset:0  lds
    buffer_store_dwordx4 v[160:163], v2, s[52:55], s70 offen sc1
    v_cvt_pk_bf16_f32 v168, v168, v169
    v_cvt_pk_bf16_f32 v169, v170, v171
    v_mfma_f32_16x16x32_bf16 v[124:127], v[180:183], v[44:47], v[124:127]
    buffer_load_dwordx4 v13, s[56:59], s64 offen offset:1024  lds
    v_cvt_pk_bf16_f32 v170, v172, v173
    v_cvt_pk_bf16_f32 v171, v174, v175
    s_add_u32 s70, s77, 57344
    buffer_store_dwordx4 v[168:171], v2, s[52:55], s70 offen sc1
    s_waitcnt lgkmcnt(4)
    v_mfma_f32_16x16x32_bf16 v[112:115], v[184:187], v[48:51], v[112:115]
    ds_read_b64_tr_b16 v[176:177], v252 offset:40960
    v_mfma_f32_16x16x32_bf16 v[116:119], v[184:187], v[52:55], v[116:119]
    ds_read_b64_tr_b16 v[178:179], v252 offset:43008
    v_mfma_f32_16x16x32_bf16 v[120:123], v[184:187], v[56:59], v[120:123]
    buffer_load_dwordx4 v14, s[56:59], s64 offen offset:2048  lds
    v_mfma_f32_16x16x32_bf16 v[124:127], v[184:187], v[60:63], v[124:127]
    buffer_load_dwordx4 v15, s[56:59], s64 offen offset:3072  lds
    s_add_u32 s70, s82, 0
    buffer_load_dwordx4 v[160:163], v208, s[40:43], s70 offen
    s_add_u32 s70, s82, 36864
    buffer_load_dwordx4 v[164:167], v208, s[40:43], s70 offen
    buffer_load_dwordx2 v[168:169], v209, s[44:47], s81 offen
    v_mfma_f32_16x16x32_bf16 v[112:115], v[188:191], v[64:67], v[112:115]
    ds_read_b64_tr_b16 v[180:181], v252 offset:45056
    v_mfma_f32_16x16x32_bf16 v[116:119], v[188:191], v[68:71], v[116:119]
    ds_read_b64_tr_b16 v[182:183], v252 offset:47104
    v_mfma_f32_16x16x32_bf16 v[120:123], v[188:191], v[72:75], v[120:123]
    v_mfma_f32_16x16x32_bf16 v[124:127], v[188:191], v[76:79], v[124:127]
    s_waitcnt lgkmcnt(4)
    v_mfma_f32_16x16x32_bf16 v[112:115], v[192:195], v[80:83], v[112:115]
    ds_read_b64_tr_b16 v[184:185], v252 offset:49152
    v_mfma_f32_16x16x32_bf16 v[116:119], v[192:195], v[84:87], v[116:119]
    ds_read_b64_tr_b16 v[186:187], v252 offset:51200
    v_mfma_f32_16x16x32_bf16 v[120:123], v[192:195], v[88:91], v[120:123]
    v_mfma_f32_16x16x32_bf16 v[124:127], v[192:195], v[92:95], v[124:127]
    v_mfma_f32_16x16x32_bf16 v[112:115], v[196:199], v[96:99], v[112:115]
    ds_read_b64_tr_b16 v[188:189], v252 offset:53248
    v_mfma_f32_16x16x32_bf16 v[116:119], v[196:199], v[100:103], v[116:119]
    ds_read_b64_tr_b16 v[190:191], v252 offset:55296
    v_mfma_f32_16x16x32_bf16 v[120:123], v[196:199], v[104:107], v[120:123]
    v_mfma_f32_16x16x32_bf16 v[124:127], v[196:199], v[108:111], v[124:127]
    s_waitcnt lgkmcnt(4)
    v_mfma_f32_16x16x32_bf16 v[112:115], v[176:179], v[200:203], v[112:115]
    ds_read_b64_tr_b16 v[192:193], v252 offset:57344
    v_mfma_f32_16x16x32_bf16 v[116:119], v[176:179], v[204:207], v[116:119]
    ds_read_b64_tr_b16 v[194:195], v252 offset:59392
    v_mfma_f32_16x16x32_bf16 v[120:123], v[176:179], v[216:219], v[120:123]
    v_mfma_f32_16x16x32_bf16 v[124:127], v[176:179], v[220:223], v[124:127]
    v_mfma_f32_16x16x32_bf16 v[112:115], v[180:183], v[224:227], v[112:115]
    ds_read_b64_tr_b16 v[196:197], v252 offset:61440
    v_mfma_f32_16x16x32_bf16 v[116:119], v[180:183], v[228:231], v[116:119]
    ds_read_b64_tr_b16 v[198:199], v252 offset:63488
    v_mfma_f32_16x16x32_bf16 v[120:123], v[180:183], v[232:235], v[120:123]
    v_mfma_f32_16x16x32_bf16 v[124:127], v[180:183], v[236:239], v[124:127]
    s_waitcnt lgkmcnt(4)
    v_mfma_f32_16x16x32_bf16 v[112:115], v[184:187], a[0:3], v[112:115]
    ds_read_b64_tr_b16 v[176:177], v254 offset:16384
    v_mfma_f32_16x16x32_bf16 v[116:119], v[184:187], a[4:7], v[116:119]
    ds_read_b64_tr_b16 v[178:179], v254 offset:18432
    v_mfma_f32_16x16x32_bf16 v[120:123], v[184:187], a[8:11], v[120:123]
    v_mfma_f32_16x16x32_bf16 v[124:127], v[184:187], a[12:15], v[124:127]
    v_mfma_f32_16x16x32_bf16 v[112:115], v[188:191], a[16:19], v[112:115]
    ds_read_b64_tr_b16 v[180:181], v254 offset:20480
    v_mfma_f32_16x16x32_bf16 v[116:119], v[188:191], a[20:23], v[116:119]
    ds_read_b64_tr_b16 v[182:183], v254 offset:22528
    v_mfma_f32_16x16x32_bf16 v[120:123], v[188:191], a[24:27], v[120:123]
    v_mfma_f32_16x16x32_bf16 v[124:127], v[188:191], a[28:31], v[124:127]
    s_waitcnt lgkmcnt(4)
    v_mfma_f32_16x16x32_bf16 v[112:115], v[192:195], a[32:35], v[112:115]
    ds_read_b64_tr_b16 v[184:185], v254 offset:24576
    v_mfma_f32_16x16x32_bf16 v[116:119], v[192:195], a[36:39], v[116:119]
    ds_read_b64_tr_b16 v[186:187], v254 offset:26624
    v_mfma_f32_16x16x32_bf16 v[120:123], v[192:195], a[40:43], v[120:123]
    v_mfma_f32_16x16x32_bf16 v[124:127], v[192:195], a[44:47], v[124:127]
    v_mfma_f32_16x16x32_bf16 v[112:115], v[196:199], a[48:51], v[112:115]
    ds_read_b64_tr_b16 v[188:189], v254 offset:28672
    v_mfma_f32_16x16x32_bf16 v[116:119], v[196:199], a[52:55], v[116:119]
    ds_read_b64_tr_b16 v[190:191], v254 offset:30720
    v_mfma_f32_16x16x32_bf16 v[120:123], v[196:199], a[56:59], v[120:123]
    v_mfma_f32_16x16x32_bf16 v[124:127], v[196:199], a[60:63], v[124:127]
    s_waitcnt lgkmcnt(4)
    v_mfma_f32_16x16x32_bf16 v[112:115], v[176:179], a[64:67], v[112:115]
    s_waitcnt vmcnt(19)
    s_barrier
    ds_read_b64_tr_b16 v[192:193], v253 offset:32768
    v_mfma_f32_16x16x32_bf16 v[116:119], v[176:179], a[68:71], v[116:119]
    ds_read_b64_tr_b16 v[194:195], v253 offset:34816
    v_mfma_f32_16x16x32_bf16 v[120:123], v[176:179], a[72:75], v[120:123]
    s_add_u32 m0, s7, 81920
    s_add_u32 s64, s94, 32768
    buffer_load_dwordx4 v2, s[52:55], s64 offen offset:0 sc1 lds
    v_mfma_f32_16x16x32_bf16 v[124:127], v[176:179], a[76:79], v[124:127]
    buffer_load_dwordx4 v2, s[52:55], s64 offen offset:1024 sc1 lds
    v_mfma_f32_16x16x32_bf16 v[112:115], v[180:183], a[80:83], v[112:115]
    ds_read_b64_tr_b16 v[196:197], v253 offset:36864
    v_mfma_f32_16x16x32_bf16 v[116:119], v[180:183], a[84:87], v[116:119]
    ds_read_b64_tr_b16 v[198:199], v253 offset:38912
    v_mfma_f32_16x16x32_bf16 v[120:123], v[180:183], a[88:91], v[120:123]
    buffer_load_dwordx4 v2, s[52:55], s64 offen offset:2048 sc1 lds
    v_mfma_f32_16x16x32_bf16 v[124:127], v[180:183], a[92:95], v[124:127]
    buffer_load_dwordx4 v2, s[52:55], s64 offen offset:3072 sc1 lds
    s_waitcnt lgkmcnt(4)
    v_mfma_f32_16x16x32_bf16 v[112:115], v[184:187], a[96:99], v[112:115]
    ds_read_b64_tr_b16 v[176:177], v253 offset:40960
    v_mfma_f32_16x16x32_bf16 v[116:119], v[184:187], a[100:103], v[116:119]
    ds_read_b64_tr_b16 v[178:179], v253 offset:43008
    v_mfma_f32_16x16x32_bf16 v[120:123], v[184:187], a[104:107], v[120:123]
    s_add_u32 m0, s7, 32768
    s_add_u32 s64, s88, 294912
    buffer_load_dwordx4 v12, s[56:59], s64 offen offset:0  lds
    v_mfma_f32_16x16x32_bf16 v[124:127], v[184:187], a[108:111], v[124:127]
    buffer_load_dwordx4 v13, s[56:59], s64 offen offset:1024  lds
    v_mfma_f32_16x16x32_bf16 v[112:115], v[188:191], a[112:115], v[112:115]
    ds_read_b64_tr_b16 v[180:181], v253 offset:45056
    v_mfma_f32_16x16x32_bf16 v[116:119], v[188:191], a[116:119], v[116:119]
    ds_read_b64_tr_b16 v[182:183], v253 offset:47104
    v_mfma_f32_16x16x32_bf16 v[120:123], v[188:191], a[120:123], v[120:123]
    buffer_load_dwordx4 v14, s[56:59], s64 offen offset:2048  lds
    v_mfma_f32_16x16x32_bf16 v[124:127], v[188:191], a[124:127], v[124:127]
    buffer_load_dwordx4 v15, s[56:59], s64 offen offset:3072  lds
    s_waitcnt vmcnt(13)
    v_mov_b32 v214, 0
    v_mov_b32 v215, s86
    s_mov_b64 exec, 1
    buffer_store_dword v215, v214, s[52:55], s79 offen sc1
    s_mov_b64 exec, -1
    s_waitcnt lgkmcnt(4)
    v_mfma_f32_16x16x32_bf16 v[112:115], v[192:195], a[128:131], v[112:115]
    ds_read_b64_tr_b16 v[184:185], v253 offset:49152
    v_mfma_f32_16x16x32_bf16 v[116:119], v[192:195], a[132:135], v[116:119]
    ds_read_b64_tr_b16 v[186:187], v253 offset:51200
    v_mfma_f32_16x16x32_bf16 v[120:123], v[192:195], a[136:139], v[120:123]
    s_add_u32 m0, s7, 49152
    s_add_u32 s64, s94, 49152
    buffer_load_dwordx4 v2, s[52:55], s64 offen offset:0 sc1 lds
    v_mfma_f32_16x16x32_bf16 v[124:127], v[192:195], a[140:143], v[124:127]
    buffer_load_dwordx4 v2, s[52:55], s64 offen offset:1024 sc1 lds
    v_mfma_f32_16x16x32_bf16 v[112:115], v[196:199], a[144:147], v[112:115]
    ds_read_b64_tr_b16 v[188:189], v253 offset:53248
    v_mfma_f32_16x16x32_bf16 v[116:119], v[196:199], a[148:151], v[116:119]
    ds_read_b64_tr_b16 v[190:191], v253 offset:55296
    v_mfma_f32_16x16x32_bf16 v[120:123], v[196:199], a[152:155], v[120:123]
    buffer_load_dwordx4 v2, s[52:55], s64 offen offset:2048 sc1 lds
    v_mfma_f32_16x16x32_bf16 v[124:127], v[196:199], a[156:159], v[124:127]
    buffer_load_dwordx4 v2, s[52:55], s64 offen offset:3072 sc1 lds
    s_waitcnt lgkmcnt(4)
    v_mfma_f32_16x16x32_bf16 v[112:115], v[176:179], a[160:163], v[112:115]
    ds_read_b64_tr_b16 v[192:193], v253 offset:57344
    v_mfma_f32_16x16x32_bf16 v[116:119], v[176:179], a[164:167], v[116:119]
    ds_read_b64_tr_b16 v[194:195], v253 offset:59392
    v_mfma_f32_16x16x32_bf16 v[120:123], v[176:179], a[168:171], v[120:123]
    v_mfma_f32_16x16x32_bf16 v[124:127], v[176:179], a[172:175], v[124:127]
    v_mfma_f32_16x16x32_bf16 v[112:115], v[180:183], a[176:179], v[112:115]
    ds_read_b64_tr_b16 v[196:197], v253 offset:61440
    v_mfma_f32_16x16x32_bf16 v[116:119], v[180:183], a[180:183], v[116:119]
    ds_read_b64_tr_b16 v[198:199], v253 offset:63488
    v_mfma_f32_16x16x32_bf16 v[120:123], v[180:183], a[184:187], v[120:123]
    v_mfma_f32_16x16x32_bf16 v[124:127], v[180:183], a[188:191], v[124:127]
    s_waitcnt lgkmcnt(4)
    v_mfma_f32_16x16x32_bf16 v[112:115], v[184:187], a[192:195], v[112:115]
    ds_read_b128 a[0:3], v9 offset:0
    ds_read_b128 a[4:7], v9 offset:1024
    ds_read_b64_tr_b16 v[176:177], v252 offset:0
    v_mfma_f32_16x16x32_bf16 v[116:119], v[184:187], a[196:199], v[116:119]
    ds_read_b128 a[8:11], v9 offset:2048
    ds_read_b128 a[12:15], v9 offset:3072
    ds_read_b64_tr_b16 v[178:179], v252 offset:2048
    v_mfma_f32_16x16x32_bf16 v[120:123], v[184:187], a[200:203], v[120:123]
    v_mfma_f32_16x16x32_bf16 v[124:127], v[184:187], a[204:207], v[124:127]
    v_mfma_f32_16x16x32_bf16 v[112:115], v[188:191], a[208:211], v[112:115]
    ds_read_b128 a[16:19], v9 offset:4096
    ds_read_b128 a[20:23], v9 offset:5120
    ds_read_b64_tr_b16 v[180:181], v252 offset:4096
    v_mfma_f32_16x16x32_bf16 v[116:119], v[188:191], a[212:215], v[116:119]
    ds_read_b128 a[24:27], v9 offset:6144
    ds_read_b128 a[28:31], v9 offset:7168
    ds_read_b64_tr_b16 v[182:183], v252 offset:6144
    v_mfma_f32_16x16x32_bf16 v[120:123], v[188:191], a[216:219], v[120:123]
    v_mfma_f32_16x16x32_bf16 v[124:127], v[188:191], a[220:223], v[124:127]
    s_waitcnt lgkmcnt(12)
    v_mfma_f32_16x16x32_bf16 v[112:115], v[192:195], a[224:227], v[112:115]
    ds_read_b128 a[32:35], v9 offset:8192
    ds_read_b128 a[36:39], v9 offset:9216
    ds_read_b64_tr_b16 v[184:185], v252 offset:8192
    v_mfma_f32_16x16x32_bf16 v[116:119], v[192:195], a[228:231], v[116:119]
    ds_read_b128 a[40:43], v9 offset:10240
    ds_read_b128 a[44:47], v9 offset:11264
    ds_read_b64_tr_b16 v[186:187], v252 offset:10240
    v_mfma_f32_16x16x32_bf16 v[120:123], v[192:195], a[232:235], v[120:123]
    v_mfma_f32_16x16x32_bf16 v[124:127], v[192:195], a[236:239], v[124:127]
    v_mfma_f32_16x16x32_bf16 v[112:115], v[196:199], a[240:243], v[112:115]
    ds_read_b128 a[48:51], v9 offset:12288
    ds_read_b128 a[52:55], v9 offset:13312
    ds_read_b64_tr_b16 v[188:189], v252 offset:12288
    v_mfma_f32_16x16x32_bf16 v[116:119], v[196:199], a[244:247], v[116:119]
    ds_read_b128 a[56:59], v9 offset:14336
    ds_read_b128 a[60:63], v9 offset:15360
    ds_read_b64_tr_b16 v[190:191], v252 offset:14336
    v_mfma_f32_16x16x32_bf16 v[120:123], v[196:199], a[248:251], v[120:123]
    v_mfma_f32_16x16x32_bf16 v[124:127], v[196:199], a[252:255], v[124:127]
    s_waitcnt lgkmcnt(12)
    v_mfma_f32_16x16x32_bf16 v[128:131], v[176:179], a[0:3], 0
    s_waitcnt vmcnt(5)
    s_barrier
    ds_read_b128 a[64:67], v2 offset:16384
    ds_read_b128 a[68:71], v2 offset:17408
    ds_read_b64_tr_b16 v[192:193], v253 offset:0
    v_mfma_f32_16x16x32_bf16 v[132:135], v[176:179], a[4:7], 0
    ds_read_b128 a[72:75], v2 offset:18432
    ds_read_b128 a[76:79], v2 offset:19456
    ds_read_b64_tr_b16 v[194:195], v253 offset:2048
    v_mfma_f32_16x16x32_bf16 v[136:139], v[176:179], a[8:11], 0
    s_add_u32 m0, s7, 147456
    s_add_u32 s64, s88, 442368
    buffer_load_dwordx4 v12, s[56:59], s64 offen offset:0  lds
    v_mfma_f32_16x16x32_bf16 v[140:143], v[176:179], a[12:15], 0
    buffer_load_dwordx4 v13, s[56:59], s64 offen offset:1024  lds
    v_mfma_f32_16x16x32_bf16 v[128:131], v[180:183], a[16:19], v[128:131]
    ds_read_b128 a[80:83], v2 offset:20480
    ds_read_b128 a[84:87], v2 offset:21504
    ds_read_b64_tr_b16 v[196:197], v253 offset:4096
    v_mfma_f32_16x16x32_bf16 v[132:135], v[180:183], a[20:23], v[132:135]
    ds_read_b128 a[88:91], v2 offset:22528
    ds_read_b128 a[92:95], v2 offset:23552
    ds_read_b64_tr_b16 v[198:199], v253 offset:6144
    v_mfma_f32_16x16x32_bf16 v[136:139], v[180:183], a[24:27], v[136:139]
    buffer_load_dwordx4 v14, s[56:59], s64 offen offset:2048  lds
    v_mfma_f32_16x16x32_bf16 v[140:143], v[180:183], a[28:31], v[140:143]
    buffer_load_dwordx4 v15, s[56:59], s64 offen offset:3072  lds
    buffer_load_dword v213, v212, s[52:55], s83 offen sc1
    s_waitcnt lgkmcnt(12)
    v_mfma_f32_16x16x32_bf16 v[128:131], v[184:187], a[32:35], v[128:131]
    ds_read_b128 a[0:3], v2 offset:24576
    ds_read_b128 a[4:7], v2 offset:25600
    ds_read_b64_tr_b16 v[176:177], v253 offset:8192
    v_mfma_f32_16x16x32_bf16 v[132:135], v[184:187], a[36:39], v[132:135]
    ds_read_b128 a[8:11], v2 offset:26624
    ds_read_b128 a[12:15], v2 offset:27648
    ds_read_b64_tr_b16 v[178:179], v253 offset:10240
    v_mfma_f32_16x16x32_bf16 v[136:139], v[184:187], a[40:43], v[136:139]
    s_add_u32 m0, s7, 98304
    s_add_u32 s64, s94, 65536
    buffer_load_dwordx4 v2, s[52:55], s64 offen offset:0 sc1 lds
    v_mfma_f32_16x16x32_bf16 v[140:143], v[184:187], a[44:47], v[140:143]
    buffer_load_dwordx4 v2, s[52:55], s64 offen offset:1024 sc1 lds
    v_mfma_f32_16x16x32_bf16 v[128:131], v[188:191], a[48:51], v[128:131]
    ds_read_b128 a[16:19], v2 offset:28672
    ds_read_b128 a[20:23], v2 offset:29696
    ds_read_b64_tr_b16 v[180:181], v253 offset:12288
    v_mfma_f32_16x16x32_bf16 v[132:135], v[188:191], a[52:55], v[132:135]
    ds_read_b128 a[24:27], v2 offset:30720
    ds_read_b128 a[28:31], v2 offset:31744
    ds_read_b64_tr_b16 v[182:183], v253 offset:14336
    v_mfma_f32_16x16x32_bf16 v[136:139], v[188:191], a[56:59], v[136:139]
    buffer_load_dwordx4 v2, s[52:55], s64 offen offset:2048 sc1 lds
    v_mfma_f32_16x16x32_bf16 v[140:143], v[188:191], a[60:63], v[140:143]
    buffer_load_dwordx4 v2, s[52:55], s64 offen offset:3072 sc1 lds
    s_waitcnt lgkmcnt(12)
    v_mfma_f32_16x16x32_bf16 v[128:131], v[192:195], a[64:67], v[128:131]
    ds_read_b128 a[32:35], v3 offset:16384
    ds_read_b128 a[36:39], v3 offset:17408
    ds_read_b64_tr_b16 v[184:185], v252 offset:32768
    v_mfma_f32_16x16x32_bf16 v[132:135], v[192:195], a[68:71], v[132:135]
    ds_read_b128 a[40:43], v3 offset:18432
    ds_read_b128 a[44:47], v3 offset:19456
    ds_read_b64_tr_b16 v[186:187], v252 offset:34816
    v_mfma_f32_16x16x32_bf16 v[136:139], v[192:195], a[72:75], v[136:139]
    s_add_u32 m0, s7, 114688
    s_add_u32 s64, s88, 589824
    buffer_load_dwordx4 v12, s[56:59], s64 offen offset:0  lds
    v_mfma_f32_16x16x32_bf16 v[140:143], v[192:195], a[76:79], v[140:143]
    buffer_load_dwordx4 v13, s[56:59], s64 offen offset:1024  lds
    v_mfma_f32_16x16x32_bf16 v[128:131], v[196:199], a[80:83], v[128:131]
    ds_read_b128 a[48:51], v3 offset:20480
    ds_read_b128 a[52:55], v3 offset:21504
    ds_read_b64_tr_b16 v[188:189], v252 offset:36864
    v_mfma_f32_16x16x32_bf16 v[132:135], v[196:199], a[84:87], v[132:135]
    ds_read_b128 a[56:59], v3 offset:22528
    ds_read_b128 a[60:63], v3 offset:23552
    ds_read_b64_tr_b16 v[190:191], v252 offset:38912
    v_mfma_f32_16x16x32_bf16 v[136:139], v[196:199], a[88:91], v[136:139]
    buffer_load_dwordx4 v14, s[56:59], s64 offen offset:2048  lds
    v_mfma_f32_16x16x32_bf16 v[140:143], v[196:199], a[92:95], v[140:143]
    buffer_load_dwordx4 v15, s[56:59], s64 offen offset:3072  lds
    s_waitcnt lgkmcnt(12)
    v_mfma_f32_16x16x32_bf16 v[128:131], v[176:179], a[0:3], v[128:131]
    ds_read_b128 a[64:67], v3 offset:24576
    ds_read_b128 a[68:71], v3 offset:25600
    ds_read_b64_tr_b16 v[192:193], v252 offset:40960
    v_mfma_f32_16x16x32_bf16 v[132:135], v[176:179], a[4:7], v[132:135]
    ds_read_b128 a[72:75], v3 offset:26624
    ds_read_b128 a[76:79], v3 offset:27648
    ds_read_b64_tr_b16 v[194:195], v252 offset:43008
    v_mfma_f32_16x16x32_bf16 v[136:139], v[176:179], a[8:11], v[136:139]
    v_mfma_f32_16x16x32_bf16 v[140:143], v[176:179], a[12:15], v[140:143]
    v_mfma_f32_16x16x32_bf16 v[128:131], v[180:183], a[16:19], v[128:131]
    ds_read_b128 a[80:83], v3 offset:28672
    ds_read_b128 a[84:87], v3 offset:29696
    ds_read_b64_tr_b16 v[196:197], v252 offset:45056
    v_mfma_f32_16x16x32_bf16 v[132:135], v[180:183], a[20:23], v[132:135]
    ds_read_b128 a[88:91], v3 offset:30720
    ds_read_b128 a[92:95], v3 offset:31744
    ds_read_b64_tr_b16 v[198:199], v252 offset:47104
    v_mfma_f32_16x16x32_bf16 v[136:139], v[180:183], a[24:27], v[136:139]
    v_mfma_f32_16x16x32_bf16 v[140:143], v[180:183], a[28:31], v[140:143]
    s_waitcnt vmcnt(8)
    s_mov_b32 s71, 0
L_poll_pm:
    v_cmp_eq_u32 vcc, s86, v213
    s_add_u32 s71, s71, 1
    s_nop 2
    s_cmp_eq_u64 vcc, -1
    s_cbranch_scc1 L_polled_pm
    s_sleep 1
    buffer_load_dword v213, v212, s[52:55], s83 offen sc1
    s_waitcnt vmcnt(0)
    s_cmp_lt_u32 s71, 0x20000
    s_cbranch_scc1 L_poll_pm
L_polled_pm:
    s_add_u32 s70, s6, 5
    s_cmp_ge_u32 s70, 6
    s_cselect_b32 s71, 6, 0
    s_sub_u32 s70, s70, s71
    s_lshl_b32 s70, s70, 10
    s_add_u32 s70, s70, s80
    buffer_load_dwordx4 v[16:19], v2, s[52:55], s70 offen sc1
    s_add_u32 s70, s70, 8192
    buffer_load_dwordx4 v[20:23], v2, s[52:55], s70 offen sc1
    s_add_u32 s70, s6, 4
    s_cmp_ge_u32 s70, 6
    s_cselect_b32 s71, 6, 0
    s_sub_u32 s70, s70, s71
    s_lshl_b32 s70, s70, 10
    s_add_u32 s70, s70, s80
    buffer_load_dwordx4 v[24:27], v2, s[52:55], s70 offen sc1
    s_add_u32 s70, s70, 8192
    buffer_load_dwordx4 v[28:31], v2, s[52:55], s70 offen sc1
    s_add_u32 s70, s6, 3
    s_cmp_ge_u32 s70, 6
    s_cselect_b32 s71, 6, 0
    s_sub_u32 s70, s70, s71
    s_lshl_b32 s70, s70, 10
    s_add_u32 s70, s70, s80
    buffer_load_dwordx4 v[32:35], v2, s[52:55], s70 offen sc1
    s_add_u32 s70, s70, 8192
    buffer_load_dwordx4 v[36:39], v2, s[52:55], s70 offen sc1
    s_add_u32 s70, s6, 2
    s_cmp_ge_u32 s70, 6
    s_cselect_b32 s71, 6, 0
    s_sub_u32 s70, s70, s71
    s_lshl_b32 s70, s70, 10
    s_add_u32 s70, s70, s80
    buffer_load_dwordx4 v[40:43], v2, s[52:55], s70 offen sc1
    s_add_u32 s70, s70, 8192
    buffer_load_dwordx4 v[44:47], v2, s[52:55], s70 offen sc1
    s_add_u32 s70, s6, 1
    s_cmp_ge_u32 s70, 6
    s_cselect_b32 s71, 6, 0
    s_sub_u32 s70, s70, s71
    s_lshl_b32 s70, s70, 10
    s_add_u32 s70, s70, s80
    buffer_load_dwordx4 v[48:51], v2, s[52:55], s70 offen sc1
    s_add_u32 s70, s70, 8192
    buffer_load_dwordx4 v[52:55], v2, s[52:55], s70 offen sc1
    s_waitcnt lgkmcnt(12)
    v_mfma_f32_16x16x32_bf16 v[128:131], v[184:187], a[32:35], v[128:131]
    s_waitcnt vmcnt(10)
    s_barrier
    ds_read_b128 a[0:3], v2 offset:49152
    ds_read_b128 a[4:7], v2 offset:50176
    ds_read_b64_tr_b16 v[176:177], v254 offset:16384
    v_mfma_f32_16x16x32_bf16 v[132:135], v[184:187], a[36:39], v[132:135]
    ds_read_b128 a[8:11], v2 offset:51200
    ds_read_b128 a[12:15], v2 offset:52224
    ds_read_b64_tr_b16 v[178:179], v254 offset:18432
    v_mfma_f32_16x16x32_bf16 v[136:139], v[184:187], a[40:43], v[136:139]
    v_mfma_f32_16x16x32_bf16 v[140:143], v[184:187], a[44:47], v[140:143]
    v_mfma_f32_16x16x32_bf16 v[128:131], v[188:191], a[48:51], v[128:131]
    ds_read_b128 a[16:19], v2 offset:53248
    ds_read_b128 a[20:23], v2 offset:54272
    ds_read_b64_tr_b16 v[180:181], v254 offset:20480
    v_mfma_f32_16x16x32_bf16 v[132:135], v[188:191], a[52:55], v[132:135]
    ds_read_b128 a[24:27], v2 offset:55296
    ds_read_b128 a[28:31], v2 offset:56320
    ds_read_b64_tr_b16 v[182:183], v254 offset:22528
    v_mfma_f32_16x16x32_bf16 v[136:139], v[188:191], a[56:59], v[136:139]
    v_mfma_f32_16x16x32_bf16 v[140:143], v[188:191], a[60:63], v[140:143]
    s_waitcnt lgkmcnt(12)
    v_mfma_f32_16x16x32_bf16 v[128:131], v[192:195], a[64:67], v[128:131]
    ds_read_b128 a[32:35], v2 offset:57344
    ds_read_b128 a[36:39], v2 offset:58368
    ds_read_b64_tr_b16 v[184:185], v254 offset:24576
    v_mfma_f32_16x16x32_bf16 v[132:135], v[192:195], a[68:71], v[132:135]
    ds_read_b128 a[40:43], v2 offset:59392
    ds_read_b128 a[44:47], v2 offset:60416
    ds_read_b64_tr_b16 v[186:187], v254 offset:26624
    v_mfma_f32_16x16x32_bf16 v[136:139], v[192:195], a[72:75], v[136:139]
    v_mfma_f32_16x16x32_bf16 v[140:143], v[192:195], a[76:79], v[140:143]
    v_mfma_f32_16x16x32_bf16 v[128:131], v[196:199], a[80:83], v[128:131]
    ds_read_b128 a[48:51], v2 offset:61440
    ds_read_b128 a[52:55], v2 offset:62464
    ds_read_b64_tr_b16 v[188:189], v254 offset:28672
    v_mfma_f32_16x16x32_bf16 v[132:135], v[196:199], a[84:87], v[132:135]
    ds_read_b128 a[56:59], v2 offset:63488
    ds_read_b128 a[60:63], v2 offset:64512
    ds_read_b64_tr_b16 v[190:191], v254 offset:30720
    v_mfma_f32_16x16x32_bf16 v[136:139], v[196:199], a[88:91], v[136:139]
    v_mfma_f32_16x16x32_bf16 v[140:143], v[196:199], a[92:95], v[140:143]
    s_waitcnt lgkmcnt(12)
    v_mfma_f32_16x16x32_bf16 v[128:131], v[176:179], a[0:3], v[128:131]
    ds_read_b128 a[64:67], v3 offset:32768
    ds_read_b128 a[68:71], v3 offset:33792
    ds_read_b64_tr_b16 v[192:193], v253 offset:49152
    v_mfma_f32_16x16x32_bf16 v[132:135], v[176:179], a[4:7], v[132:135]
    ds_read_b128 a[72:75], v3 offset:34816
    ds_read_b128 a[76:79], v3 offset:35840
    ds_read_b64_tr_b16 v[194:195], v253 offset:51200
    v_mfma_f32_16x16x32_bf16 v[136:139], v[176:179], a[8:11], v[136:139]
    v_mfma_f32_16x16x32_bf16 v[140:143], v[176:179], a[12:15], v[140:143]
    v_mfma_f32_16x16x32_bf16 v[128:131], v[180:183], a[16:19], v[128:131]
    ds_read_b128 a[80:83], v3 offset:36864
    ds_read_b128 a[84:87], v3 offset:37888
    ds_read_b64_tr_b16 v[196:197], v253 offset:53248
    v_mfma_f32_16x16x32_bf16 v[132:135], v[180:183], a[20:23], v[132:135]
    ds_read_b128 a[88:91], v3 offset:38912
    ds_read_b128 a[92:95], v3 offset:39936
    ds_read_b64_tr_b16 v[198:199], v253 offset:55296
    v_mfma_f32_16x16x32_bf16 v[136:139], v[180:183], a[24:27], v[136:139]
    v_mfma_f32_16x16x32_bf16 v[140:143], v[180:183], a[28:31], v[140:143]
    s_waitcnt lgkmcnt(12)
    v_mfma_f32_16x16x32_bf16 v[128:131], v[184:187], a[32:35], v[128:131]
    v_mfma_f32_16x16x32_bf16 v[132:135], v[184:187], a[36:39], v[132:135]
    v_mfma_f32_16x16x32_bf16 v[136:139], v[184:187], a[40:43], v[136:139]
    v_mfma_f32_16x16x32_bf16 v[140:143], v[184:187], a[44:47], v[140:143]
    v_mfma_f32_16x16x32_bf16 v[128:131], v[188:191], a[48:51], v[128:131]
    v_mfma_f32_16x16x32_bf16 v[132:135], v[188:191], a[52:55], v[132:135]
    v_mfma_f32_16x16x32_bf16 v[136:139], v[188:191], a[56:59], v[136:139]
    v_mfma_f32_16x16x32_bf16 v[140:143], v[188:191], a[60:63], v[140:143]
    s_waitcnt lgkmcnt(0)
    v_mfma_f32_16x16x32_bf16 v[128:131], v[192:195], a[64:67], v[128:131]
    v_mfma_f32_16x16x32_bf16 v[132:135], v[192:195], a[68:71], v[132:135]
    v_mfma_f32_16x16x32_bf16 v[136:139], v[192:195], a[72:75], v[136:139]
    v_mfma_f32_16x16x32_bf16 v[140:143], v[192:195], a[76:79], v[140:143]
    v_mfma_f32_16x16x32_bf16 v[128:131], v[196:199], a[80:83], v[128:131]
    v_mfma_f32_16x16x32_bf16 v[132:135], v[196:199], a[84:87], v[132:135]
    v_mfma_f32_16x16x32_bf16 v[136:139], v[196:199], a[88:91], v[136:139]
    v_mfma_f32_16x16x32_bf16 v[140:143], v[196:199], a[92:95], v[140:143]
    s_mov_b32 s48, s32
    s_and_b32 s49, s33, 0xffff
    s_mov_b32 s50, 2359296
    s_mov_b32 s51, 0x00020000
    v_lshlrev_b32 v172, 16, v168
    v_and_b32 v173, s13, v168
    v_lshlrev_b32 v174, 16, v169
    v_and_b32 v175, s13, v169
    s_waitcnt vmcnt(8)
    v_dot2c_f32_bf16 v112, s92, v16
    v_dot2c_f32_bf16 v113, s93, v16
    v_dot2c_f32_bf16 v114, s92, v17
    v_dot2c_f32_bf16 v115, s93, v17
    v_dot2c_f32_bf16 v116, s92, v18
    v_dot2c_f32_bf16 v117, s93, v18
    v_dot2c_f32_bf16 v118, s92, v19
    v_dot2c_f32_bf16 v119, s93, v19
    v_dot2c_f32_bf16 v120, s92, v20
    v_dot2c_f32_bf16 v121, s93, v20
    v_dot2c_f32_bf16 v122, s92, v21
    v_dot2c_f32_bf16 v123, s93, v21
    v_dot2c_f32_bf16 v124, s92, v22
    v_dot2c_f32_bf16 v125, s93, v22
    v_dot2c_f32_bf16 v126, s92, v23
    v_dot2c_f32_bf16 v127, s93, v23
    s_waitcnt vmcnt(6)
    v_dot2c_f32_bf16 v112, s92, v24
    v_dot2c_f32_bf16 v113, s93, v24
    v_dot2c_f32_bf16 v114, s92, v25
    v_dot2c_f32_bf16 v115, s93, v25
    v_dot2c_f32_bf16 v116, s92, v26
    v_dot2c_f32_bf16 v117, s93, v26
    v_dot2c_f32_bf16 v118, s92, v27
    v_dot2c_f32_bf16 v119, s93, v27
    v_dot2c_f32_bf16 v120, s92, v28
    v_dot2c_f32_bf16 v121, s93, v28
    v_dot2c_f32_bf16 v122, s92, v29
    v_dot2c_f32_bf16 v123, s93, v29
    v_dot2c_f32_bf16 v124, s92, v30
    v_dot2c_f32_bf16 v125, s93, v30
    v_dot2c_f32_bf16 v126, s92, v31
    v_dot2c_f32_bf16 v127, s93, v31
    s_waitcnt vmcnt(4)
    v_dot2c_f32_bf16 v112, s92, v32
    v_dot2c_f32_bf16 v113, s93, v32
    v_dot2c_f32_bf16 v114, s92, v33
    v_dot2c_f32_bf16 v115, s93, v33
    v_dot2c_f32_bf16 v116, s92, v34
    v_dot2c_f32_bf16 v117, s93, v34
    v_dot2c_f32_bf16 v118, s92, v35
    v_dot2c_f32_bf16 v119, s93, v35
    v_dot2c_f32_bf16 v120, s92, v36
    v_dot2c_f32_bf16 v121, s93, v36
    v_dot2c_f32_bf16 v122, s92, v37
    v_dot2c_f32_bf16 v123, s93, v37
    v_dot2c_f32_bf16 v124, s92, v38
    v_dot2c_f32_bf16 v125, s93, v38
    v_dot2c_f32_bf16 v126, s92, v39
    v_dot2c_f32_bf16 v127, s93, v39
    s_waitcnt vmcnt(2)
    v_dot2c_f32_bf16 v112, s92, v40
    v_dot2c_f32_bf16 v113, s93, v40
    v_dot2c_f32_bf16 v114, s92, v41
    v_dot2c_f32_bf16 v115, s93, v41
    v_dot2c_f32_bf16 v116, s92, v42
    v_dot2c_f32_bf16 v117, s93, v42
    v_dot2c_f32_bf16 v118, s92, v43
    v_dot2c_f32_bf16 v119, s93, v43
    v_dot2c_f32_bf16 v120, s92, v44
    v_dot2c_f32_bf16 v121, s93, v44
    v_dot2c_f32_bf16 v122, s92, v45
    v_dot2c_f32_bf16 v123, s93, v45
    v_dot2c_f32_bf16 v124, s92, v46
    v_dot2c_f32_bf16 v125, s93, v46
    v_dot2c_f32_bf16 v126, s92, v47
    v_dot2c_f32_bf16 v127, s93, v47
    s_waitcnt vmcnt(0)
    v_dot2c_f32_bf16 v112, s92, v48
    v_dot2c_f32_bf16 v113, s93, v48
    v_dot2c_f32_bf16 v114, s92, v49
    v_dot2c_f32_bf16 v115, s93, v49
    v_dot2c_f32_bf16 v116, s92, v50
    v_dot2c_f32_bf16 v117, s93, v50
    v_dot2c_f32_bf16 v118, s92, v51
    v_dot2c_f32_bf16 v119, s93, v51
    v_dot2c_f32_bf16 v120, s92, v52
    v_dot2c_f32_bf16 v121, s93, v52
    v_dot2c_f32_bf16 v122, s92, v53
    v_dot2c_f32_bf16 v123, s93, v53
    v_dot2c_f32_bf16 v124, s92, v54
    v_dot2c_f32_bf16 v125, s93, v54
    v_dot2c_f32_bf16 v126, s92, v55
    v_dot2c_f32_bf16 v127, s93, v55
    v_fma_f32 v112, v112, s87, v172
    v_fma_f32 v113, v113, s87, v173
    v_fma_f32 v114, v114, s87, v174
    v_fma_f32 v115, v115, s87, v175
    v_fma_f32 v116, v116, s87, v172
    v_fma_f32 v117, v117, s87, v173
    v_fma_f32 v118, v118, s87, v174
    v_fma_f32 v119, v119, s87, v175
    v_mul_f32 v96, 0xbfb8aa3b, v112
    v_mul_f32 v97, 0xbfb8aa3b, v113
    v_mul_f32 v98, 0xbfb8aa3b, v114
    v_mul_f32 v99, 0xbfb8aa3b, v115
    v_mul_f32 v100, 0xbfb8aa3b, v116
    v_mul_f32 v101, 0xbfb8aa3b, v117
    v_mul_f32 v102, 0xbfb8aa3b, v118
    v_mul_f32 v103, 0xbfb8aa3b, v119
    v_exp_f32 v96, v96
    v_exp_f32 v97, v97
    v_exp_f32 v98, v98
    v_exp_f32 v99, v99
    v_exp_f32 v100, v100
    v_exp_f32 v101, v101
    v_exp_f32 v102, v102
    v_exp_f32 v103, v103
    v_mul_f32 v112, v112, v128
    v_mul_f32 v113, v113, v129
    v_mul_f32 v114, v114, v130
    v_mul_f32 v115, v115, v131
    v_mul_f32 v116, v116, v132
    v_mul_f32 v117, v117, v133
    v_mul_f32 v118, v118, v134
    v_mul_f32 v119, v119, v135
    v_add_f32 v96, 1.0, v96
    v_add_f32 v97, 1.0, v97
    v_add_f32 v98, 1.0, v98
    v_add_f32 v99, 1.0, v99
    v_add_f32 v100, 1.0, v100
    v_add_f32 v101, 1.0, v101
    v_add_f32 v102, 1.0, v102
    v_add_f32 v103, 1.0, v103
    v_rcp_f32 v96, v96
    v_rcp_f32 v97, v97
    v_rcp_f32 v98, v98
    v_rcp_f32 v99, v99
    v_rcp_f32 v100, v100
    v_rcp_f32 v101, v101
    v_rcp_f32 v102, v102
    v_rcp_f32 v103, v103
    v_mul_f32 v112, v112, v96
    v_mul_f32 v113, v113, v97
    v_mul_f32 v114, v114, v98
    v_mul_f32 v115, v115, v99
    v_mul_f32 v116, v116, v100
    v_mul_f32 v117, v117, v101
    v_mul_f32 v118, v118, v102
    v_mul_f32 v119, v119, v103
    v_permlane16_swap_b32 v112, v116
    v_permlane16_swap_b32 v113, v117
    v_permlane16_swap_b32 v114, v118
    v_permlane16_swap_b32 v115, v119
    v_dot2c_f32_bf16 v112, s92, v160
    v_dot2c_f32_bf16 v113, s93, v160
    v_dot2c_f32_bf16 v114, s92, v161
    v_dot2c_f32_bf16 v115, s93, v161
    v_dot2c_f32_bf16 v116, s92, v162
    v_dot2c_f32_bf16 v117, s93, v162
    v_dot2c_f32_bf16 v118, s92, v163
    v_dot2c_f32_bf16 v119, s93, v163
    v_cvt_pk_bf16_f32 v160, v112, v113
    v_cvt_pk_bf16_f32 v161, v114, v115
    v_cvt_pk_bf16_f32 v162, v116, v117
    v_cvt_pk_bf16_f32 v163, v118, v119
    s_add_u32 s70, s82, 0
    buffer_store_dwordx4 v[160:163], v208, s[48:51], s70 offen
    v_fma_f32 v120, v120, s87, v172
    v_fma_f32 v121, v121, s87, v173
    v_fma_f32 v122, v122, s87, v174
    v_fma_f32 v123, v123, s87, v175
    v_fma_f32 v124, v124, s87, v172
    v_fma_f32 v125, v125, s87, v173
    v_fma_f32 v126, v126, s87, v174
    v_fma_f32 v127, v127, s87, v175
    v_mul_f32 v96, 0xbfb8aa3b, v120
    v_mul_f32 v97, 0xbfb8aa3b, v121
    v_mul_f32 v98, 0xbfb8aa3b, v122
    v_mul_f32 v99, 0xbfb8aa3b, v123
    v_mul_f32 v100, 0xbfb8aa3b, v124
    v_mul_f32 v101, 0xbfb8aa3b, v125
    v_mul_f32 v102, 0xbfb8aa3b, v126
    v_mul_f32 v103, 0xbfb8aa3b, v127
    v_exp_f32 v96, v96
    v_exp_f32 v97, v97
    v_exp_f32 v98, v98
    v_exp_f32 v99, v99
    v_exp_f32 v100, v100
    v_exp_f32 v101, v101
    v_exp_f32 v102, v102
    v_exp_f32 v103, v103
    v_mul_f32 v120, v120, v136
    v_mul_f32 v121, v121, v137
    v_mul_f32 v122, v122, v138
    v_mul_f32 v123, v123, v139
    v_mul_f32 v124, v124, v140
    v_mul_f32 v125, v125, v141
    v_mul_f32 v126, v126, v142
    v_mul_f32 v127, v127, v143
    v_add_f32 v96, 1.0, v96
    v_add_f32 v97, 1.0, v97
    v_add_f32 v98, 1.0, v98
    v_add_f32 v99, 1.0, v99
    v_add_f32 v100, 1.0, v100
    v_add_f32 v101, 1.0, v101
    v_add_f32 v102, 1.0, v102
    v_add_f32 v103, 1.0, v103
    v_rcp_f32 v96, v96
    v_rcp_f32 v97, v97
    v_rcp_f32 v98, v98
    v_rcp_f32 v99, v99
    v_rcp_f32 v100, v100
    v_rcp_f32 v101, v101
    v_rcp_f32 v102, v102
    v_rcp_f32 v103, v103
    v_mul_f32 v120, v120, v96
    v_mul_f32 v121, v121, v97
    v_mul_f32 v122, v122, v98
    v_mul_f32 v123, v123, v99
    v_mul_f32 v124, v124, v100
    v_mul_f32 v125, v125, v101
    v_mul_f32 v126, v126, v102
    v_mul_f32 v127, v127, v103
    v_permlane16_swap_b32 v120, v124
    v_permlane16_swap_b32 v121, v125
    v_permlane16_swap_b32 v122, v126
    v_permlane16_swap_b32 v123, v127
    v_dot2c_f32_bf16 v120, s92, v164
    v_dot2c_f32_bf16 v121, s93, v164
    v_dot2c_f32_bf16 v122, s92, v165
    v_dot2c_f32_bf16 v123, s93, v165
    v_dot2c_f32_bf16 v124, s92, v166
    v_dot2c_f32_bf16 v125, s93, v166
    v_dot2c_f32_bf16 v126, s92, v167
    v_dot2c_f32_bf16 v127, s93, v167
    v_cvt_pk_bf16_f32 v164, v120, v121
    v_cvt_pk_bf16_f32 v165, v122, v123
    v_cvt_pk_bf16_f32 v166, v124, v125
    v_cvt_pk_bf16_f32 v167, v126, v127
    s_add_u32 s70, s82, 36864
    buffer_store_dwordx4 v[164:167], v208, s[48:51], s70 offen
    s_branch L_k1_end
L_attn:
    s_nop 7
    s_nop 3
    s_mov_b32 s44, s18
    s_and_b32 s45, s19, 0xffff
    s_mov_b32 s46, 1990656
    s_mov_b32 s47, 0x00020000
    s_lshl_b32 s83, s6, 9
    s_mul_i32 s67, s6, 331776
    s_mov_b32 s72, s4
    s_lshl_b32 s73, s3, 6
    s_cmp_ge_u32 s73, 54
    s_cbranch_scc1 L_pf5
    s_mul_i32 s72, s72, 62208
    s_add_u32 s72, s72, s83
    s_add_u32 s72, s72, 1276
    v_add_u32 v178, s73, v1
    v_min_u32 v178, 53, v178
    v_mul_u32_u24 v179, 21846, v178
    v_lshrrev_b32 v179, 16, v179
    v_lshlrev_b32 v178, 8, v178
    v_mul_u32_u24 v179, 2688, v179
    v_add_u32 v178, v178, v179
    buffer_load_dwordx2 v[178:179], v178, s[44:47], s72 offen
L_pf5:
    s_mul_i32 s10, s6, 640
    s_lshl_b32 s9, s3, 7
    s_add_u32 s10, s10, s9
    s_add_u32 s9, s3, 1
    s_mul_i32 s9, s9, 1152
    s_cmp_eq_u32 s3, 2
    s_cselect_b32 s9, 0, s9
    s_cmp_eq_u32 s3, 3
    s_cselect_b32 s9, 0x7f000000, s9
    s_lshl_b32 s66, s6, 6
    s_add_u32 s66, s66, 512
    s_add_u32 s66, s66, s9
    s_mov_b32 s68, 0x358637bd
    s_add_u32 s69, s6, 6
    v_lshrrev_b32 v216, 3, v1
    v_bfe_u32 v217, v1, 1, 2
    v_bfe_u32 v218, v1, 4, 2
    v_xor_b32 v217, v217, v218
    v_lshlrev_b32 v217, 5, v217
    v_and_b32 v218, 1, v1
    v_lshl_add_u32 v217, v218, 4, v217
    v_lshrrev_b32 v218, 2, v216
    v_and_b32 v216, 3, v216
    v_lshl_add_u32 v216, v218, 3, v216
    v_mul_u32_u24 v216, 3456, v216
    v_add_u32 v252, v216, v217
    v_add_u32 v253, 54272, v252
    v_add_u32 v254, 11776, v252
    v_add_u32 v255, 66048, v252
    s_mov_b32 s48, s20
    s_and_b32 s49, s21, 0xffff
    s_mov_b32 s50, 663552
    s_mov_b32 s51, 0x00020000
    v_lshrrev_b32 v216, 5, v1
    v_lshlrev_b32 v216, 10, v216
    v_bfe_u32 v217, v1, 2, 3
    v_lshl_add_u32 v216, v217, 7, v216
    v_lshrrev_b32 v217, 1, v217
    v_lshl_add_u32 v216, v217, 5, v216
    v_and_b32 v217, 3, v1
    v_lshl_add_u32 v216, v217, 3, v216
    v_add_u32 v240, s7, v216
    v_xor_b32 v241, 32, v240
    v_xor_b32 v242, 64, v240
    v_xor_b32 v243, 96, v240
    v_add_u32 v244, 65536, v240
    v_add_u32 v245, 65536, v241
    v_add_u32 v246, 65536, v242
    v_add_u32 v247, 65536, v243
    v_add_u32 v248, 131072, v240
    v_add_u32 v249, 131072, v241
    v_add_u32 v250, 131072, v242
    v_add_u32 v251, 131072, v243
    v_lshrrev_b32 v216, 4, v1
    v_bfe_u32 v217, v1, 1, 1
    v_xor_b32 v217, v217, v216
    v_and_b32 v217, 1, v217
    v_lshlrev_b32 v217, 5, v217
    v_and_b32 v218, 1, v1
    v_lshl_add_u32 v217, v218, 4, v217
    v_bfe_u32 v218, v1, 2, 2
    v_lshl_add_u32 v216, v216, 3, v218
    v_mul_u32_u24 v216, 3456, v216
    v_add_u32 v236, v216, v217
    v_add_u32 v237, 12800, v236
    v_add_u32 v238, 108544, v236
    v_add_u32 v239, 121344, v236
    v_mov_b32 v232, s68
    v_mov_b32 v233, s68
    v_mov_b32 v234, s68
    v_mov_b32 v235, s68
    s_mul_i32 s9, s3, 36864
    s_add_u32 s76, s9, s67
    s_sub_u32 s15, 331776, s67
    s_add_u32 s77, s9, s15
    s_lshl_b32 s9, s69, 7
    s_add_u32 s74, s76, s9
    s_add_u32 s75, s77, s9
    s_add_u32 s76, s76, 1024
    s_add_u32 s77, s77, 1024
    s_lshr_b32 s80, s3, 1
    s_mul_i32 s80, s80, 9
    s_and_b32 s15, s3, 1
    s_lshl_b32 s15, s15, 2
    s_add_u32 s80, s80, s15
    s_lshl_b32 s91, s6, 2
    s_add_u32 s9, s91, s3
    s_mul_i32 s82, s9, 12288
    s_add_u32 s82, s82, 46137344
    s_lshl_b32 s9, s9, 5
    s_add_u32 s9, s9, s4
    s_mul_i32 s81, s9, 12288
    s_add_u32 s81, s81, 41943040
    s_lshl_b32 s9, s4, 2
    s_add_u32 s9, s9, s3
    s_cmp_ge_u32 s9, 96
    s_cselect_b32 s15, 96, 0
    s_sub_u32 s9, s9, s15
    s_mul_i32 s15, s9, 43
    s_lshr_b32 s15, s15, 10
    s_mul_i32 s90, s15, 24
    s_sub_u32 s9, s9, s90
    s_add_u32 s15, s15, s91
    s_lshl_b32 s9, s9, 9
    s_mul_i32 s90, s15, 12288
    s_add_u32 s90, s90, s9
    s_add_u32 s90, s90, 46137344
    s_mul_i32 s89, s15, 393216
    s_add_u32 s89, s89, s9
    s_add_u32 s89, s89, 41943040
    s_mov_b32 s84, 0x00003f80
    s_mov_b32 s85, 0x3f800000
    v_and_b32 v6, 15, v1
    v_lshrrev_b32 v7, 4, v1
    v_lshrrev_b32 v8, 1, v6
    v_xor_b32 v8, v8, v7
    v_lshlrev_b32 v8, 4, v8
    v_lshl_add_u32 v8, v6, 7, v8
    v_add_u32 v4, s7, v8
    v_xor_b32 v5, 64, v4
    v_add_u32 v6, 0x10000, v4
    v_add_u32 v7, 0x10000, v5
    v_mov_b32 v8, 0
    v_mov_b32 v9, 0
    v_mov_b32 v10, 0
    v_mov_b32 v14, 0
    s_waitcnt vmcnt(16)
    ds_read_b128 v[48:51], v4 offset:0
    ds_read_b128 v[52:55], v5 offset:0
    s_waitcnt vmcnt(14)
    ds_read_b128 v[56:59], v4 offset:2048
    ds_read_b128 v[60:63], v5 offset:2048
    s_add_u32 m0, s7, 81920
    s_add_u32 s64, s10, 1152
    buffer_load_dwordx4 v252, s[44:47], s64 offen offset:0  lds
    buffer_load_dwordx4 v253, s[44:47], s64 offen offset:1024  lds
    s_waitcnt lgkmcnt(2)
    v_dot2c_f32_bf16 v8, s14, v48
    v_dot2c_f32_bf16 v10, v48, v48
    v_dot2c_f32_bf16 v9, s14, v49
    v_dot2c_f32_bf16 v14, v49, v49
    v_dot2c_f32_bf16 v8, s14, v50
    v_dot2c_f32_bf16 v10, v50, v50
    v_dot2c_f32_bf16 v9, s14, v51
    v_dot2c_f32_bf16 v14, v51, v51
    v_dot2c_f32_bf16 v8, s14, v52
    v_dot2c_f32_bf16 v10, v52, v52
    v_dot2c_f32_bf16 v9, s14, v53
    v_dot2c_f32_bf16 v14, v53, v53
    v_dot2c_f32_bf16 v8, s14, v54
    v_dot2c_f32_bf16 v10, v54, v54
    v_dot2c_f32_bf16 v9, s14, v55
    v_dot2c_f32_bf16 v14, v55, v55
    s_waitcnt vmcnt(14)
    ds_read_b128 v[64:67], v4 offset:16384
    ds_read_b128 v[68:71], v5 offset:16384
    buffer_load_dwordx4 v254, s[44:47], s64 offen offset:2048  lds
    buffer_load_dwordx4 v255, s[44:47], s64 offen offset:3072  lds
    s_waitcnt lgkmcnt(2)
    v_dot2c_f32_bf16 v8, s14, v56
    v_dot2c_f32_bf16 v10, v56, v56
    v_dot2c_f32_bf16 v9, s14, v57
    v_dot2c_f32_bf16 v14, v57, v57
    v_dot2c_f32_bf16 v8, s14, v58
    v_dot2c_f32_bf16 v10, v58, v58
    v_dot2c_f32_bf16 v9, s14, v59
    v_dot2c_f32_bf16 v14, v59, v59
    v_dot2c_f32_bf16 v8, s14, v60
    v_dot2c_f32_bf16 v10, v60, v60
    v_dot2c_f32_bf16 v9, s14, v61
    v_dot2c_f32_bf16 v14, v61, v61
    v_dot2c_f32_bf16 v8, s14, v62
    v_dot2c_f32_bf16 v10, v62, v62
    v_dot2c_f32_bf16 v9, s14, v63
    v_dot2c_f32_bf16 v14, v63, v63
    s_waitcnt vmcnt(14)
    ds_read_b128 v[72:75], v4 offset:18432
    ds_read_b128 v[76:79], v5 offset:18432
    s_add_u32 m0, s7, 98304
    s_add_u32 s64, s10, 111744
    buffer_load_dwordx4 v252, s[44:47], s64 offen offset:0  lds
    buffer_load_dwordx4 v253, s[44:47], s64 offen offset:1024  lds
    s_waitcnt lgkmcnt(2)
    v_dot2c_f32_bf16 v8, s14, v64
    v_dot2c_f32_bf16 v10, v64, v64
    v_dot2c_f32_bf16 v9, s14, v65
    v_dot2c_f32_bf16 v14, v65, v65
    v_dot2c_f32_bf16 v8, s14, v66
    v_dot2c_f32_bf16 v10, v66, v66
    v_dot2c_f32_bf16 v9, s14, v67
    v_dot2c_f32_bf16 v14, v67, v67
    v_dot2c_f32_bf16 v8, s14, v68
    v_dot2c_f32_bf16 v10, v68, v68
    v_dot2c_f32_bf16 v9, s14, v69
    v_dot2c_f32_bf16 v14, v69, v69
    v_dot2c_f32_bf16 v8, s14, v70
    v_dot2c_f32_bf16 v10, v70, v70
    v_dot2c_f32_bf16 v9, s14, v71
    v_dot2c_f32_bf16 v14, v71, v71
    s_waitcnt vmcnt(14)
    ds_read_b128 v[80:83], v4 offset:32768
    ds_read_b128 v[84:87], v5 offset:32768
    buffer_load_dwordx4 v254, s[44:47], s64 offen offset:2048  lds
    buffer_load_dwordx4 v255, s[44:47], s64 offen offset:3072  lds
    s_waitcnt lgkmcnt(2)
    v_dot2c_f32_bf16 v8, s14, v72
    v_dot2c_f32_bf16 v10, v72, v72
    v_dot2c_f32_bf16 v9, s14, v73
    v_dot2c_f32_bf16 v14, v73, v73
    v_dot2c_f32_bf16 v8, s14, v74
    v_dot2c_f32_bf16 v10, v74, v74
    v_dot2c_f32_bf16 v9, s14, v75
    v_dot2c_f32_bf16 v14, v75, v75
    v_dot2c_f32_bf16 v8, s14, v76
    v_dot2c_f32_bf16 v10, v76, v76
    v_dot2c_f32_bf16 v9, s14, v77
    v_dot2c_f32_bf16 v14, v77, v77
    v_dot2c_f32_bf16 v8, s14, v78
    v_dot2c_f32_bf16 v10, v78, v78
    v_dot2c_f32_bf16 v9, s14, v79
    v_dot2c_f32_bf16 v14, v79, v79
    s_waitcnt vmcnt(14)
    ds_read_b128 v[88:91], v4 offset:34816
    ds_read_b128 v[92:95], v5 offset:34816
    s_add_u32 m0, s7, 114688
    s_add_u32 s64, s10, 222336
    buffer_load_dwordx4 v252, s[44:47], s64 offen offset:0  lds
    buffer_load_dwordx4 v253, s[44:47], s64 offen offset:1024  lds
    s_waitcnt lgkmcnt(2)
    v_dot2c_f32_bf16 v8, s14, v80
    v_dot2c_f32_bf16 v10, v80, v80
    v_dot2c_f32_bf16 v9, s14, v81
    v_dot2c_f32_bf16 v14, v81, v81
    v_dot2c_f32_bf16 v8, s14, v82
    v_dot2c_f32_bf16 v10, v82, v82
    v_dot2c_f32_bf16 v9, s14, v83
    v_dot2c_f32_bf16 v14, v83, v83
    v_dot2c_f32_bf16 v8, s14, v84
    v_dot2c_f32_bf16 v10, v84, v84
    v_dot2c_f32_bf16 v9, s14, v85
    v_dot2c_f32_bf16 v14, v85, v85
    v_dot2c_f32_bf16 v8, s14, v86
    v_dot2c_f32_bf16 v10, v86, v86
    v_dot2c_f32_bf16 v9, s14, v87
    v_dot2c_f32_bf16 v14, v87, v87
    s_waitcnt vmcnt(14)
    ds_read_b128 v[96:99], v4 offset:49152
    ds_read_b128 v[100:103], v5 offset:49152
    buffer_load_dwordx4 v254, s[44:47], s64 offen offset:2048  lds
    buffer_load_dwordx4 v255, s[44:47], s64 offen offset:3072  lds
    s_waitcnt lgkmcnt(2)
    v_dot2c_f32_bf16 v8, s14, v88
    v_dot2c_f32_bf16 v10, v88, v88
    v_dot2c_f32_bf16 v9, s14, v89
    v_dot2c_f32_bf16 v14, v89, v89
    v_dot2c_f32_bf16 v8, s14, v90
    v_dot2c_f32_bf16 v10, v90, v90
    v_dot2c_f32_bf16 v9, s14, v91
    v_dot2c_f32_bf16 v14, v91, v91
    v_dot2c_f32_bf16 v8, s14, v92
    v_dot2c_f32_bf16 v10, v92, v92
    v_dot2c_f32_bf16 v9, s14, v93
    v_dot2c_f32_bf16 v14, v93, v93
    v_dot2c_f32_bf16 v8, s14, v94
    v_dot2c_f32_bf16 v10, v94, v94
    v_dot2c_f32_bf16 v9, s14, v95
    v_dot2c_f32_bf16 v14, v95, v95
    s_waitcnt vmcnt(14)
    ds_read_b128 v[104:107], v4 offset:51200
    ds_read_b128 v[108:111], v5 offset:51200
    s_add_u32 m0, s7, 131072
    s_add_u32 s64, s10, 332928
    buffer_load_dwordx4 v252, s[44:47], s64 offen offset:0  lds
    buffer_load_dwordx4 v253, s[44:47], s64 offen offset:1024  lds
    s_waitcnt lgkmcnt(2)
    v_dot2c_f32_bf16 v8, s14, v96
    v_dot2c_f32_bf16 v10, v96, v96
    v_dot2c_f32_bf16 v9, s14, v97
    v_dot2c_f32_bf16 v14, v97, v97
    v_dot2c_f32_bf16 v8, s14, v98
    v_dot2c_f32_bf16 v10, v98, v98
    v_dot2c_f32_bf16 v9, s14, v99
    v_dot2c_f32_bf16 v14, v99, v99
    v_dot2c_f32_bf16 v8, s14, v100
    v_dot2c_f32_bf16 v10, v100, v100
    v_dot2c_f32_bf16 v9, s14, v101
    v_dot2c_f32_bf16 v14, v101, v101
    v_dot2c_f32_bf16 v8, s14, v102
    v_dot2c_f32_bf16 v10, v102, v102
    v_dot2c_f32_bf16 v9, s14, v103
    v_dot2c_f32_bf16 v14, v103, v103
    s_waitcnt vmcnt(14)
    ds_read_b128 v[112:115], v6 offset:0
    ds_read_b128 v[116:119], v7 offset:0
    buffer_load_dwordx4 v254, s[44:47], s64 offen offset:2048  lds
    buffer_load_dwordx4 v255, s[44:47], s64 offen offset:3072  lds
    s_waitcnt lgkmcnt(2)
    v_dot2c_f32_bf16 v8, s14, v104
    v_dot2c_f32_bf16 v10, v104, v104
    v_dot2c_f32_bf16 v9, s14, v105
    v_dot2c_f32_bf16 v14, v105, v105
    v_dot2c_f32_bf16 v8, s14, v106
    v_dot2c_f32_bf16 v10, v106, v106
    v_dot2c_f32_bf16 v9, s14, v107
    v_dot2c_f32_bf16 v14, v107, v107
    v_dot2c_f32_bf16 v8, s14, v108
    v_dot2c_f32_bf16 v10, v108, v108
    v_dot2c_f32_bf16 v9, s14, v109
    v_dot2c_f32_bf16 v14, v109, v109
    v_dot2c_f32_bf16 v8, s14, v110
    v_dot2c_f32_bf16 v10, v110, v110
    v_dot2c_f32_bf16 v9, s14, v111
    v_dot2c_f32_bf16 v14, v111, v111
    s_add_u32 m0, s7, 147456
    s_add_u32 s64, s10, 443520
    buffer_load_dwordx4 v252, s[44:47], s64 offen offset:0  lds
    buffer_load_dwordx4 v253, s[44:47], s64 offen offset:1024  lds
    s_waitcnt lgkmcnt(0)
    v_dot2c_f32_bf16 v8, s14, v112
    v_dot2c_f32_bf16 v10, v112, v112
    v_dot2c_f32_bf16 v9, s14, v113
    v_dot2c_f32_bf16 v14, v113, v113
    v_dot2c_f32_bf16 v8, s14, v114
    v_dot2c_f32_bf16 v10, v114, v114
    v_dot2c_f32_bf16 v9, s14, v115
    v_dot2c_f32_bf16 v14, v115, v115
    v_dot2c_f32_bf16 v8, s14, v116
    v_dot2c_f32_bf16 v10, v116, v116
    v_dot2c_f32_bf16 v9, s14, v117
    v_dot2c_f32_bf16 v14, v117, v117
    v_dot2c_f32_bf16 v8, s14, v118
    v_dot2c_f32_bf16 v10, v118, v118
    v_dot2c_f32_bf16 v9, s14, v119
    v_dot2c_f32_bf16 v14, v119, v119
    s_nop 1
    v_add_f32 v8, v8, v9
    v_add_f32 v9, v10, v14
    v_mov_b32 v12, v8
    v_mov_b32 v13, v9
    s_nop 0
    v_permlane16_swap_b32 v8, v12
    v_permlane16_swap_b32 v9, v13
    v_add_f32 v8, v8, v12
    v_add_f32 v9, v9, v13
    v_mov_b32 v12, v8
    v_mov_b32 v13, v9
    s_nop 0
    v_permlane32_swap_b32 v8, v12
    v_permlane32_swap_b32 v9, v13
    v_add_f32 v8, v8, v12
    v_add_f32 v9, v9, v13
    v_mul_f32 v10, 0xbae38e39, v8
    v_mul_f32 v9, 0x3ae38e39, v9
    v_fma_f32 v9, -v10, v10, v9
    v_max_f32 v9, 0, v9
    v_add_f32 v9, 0x3727c5ac, v9
    v_rsq_f32 v8, v9
    s_nop 0
    v_cvt_pk_bf16_f32 v8, v8, 0
    v_lshlrev_b32 v12, 16, v8
    v_mul_f32 v9, v10, v12
    v_mov_b32 v10, v12
    v_add_u32 v4, s7, v2
    v_add_u32 v5, 0x10000, v4
    s_add_u32 s9, s2, s3
    s_cmp_lg_u32 s9, 0
    s_cbranch_scc1 L_ep_a
    s_mov_b32 s9, 0x9e3779b1
    v_mul_lo_u32 v15, v15, s9
    v_add_u32 v15, 0x7f4a7c15, v15
    v_or_b32 v15, 1, v15
    v_mov_b32 v14, 0
    s_mov_b32 s9, 48300032
    s_mov_b64 exec, 1
    buffer_store_dword v15, v14, s[60:63], 0 offen sc1
    buffer_store_dword v15, v14, s[52:55], s9 offen sc1
    s_mov_b64 exec, -1
L_ep_a:
    v_lshrrev_b32 v216, 3, v1
    v_bfe_u32 v217, v1, 1, 2
    v_bfe_u32 v218, v1, 4, 2
    v_xor_b32 v217, v217, v218
    v_lshlrev_b32 v217, 5, v217
    v_and_b32 v218, 1, v1
    v_lshl_add_u32 v217, v218, 4, v217
    v_mul_u32_u24 v216, 1152, v216
    v_add_u32 v12, v216, v217
    v_add_u32 v13, 8192, v12
    v_add_u32 v14, 16384, v12
    v_add_u32 v15, 24576, v12
    v_dot2_f32_bf16 v200, v48, v8, v9
    v_dot2_f32_bf16 v201, v48, v10, v9
    v_dot2_f32_bf16 v202, v49, v8, v9
    v_dot2_f32_bf16 v203, v49, v10, v9
    v_dot2_f32_bf16 v204, v50, v8, v9
    v_dot2_f32_bf16 v205, v50, v10, v9
    v_dot2_f32_bf16 v206, v51, v8, v9
    v_dot2_f32_bf16 v207, v51, v10, v9
    v_dot2_f32_bf16 v208, v52, v8, v9
    v_dot2_f32_bf16 v209, v52, v10, v9
    v_dot2_f32_bf16 v210, v53, v8, v9
    v_dot2_f32_bf16 v211, v53, v10, v9
    v_dot2_f32_bf16 v212, v54, v8, v9
    v_dot2_f32_bf16 v213, v54, v10, v9
    v_dot2_f32_bf16 v214, v55, v8, v9
    v_dot2_f32_bf16 v215, v55, v10, v9
    v_cvt_pk_bf16_f32 v48, v200, v201
    v_cvt_pk_bf16_f32 v49, v202, v203
    v_cvt_pk_bf16_f32 v50, v204, v205
    v_cvt_pk_bf16_f32 v51, v206, v207
    ds_write_b128 v4, v[48:51] offset:0
    v_dot2_f32_bf16 v200, v56, v8, v9
    v_dot2_f32_bf16 v201, v56, v10, v9
    v_dot2_f32_bf16 v202, v57, v8, v9
    v_dot2_f32_bf16 v203, v57, v10, v9
    v_dot2_f32_bf16 v204, v58, v8, v9
    v_dot2_f32_bf16 v205, v58, v10, v9
    v_dot2_f32_bf16 v206, v59, v8, v9
    v_dot2_f32_bf16 v207, v59, v10, v9
    v_cvt_pk_bf16_f32 v52, v208, v209
    v_cvt_pk_bf16_f32 v53, v210, v211
    v_cvt_pk_bf16_f32 v54, v212, v213
    v_cvt_pk_bf16_f32 v55, v214, v215
    ds_write_b128 v4, v[52:55] offset:1024
    v_dot2_f32_bf16 v208, v60, v8, v9
    v_dot2_f32_bf16 v209, v60, v10, v9
    v_dot2_f32_bf16 v210, v61, v8, v9
    v_dot2_f32_bf16 v211, v61, v10, v9
    v_dot2_f32_bf16 v212, v62, v8, v9
    v_dot2_f32_bf16 v213, v62, v10, v9
    v_dot2_f32_bf16 v214, v63, v8, v9
    v_dot2_f32_bf16 v215, v63, v10, v9
    v_cvt_pk_bf16_f32 v56, v200, v201
    v_cvt_pk_bf16_f32 v57, v202, v203
    v_cvt_pk_bf16_f32 v58, v204, v205
    v_cvt_pk_bf16_f32 v59, v206, v207
    ds_write_b128 v4, v[56:59] offset:2048
    v_dot2_f32_bf16 v200, v64, v8, v9
    v_dot2_f32_bf16 v201, v64, v10, v9
    v_dot2_f32_bf16 v202, v65, v8, v9
    v_dot2_f32_bf16 v203, v65, v10, v9
    v_dot2_f32_bf16 v204, v66, v8, v9
    v_dot2_f32_bf16 v205, v66, v10, v9
    v_dot2_f32_bf16 v206, v67, v8, v9
    v_dot2_f32_bf16 v207, v67, v10, v9
    v_cvt_pk_bf16_f32 v60, v208, v209
    v_cvt_pk_bf16_f32 v61, v210, v211
    v_cvt_pk_bf16_f32 v62, v212, v213
    v_cvt_pk_bf16_f32 v63, v214, v215
    ds_write_b128 v4, v[60:63] offset:3072
    v_dot2_f32_bf16 v208, v68, v8, v9
    v_dot2_f32_bf16 v209, v68, v10, v9
    v_dot2_f32_bf16 v210, v69, v8, v9
    v_dot2_f32_bf16 v211, v69, v10, v9
    v_dot2_f32_bf16 v212, v70, v8, v9
    v_dot2_f32_bf16 v213, v70, v10, v9
    v_dot2_f32_bf16 v214, v71, v8, v9
    v_dot2_f32_bf16 v215, v71, v10, v9
    v_cvt_pk_bf16_f32 v64, v200, v201
    v_cvt_pk_bf16_f32 v65, v202, v203
    v_cvt_pk_bf16_f32 v66, v204, v205
    v_cvt_pk_bf16_f32 v67, v206, v207
    ds_write_b128 v4, v[64:67] offset:16384
    v_dot2_f32_bf16 v200, v72, v8, v9
    v_dot2_f32_bf16 v201, v72, v10, v9
    v_dot2_f32_bf16 v202, v73, v8, v9
    v_dot2_f32_bf16 v203, v73, v10, v9
    v_dot2_f32_bf16 v204, v74, v8, v9
    v_dot2_f32_bf16 v205, v74, v10, v9
    v_dot2_f32_bf16 v206, v75, v8, v9
    v_dot2_f32_bf16 v207, v75, v10, v9
    v_cvt_pk_bf16_f32 v68, v208, v209
    v_cvt_pk_bf16_f32 v69, v210, v211
    v_cvt_pk_bf16_f32 v70, v212, v213
    v_cvt_pk_bf16_f32 v71, v214, v215
    ds_write_b128 v4, v[68:71] offset:17408
    v_dot2_f32_bf16 v208, v76, v8, v9
    v_dot2_f32_bf16 v209, v76, v10, v9
    v_dot2_f32_bf16 v210, v77, v8, v9
    v_dot2_f32_bf16 v211, v77, v10, v9
    v_dot2_f32_bf16 v212, v78, v8, v9
    v_dot2_f32_bf16 v213, v78, v10, v9
    v_dot2_f32_bf16 v214, v79, v8, v9
    v_dot2_f32_bf16 v215, v79, v10, v9
    v_cvt_pk_bf16_f32 v72, v200, v201
    v_cvt_pk_bf16_f32 v73, v202, v203
    v_cvt_pk_bf16_f32 v74, v204, v205
    v_cvt_pk_bf16_f32 v75, v206, v207
    ds_write_b128 v4, v[72:75] offset:18432
    v_dot2_f32_bf16 v200, v80, v8, v9
    v_dot2_f32_bf16 v201, v80, v10, v9
    v_dot2_f32_bf16 v202, v81, v8, v9
    v_dot2_f32_bf16 v203, v81, v10, v9
    v_dot2_f32_bf16 v204, v82, v8, v9
    v_dot2_f32_bf16 v205, v82, v10, v9
    v_dot2_f32_bf16 v206, v83, v8, v9
    v_dot2_f32_bf16 v207, v83, v10, v9
    v_cvt_pk_bf16_f32 v76, v208, v209
    v_cvt_pk_bf16_f32 v77, v210, v211
    v_cvt_pk_bf16_f32 v78, v212, v213
    v_cvt_pk_bf16_f32 v79, v214, v215
    ds_write_b128 v4, v[76:79] offset:19456
    v_dot2_f32_bf16 v208, v84, v8, v9
    v_dot2_f32_bf16 v209, v84, v10, v9
    v_dot2_f32_bf16 v210, v85, v8, v9
    v_dot2_f32_bf16 v211, v85, v10, v9
    v_dot2_f32_bf16 v212, v86, v8, v9
    v_dot2_f32_bf16 v213, v86, v10, v9
    v_dot2_f32_bf16 v214, v87, v8, v9
    v_dot2_f32_bf16 v215, v87, v10, v9
    v_cvt_pk_bf16_f32 v80, v200, v201
    v_cvt_pk_bf16_f32 v81, v202, v203
    v_cvt_pk_bf16_f32 v82, v204, v205
    v_cvt_pk_bf16_f32 v83, v206, v207
    ds_write_b128 v4, v[80:83] offset:32768
    v_dot2_f32_bf16 v200, v88, v8, v9
    v_dot2_f32_bf16 v201, v88, v10, v9
    v_dot2_f32_bf16 v202, v89, v8, v9
    v_dot2_f32_bf16 v203, v89, v10, v9
    v_dot2_f32_bf16 v204, v90, v8, v9
    v_dot2_f32_bf16 v205, v90, v10, v9
    v_dot2_f32_bf16 v206, v91, v8, v9
    v_dot2_f32_bf16 v207, v91, v10, v9
    v_cvt_pk_bf16_f32 v84, v208, v209
    v_cvt_pk_bf16_f32 v85, v210, v211
    v_cvt_pk_bf16_f32 v86, v212, v213
    v_cvt_pk_bf16_f32 v87, v214, v215
    ds_write_b128 v4, v[84:87] offset:33792
    v_dot2_f32_bf16 v208, v92, v8, v9
    v_dot2_f32_bf16 v209, v92, v10, v9
    v_dot2_f32_bf16 v210, v93, v8, v9
    v_dot2_f32_bf16 v211, v93, v10, v9
    v_dot2_f32_bf16 v212, v94, v8, v9
    v_dot2_f32_bf16 v213, v94, v10, v9
    v_dot2_f32_bf16 v214, v95, v8, v9
    v_dot2_f32_bf16 v215, v95, v10, v9
    v_cvt_pk_bf16_f32 v88, v200, v201
    v_cvt_pk_bf16_f32 v89, v202, v203
    v_cvt_pk_bf16_f32 v90, v204, v205
    v_cvt_pk_bf16_f32 v91, v206, v207
    ds_write_b128 v4, v[88:91] offset:34816
    v_dot2_f32_bf16 v200, v96, v8, v9
    v_dot2_f32_bf16 v201, v96, v10, v9
    v_dot2_f32_bf16 v202, v97, v8, v9
    v_dot2_f32_bf16 v203, v97, v10, v9
    v_dot2_f32_bf16 v204, v98, v8, v9
    v_dot2_f32_bf16 v205, v98, v10, v9
    v_dot2_f32_bf16 v206, v99, v8, v9
    v_dot2_f32_bf16 v207, v99, v10, v9
    v_cvt_pk_bf16_f32 v92, v208, v209
    v_cvt_pk_bf16_f32 v93, v210, v211
    v_cvt_pk_bf16_f32 v94, v212, v213
    v_cvt_pk_bf16_f32 v95, v214, v215
    ds_write_b128 v4, v[92:95] offset:35840
    v_dot2_f32_bf16 v208, v100, v8, v9
    v_dot2_f32_bf16 v209, v100, v10, v9
    v_dot2_f32_bf16 v210, v101, v8, v9
    v_dot2_f32_bf16 v211, v101, v10, v9
    v_dot2_f32_bf16 v212, v102, v8, v9
    v_dot2_f32_bf16 v213, v102, v10, v9
    v_dot2_f32_bf16 v214, v103, v8, v9
    v_dot2_f32_bf16 v215, v103, v10, v9
    v_cvt_pk_bf16_f32 v96, v200, v201
    v_cvt_pk_bf16_f32 v97, v202, v203
    v_cvt_pk_bf16_f32 v98, v204, v205
    v_cvt_pk_bf16_f32 v99, v206, v207
    ds_write_b128 v4, v[96:99] offset:49152
    v_dot2_f32_bf16 v200, v104, v8, v9
    v_dot2_f32_bf16 v201, v104, v10, v9
    v_dot2_f32_bf16 v202, v105, v8, v9
    v_dot2_f32_bf16 v203, v105, v10, v9
    v_dot2_f32_bf16 v204, v106, v8, v9
    v_dot2_f32_bf16 v205, v106, v10, v9
    v_dot2_f32_bf16 v206, v107, v8, v9
    v_dot2_f32_bf16 v207, v107, v10, v9
    v_cvt_pk_bf16_f32 v100, v208, v209
    v_cvt_pk_bf16_f32 v101, v210, v211
    v_cvt_pk_bf16_f32 v102, v212, v213
    v_cvt_pk_bf16_f32 v103, v214, v215
    ds_write_b128 v4, v[100:103] offset:50176
    v_dot2_f32_bf16 v208, v108, v8, v9
    v_dot2_f32_bf16 v209, v108, v10, v9
    v_dot2_f32_bf16 v210, v109, v8, v9
    v_dot2_f32_bf16 v211, v109, v10, v9
    v_dot2_f32_bf16 v212, v110, v8, v9
    v_dot2_f32_bf16 v213, v110, v10, v9
    v_dot2_f32_bf16 v214, v111, v8, v9
    v_dot2_f32_bf16 v215, v111, v10, v9
    v_cvt_pk_bf16_f32 v104, v200, v201
    v_cvt_pk_bf16_f32 v105, v202, v203
    v_cvt_pk_bf16_f32 v106, v204, v205
    v_cvt_pk_bf16_f32 v107, v206, v207
    ds_write_b128 v4, v[104:107] offset:51200
    v_dot2_f32_bf16 v200, v112, v8, v9
    v_dot2_f32_bf16 v201, v112, v10, v9
    v_dot2_f32_bf16 v202, v113, v8, v9
    v_dot2_f32_bf16 v203, v113, v10, v9
    v_dot2_f32_bf16 v204, v114, v8, v9
    v_dot2_f32_bf16 v205, v114, v10, v9
    v_dot2_f32_bf16 v206, v115, v8, v9
    v_dot2_f32_bf16 v207, v115, v10, v9
    v_cvt_pk_bf16_f32 v108, v208, v209
    v_cvt_pk_bf16_f32 v109, v210, v211
    v_cvt_pk_bf16_f32 v110, v212, v213
    v_cvt_pk_bf16_f32 v111, v214, v215
    ds_write_b128 v4, v[108:111] offset:52224
    v_dot2_f32_bf16 v208, v116, v8, v9
    v_dot2_f32_bf16 v209, v116, v10, v9
    v_dot2_f32_bf16 v210, v117, v8, v9
    v_dot2_f32_bf16 v211, v117, v10, v9
    v_dot2_f32_bf16 v212, v118, v8, v9
    v_dot2_f32_bf16 v213, v118, v10, v9
    v_dot2_f32_bf16 v214, v119, v8, v9
    v_dot2_f32_bf16 v215, v119, v10, v9
    v_cvt_pk_bf16_f32 v112, v200, v201
    v_cvt_pk_bf16_f32 v113, v202, v203
    v_cvt_pk_bf16_f32 v114, v204, v205
    v_cvt_pk_bf16_f32 v115, v206, v207
    ds_write_b128 v5, v[112:115] offset:0
    v_cvt_pk_bf16_f32 v116, v208, v209
    v_cvt_pk_bf16_f32 v117, v210, v211
    v_cvt_pk_bf16_f32 v118, v212, v213
    v_cvt_pk_bf16_f32 v119, v214, v215
    ds_write_b128 v5, v[116:119] offset:1024
    s_waitcnt lgkmcnt(0)
    s_barrier
    ds_read_b128 a[0:3], v2 offset:0
    ds_read_b128 a[4:7], v2 offset:4096
    ds_read_b128 a[8:11], v2 offset:8192
    ds_read_b128 a[12:15], v2 offset:12288
    ds_read_b128 a[16:19], v2 offset:1024
    ds_read_b128 a[20:23], v2 offset:5120
    ds_read_b128 a[24:27], v2 offset:9216
    ds_read_b128 a[28:31], v2 offset:13312
    s_waitcnt vmcnt(14)
    ds_read_b64_tr_b16 v[176:177], v244 offset:16384
    ds_read_b64_tr_b16 v[178:179], v244 offset:18432
    ds_read_b64_tr_b16 v[180:181], v245 offset:16384
    ds_read_b64_tr_b16 v[182:183], v245 offset:18432
    ds_read_b64_tr_b16 v[184:185], v246 offset:16384
    ds_read_b64_tr_b16 v[186:187], v246 offset:18432
    ds_read_b64_tr_b16 v[188:189], v247 offset:16384
    ds_read_b64_tr_b16 v[190:191], v247 offset:18432
    s_waitcnt lgkmcnt(12)
    ds_read_b128 a[32:35], v2 offset:2048
    ds_read_b128 a[48:51], v2 offset:3072
    s_waitcnt lgkmcnt(6)
    v_mfma_f32_16x16x32_bf16 v[48:51], a[0:3], v[176:179], v[232:235]
    s_waitcnt vmcnt(10)
    ds_read_b64_tr_b16 v[192:193], v244 offset:32768
    v_mfma_f32_16x16x32_bf16 v[52:55], a[4:7], v[176:179], v[232:235]
    ds_read_b64_tr_b16 v[194:195], v244 offset:34816
    v_mfma_f32_16x16x32_bf16 v[56:59], a[8:11], v[176:179], v[232:235]
    buffer_load_dwordx4 v254, s[44:47], s64 offen offset:2048  lds
    v_mfma_f32_16x16x32_bf16 v[60:63], a[12:15], v[176:179], v[232:235]
    buffer_load_dwordx4 v255, s[44:47], s64 offen offset:3072  lds
    ds_read_b128 a[36:39], v2 offset:6144
    ds_read_b128 a[52:55], v2 offset:7168
    v_mfma_f32_16x16x32_bf16 v[64:67], a[0:3], v[180:183], v[232:235]
    ds_read_b64_tr_b16 v[196:197], v245 offset:32768
    v_mfma_f32_16x16x32_bf16 v[68:71], a[4:7], v[180:183], v[232:235]
    ds_read_b64_tr_b16 v[198:199], v245 offset:34816
    v_mfma_f32_16x16x32_bf16 v[72:75], a[8:11], v[180:183], v[232:235]
    v_mfma_f32_16x16x32_bf16 v[76:79], a[12:15], v[180:183], v[232:235]
    ds_read_b128 a[40:43], v2 offset:10240
    ds_read_b128 a[56:59], v2 offset:11264
    s_waitcnt lgkmcnt(10)
    v_mfma_f32_16x16x32_bf16 v[80:83], a[0:3], v[184:187], v[232:235]
    ds_read_b64_tr_b16 v[176:177], v246 offset:32768
    v_mfma_f32_16x16x32_bf16 v[84:87], a[4:7], v[184:187], v[232:235]
    ds_read_b64_tr_b16 v[178:179], v246 offset:34816
    v_mfma_f32_16x16x32_bf16 v[88:91], a[8:11], v[184:187], v[232:235]
    s_add_u32 m0, s7, 81920
    s_add_u32 s64, s10, 554112
    buffer_load_dwordx4 v252, s[44:47], s64 offen offset:0  lds
    v_mfma_f32_16x16x32_bf16 v[92:95], a[12:15], v[184:187], v[232:235]
    ds_read_b128 a[44:47], v2 offset:14336
    ds_read_b128 a[60:63], v2 offset:15360
    v_mfma_f32_16x16x32_bf16 v[96:99], a[0:3], v[188:191], v[232:235]
    ds_read_b64_tr_b16 v[180:181], v247 offset:32768
    v_mfma_f32_16x16x32_bf16 v[100:103], a[4:7], v[188:191], v[232:235]
    ds_read_b64_tr_b16 v[182:183], v247 offset:34816
    v_mfma_f32_16x16x32_bf16 v[104:107], a[8:11], v[188:191], v[232:235]
    buffer_load_dwordx4 v253, s[44:47], s64 offen offset:1024  lds
    v_mfma_f32_16x16x32_bf16 v[108:111], a[12:15], v[188:191], v[232:235]
    ds_read_b128 a[64:67], v2 offset:16384
    ds_read_b128 a[80:83], v2 offset:17408
    s_waitcnt lgkmcnt(10)
    v_mfma_f32_16x16x32_bf16 v[48:51], a[16:19], v[192:195], v[48:51]
    s_waitcnt vmcnt(10)
    ds_read_b64_tr_b16 v[184:185], v244 offset:49152
    v_mfma_f32_16x16x32_bf16 v[52:55], a[20:23], v[192:195], v[52:55]
    ds_read_b64_tr_b16 v[186:187], v244 offset:51200
    v_mfma_f32_16x16x32_bf16 v[56:59], a[24:27], v[192:195], v[56:59]
    buffer_load_dwordx4 v254, s[44:47], s64 offen offset:2048  lds
    v_mfma_f32_16x16x32_bf16 v[60:63], a[28:31], v[192:195], v[60:63]
    ds_read_b128 a[68:71], v2 offset:20480
    ds_read_b128 a[84:87], v2 offset:21504
    v_mfma_f32_16x16x32_bf16 v[64:67], a[16:19], v[196:199], v[64:67]
    ds_read_b64_tr_b16 v[188:189], v245 offset:49152
    v_mfma_f32_16x16x32_bf16 v[68:71], a[20:23], v[196:199], v[68:71]
    ds_read_b64_tr_b16 v[190:191], v245 offset:51200
    v_mfma_f32_16x16x32_bf16 v[72:75], a[24:27], v[196:199], v[72:75]
    buffer_load_dwordx4 v255, s[44:47], s64 offen offset:3072  lds
    v_mfma_f32_16x16x32_bf16 v[76:79], a[28:31], v[196:199], v[76:79]
    ds_read_b128 a[72:75], v2 offset:24576
    ds_read_b128 a[88:91], v2 offset:25600
    s_waitcnt lgkmcnt(10)
    v_mfma_f32_16x16x32_bf16 v[80:83], a[16:19], v[176:179], v[80:83]
    ds_read_b64_tr_b16 v[192:193], v246 offset:49152
    v_mfma_f32_16x16x32_bf16 v[84:87], a[20:23], v[176:179], v[84:87]
    ds_read_b64_tr_b16 v[194:195], v246 offset:51200
    v_mfma_f32_16x16x32_bf16 v[88:91], a[24:27], v[176:179], v[88:91]
    s_add_u32 m0, s7, 98304
    s_add_u32 s64, s10, 664704
    buffer_load_dwordx4 v252, s[44:47], s64 offen offset:0  lds
    v_mfma_f32_16x16x32_bf16 v[92:95], a[28:31], v[176:179], v[92:95]
    buffer_load_dwordx4 v253, s[44:47], s64 offen offset:1024  lds
    ds_read_b128 a[76:79], v2 offset:28672
    ds_read_b128 a[92:95], v2 offset:29696
    v_mfma_f32_16x16x32_bf16 v[96:99], a[16:19], v[180:183], v[96:99]
    ds_read_b64_tr_b16 v[196:197], v247 offset:49152
    v_mfma_f32_16x16x32_bf16 v[100:103], a[20:23], v[180:183], v[100:103]
    ds_read_b64_tr_b16 v[198:199], v247 offset:51200
    v_mfma_f32_16x16x32_bf16 v[104:107], a[24:27], v[180:183], v[104:107]
    buffer_load_dwordx4 v254, s[44:47], s64 offen offset:2048  lds
    v_mfma_f32_16x16x32_bf16 v[108:111], a[28:31], v[180:183], v[108:111]
    ds_read_b128 a[96:99], v2 offset:18432
    ds_read_b128 a[112:115], v2 offset:19456
    s_waitcnt lgkmcnt(10)
    v_mfma_f32_16x16x32_bf16 v[48:51], a[32:35], v[184:187], v[48:51]
    s_waitcnt vmcnt(11)
    ds_read_b64_tr_b16 v[176:177], v248 offset:0
    v_mfma_f32_16x16x32_bf16 v[52:55], a[36:39], v[184:187], v[52:55]
    ds_read_b64_tr_b16 v[178:179], v248 offset:2048
    v_mfma_f32_16x16x32_bf16 v[56:59], a[40:43], v[184:187], v[56:59]
    buffer_load_dwordx4 v255, s[44:47], s64 offen offset:3072  lds
    v_mfma_f32_16x16x32_bf16 v[60:63], a[44:47], v[184:187], v[60:63]
    ds_read_b128 a[100:103], v2 offset:22528
    ds_read_b128 a[116:119], v2 offset:23552
    v_mfma_f32_16x16x32_bf16 v[64:67], a[32:35], v[188:191], v[64:67]
    ds_read_b64_tr_b16 v[180:181], v249 offset:0
    v_mfma_f32_16x16x32_bf16 v[68:71], a[36:39], v[188:191], v[68:71]
    ds_read_b64_tr_b16 v[182:183], v249 offset:2048
    v_mfma_f32_16x16x32_bf16 v[72:75], a[40:43], v[188:191], v[72:75]
    v_mfma_f32_16x16x32_bf16 v[76:79], a[44:47], v[188:191], v[76:79]
    ds_read_b128 a[104:107], v2 offset:26624
    ds_read_b128 a[120:123], v2 offset:27648
    s_waitcnt lgkmcnt(10)
    v_mfma_f32_16x16x32_bf16 v[80:83], a[32:35], v[192:195], v[80:83]
    ds_read_b64_tr_b16 v[184:185], v250 offset:0
    v_mfma_f32_16x16x32_bf16 v[84:87], a[36:39], v[192:195], v[84:87]
    ds_read_b64_tr_b16 v[186:187], v250 offset:2048
    v_mfma_f32_16x16x32_bf16 v[88:91], a[40:43], v[192:195], v[88:91]
    s_add_u32 m0, s7, 114688
    s_add_u32 s64, s10, 775296
    buffer_load_dwordx4 v252, s[44:47], s64 offen offset:0  lds
    v_mfma_f32_16x16x32_bf16 v[92:95], a[44:47], v[192:195], v[92:95]
    ds_read_b128 a[108:111], v2 offset:30720
    ds_read_b128 a[124:127], v2 offset:31744
    v_mfma_f32_16x16x32_bf16 v[96:99], a[32:35], v[196:199], v[96:99]
    ds_read_b64_tr_b16 v[188:189], v251 offset:0
    v_mfma_f32_16x16x32_bf16 v[100:103], a[36:39], v[196:199], v[100:103]
    ds_read_b64_tr_b16 v[190:191], v251 offset:2048
    v_mfma_f32_16x16x32_bf16 v[104:107], a[40:43], v[196:199], v[104:107]
    buffer_load_dwordx4 v253, s[44:47], s64 offen offset:1024  lds
    v_mfma_f32_16x16x32_bf16 v[108:111], a[44:47], v[196:199], v[108:111]
    ds_read_b128 a[128:131], v2 offset:32768
    ds_read_b128 a[144:147], v2 offset:33792
    s_waitcnt lgkmcnt(10)
    v_mfma_f32_16x16x32_bf16 v[48:51], a[48:51], v[176:179], v[48:51]
    s_waitcnt vmcnt(10)
    ds_read_b64_tr_b16 v[192:193], v248 offset:16384
    v_mfma_f32_16x16x32_bf16 v[52:55], a[52:55], v[176:179], v[52:55]
    ds_read_b64_tr_b16 v[194:195], v248 offset:18432
    v_mfma_f32_16x16x32_bf16 v[56:59], a[56:59], v[176:179], v[56:59]
    buffer_load_dwordx4 v254, s[44:47], s64 offen offset:2048  lds
    v_mfma_f32_16x16x32_bf16 v[60:63], a[60:63], v[176:179], v[60:63]
    buffer_load_dwordx4 v255, s[44:47], s64 offen offset:3072  lds
    ds_read_b128 a[132:135], v2 offset:36864
    ds_read_b128 a[148:151], v2 offset:37888
    v_mfma_f32_16x16x32_bf16 v[64:67], a[48:51], v[180:183], v[64:67]
    ds_read_b64_tr_b16 v[196:197], v249 offset:16384
    v_mfma_f32_16x16x32_bf16 v[68:71], a[52:55], v[180:183], v[68:71]
    ds_read_b64_tr_b16 v[198:199], v249 offset:18432
    v_mfma_f32_16x16x32_bf16 v[72:75], a[56:59], v[180:183], v[72:75]
    v_mfma_f32_16x16x32_bf16 v[76:79], a[60:63], v[180:183], v[76:79]
    ds_read_b128 a[136:139], v2 offset:40960
    ds_read_b128 a[152:155], v2 offset:41984
    s_waitcnt lgkmcnt(10)
    v_mfma_f32_16x16x32_bf16 v[80:83], a[48:51], v[184:187], v[80:83]
    ds_read_b64_tr_b16 v[176:177], v250 offset:16384
    v_mfma_f32_16x16x32_bf16 v[84:87], a[52:55], v[184:187], v[84:87]
    ds_read_b64_tr_b16 v[178:179], v250 offset:18432
    v_mfma_f32_16x16x32_bf16 v[88:91], a[56:59], v[184:187], v[88:91]
    s_add_u32 m0, s7, 131072
    s_add_u32 s64, s10, 885888
    buffer_load_dwordx4 v252, s[44:47], s64 offen offset:0  lds
    v_mfma_f32_16x16x32_bf16 v[92:95], a[60:63], v[184:187], v[92:95]
    ds_read_b128 a[140:143], v2 offset:45056
    ds_read_b128 a[156:159], v2 offset:46080
    v_mfma_f32_16x16x32_bf16 v[96:99], a[48:51], v[188:191], v[96:99]
    ds_read_b64_tr_b16 v[180:181], v251 offset:16384
    v_mfma_f32_16x16x32_bf16 v[100:103], a[52:55], v[188:191], v[100:103]
    ds_read_b64_tr_b16 v[182:183], v251 offset:18432
    v_mfma_f32_16x16x32_bf16 v[104:107], a[56:59], v[188:191], v[104:107]
    buffer_load_dwordx4 v253, s[44:47], s64 offen offset:1024  lds
    v_mfma_f32_16x16x32_bf16 v[108:111], a[60:63], v[188:191], v[108:111]
    ds_read_b128 a[160:163], v2 offset:34816
    ds_read_b128 a[176:179], v2 offset:35840
    s_and_b32 s72, s4, 3
    s_cmp_lg_u32 s72, 0
    s_cbranch_scc1 L_pf6
    s_lshr_b32 s72, s4, 2
    s_lshl_b32 s73, s3, 6
    s_cmp_ge_u32 s73, 216
    s_cbranch_scc1 L_pf6
    s_mul_i32 s72, s72, 248832
    s_add_u32 s72, s72, s83
    s_add_u32 s72, s72, 2428
    v_add_u32 v214, s73, v1
    v_min_u32 v214, 215, v214
    v_mul_u32_u24 v215, 21846, v214
    v_lshrrev_b32 v215, 16, v215
    v_lshlrev_b32 v214, 8, v214
    v_mul_u32_u24 v215, 2688, v215
    v_add_u32 v214, v214, v215
    buffer_load_dwordx2 v[214:215], v214, s[44:47], s72 offen
L_pf6:
    s_waitcnt lgkmcnt(10)
    v_mfma_f32_16x16x32_bf16 v[48:51], a[64:67], v[192:195], v[48:51]
    s_waitcnt vmcnt(10)
    ds_read_b64_tr_b16 v[184:185], v244 offset:16384
    v_mfma_f32_16x16x32_bf16 v[52:55], a[68:71], v[192:195], v[52:55]
    ds_read_b64_tr_b16 v[186:187], v244 offset:18432
    v_mfma_f32_16x16x32_bf16 v[56:59], a[72:75], v[192:195], v[56:59]
    buffer_load_dwordx4 v254, s[44:47], s64 offen offset:2048  lds
    v_mfma_f32_16x16x32_bf16 v[60:63], a[76:79], v[192:195], v[60:63]
    ds_read_b128 a[164:167], v2 offset:38912
    ds_read_b128 a[180:183], v2 offset:39936
    v_mfma_f32_16x16x32_bf16 v[64:67], a[64:67], v[196:199], v[64:67]
    ds_read_b64_tr_b16 v[188:189], v245 offset:16384
    v_mfma_f32_16x16x32_bf16 v[68:71], a[68:71], v[196:199], v[68:71]
    ds_read_b64_tr_b16 v[190:191], v245 offset:18432
    v_mfma_f32_16x16x32_bf16 v[72:75], a[72:75], v[196:199], v[72:75]
    buffer_load_dwordx4 v255, s[44:47], s64 offen offset:3072  lds
    v_mfma_f32_16x16x32_bf16 v[76:79], a[76:79], v[196:199], v[76:79]
    ds_read_b128 a[168:171], v2 offset:43008
    ds_read_b128 a[184:187], v2 offset:44032
    s_waitcnt lgkmcnt(10)
    v_mfma_f32_16x16x32_bf16 v[80:83], a[64:67], v[176:179], v[80:83]
    ds_read_b64_tr_b16 v[192:193], v246 offset:16384
    v_mfma_f32_16x16x32_bf16 v[84:87], a[68:71], v[176:179], v[84:87]
    ds_read_b64_tr_b16 v[194:195], v246 offset:18432
    v_mfma_f32_16x16x32_bf16 v[88:91], a[72:75], v[176:179], v[88:91]
    s_add_u32 m0, s7, 147456
    s_add_u32 s64, s10, 996480
    buffer_load_dwordx4 v252, s[44:47], s64 offen offset:0  lds
    v_mfma_f32_16x16x32_bf16 v[92:95], a[76:79], v[176:179], v[92:95]
    buffer_load_dwordx4 v253, s[44:47], s64 offen offset:1024  lds
    ds_read_b128 a[172:175], v2 offset:47104
    ds_read_b128 a[188:191], v2 offset:48128
    v_mfma_f32_16x16x32_bf16 v[96:99], a[64:67], v[180:183], v[96:99]
    ds_read_b64_tr_b16 v[196:197], v247 offset:16384
    v_mfma_f32_16x16x32_bf16 v[100:103], a[68:71], v[180:183], v[100:103]
    ds_read_b64_tr_b16 v[198:199], v247 offset:18432
    v_mfma_f32_16x16x32_bf16 v[104:107], a[72:75], v[180:183], v[104:107]
    buffer_load_dwordx4 v254, s[44:47], s64 offen offset:2048  lds
    v_mfma_f32_16x16x32_bf16 v[108:111], a[76:79], v[180:183], v[108:111]
    ds_read_b128 a[192:195], v2 offset:49152
    ds_read_b128 a[208:211], v2 offset:50176
    s_waitcnt lgkmcnt(10)
    v_mfma_f32_16x16x32_bf16 v[48:51], a[80:83], v[184:187], v[48:51]
    s_waitcnt vmcnt(11)
    ds_read_b64_tr_b16 v[176:177], v244 offset:32768
    v_mfma_f32_16x16x32_bf16 v[52:55], a[84:87], v[184:187], v[52:55]
    ds_read_b64_tr_b16 v[178:179], v244 offset:34816
    v_mfma_f32_16x16x32_bf16 v[56:59], a[88:91], v[184:187], v[56:59]
    buffer_load_dwordx4 v255, s[44:47], s64 offen offset:3072  lds
    v_mfma_f32_16x16x32_bf16 v[60:63], a[92:95], v[184:187], v[60:63]
    ds_read_b128 a[196:199], v2 offset:53248
    ds_read_b128 a[212:215], v2 offset:54272
    v_mfma_f32_16x16x32_bf16 v[64:67], a[80:83], v[188:191], v[64:67]
    ds_read_b64_tr_b16 v[180:181], v245 offset:32768
    v_mfma_f32_16x16x32_bf16 v[68:71], a[84:87], v[188:191], v[68:71]
    ds_read_b64_tr_b16 v[182:183], v245 offset:34816
    v_mfma_f32_16x16x32_bf16 v[72:75], a[88:91], v[188:191], v[72:75]
    v_mfma_f32_16x16x32_bf16 v[76:79], a[92:95], v[188:191], v[76:79]
    ds_read_b128 a[200:203], v2 offset:57344
    ds_read_b128 a[216:219], v2 offset:58368
    s_waitcnt lgkmcnt(10)
    v_mfma_f32_16x16x32_bf16 v[80:83], a[80:83], v[192:195], v[80:83]
    ds_read_b64_tr_b16 v[184:185], v246 offset:32768
    v_mfma_f32_16x16x32_bf16 v[84:87], a[84:87], v[192:195], v[84:87]
    ds_read_b64_tr_b16 v[186:187], v246 offset:34816
    v_mfma_f32_16x16x32_bf16 v[88:91], a[88:91], v[192:195], v[88:91]
    s_add_u32 m0, s7, 81920
    s_add_u32 s64, s10, 1107072
    buffer_load_dwordx4 v252, s[44:47], s64 offen offset:0  lds
    v_mfma_f32_16x16x32_bf16 v[92:95], a[92:95], v[192:195], v[92:95]
    ds_read_b128 a[204:207], v2 offset:61440
    ds_read_b128 a[220:223], v2 offset:62464
    v_mfma_f32_16x16x32_bf16 v[96:99], a[80:83], v[196:199], v[96:99]
    ds_read_b64_tr_b16 v[188:189], v247 offset:32768
    v_mfma_f32_16x16x32_bf16 v[100:103], a[84:87], v[196:199], v[100:103]
    ds_read_b64_tr_b16 v[190:191], v247 offset:34816
    v_mfma_f32_16x16x32_bf16 v[104:107], a[88:91], v[196:199], v[104:107]
    buffer_load_dwordx4 v253, s[44:47], s64 offen offset:1024  lds
    v_mfma_f32_16x16x32_bf16 v[108:111], a[92:95], v[196:199], v[108:111]
    ds_read_b128 a[224:227], v2 offset:51200
    ds_read_b128 a[240:243], v2 offset:52224
    s_waitcnt lgkmcnt(10)
    v_mfma_f32_16x16x32_bf16 v[48:51], a[96:99], v[176:179], v[48:51]
    s_waitcnt vmcnt(10)
    ds_read_b64_tr_b16 v[192:193], v244 offset:49152
    v_mfma_f32_16x16x32_bf16 v[52:55], a[100:103], v[176:179], v[52:55]
    ds_read_b64_tr_b16 v[194:195], v244 offset:51200
    v_mfma_f32_16x16x32_bf16 v[56:59], a[104:107], v[176:179], v[56:59]
    buffer_load_dwordx4 v254, s[44:47], s64 offen offset:2048  lds
    v_mfma_f32_16x16x32_bf16 v[60:63], a[108:111], v[176:179], v[60:63]
    buffer_load_dwordx4 v255, s[44:47], s64 offen offset:3072  lds
    ds_read_b128 a[228:231], v2 offset:55296
    ds_read_b128 a[244:247], v2 offset:56320
    v_mfma_f32_16x16x32_bf16 v[64:67], a[96:99], v[180:183], v[64:67]
    ds_read_b64_tr_b16 v[196:197], v245 offset:49152
    v_mfma_f32_16x16x32_bf16 v[68:71], a[100:103], v[180:183], v[68:71]
    ds_read_b64_tr_b16 v[198:199], v245 offset:51200
    v_mfma_f32_16x16x32_bf16 v[72:75], a[104:107], v[180:183], v[72:75]
    v_mfma_f32_16x16x32_bf16 v[76:79], a[108:111], v[180:183], v[76:79]
    ds_read_b128 a[232:235], v2 offset:59392
    ds_read_b128 a[248:251], v2 offset:60416
    s_waitcnt lgkmcnt(10)
    v_mfma_f32_16x16x32_bf16 v[80:83], a[96:99], v[184:187], v[80:83]
    ds_read_b64_tr_b16 v[176:177], v246 offset:49152
    v_mfma_f32_16x16x32_bf16 v[84:87], a[100:103], v[184:187], v[84:87]
    ds_read_b64_tr_b16 v[178:179], v246 offset:51200
    v_mfma_f32_16x16x32_bf16 v[88:91], a[104:107], v[184:187], v[88:91]
    s_add_u32 m0, s7, 98304
    s_add_u32 s64, s10, 1217664
    buffer_load_dwordx4 v252, s[44:47], s64 offen offset:0  lds
    v_mfma_f32_16x16x32_bf16 v[92:95], a[108:111], v[184:187], v[92:95]
    ds_read_b128 a[236:239], v2 offset:63488
    ds_read_b128 a[252:255], v2 offset:64512
    v_mfma_f32_16x16x32_bf16 v[96:99], a[96:99], v[188:191], v[96:99]
    ds_read_b64_tr_b16 v[180:181], v247 offset:49152
    v_mfma_f32_16x16x32_bf16 v[100:103], a[100:103], v[188:191], v[100:103]
    ds_read_b64_tr_b16 v[182:183], v247 offset:51200
    v_mfma_f32_16x16x32_bf16 v[104:107], a[104:107], v[188:191], v[104:107]
    buffer_load_dwordx4 v253, s[44:47], s64 offen offset:1024  lds
    v_mfma_f32_16x16x32_bf16 v[108:111], a[108:111], v[188:191], v[108:111]
    ds_read_b128 v[16:19], v3 offset:0
    ds_read_b128 v[32:35], v3 offset:1024
    s_waitcnt lgkmcnt(10)
    v_mfma_f32_16x16x32_bf16 v[48:51], a[112:115], v[192:195], v[48:51]
    s_waitcnt vmcnt(10)
    ds_read_b64_tr_b16 v[184:185], v248 offset:0
    v_mfma_f32_16x16x32_bf16 v[52:55], a[116:119], v[192:195], v[52:55]
    ds_read_b64_tr_b16 v[186:187], v248 offset:2048
    v_mfma_f32_16x16x32_bf16 v[56:59], a[120:123], v[192:195], v[56:59]
    buffer_load_dwordx4 v254, s[44:47], s64 offen offset:2048  lds
    v_mfma_f32_16x16x32_bf16 v[60:63], a[124:127], v[192:195], v[60:63]
    ds_read_b128 v[20:23], v3 offset:4096
    ds_read_b128 v[36:39], v3 offset:5120
    v_mfma_f32_16x16x32_bf16 v[64:67], a[112:115], v[196:199], v[64:67]
    ds_read_b64_tr_b16 v[188:189], v249 offset:0
    v_mfma_f32_16x16x32_bf16 v[68:71], a[116:119], v[196:199], v[68:71]
    ds_read_b64_tr_b16 v[190:191], v249 offset:2048
    v_mfma_f32_16x16x32_bf16 v[72:75], a[120:123], v[196:199], v[72:75]
    buffer_load_dwordx4 v255, s[44:47], s64 offen offset:3072  lds
    v_mfma_f32_16x16x32_bf16 v[76:79], a[124:127], v[196:199], v[76:79]
    ds_read_b128 v[24:27], v3 offset:8192
    ds_read_b128 v[40:43], v3 offset:9216
    s_waitcnt lgkmcnt(10)
    v_mfma_f32_16x16x32_bf16 v[80:83], a[112:115], v[176:179], v[80:83]
    ds_read_b64_tr_b16 v[192:193], v250 offset:0
    v_mfma_f32_16x16x32_bf16 v[84:87], a[116:119], v[176:179], v[84:87]
    ds_read_b64_tr_b16 v[194:195], v250 offset:2048
    v_mfma_f32_16x16x32_bf16 v[88:91], a[120:123], v[176:179], v[88:91]
    s_add_u32 m0, s7, 114688
    s_add_u32 s64, s10, 1328256
    buffer_load_dwordx4 v252, s[44:47], s64 offen offset:0  lds
    v_mfma_f32_16x16x32_bf16 v[92:95], a[124:127], v[176:179], v[92:95]
    buffer_load_dwordx4 v253, s[44:47], s64 offen offset:1024  lds
    ds_read_b128 v[28:31], v3 offset:12288
    ds_read_b128 v[44:47], v3 offset:13312
    v_mfma_f32_16x16x32_bf16 v[96:99], a[112:115], v[180:183], v[96:99]
    ds_read_b64_tr_b16 v[196:197], v251 offset:0
    v_mfma_f32_16x16x32_bf16 v[100:103], a[116:119], v[180:183], v[100:103]
    ds_read_b64_tr_b16 v[198:199], v251 offset:2048
    v_mfma_f32_16x16x32_bf16 v[104:107], a[120:123], v[180:183], v[104:107]
    buffer_load_dwordx4 v254, s[44:47], s64 offen offset:2048  lds
    v_mfma_f32_16x16x32_bf16 v[108:111], a[124:127], v[180:183], v[108:111]
    s_waitcnt lgkmcnt(8)
    v_mfma_f32_16x16x32_bf16 v[48:51], a[128:131], v[184:187], v[48:51]
    s_waitcnt vmcnt(11)
    ds_read_b64_tr_b16 v[176:177], v248 offset:16384
    v_mfma_f32_16x16x32_bf16 v[52:55], a[132:135], v[184:187], v[52:55]
    ds_read_b64_tr_b16 v[178:179], v248 offset:18432
    v_mfma_f32_16x16x32_bf16 v[56:59], a[136:139], v[184:187], v[56:59]
    buffer_load_dwordx4 v255, s[44:47], s64 offen offset:3072  lds
    v_mfma_f32_16x16x32_bf16 v[60:63], a[140:143], v[184:187], v[60:63]
    v_mfma_f32_16x16x32_bf16 v[64:67], a[128:131], v[188:191], v[64:67]
    ds_read_b64_tr_b16 v[180:181], v249 offset:16384
    v_mfma_f32_16x16x32_bf16 v[68:71], a[132:135], v[188:191], v[68:71]
    ds_read_b64_tr_b16 v[182:183], v249 offset:18432
    v_mfma_f32_16x16x32_bf16 v[72:75], a[136:139], v[188:191], v[72:75]
    v_mfma_f32_16x16x32_bf16 v[76:79], a[140:143], v[188:191], v[76:79]
    s_waitcnt lgkmcnt(4)
    v_mfma_f32_16x16x32_bf16 v[80:83], a[128:131], v[192:195], v[80:83]
    ds_read_b64_tr_b16 v[184:185], v250 offset:16384
    v_mfma_f32_16x16x32_bf16 v[84:87], a[132:135], v[192:195], v[84:87]
    ds_read_b64_tr_b16 v[186:187], v250 offset:18432
    v_mfma_f32_16x16x32_bf16 v[88:91], a[136:139], v[192:195], v[88:91]
    s_add_u32 m0, s7, 131072
    s_add_u32 s64, s10, 1438848
    buffer_load_dwordx4 v252, s[44:47], s64 offen offset:0  lds
    v_mfma_f32_16x16x32_bf16 v[92:95], a[140:143], v[192:195], v[92:95]
    v_mfma_f32_16x16x32_bf16 v[96:99], a[128:131], v[196:199], v[96:99]
    ds_read_b64_tr_b16 v[188:189], v251 offset:16384
    v_mfma_f32_16x16x32_bf16 v[100:103], a[132:135], v[196:199], v[100:103]
    ds_read_b64_tr_b16 v[190:191], v251 offset:18432
    v_mfma_f32_16x16x32_bf16 v[104:107], a[136:139], v[196:199], v[104:107]
    buffer_load_dwordx4 v253, s[44:47], s64 offen offset:1024  lds
    v_mfma_f32_16x16x32_bf16 v[108:111], a[140:143], v[196:199], v[108:111]
    s_barrier
    s_waitcnt lgkmcnt(4)
    v_mfma_f32_16x16x32_bf16 v[48:51], a[144:147], v[176:179], v[48:51]
    s_waitcnt vmcnt(10)
    ds_read_b64_tr_b16 v[192:193], v244 offset:16384
    v_mfma_f32_16x16x32_bf16 v[52:55], a[148:151], v[176:179], v[52:55]
    ds_read_b64_tr_b16 v[194:195], v244 offset:18432
    v_mfma_f32_16x16x32_bf16 v[56:59], a[152:155], v[176:179], v[56:59]
    buffer_load_dwordx4 v254, s[44:47], s64 offen offset:2048  lds
    v_mfma_f32_16x16x32_bf16 v[60:63], a[156:159], v[176:179], v[60:63]
    buffer_load_dwordx4 v255, s[44:47], s64 offen offset:3072  lds
    v_mfma_f32_16x16x32_bf16 v[64:67], a[144:147], v[180:183], v[64:67]
    ds_read_b64_tr_b16 v[196:197], v245 offset:16384
    v_mfma_f32_16x16x32_bf16 v[68:71], a[148:151], v[180:183], v[68:71]
    ds_read_b64_tr_b16 v[198:199], v245 offset:18432
    v_mfma_f32_16x16x32_bf16 v[72:75], a[152:155], v[180:183], v[72:75]
    v_mfma_f32_16x16x32_bf16 v[76:79], a[156:159], v[180:183], v[76:79]
    s_waitcnt lgkmcnt(4)
    v_mfma_f32_16x16x32_bf16 v[80:83], a[144:147], v[184:187], v[80:83]
    ds_read_b64_tr_b16 v[176:177], v246 offset:16384
    v_mfma_f32_16x16x32_bf16 v[84:87], a[148:151], v[184:187], v[84:87]
    ds_read_b64_tr_b16 v[178:179], v246 offset:18432
    v_mfma_f32_16x16x32_bf16 v[88:91], a[152:155], v[184:187], v[88:91]
    s_add_u32 m0, s7, 147456
    s_add_u32 s64, s10, 1549440
    buffer_load_dwordx4 v252, s[44:47], s64 offen offset:0  lds
    v_mfma_f32_16x16x32_bf16 v[92:95], a[156:159], v[184:187], v[92:95]
    v_mfma_f32_16x16x32_bf16 v[96:99], a[144:147], v[188:191], v[96:99]
    ds_read_b64_tr_b16 v[180:181], v247 offset:16384
    v_mfma_f32_16x16x32_bf16 v[100:103], a[148:151], v[188:191], v[100:103]
    ds_read_b64_tr_b16 v[182:183], v247 offset:18432
    v_mfma_f32_16x16x32_bf16 v[104:107], a[152:155], v[188:191], v[104:107]
    buffer_load_dwordx4 v253, s[44:47], s64 offen offset:1024  lds
    v_mfma_f32_16x16x32_bf16 v[108:111], a[156:159], v[188:191], v[108:111]
    s_waitcnt lgkmcnt(4)
    v_mfma_f32_16x16x32_bf16 v[48:51], a[160:163], v[192:195], v[48:51]
    s_waitcnt vmcnt(10)
    ds_read_b64_tr_b16 v[184:185], v244 offset:32768
    v_mfma_f32_16x16x32_bf16 v[52:55], a[164:167], v[192:195], v[52:55]
    ds_read_b64_tr_b16 v[186:187], v244 offset:34816
    v_mfma_f32_16x16x32_bf16 v[56:59], a[168:171], v[192:195], v[56:59]
    buffer_load_dwordx4 v254, s[44:47], s64 offen offset:2048  lds
    v_mfma_f32_16x16x32_bf16 v[60:63], a[172:175], v[192:195], v[60:63]
    v_mfma_f32_16x16x32_bf16 v[64:67], a[160:163], v[196:199], v[64:67]
    ds_read_b64_tr_b16 v[188:189], v245 offset:32768
    v_mfma_f32_16x16x32_bf16 v[68:71], a[164:167], v[196:199], v[68:71]
    ds_read_b64_tr_b16 v[190:191], v245 offset:34816
    v_mfma_f32_16x16x32_bf16 v[72:75], a[168:171], v[196:199], v[72:75]
    buffer_load_dwordx4 v255, s[44:47], s64 offen offset:3072  lds
    v_mfma_f32_16x16x32_bf16 v[76:79], a[172:175], v[196:199], v[76:79]
    s_waitcnt lgkmcnt(4)
    v_mfma_f32_16x16x32_bf16 v[80:83], a[160:163], v[176:179], v[80:83]
    ds_read_b64_tr_b16 v[192:193], v246 offset:32768
    v_mfma_f32_16x16x32_bf16 v[84:87], a[164:167], v[176:179], v[84:87]
    ds_read_b64_tr_b16 v[194:195], v246 offset:34816
    v_mfma_f32_16x16x32_bf16 v[88:91], a[168:171], v[176:179], v[88:91]
    s_add_u32 m0, s7, 81920
    s_add_u32 s64, s10, 1660032
    buffer_load_dwordx4 v252, s[44:47], s64 offen offset:0  lds
    v_mfma_f32_16x16x32_bf16 v[92:95], a[172:175], v[176:179], v[92:95]
    buffer_load_dwordx4 v253, s[44:47], s64 offen offset:1024  lds
    v_mfma_f32_16x16x32_bf16 v[96:99], a[160:163], v[180:183], v[96:99]
    ds_read_b64_tr_b16 v[196:197], v247 offset:32768
    v_mfma_f32_16x16x32_bf16 v[100:103], a[164:167], v[180:183], v[100:103]
    ds_read_b64_tr_b16 v[198:199], v247 offset:34816
    v_mfma_f32_16x16x32_bf16 v[104:107], a[168:171], v[180:183], v[104:107]
    buffer_load_dwordx4 v254, s[44:47], s64 offen offset:2048  lds
    v_mfma_f32_16x16x32_bf16 v[108:111], a[172:175], v[180:183], v[108:111]
    s_waitcnt lgkmcnt(4)
    v_mfma_f32_16x16x32_bf16 v[48:51], a[176:179], v[184:187], v[48:51]
    s_waitcnt vmcnt(11)
    ds_read_b64_tr_b16 v[176:177], v244 offset:49152
    v_mfma_f32_16x16x32_bf16 v[52:55], a[180:183], v[184:187], v[52:55]
    ds_read_b64_tr_b16 v[178:179], v244 offset:51200
    v_mfma_f32_16x16x32_bf16 v[56:59], a[184:187], v[184:187], v[56:59]
    buffer_load_dwordx4 v255, s[44:47], s64 offen offset:3072  lds
    v_mfma_f32_16x16x32_bf16 v[60:63], a[188:191], v[184:187], v[60:63]
    v_mfma_f32_16x16x32_bf16 v[64:67], a[176:179], v[188:191], v[64:67]
    ds_read_b64_tr_b16 v[180:181], v245 offset:49152
    v_mfma_f32_16x16x32_bf16 v[68:71], a[180:183], v[188:191], v[68:71]
    ds_read_b64_tr_b16 v[182:183], v245 offset:51200
    v_mfma_f32_16x16x32_bf16 v[72:75], a[184:187], v[188:191], v[72:75]
    v_mfma_f32_16x16x32_bf16 v[76:79], a[188:191], v[188:191], v[76:79]
    s_waitcnt lgkmcnt(4)
    v_mfma_f32_16x16x32_bf16 v[80:83], a[176:179], v[192:195], v[80:83]
    ds_read_b64_tr_b16 v[184:185], v246 offset:49152
    v_mfma_f32_16x16x32_bf16 v[84:87], a[180:183], v[192:195], v[84:87]
    ds_read_b64_tr_b16 v[186:187], v246 offset:51200
    v_mfma_f32_16x16x32_bf16 v[88:91], a[184:187], v[192:195], v[88:91]
    s_add_u32 m0, s7, 98304
    s_add_u32 s64, s10, 1770624
    buffer_load_dwordx4 v252, s[44:47], s64 offen offset:0  lds
    v_mfma_f32_16x16x32_bf16 v[92:95], a[188:191], v[192:195], v[92:95]
    v_mfma_f32_16x16x32_bf16 v[96:99], a[176:179], v[196:199], v[96:99]
    ds_read_b64_tr_b16 v[188:189], v247 offset:49152
    v_mfma_f32_16x16x32_bf16 v[100:103], a[180:183], v[196:199], v[100:103]
    ds_read_b64_tr_b16 v[190:191], v247 offset:51200
    v_mfma_f32_16x16x32_bf16 v[104:107], a[184:187], v[196:199], v[104:107]
    buffer_load_dwordx4 v253, s[44:47], s64 offen offset:1024  lds
    v_mfma_f32_16x16x32_bf16 v[108:111], a[188:191], v[196:199], v[108:111]
    s_lshl_b32 s9, s3, 2
    s_lshl_b32 s15, s6, 1
    s_add_u32 s9, s9, s15
    s_lshl_b32 s9, s9, 11
    v_add_u32 v4, s9, v2
    s_xor_b32 s9, s6, 1
    s_lshl_b32 s9, s9, 15
    s_cmp_eq_u32 s3, 1
    s_cselect_b32 s15, 36864, 0
    s_add_u32 s9, s9, s15
    v_add_u32 v5, s9, v2
    v_lshrrev_b32 v216, 2, v1
    v_lshlrev_b32 v216, 6, v216
    v_bfe_u32 v217, v1, 4, 1
    v_lshl_add_u32 v216, v217, 5, v216
    v_and_b32 v217, 3, v1
    v_lshl_add_u32 v216, v217, 3, v216
    v_add_u32 v6, s7, v216
    v_xor_b32 v7, 32, v6
    v_add_u32 v8, 0x10000, v6
    v_add_u32 v9, 0x10000, v7
    v_add_u32 v10, 0x20000, v6
    v_add_u32 v11, 0x20000, v7
    s_waitcnt lgkmcnt(4)
    v_mfma_f32_16x16x32_bf16 v[48:51], a[192:195], v[176:179], v[48:51]
    s_waitcnt vmcnt(10)
    ds_read_b64_tr_b16 v[192:193], v248 offset:0
    v_mfma_f32_16x16x32_bf16 v[52:55], a[196:199], v[176:179], v[52:55]
    ds_read_b64_tr_b16 v[194:195], v248 offset:2048
    v_mfma_f32_16x16x32_bf16 v[56:59], a[200:203], v[176:179], v[56:59]
    buffer_load_dwordx4 v254, s[44:47], s64 offen offset:2048  lds
    v_mfma_f32_16x16x32_bf16 v[60:63], a[204:207], v[176:179], v[60:63]
    buffer_load_dwordx4 v255, s[44:47], s64 offen offset:3072  lds
    v_mfma_f32_16x16x32_bf16 v[64:67], a[192:195], v[180:183], v[64:67]
    ds_read_b64_tr_b16 v[196:197], v249 offset:0
    v_mfma_f32_16x16x32_bf16 v[68:71], a[196:199], v[180:183], v[68:71]
    ds_read_b64_tr_b16 v[198:199], v249 offset:2048
    v_mfma_f32_16x16x32_bf16 v[72:75], a[200:203], v[180:183], v[72:75]
    v_mfma_f32_16x16x32_bf16 v[76:79], a[204:207], v[180:183], v[76:79]
    s_waitcnt lgkmcnt(4)
    v_mfma_f32_16x16x32_bf16 v[80:83], a[192:195], v[184:187], v[80:83]
    ds_read_b64_tr_b16 v[176:177], v250 offset:0
    v_mfma_f32_16x16x32_bf16 v[84:87], a[196:199], v[184:187], v[84:87]
    ds_read_b64_tr_b16 v[178:179], v250 offset:2048
    v_mfma_f32_16x16x32_bf16 v[88:91], a[200:203], v[184:187], v[88:91]
    s_add_u32 m0, s7, 114688
    s_add_u32 s64, s10, 1881216
    buffer_load_dwordx4 v252, s[44:47], s64 offen offset:0  lds
    v_mfma_f32_16x16x32_bf16 v[92:95], a[204:207], v[184:187], v[92:95]
    v_mfma_f32_16x16x32_bf16 v[96:99], a[192:195], v[188:191], v[96:99]
    ds_read_b64_tr_b16 v[180:181], v251 offset:0
    v_mfma_f32_16x16x32_bf16 v[100:103], a[196:199], v[188:191], v[100:103]
    ds_read_b64_tr_b16 v[182:183], v251 offset:2048
    v_mfma_f32_16x16x32_bf16 v[104:107], a[200:203], v[188:191], v[104:107]
    buffer_load_dwordx4 v253, s[44:47], s64 offen offset:1024  lds
    v_mfma_f32_16x16x32_bf16 v[108:111], a[204:207], v[188:191], v[108:111]
    s_waitcnt lgkmcnt(4)
    v_mfma_f32_16x16x32_bf16 v[48:51], a[208:211], v[192:195], v[48:51]
    s_waitcnt vmcnt(10)
    ds_read_b64_tr_b16 v[184:185], v248 offset:16384
    v_mfma_f32_16x16x32_bf16 v[52:55], a[212:215], v[192:195], v[52:55]
    ds_read_b64_tr_b16 v[186:187], v248 offset:18432
    v_mfma_f32_16x16x32_bf16 v[56:59], a[216:219], v[192:195], v[56:59]
    buffer_load_dwordx4 v254, s[44:47], s64 offen offset:2048  lds
    v_mfma_f32_16x16x32_bf16 v[60:63], a[220:223], v[192:195], v[60:63]
    v_mfma_f32_16x16x32_bf16 v[64:67], a[208:211], v[196:199], v[64:67]
    ds_read_b64_tr_b16 v[188:189], v249 offset:16384
    v_mfma_f32_16x16x32_bf16 v[68:71], a[212:215], v[196:199], v[68:71]
    ds_read_b64_tr_b16 v[190:191], v249 offset:18432
    v_mfma_f32_16x16x32_bf16 v[72:75], a[216:219], v[196:199], v[72:75]
    buffer_load_dwordx4 v255, s[44:47], s64 offen offset:3072  lds
    v_mfma_f32_16x16x32_bf16 v[76:79], a[220:223], v[196:199], v[76:79]
    s_waitcnt lgkmcnt(4)
    v_mfma_f32_16x16x32_bf16 v[80:83], a[208:211], v[176:179], v[80:83]
    ds_read_b64_tr_b16 v[192:193], v250 offset:16384
    v_mfma_f32_16x16x32_bf16 v[84:87], a[212:215], v[176:179], v[84:87]
    ds_read_b64_tr_b16 v[194:195], v250 offset:18432
    v_mfma_f32_16x16x32_bf16 v[88:91], a[216:219], v[176:179], v[88:91]
    s_add_u32 m0, s7, 131072
    s_add_u32 s64, s10, 2304
    buffer_load_dwordx4 v252, s[44:47], s64 offen offset:0  lds
    v_mfma_f32_16x16x32_bf16 v[92:95], a[220:223], v[176:179], v[92:95]
    buffer_load_dwordx4 v253, s[44:47], s64 offen offset:1024  lds
    v_mfma_f32_16x16x32_bf16 v[96:99], a[208:211], v[180:183], v[96:99]
    ds_read_b64_tr_b16 v[196:197], v251 offset:16384
    v_mfma_f32_16x16x32_bf16 v[100:103], a[212:215], v[180:183], v[100:103]
    ds_read_b64_tr_b16 v[198:199], v251 offset:18432
    v_mfma_f32_16x16x32_bf16 v[104:107], a[216:219], v[180:183], v[104:107]
    buffer_load_dwordx4 v254, s[44:47], s64 offen offset:2048  lds
    v_mfma_f32_16x16x32_bf16 v[108:111], a[220:223], v[180:183], v[108:111]
    s_and_b32 s72, s4, 3
    s_cmp_lg_u32 s72, 1
    s_cbranch_scc1 L_pf7
    s_lshr_b32 s72, s4, 2
    s_lshl_b32 s73, s3, 6
    s_cmp_ge_u32 s73, 216
    s_cbranch_scc1 L_pf7
    s_mul_i32 s72, s72, 248832
    s_add_u32 s72, s72, s83
    s_add_u32 s72, s72, 124
    v_add_u32 v214, s73, v1
    v_min_u32 v214, 215, v214
    v_mul_u32_u24 v215, 21846, v214
    v_lshrrev_b32 v215, 16, v215
    v_lshlrev_b32 v214, 8, v214
    v_mul_u32_u24 v215, 2688, v215
    v_add_u32 v214, v214, v215
    buffer_load_dwordx2 v[214:215], v214, s[44:47], s72 offen
L_pf7:
    s_waitcnt lgkmcnt(4)
    v_mfma_f32_16x16x32_bf16 v[48:51], a[224:227], v[184:187], v[48:51]
    s_waitcnt vmcnt(11)
    ds_read_b64_tr_b16 v[176:177], v244 offset:16384
    v_mfma_f32_16x16x32_bf16 v[52:55], a[228:231], v[184:187], v[52:55]
    ds_read_b64_tr_b16 v[178:179], v244 offset:18432
    v_mfma_f32_16x16x32_bf16 v[56:59], a[232:235], v[184:187], v[56:59]
    buffer_load_dwordx4 v255, s[44:47], s64 offen offset:3072  lds
    v_mfma_f32_16x16x32_bf16 v[60:63], a[236:239], v[184:187], v[60:63]
    v_mfma_f32_16x16x32_bf16 v[64:67], a[224:227], v[188:191], v[64:67]
    ds_read_b64_tr_b16 v[180:181], v245 offset:16384
    v_mfma_f32_16x16x32_bf16 v[68:71], a[228:231], v[188:191], v[68:71]
    ds_read_b64_tr_b16 v[182:183], v245 offset:18432
    v_mfma_f32_16x16x32_bf16 v[72:75], a[232:235], v[188:191], v[72:75]
    v_mfma_f32_16x16x32_bf16 v[76:79], a[236:239], v[188:191], v[76:79]
    s_waitcnt lgkmcnt(4)
    v_mfma_f32_16x16x32_bf16 v[80:83], a[224:227], v[192:195], v[80:83]
    ds_read_b64_tr_b16 v[184:185], v246 offset:16384
    v_mfma_f32_16x16x32_bf16 v[84:87], a[228:231], v[192:195], v[84:87]
    ds_read_b64_tr_b16 v[186:187], v246 offset:18432
    v_mfma_f32_16x16x32_bf16 v[88:91], a[232:235], v[192:195], v[88:91]
    s_add_u32 m0, s7, 147456
    s_add_u32 s64, s10, 112896
    buffer_load_dwordx4 v252, s[44:47], s64 offen offset:0  lds
    v_mfma_f32_16x16x32_bf16 v[92:95], a[236:239], v[192:195], v[92:95]
    v_mfma_f32_16x16x32_bf16 v[96:99], a[224:227], v[196:199], v[96:99]
    ds_read_b64_tr_b16 v[188:189], v247 offset:16384
    v_mfma_f32_16x16x32_bf16 v[100:103], a[228:231], v[196:199], v[100:103]
    ds_read_b64_tr_b16 v[190:191], v247 offset:18432
    v_mfma_f32_16x16x32_bf16 v[104:107], a[232:235], v[196:199], v[104:107]
    buffer_load_dwordx4 v253, s[44:47], s64 offen offset:1024  lds
    v_mfma_f32_16x16x32_bf16 v[108:111], a[236:239], v[196:199], v[108:111]
    s_waitcnt lgkmcnt(4)
    v_mfma_f32_16x16x32_bf16 v[48:51], a[240:243], v[176:179], v[48:51]
    s_waitcnt vmcnt(10)
    ds_read_b64_tr_b16 v[192:193], v244 offset:32768
    v_mfma_f32_16x16x32_bf16 v[52:55], a[244:247], v[176:179], v[52:55]
    ds_read_b64_tr_b16 v[194:195], v244 offset:34816
    v_mfma_f32_16x16x32_bf16 v[56:59], a[248:251], v[176:179], v[56:59]
    buffer_load_dwordx4 v254, s[44:47], s64 offen offset:2048  lds
    v_mfma_f32_16x16x32_bf16 v[60:63], a[252:255], v[176:179], v[60:63]
    buffer_load_dwordx4 v255, s[44:47], s64 offen offset:3072  lds
    v_mfma_f32_16x16x32_bf16 v[64:67], a[240:243], v[180:183], v[64:67]
    ds_read_b64_tr_b16 v[196:197], v245 offset:32768
    v_mfma_f32_16x16x32_bf16 v[68:71], a[244:247], v[180:183], v[68:71]
    ds_read_b64_tr_b16 v[198:199], v245 offset:34816
    v_mfma_f32_16x16x32_bf16 v[72:75], a[248:251], v[180:183], v[72:75]
    v_mfma_f32_16x16x32_bf16 v[76:79], a[252:255], v[180:183], v[76:79]
    s_waitcnt lgkmcnt(4)
    v_mfma_f32_16x16x32_bf16 v[80:83], a[240:243], v[184:187], v[80:83]
    ds_read_b64_tr_b16 v[176:177], v246 offset:32768
    v_mfma_f32_16x16x32_bf16 v[84:87], a[244:247], v[184:187], v[84:87]
    ds_read_b64_tr_b16 v[178:179], v246 offset:34816
    v_mfma_f32_16x16x32_bf16 v[88:91], a[248:251], v[184:187], v[88:91]
    s_add_u32 m0, s7, 81920
    s_add_u32 s64, s10, 223488
    buffer_load_dwordx4 v252, s[44:47], s64 offen offset:0  lds
    v_mfma_f32_16x16x32_bf16 v[92:95], a[252:255], v[184:187], v[92:95]
    v_mfma_f32_16x16x32_bf16 v[96:99], a[240:243], v[188:191], v[96:99]
    ds_read_b64_tr_b16 v[180:181], v247 offset:32768
    v_mfma_f32_16x16x32_bf16 v[100:103], a[244:247], v[188:191], v[100:103]
    ds_read_b64_tr_b16 v[182:183], v247 offset:34816
    v_mfma_f32_16x16x32_bf16 v[104:107], a[248:251], v[188:191], v[104:107]
    buffer_load_dwordx4 v253, s[44:47], s64 offen offset:1024  lds
    v_mfma_f32_16x16x32_bf16 v[108:111], a[252:255], v[188:191], v[108:111]
    s_waitcnt lgkmcnt(4)
    v_mfma_f32_16x16x32_bf16 v[48:51], v[16:19], v[192:195], v[48:51]
    s_waitcnt vmcnt(10)
    ds_read_b64_tr_b16 v[184:185], v244 offset:49152
    v_mfma_f32_16x16x32_bf16 v[52:55], v[20:23], v[192:195], v[52:55]
    ds_read_b64_tr_b16 v[186:187], v244 offset:51200
    v_mfma_f32_16x16x32_bf16 v[56:59], v[24:27], v[192:195], v[56:59]
    buffer_load_dwordx4 v254, s[44:47], s64 offen offset:2048  lds
    v_mfma_f32_16x16x32_bf16 v[60:63], v[28:31], v[192:195], v[60:63]
    v_mfma_f32_16x16x32_bf16 v[64:67], v[16:19], v[196:199], v[64:67]
    ds_read_b64_tr_b16 v[188:189], v245 offset:49152
    v_mfma_f32_16x16x32_bf16 v[68:71], v[20:23], v[196:199], v[68:71]
    ds_read_b64_tr_b16 v[190:191], v245 offset:51200
    v_mfma_f32_16x16x32_bf16 v[72:75], v[24:27], v[196:199], v[72:75]
    buffer_load_dwordx4 v255, s[44:47], s64 offen offset:3072  lds
    v_mfma_f32_16x16x32_bf16 v[76:79], v[28:31], v[196:199], v[76:79]
    s_waitcnt lgkmcnt(4)
    v_mfma_f32_16x16x32_bf16 v[80:83], v[16:19], v[176:179], v[80:83]
    ds_read_b64_tr_b16 v[192:193], v246 offset:49152
    v_mfma_f32_16x16x32_bf16 v[84:87], v[20:23], v[176:179], v[84:87]
    ds_read_b64_tr_b16 v[194:195], v246 offset:51200
    v_mfma_f32_16x16x32_bf16 v[88:91], v[24:27], v[176:179], v[88:91]
    s_add_u32 m0, s7, 98304
    s_add_u32 s64, s10, 334080
    buffer_load_dwordx4 v252, s[44:47], s64 offen offset:0  lds
    v_mfma_f32_16x16x32_bf16 v[92:95], v[28:31], v[176:179], v[92:95]
    buffer_load_dwordx4 v253, s[44:47], s64 offen offset:1024  lds
    v_mfma_f32_16x16x32_bf16 v[96:99], v[16:19], v[180:183], v[96:99]
    ds_read_b64_tr_b16 v[196:197], v247 offset:49152
    v_mfma_f32_16x16x32_bf16 v[100:103], v[20:23], v[180:183], v[100:103]
    ds_read_b64_tr_b16 v[198:199], v247 offset:51200
    v_mfma_f32_16x16x32_bf16 v[104:107], v[24:27], v[180:183], v[104:107]
    buffer_load_dwordx4 v254, s[44:47], s64 offen offset:2048  lds
    v_mfma_f32_16x16x32_bf16 v[108:111], v[28:31], v[180:183], v[108:111]
    s_waitcnt lgkmcnt(4)
    v_mfma_f32_16x16x32_bf16 v[48:51], v[32:35], v[184:187], v[48:51]
    s_waitcnt vmcnt(11)
    ds_read_b64_tr_b16 v[176:177], v248 offset:0
    v_mfma_f32_16x16x32_bf16 v[52:55], v[36:39], v[184:187], v[52:55]
    ds_read_b64_tr_b16 v[178:179], v248 offset:2048
    v_mfma_f32_16x16x32_bf16 v[56:59], v[40:43], v[184:187], v[56:59]
    buffer_load_dwordx4 v255, s[44:47], s64 offen offset:3072  lds
    v_mfma_f32_16x16x32_bf16 v[60:63], v[44:47], v[184:187], v[60:63]
    v_mfma_f32_16x16x32_bf16 v[64:67], v[32:35], v[188:191], v[64:67]
    ds_read_b64_tr_b16 v[180:181], v249 offset:0
    v_mfma_f32_16x16x32_bf16 v[68:71], v[36:39], v[188:191], v[68:71]
    ds_read_b64_tr_b16 v[182:183], v249 offset:2048
    v_mfma_f32_16x16x32_bf16 v[72:75], v[40:43], v[188:191], v[72:75]
    v_mfma_f32_16x16x32_bf16 v[76:79], v[44:47], v[188:191], v[76:79]
    s_waitcnt lgkmcnt(4)
    v_mfma_f32_16x16x32_bf16 v[80:83], v[32:35], v[192:195], v[80:83]
    ds_read_b64_tr_b16 v[184:185], v250 offset:0
    v_mfma_f32_16x16x32_bf16 v[84:87], v[36:39], v[192:195], v[84:87]
    ds_read_b64_tr_b16 v[186:187], v250 offset:2048
    v_mfma_f32_16x16x32_bf16 v[88:91], v[40:43], v[192:195], v[88:91]
    s_add_u32 m0, s7, 114688
    s_add_u32 s64, s10, 444672
    buffer_load_dwordx4 v252, s[44:47], s64 offen offset:0  lds
    v_mfma_f32_16x16x32_bf16 v[92:95], v[44:47], v[192:195], v[92:95]
    v_mfma_f32_16x16x32_bf16 v[96:99], v[32:35], v[196:199], v[96:99]
    ds_read_b64_tr_b16 v[188:189], v251 offset:0
    v_mfma_f32_16x16x32_bf16 v[100:103], v[36:39], v[196:199], v[100:103]
    ds_read_b64_tr_b16 v[190:191], v251 offset:2048
    v_mfma_f32_16x16x32_bf16 v[104:107], v[40:43], v[196:199], v[104:107]
    buffer_load_dwordx4 v253, s[44:47], s64 offen offset:1024  lds
    v_mfma_f32_16x16x32_bf16 v[108:111], v[44:47], v[196:199], v[108:111]
    s_waitcnt lgkmcnt(4)
    v_mfma_f32_16x16x32_bf16 v[112:115], a[0:3], v[176:179], 0
    s_waitcnt vmcnt(10)
    ds_read_b64_tr_b16 v[192:193], v248 offset:16384
    v_mfma_f32_16x16x32_bf16 v[116:119], a[4:7], v[176:179], 0
    ds_read_b64_tr_b16 v[194:195], v248 offset:18432
    v_mfma_f32_16x16x32_bf16 v[120:123], a[8:11], v[176:179], 0
    buffer_load_dwordx4 v254, s[44:47], s64 offen offset:2048  lds
    v_mfma_f32_16x16x32_bf16 v[124:127], a[12:15], v[176:179], 0
    buffer_load_dwordx4 v255, s[44:47], s64 offen offset:3072  lds
    v_mfma_f32_16x16x32_bf16 v[128:131], a[0:3], v[180:183], 0
    ds_read_b64_tr_b16 v[196:197], v249 offset:16384
    v_mfma_f32_16x16x32_bf16 v[132:135], a[4:7], v[180:183], 0
    ds_read_b64_tr_b16 v[198:199], v249 offset:18432
    v_mul_f32 v200, 0x3fb8aa3b, v48
    v_mfma_f32_16x16x32_bf16 v[136:139], a[8:11], v[180:183], 0
    v_exp_f32_e64 v200, v200 clamp
    v_mfma_f32_16x16x32_bf16 v[140:143], a[12:15], v[180:183], 0
    v_mul_f32 v201, 0x3fb8aa3b, v49
    s_waitcnt lgkmcnt(4)
    v_mfma_f32_16x16x32_bf16 v[144:147], a[0:3], v[184:187], 0
    ds_read_b64_tr_b16 v[176:177], v250 offset:16384
    v_max_f32 v48, s68, v48
    v_mfma_f32_16x16x32_bf16 v[148:151], a[4:7], v[184:187], 0
    ds_read_b64_tr_b16 v[178:179], v250 offset:18432
    v_exp_f32_e64 v201, v201 clamp
    v_mul_f32 v202, 0x3fb8aa3b, v50
    v_mfma_f32_16x16x32_bf16 v[152:155], a[8:11], v[184:187], 0
    s_add_u32 m0, s7, 131072
    s_add_u32 s64, s10, 555264
    buffer_load_dwordx4 v252, s[44:47], s64 offen offset:0  lds
    v_add_f32 v48, v48, v200
    v_mfma_f32_16x16x32_bf16 v[156:159], a[12:15], v[184:187], 0
    v_max_f32 v49, s68, v49
    v_mfma_f32_16x16x32_bf16 v[160:163], a[0:3], v[188:191], 0
    ds_read_b64_tr_b16 v[180:181], v251 offset:16384
    v_exp_f32_e64 v202, v202 clamp
    v_mfma_f32_16x16x32_bf16 v[164:167], a[4:7], v[188:191], 0
    ds_read_b64_tr_b16 v[182:183], v251 offset:18432
    v_mul_f32 v203, 0x3fb8aa3b, v51
    v_mfma_f32_16x16x32_bf16 v[168:171], a[8:11], v[188:191], 0
    buffer_load_dwordx4 v253, s[44:47], s64 offen offset:1024  lds
    v_add_f32 v49, v49, v201
    v_max_f32 v50, s68, v50
    v_mfma_f32_16x16x32_bf16 v[172:175], a[12:15], v[188:191], 0
    v_exp_f32_e64 v203, v203 clamp
    s_waitcnt lgkmcnt(4)
    v_mfma_f32_16x16x32_bf16 v[112:115], a[16:19], v[192:195], v[112:115]
    s_waitcnt vmcnt(10)
    ds_read_b64_tr_b16 v[184:185], v244 offset:16384
    v_mul_f32 v204, 0x3fb8aa3b, v52
    v_mfma_f32_16x16x32_bf16 v[116:119], a[20:23], v[192:195], v[116:119]
    ds_read_b64_tr_b16 v[186:187], v244 offset:18432
    v_cvt_pk_bf16_f32 v48, v48, v49
    v_mfma_f32_16x16x32_bf16 v[120:123], a[24:27], v[192:195], v[120:123]
    buffer_load_dwordx4 v254, s[44:47], s64 offen offset:2048  lds
    v_add_f32 v50, v50, v202
    v_mfma_f32_16x16x32_bf16 v[124:127], a[28:31], v[192:195], v[124:127]
    v_max_f32 v51, s68, v51
    v_exp_f32_e64 v204, v204 clamp
    v_mfma_f32_16x16x32_bf16 v[128:131], a[16:19], v[196:199], v[128:131]
    ds_read_b64_tr_b16 v[188:189], v245 offset:16384
    v_mul_f32 v205, 0x3fb8aa3b, v53
    v_mfma_f32_16x16x32_bf16 v[132:135], a[20:23], v[196:199], v[132:135]
    ds_read_b64_tr_b16 v[190:191], v245 offset:18432
    v_add_f32 v51, v51, v203
    v_mfma_f32_16x16x32_bf16 v[136:139], a[24:27], v[196:199], v[136:139]
    buffer_load_dwordx4 v255, s[44:47], s64 offen offset:3072  lds
    v_max_f32 v52, s68, v52
    v_mfma_f32_16x16x32_bf16 v[140:143], a[28:31], v[196:199], v[140:143]
    v_exp_f32_e64 v205, v205 clamp
    s_waitcnt lgkmcnt(4)
    v_mfma_f32_16x16x32_bf16 v[144:147], a[16:19], v[176:179], v[144:147]
    ds_read_b64_tr_b16 v[192:193], v246 offset:16384
    v_mul_f32 v206, 0x3fb8aa3b, v54
    v_cvt_pk_bf16_f32 v49, v50, v51
    v_mfma_f32_16x16x32_bf16 v[148:151], a[20:23], v[176:179], v[148:151]
    ds_read_b64_tr_b16 v[194:195], v246 offset:18432
    v_add_f32 v52, v52, v204
    v_mfma_f32_16x16x32_bf16 v[152:155], a[24:27], v[176:179], v[152:155]
    s_add_u32 m0, s7, 147456
    s_add_u32 s64, s10, 665856
    buffer_load_dwordx4 v252, s[44:47], s64 offen offset:0  lds
    v_max_f32 v53, s68, v53
    v_mfma_f32_16x16x32_bf16 v[156:159], a[28:31], v[176:179], v[156:159]
    buffer_load_dwordx4 v253, s[44:47], s64 offen offset:1024  lds
    v_exp_f32_e64 v206, v206 clamp
    v_mfma_f32_16x16x32_bf16 v[160:163], a[16:19], v[180:183], v[160:163]
    ds_read_b64_tr_b16 v[196:197], v247 offset:16384
    v_mul_f32 v207, 0x3fb8aa3b, v55
    v_add_f32 v53, v53, v205
    v_mfma_f32_16x16x32_bf16 v[164:167], a[20:23], v[180:183], v[164:167]
    ds_read_b64_tr_b16 v[198:199], v247 offset:18432
    v_max_f32 v54, s68, v54
    v_mfma_f32_16x16x32_bf16 v[168:171], a[24:27], v[180:183], v[168:171]
    buffer_load_dwordx4 v254, s[44:47], s64 offen offset:2048  lds
    v_exp_f32_e64 v207, v207 clamp
    v_mfma_f32_16x16x32_bf16 v[172:175], a[28:31], v[180:183], v[172:175]
    v_mul_f32 v200, 0x3fb8aa3b, v56
    s_waitcnt lgkmcnt(4)
    v_mfma_f32_16x16x32_bf16 v[112:115], a[32:35], v[184:187], v[112:115]
    s_waitcnt vmcnt(11)
    ds_read_b64_tr_b16 v[176:177], v244 offset:32768
    v_cvt_pk_bf16_f32 v50, v52, v53
    v_mfma_f32_16x16x32_bf16 v[116:119], a[36:39], v[184:187], v[116:119]
    ds_read_b64_tr_b16 v[178:179], v244 offset:34816
    v_add_f32 v54, v54, v206
    v_max_f32 v55, s68, v55
    v_mfma_f32_16x16x32_bf16 v[120:123], a[40:43], v[184:187], v[120:123]
    buffer_load_dwordx4 v255, s[44:47], s64 offen offset:3072  lds
    v_exp_f32_e64 v200, v200 clamp
    v_mfma_f32_16x16x32_bf16 v[124:127], a[44:47], v[184:187], v[124:127]
    v_mul_f32 v201, 0x3fb8aa3b, v57
    v_mfma_f32_16x16x32_bf16 v[128:131], a[32:35], v[188:191], v[128:131]
    ds_read_b64_tr_b16 v[180:181], v245 offset:32768
    v_add_f32 v55, v55, v207
    v_mfma_f32_16x16x32_bf16 v[132:135], a[36:39], v[188:191], v[132:135]
    ds_read_b64_tr_b16 v[182:183], v245 offset:34816
    v_max_f32 v56, s68, v56
    v_mfma_f32_16x16x32_bf16 v[136:139], a[40:43], v[188:191], v[136:139]
    v_exp_f32_e64 v201, v201 clamp
    v_mul_f32 v202, 0x3fb8aa3b, v58
    v_mfma_f32_16x16x32_bf16 v[140:143], a[44:47], v[188:191], v[140:143]
    v_cvt_pk_bf16_f32 v51, v54, v55
    s_waitcnt lgkmcnt(4)
    v_mfma_f32_16x16x32_bf16 v[144:147], a[32:35], v[192:195], v[144:147]
    ds_read_b64_tr_b16 v[184:185], v246 offset:32768
    v_add_f32 v56, v56, v200
    v_mfma_f32_16x16x32_bf16 v[148:151], a[36:39], v[192:195], v[148:151]
    ds_read_b64_tr_b16 v[186:187], v246 offset:34816
    v_max_f32 v57, s68, v57
    v_mfma_f32_16x16x32_bf16 v[152:155], a[40:43], v[192:195], v[152:155]
    s_add_u32 m0, s7, 81920
    s_add_u32 s64, s10, 776448
    buffer_load_dwordx4 v252, s[44:47], s64 offen offset:0  lds
    v_exp_f32_e64 v202, v202 clamp
    v_mfma_f32_16x16x32_bf16 v[156:159], a[44:47], v[192:195], v[156:159]
    v_mul_f32 v203, 0x3fb8aa3b, v59
    ds_write_b128 v4, v[48:51] offset:0
    v_mfma_f32_16x16x32_bf16 v[160:163], a[32:35], v[196:199], v[160:163]
    ds_read_b64_tr_b16 v[188:189], v247 offset:32768
    v_add_f32 v57, v57, v201
    v_mfma_f32_16x16x32_bf16 v[164:167], a[36:39], v[196:199], v[164:167]
    ds_read_b64_tr_b16 v[190:191], v247 offset:34816
    v_max_f32 v58, s68, v58
    v_mfma_f32_16x16x32_bf16 v[168:171], a[40:43], v[196:199], v[168:171]
    buffer_load_dwordx4 v253, s[44:47], s64 offen offset:1024  lds
    v_exp_f32_e64 v203, v203 clamp
    v_mfma_f32_16x16x32_bf16 v[172:175], a[44:47], v[196:199], v[172:175]
    v_mul_f32 v204, 0x3fb8aa3b, v60
    s_waitcnt lgkmcnt(5)
    v_mfma_f32_16x16x32_bf16 v[112:115], a[48:51], v[176:179], v[112:115]
    s_waitcnt vmcnt(10)
    ds_read_b64_tr_b16 v[192:193], v244 offset:49152
    v_cvt_pk_bf16_f32 v56, v56, v57
    v_add_f32 v58, v58, v202
    v_mfma_f32_16x16x32_bf16 v[116:119], a[52:55], v[176:179], v[116:119]
    ds_read_b64_tr_b16 v[194:195], v244 offset:51200
    v_max_f32 v59, s68, v59
    v_mfma_f32_16x16x32_bf16 v[120:123], a[56:59], v[176:179], v[120:123]
    buffer_load_dwordx4 v254, s[44:47], s64 offen offset:2048  lds
    v_exp_f32_e64 v204, v204 clamp
    v_mfma_f32_16x16x32_bf16 v[124:127], a[60:63], v[176:179], v[124:127]
    buffer_load_dwordx4 v255, s[44:47], s64 offen offset:3072  lds
    v_mul_f32 v205, 0x3fb8aa3b, v61
    v_mfma_f32_16x16x32_bf16 v[128:131], a[48:51], v[180:183], v[128:131]
    ds_read_b64_tr_b16 v[196:197], v245 offset:49152
    v_add_f32 v59, v59, v203
    v_max_f32 v60, s68, v60
    v_mfma_f32_16x16x32_bf16 v[132:135], a[52:55], v[180:183], v[132:135]
    ds_read_b64_tr_b16 v[198:199], v245 offset:51200
    v_exp_f32_e64 v205, v205 clamp
    v_mfma_f32_16x16x32_bf16 v[136:139], a[56:59], v[180:183], v[136:139]
    v_mul_f32 v206, 0x3fb8aa3b, v62
    v_mfma_f32_16x16x32_bf16 v[140:143], a[60:63], v[180:183], v[140:143]
    v_cvt_pk_bf16_f32 v57, v58, v59
    s_waitcnt lgkmcnt(4)
    v_mfma_f32_16x16x32_bf16 v[144:147], a[48:51], v[184:187], v[144:147]
    ds_read_b64_tr_b16 v[176:177], v246 offset:49152
    v_add_f32 v60, v60, v204
    v_mfma_f32_16x16x32_bf16 v[148:151], a[52:55], v[184:187], v[148:151]
    ds_read_b64_tr_b16 v[178:179], v246 offset:51200
    v_max_f32 v61, s68, v61
    v_exp_f32_e64 v206, v206 clamp
    v_mfma_f32_16x16x32_bf16 v[152:155], a[56:59], v[184:187], v[152:155]
    s_add_u32 m0, s7, 98304
    s_add_u32 s64, s10, 887040
    buffer_load_dwordx4 v252, s[44:47], s64 offen offset:0  lds
    v_mul_f32 v207, 0x3fb8aa3b, v63
    v_mfma_f32_16x16x32_bf16 v[156:159], a[60:63], v[184:187], v[156:159]
    v_add_f32 v61, v61, v205
    v_mfma_f32_16x16x32_bf16 v[160:163], a[48:51], v[188:191], v[160:163]
    ds_read_b64_tr_b16 v[180:181], v247 offset:49152
    v_max_f32 v62, s68, v62
    v_mfma_f32_16x16x32_bf16 v[164:167], a[52:55], v[188:191], v[164:167]
    ds_read_b64_tr_b16 v[182:183], v247 offset:51200
    v_exp_f32_e64 v207, v207 clamp
    v_mfma_f32_16x16x32_bf16 v[168:171], a[56:59], v[188:191], v[168:171]
    buffer_load_dwordx4 v253, s[44:47], s64 offen offset:1024  lds
    v_mul_f32 v200, 0x3fb8aa3b, v64
    v_cvt_pk_bf16_f32 v58, v60, v61
    v_mfma_f32_16x16x32_bf16 v[172:175], a[60:63], v[188:191], v[172:175]
    v_add_f32 v62, v62, v206
    v_mov_b32 v208, 0
    buffer_load_dword v209, v208, s[60:63], 0 offen sc1
    s_waitcnt lgkmcnt(4)
    v_mfma_f32_16x16x32_bf16 v[112:115], a[64:67], v[192:195], v[112:115]
    s_waitcnt vmcnt(11)
    ds_read_b64_tr_b16 v[184:185], v248 offset:0
    v_max_f32 v63, s68, v63
    v_mfma_f32_16x16x32_bf16 v[116:119], a[68:71], v[192:195], v[116:119]
    ds_read_b64_tr_b16 v[186:187], v248 offset:2048
    v_exp_f32_e64 v200, v200 clamp
    v_mfma_f32_16x16x32_bf16 v[120:123], a[72:75], v[192:195], v[120:123]
    buffer_load_dwordx4 v254, s[44:47], s64 offen offset:2048  lds
    v_mul_f32 v201, 0x3fb8aa3b, v65
    v_mfma_f32_16x16x32_bf16 v[124:127], a[76:79], v[192:195], v[124:127]
    v_add_f32 v63, v63, v207
    v_max_f32 v64, s68, v64
    v_mfma_f32_16x16x32_bf16 v[128:131], a[64:67], v[196:199], v[128:131]
    ds_read_b64_tr_b16 v[188:189], v249 offset:0
    v_exp_f32_e64 v201, v201 clamp
    v_mfma_f32_16x16x32_bf16 v[132:135], a[68:71], v[196:199], v[132:135]
    ds_read_b64_tr_b16 v[190:191], v249 offset:2048
    v_mul_f32 v202, 0x3fb8aa3b, v66
    v_mfma_f32_16x16x32_bf16 v[136:139], a[72:75], v[196:199], v[136:139]
    buffer_load_dwordx4 v255, s[44:47], s64 offen offset:3072  lds
    v_cvt_pk_bf16_f32 v59, v62, v63
    v_mfma_f32_16x16x32_bf16 v[140:143], a[76:79], v[196:199], v[140:143]
    v_add_f32 v64, v64, v200
    s_waitcnt lgkmcnt(4)
    v_mfma_f32_16x16x32_bf16 v[144:147], a[64:67], v[176:179], v[144:147]
    ds_read_b64_tr_b16 v[192:193], v250 offset:0
    v_max_f32 v65, s68, v65
    v_exp_f32_e64 v202, v202 clamp
    v_mfma_f32_16x16x32_bf16 v[148:151], a[68:71], v[176:179], v[148:151]
    ds_read_b64_tr_b16 v[194:195], v250 offset:2048
    v_mul_f32 v203, 0x3fb8aa3b, v67
    v_mfma_f32_16x16x32_bf16 v[152:155], a[72:75], v[176:179], v[152:155]
    s_add_u32 m0, s7, 114688
    s_add_u32 s64, s10, 997632
    buffer_load_dwordx4 v252, s[44:47], s64 offen offset:0  lds
    ds_write_b128 v4, v[56:59] offset:1024
    v_mfma_f32_16x16x32_bf16 v[156:159], a[76:79], v[176:179], v[156:159]
    buffer_load_dwordx4 v253, s[44:47], s64 offen offset:1024  lds
    v_add_f32 v65, v65, v201
    v_mfma_f32_16x16x32_bf16 v[160:163], a[64:67], v[180:183], v[160:163]
    ds_read_b64_tr_b16 v[196:197], v251 offset:0
    v_max_f32 v66, s68, v66
    v_exp_f32_e64 v203, v203 clamp
    v_mfma_f32_16x16x32_bf16 v[164:167], a[68:71], v[180:183], v[164:167]
    ds_read_b64_tr_b16 v[198:199], v251 offset:2048
    v_mul_f32 v204, 0x3fb8aa3b, v68
    v_mfma_f32_16x16x32_bf16 v[168:171], a[72:75], v[180:183], v[168:171]
    buffer_load_dwordx4 v254, s[44:47], s64 offen offset:2048  lds
    v_cvt_pk_bf16_f32 v64, v64, v65
    v_mfma_f32_16x16x32_bf16 v[172:175], a[76:79], v[180:183], v[172:175]
    v_add_f32 v66, v66, v202
    s_waitcnt lgkmcnt(5)
    v_mfma_f32_16x16x32_bf16 v[112:115], a[80:83], v[184:187], v[112:115]
    s_waitcnt vmcnt(12)
    ds_read_b64_tr_b16 v[176:177], v248 offset:16384
    v_max_f32 v67, s68, v67
    v_mfma_f32_16x16x32_bf16 v[116:119], a[84:87], v[184:187], v[116:119]
    ds_read_b64_tr_b16 v[178:179], v248 offset:18432
    v_exp_f32_e64 v204, v204 clamp
    v_mul_f32 v205, 0x3fb8aa3b, v69
    v_mfma_f32_16x16x32_bf16 v[120:123], a[88:91], v[184:187], v[120:123]
    buffer_load_dwordx4 v255, s[44:47], s64 offen offset:3072  lds
    v_add_f32 v67, v67, v203
    v_mfma_f32_16x16x32_bf16 v[124:127], a[92:95], v[184:187], v[124:127]
    v_max_f32 v68, s68, v68
    v_mfma_f32_16x16x32_bf16 v[128:131], a[80:83], v[188:191], v[128:131]
    ds_read_b64_tr_b16 v[180:181], v249 offset:16384
    v_exp_f32_e64 v205, v205 clamp
    v_mfma_f32_16x16x32_bf16 v[132:135], a[84:87], v[188:191], v[132:135]
    ds_read_b64_tr_b16 v[182:183], v249 offset:18432
    v_mul_f32 v206, 0x3fb8aa3b, v70
    v_mfma_f32_16x16x32_bf16 v[136:139], a[88:91], v[188:191], v[136:139]
    v_cvt_pk_bf16_f32 v65, v66, v67
    v_add_f32 v68, v68, v204
    v_mfma_f32_16x16x32_bf16 v[140:143], a[92:95], v[188:191], v[140:143]
    v_max_f32 v69, s68, v69
    s_waitcnt lgkmcnt(4)
    v_mfma_f32_16x16x32_bf16 v[144:147], a[80:83], v[192:195], v[144:147]
    ds_read_b64_tr_b16 v[184:185], v250 offset:16384
    v_exp_f32_e64 v206, v206 clamp
    v_mfma_f32_16x16x32_bf16 v[148:151], a[84:87], v[192:195], v[148:151]
    ds_read_b64_tr_b16 v[186:187], v250 offset:18432
    v_mul_f32 v207, 0x3fb8aa3b, v71
    v_mfma_f32_16x16x32_bf16 v[152:155], a[88:91], v[192:195], v[152:155]
    s_add_u32 m0, s7, 131072
    s_add_u32 s64, s10, 1108224
    buffer_load_dwordx4 v252, s[44:47], s64 offen offset:0  lds
    v_add_f32 v69, v69, v205
    v_mfma_f32_16x16x32_bf16 v[156:159], a[92:95], v[192:195], v[156:159]
    v_max_f32 v70, s68, v70
    v_exp_f32_e64 v207, v207 clamp
    v_mfma_f32_16x16x32_bf16 v[160:163], a[80:83], v[196:199], v[160:163]
    ds_read_b64_tr_b16 v[188:189], v251 offset:16384
    v_mul_f32 v200, 0x3fb8aa3b, v72
    v_mfma_f32_16x16x32_bf16 v[164:167], a[84:87], v[196:199], v[164:167]
    ds_read_b64_tr_b16 v[190:191], v251 offset:18432
    v_cvt_pk_bf16_f32 v66, v68, v69
    v_mfma_f32_16x16x32_bf16 v[168:171], a[88:91], v[196:199], v[168:171]
    buffer_load_dwordx4 v253, s[44:47], s64 offen offset:1024  lds
    v_add_f32 v70, v70, v206
    v_mfma_f32_16x16x32_bf16 v[172:175], a[92:95], v[196:199], v[172:175]
    v_max_f32 v71, s68, v71
    s_and_b32 s72, s4, 3
    s_cmp_lg_u32 s72, 2
    s_cbranch_scc1 L_pf8
    s_lshr_b32 s72, s4, 2
    s_lshl_b32 s73, s3, 6
    s_cmp_ge_u32 s73, 162
    s_cbranch_scc1 L_pf8
    s_mul_i32 s72, s72, 41472
    s_add_u32 s72, s72, s67
    s_add_u32 s72, s72, 124
    v_add_u32 v214, s73, v1
    v_min_u32 v214, 161, v214
    v_mul_u32_u24 v214, 256, v214
    buffer_load_dwordx2 v[214:215], v214, s[48:51], s72 offen
L_pf8:
    s_waitcnt lgkmcnt(4)
    v_mfma_f32_16x16x32_bf16 v[112:115], a[96:99], v[176:179], v[112:115]
    s_waitcnt vmcnt(11)
    ds_read_b64_tr_b16 v[192:193], v244 offset:16384
    v_exp_f32_e64 v200, v200 clamp
    v_mul_f32 v201, 0x3fb8aa3b, v73
    v_mfma_f32_16x16x32_bf16 v[116:119], a[100:103], v[176:179], v[116:119]
    ds_read_b64_tr_b16 v[194:195], v244 offset:18432
    v_add_f32 v71, v71, v207
    v_mfma_f32_16x16x32_bf16 v[120:123], a[104:107], v[176:179], v[120:123]
    buffer_load_dwordx4 v254, s[44:47], s64 offen offset:2048  lds
    v_max_f32 v72, s68, v72
    v_mfma_f32_16x16x32_bf16 v[124:127], a[108:111], v[176:179], v[124:127]
    buffer_load_dwordx4 v255, s[44:47], s64 offen offset:3072  lds
    v_exp_f32_e64 v201, v201 clamp
    v_mfma_f32_16x16x32_bf16 v[128:131], a[96:99], v[180:183], v[128:131]
    ds_read_b64_tr_b16 v[196:197], v245 offset:16384
    v_mul_f32 v202, 0x3fb8aa3b, v74
    v_cvt_pk_bf16_f32 v67, v70, v71
    v_mfma_f32_16x16x32_bf16 v[132:135], a[100:103], v[180:183], v[132:135]
    ds_read_b64_tr_b16 v[198:199], v245 offset:18432
    v_add_f32 v72, v72, v200
    v_mfma_f32_16x16x32_bf16 v[136:139], a[104:107], v[180:183], v[136:139]
    v_max_f32 v73, s68, v73
    v_mfma_f32_16x16x32_bf16 v[140:143], a[108:111], v[180:183], v[140:143]
    v_exp_f32_e64 v202, v202 clamp
    s_waitcnt lgkmcnt(4)
    v_mfma_f32_16x16x32_bf16 v[144:147], a[96:99], v[184:187], v[144:147]
    ds_read_b64_tr_b16 v[176:177], v246 offset:16384
    v_mul_f32 v203, 0x3fb8aa3b, v75
    v_mfma_f32_16x16x32_bf16 v[148:151], a[100:103], v[184:187], v[148:151]
    ds_read_b64_tr_b16 v[178:179], v246 offset:18432
    ds_write_b128 v4, v[64:67] offset:2048
    v_add_f32 v73, v73, v201
    v_mfma_f32_16x16x32_bf16 v[152:155], a[104:107], v[184:187], v[152:155]
    s_add_u32 m0, s7, 147456
    s_add_u32 s64, s10, 1218816
    buffer_load_dwordx4 v252, s[44:47], s64 offen offset:0  lds
    v_max_f32 v74, s68, v74
    v_mfma_f32_16x16x32_bf16 v[156:159], a[108:111], v[184:187], v[156:159]
    v_exp_f32_e64 v203, v203 clamp
    v_mfma_f32_16x16x32_bf16 v[160:163], a[96:99], v[188:191], v[160:163]
    ds_read_b64_tr_b16 v[180:181], v247 offset:16384
    v_mul_f32 v204, 0x3fb8aa3b, v76
    v_mfma_f32_16x16x32_bf16 v[164:167], a[100:103], v[188:191], v[164:167]
    ds_read_b64_tr_b16 v[182:183], v247 offset:18432
    v_cvt_pk_bf16_f32 v72, v72, v73
    v_mfma_f32_16x16x32_bf16 v[168:171], a[104:107], v[188:191], v[168:171]
    buffer_load_dwordx4 v253, s[44:47], s64 offen offset:1024  lds
    v_add_f32 v74, v74, v202
    v_max_f32 v75, s68, v75
    v_mfma_f32_16x16x32_bf16 v[172:175], a[108:111], v[188:191], v[172:175]
    v_exp_f32_e64 v204, v204 clamp
    s_waitcnt lgkmcnt(5)
    v_mfma_f32_16x16x32_bf16 v[112:115], a[112:115], v[192:195], v[112:115]
    s_waitcnt vmcnt(10)
    ds_read_b64_tr_b16 v[184:185], v244 offset:32768
    v_mul_f32 v205, 0x3fb8aa3b, v77
    v_mfma_f32_16x16x32_bf16 v[116:119], a[116:119], v[192:195], v[116:119]
    ds_read_b64_tr_b16 v[186:187], v244 offset:34816
    v_add_f32 v75, v75, v203
    v_mfma_f32_16x16x32_bf16 v[120:123], a[120:123], v[192:195], v[120:123]
    buffer_load_dwordx4 v254, s[44:47], s64 offen offset:2048  lds
    v_max_f32 v76, s68, v76
    v_mfma_f32_16x16x32_bf16 v[124:127], a[124:127], v[192:195], v[124:127]
    v_exp_f32_e64 v205, v205 clamp
    v_mul_f32 v206, 0x3fb8aa3b, v78
    v_mfma_f32_16x16x32_bf16 v[128:131], a[112:115], v[196:199], v[128:131]
    ds_read_b64_tr_b16 v[188:189], v245 offset:32768
    v_cvt_pk_bf16_f32 v73, v74, v75
    v_mfma_f32_16x16x32_bf16 v[132:135], a[116:119], v[196:199], v[132:135]
    ds_read_b64_tr_b16 v[190:191], v245 offset:34816
    v_add_f32 v76, v76, v204
    v_mfma_f32_16x16x32_bf16 v[136:139], a[120:123], v[196:199], v[136:139]
    buffer_load_dwordx4 v255, s[44:47], s64 offen offset:3072  lds
    v_max_f32 v77, s68, v77
    v_mfma_f32_16x16x32_bf16 v[140:143], a[124:127], v[196:199], v[140:143]
    v_exp_f32_e64 v206, v206 clamp
    s_waitcnt lgkmcnt(4)
    v_mfma_f32_16x16x32_bf16 v[144:147], a[112:115], v[176:179], v[144:147]
    ds_read_b64_tr_b16 v[192:193], v246 offset:32768
    v_mul_f32 v207, 0x3fb8aa3b, v79
    v_add_f32 v77, v77, v205
    v_mfma_f32_16x16x32_bf16 v[148:151], a[116:119], v[176:179], v[148:151]
    ds_read_b64_tr_b16 v[194:195], v246 offset:34816
    v_max_f32 v78, s68, v78
    v_mfma_f32_16x16x32_bf16 v[152:155], a[120:123], v[176:179], v[152:155]
    s_add_u32 m0, s7, 81920
    s_add_u32 s64, s10, 1329408
    buffer_load_dwordx4 v252, s[44:47], s64 offen offset:0  lds
    v_exp_f32_e64 v207, v207 clamp
    v_mfma_f32_16x16x32_bf16 v[156:159], a[124:127], v[176:179], v[156:159]
    buffer_load_dwordx4 v253, s[44:47], s64 offen offset:1024  lds
    v_mul_f32 v200, 0x3fb8aa3b, v80
    v_mfma_f32_16x16x32_bf16 v[160:163], a[112:115], v[180:183], v[160:163]
    ds_read_b64_tr_b16 v[196:197], v247 offset:32768
    v_cvt_pk_bf16_f32 v74, v76, v77
    v_add_f32 v78, v78, v206
    v_mfma_f32_16x16x32_bf16 v[164:167], a[116:119], v[180:183], v[164:167]
    ds_read_b64_tr_b16 v[198:199], v247 offset:34816
    v_max_f32 v79, s68, v79
    v_mfma_f32_16x16x32_bf16 v[168:171], a[120:123], v[180:183], v[168:171]
    buffer_load_dwordx4 v254, s[44:47], s64 offen offset:2048  lds
    v_exp_f32_e64 v200, v200 clamp
    v_mfma_f32_16x16x32_bf16 v[172:175], a[124:127], v[180:183], v[172:175]
    v_mul_f32 v201, 0x3fb8aa3b, v81
    s_waitcnt lgkmcnt(4)
    v_mfma_f32_16x16x32_bf16 v[112:115], a[128:131], v[184:187], v[112:115]
    s_waitcnt vmcnt(11)
    ds_read_b64_tr_b16 v[176:177], v244 offset:49152
    v_add_f32 v79, v79, v207
    v_mfma_f32_16x16x32_bf16 v[116:119], a[132:135], v[184:187], v[116:119]
    ds_read_b64_tr_b16 v[178:179], v244 offset:51200
    v_max_f32 v80, s68, v80
    v_exp_f32_e64 v201, v201 clamp
    v_mfma_f32_16x16x32_bf16 v[120:123], a[136:139], v[184:187], v[120:123]
    buffer_load_dwordx4 v255, s[44:47], s64 offen offset:3072  lds
    v_mul_f32 v202, 0x3fb8aa3b, v82
    v_mfma_f32_16x16x32_bf16 v[124:127], a[140:143], v[184:187], v[124:127]
    v_cvt_pk_bf16_f32 v75, v78, v79
    v_mfma_f32_16x16x32_bf16 v[128:131], a[128:131], v[188:191], v[128:131]
    ds_read_b64_tr_b16 v[180:181], v245 offset:49152
    v_add_f32 v80, v80, v200
    v_mfma_f32_16x16x32_bf16 v[132:135], a[132:135], v[188:191], v[132:135]
    ds_read_b64_tr_b16 v[182:183], v245 offset:51200
    v_max_f32 v81, s68, v81
    v_mfma_f32_16x16x32_bf16 v[136:139], a[136:139], v[188:191], v[136:139]
    v_exp_f32_e64 v202, v202 clamp
    v_mul_f32 v203, 0x3fb8aa3b, v83
    v_mfma_f32_16x16x32_bf16 v[140:143], a[140:143], v[188:191], v[140:143]
    ds_write_b128 v4, v[72:75] offset:3072
    s_waitcnt lgkmcnt(5)
    v_mfma_f32_16x16x32_bf16 v[144:147], a[128:131], v[192:195], v[144:147]
    ds_read_b64_tr_b16 v[184:185], v246 offset:49152
    v_add_f32 v81, v81, v201
    v_mfma_f32_16x16x32_bf16 v[148:151], a[132:135], v[192:195], v[148:151]
    ds_read_b64_tr_b16 v[186:187], v246 offset:51200
    v_max_f32 v82, s68, v82
    v_mfma_f32_16x16x32_bf16 v[152:155], a[136:139], v[192:195], v[152:155]
    s_add_u32 m0, s7, 98304
    s_add_u32 s64, s10, 1440000
    buffer_load_dwordx4 v252, s[44:47], s64 offen offset:0  lds
    v_exp_f32_e64 v203, v203 clamp
    v_mfma_f32_16x16x32_bf16 v[156:159], a[140:143], v[192:195], v[156:159]
    v_mul_f32 v204, 0x3fb8aa3b, v84
    v_cvt_pk_bf16_f32 v80, v80, v81
    v_mfma_f32_16x16x32_bf16 v[160:163], a[128:131], v[196:199], v[160:163]
    ds_read_b64_tr_b16 v[188:189], v247 offset:49152
    v_add_f32 v82, v82, v202
    v_mfma_f32_16x16x32_bf16 v[164:167], a[132:135], v[196:199], v[164:167]
    ds_read_b64_tr_b16 v[190:191], v247 offset:51200
    v_max_f32 v83, s68, v83
    v_mfma_f32_16x16x32_bf16 v[168:171], a[136:139], v[196:199], v[168:171]
    buffer_load_dwordx4 v253, s[44:47], s64 offen offset:1024  lds
    v_exp_f32_e64 v204, v204 clamp
    v_mfma_f32_16x16x32_bf16 v[172:175], a[140:143], v[196:199], v[172:175]
    v_mul_f32 v205, 0x3fb8aa3b, v85
    s_waitcnt lgkmcnt(5)
    v_mfma_f32_16x16x32_bf16 v[112:115], a[144:147], v[176:179], v[112:115]
    s_waitcnt vmcnt(10)
    ds_read_b64_tr_b16 v[192:193], v248 offset:0
    v_add_f32 v83, v83, v203
    v_max_f32 v84, s68, v84
    v_mfma_f32_16x16x32_bf16 v[116:119], a[148:151], v[176:179], v[116:119]
    ds_read_b64_tr_b16 v[194:195], v248 offset:2048
    v_exp_f32_e64 v205, v205 clamp
    v_mfma_f32_16x16x32_bf16 v[120:123], a[152:155], v[176:179], v[120:123]
    buffer_load_dwordx4 v254, s[44:47], s64 offen offset:2048  lds
    v_mul_f32 v206, 0x3fb8aa3b, v86
    v_mfma_f32_16x16x32_bf16 v[124:127], a[156:159], v[176:179], v[124:127]
    buffer_load_dwordx4 v255, s[44:47], s64 offen offset:3072  lds
    v_cvt_pk_bf16_f32 v81, v82, v83
    v_mfma_f32_16x16x32_bf16 v[128:131], a[144:147], v[180:183], v[128:131]
    ds_read_b64_tr_b16 v[196:197], v249 offset:0
    v_add_f32 v84, v84, v204
    v_mfma_f32_16x16x32_bf16 v[132:135], a[148:151], v[180:183], v[132:135]
    ds_read_b64_tr_b16 v[198:199], v249 offset:2048
    v_max_f32 v85, s68, v85
    v_exp_f32_e64 v206, v206 clamp
    v_mfma_f32_16x16x32_bf16 v[136:139], a[152:155], v[180:183], v[136:139]
    v_mul_f32 v207, 0x3fb8aa3b, v87
    v_mfma_f32_16x16x32_bf16 v[140:143], a[156:159], v[180:183], v[140:143]
    v_add_f32 v85, v85, v205
    s_waitcnt lgkmcnt(4)
    v_mfma_f32_16x16x32_bf16 v[144:147], a[144:147], v[184:187], v[144:147]
    ds_read_b64_tr_b16 v[176:177], v250 offset:0
    v_max_f32 v86, s68, v86
    v_mfma_f32_16x16x32_bf16 v[148:151], a[148:151], v[184:187], v[148:151]
    ds_read_b64_tr_b16 v[178:179], v250 offset:2048
    v_exp_f32_e64 v207, v207 clamp
    v_mul_f32 v200, 0x3fb8aa3b, v88
    v_mfma_f32_16x16x32_bf16 v[152:155], a[152:155], v[184:187], v[152:155]
    s_add_u32 m0, s7, 114688
    s_add_u32 s64, s10, 1550592
    buffer_load_dwordx4 v252, s[44:47], s64 offen offset:0  lds
    v_cvt_pk_bf16_f32 v82, v84, v85
    v_mfma_f32_16x16x32_bf16 v[156:159], a[156:159], v[184:187], v[156:159]
    v_add_f32 v86, v86, v206
    v_mfma_f32_16x16x32_bf16 v[160:163], a[144:147], v[188:191], v[160:163]
    ds_read_b64_tr_b16 v[180:181], v251 offset:0
    v_max_f32 v87, s68, v87
    v_mfma_f32_16x16x32_bf16 v[164:167], a[148:151], v[188:191], v[164:167]
    ds_read_b64_tr_b16 v[182:183], v251 offset:2048
    v_exp_f32_e64 v200, v200 clamp
    v_mfma_f32_16x16x32_bf16 v[168:171], a[152:155], v[188:191], v[168:171]
    buffer_load_dwordx4 v253, s[44:47], s64 offen offset:1024  lds
    v_mul_f32 v201, 0x3fb8aa3b, v89
    v_add_f32 v87, v87, v207
    v_mfma_f32_16x16x32_bf16 v[172:175], a[156:159], v[188:191], v[172:175]
    v_max_f32 v88, s68, v88
    s_waitcnt lgkmcnt(4)
    v_mfma_f32_16x16x32_bf16 v[112:115], a[160:163], v[192:195], v[112:115]
    s_waitcnt vmcnt(10)
    ds_read_b64_tr_b16 v[184:185], v248 offset:16384
    v_exp_f32_e64 v201, v201 clamp
    v_mfma_f32_16x16x32_bf16 v[116:119], a[164:167], v[192:195], v[116:119]
    ds_read_b64_tr_b16 v[186:187], v248 offset:18432
    v_mul_f32 v202, 0x3fb8aa3b, v90
    v_mfma_f32_16x16x32_bf16 v[120:123], a[168:171], v[192:195], v[120:123]
    buffer_load_dwordx4 v254, s[44:47], s64 offen offset:2048  lds
    v_cvt_pk_bf16_f32 v83, v86, v87
    v_mfma_f32_16x16x32_bf16 v[124:127], a[172:175], v[192:195], v[124:127]
    v_add_f32 v88, v88, v200
    v_max_f32 v89, s68, v89
    v_mfma_f32_16x16x32_bf16 v[128:131], a[160:163], v[196:199], v[128:131]
    ds_read_b64_tr_b16 v[188:189], v249 offset:16384
    v_exp_f32_e64 v202, v202 clamp
    v_mfma_f32_16x16x32_bf16 v[132:135], a[164:167], v[196:199], v[132:135]
    ds_read_b64_tr_b16 v[190:191], v249 offset:18432
    v_mul_f32 v203, 0x3fb8aa3b, v91
    v_mfma_f32_16x16x32_bf16 v[136:139], a[168:171], v[196:199], v[136:139]
    buffer_load_dwordx4 v255, s[44:47], s64 offen offset:3072  lds
    ds_write_b128 v4, v[80:83] offset:4096
    v_mfma_f32_16x16x32_bf16 v[140:143], a[172:175], v[196:199], v[140:143]
    v_add_f32 v89, v89, v201
    s_waitcnt lgkmcnt(5)
    v_mfma_f32_16x16x32_bf16 v[144:147], a[160:163], v[176:179], v[144:147]
    ds_read_b64_tr_b16 v[192:193], v250 offset:16384
    v_max_f32 v90, s68, v90
    v_exp_f32_e64 v203, v203 clamp
    v_mfma_f32_16x16x32_bf16 v[148:151], a[164:167], v[176:179], v[148:151]
    ds_read_b64_tr_b16 v[194:195], v250 offset:18432
    v_mul_f32 v204, 0x3fb8aa3b, v92
    v_mfma_f32_16x16x32_bf16 v[152:155], a[168:171], v[176:179], v[152:155]
    s_add_u32 m0, s7, 131072
    s_add_u32 s64, s10, 1661184
    buffer_load_dwordx4 v252, s[44:47], s64 offen offset:0  lds
    v_cvt_pk_bf16_f32 v88, v88, v89
    v_mfma_f32_16x16x32_bf16 v[156:159], a[172:175], v[176:179], v[156:159]
    buffer_load_dwordx4 v253, s[44:47], s64 offen offset:1024  lds
    v_add_f32 v90, v90, v202
    v_mfma_f32_16x16x32_bf16 v[160:163], a[160:163], v[180:183], v[160:163]
    ds_read_b64_tr_b16 v[196:197], v251 offset:16384
    v_max_f32 v91, s68, v91
    v_mfma_f32_16x16x32_bf16 v[164:167], a[164:167], v[180:183], v[164:167]
    ds_read_b64_tr_b16 v[198:199], v251 offset:18432
    v_exp_f32_e64 v204, v204 clamp
    v_mul_f32 v205, 0x3fb8aa3b, v93
    v_mfma_f32_16x16x32_bf16 v[168:171], a[168:171], v[180:183], v[168:171]
    buffer_load_dwordx4 v254, s[44:47], s64 offen offset:2048  lds
    v_add_f32 v91, v91, v203
    v_mfma_f32_16x16x32_bf16 v[172:175], a[172:175], v[180:183], v[172:175]
    v_max_f32 v92, s68, v92
    s_waitcnt lgkmcnt(5)
    v_mfma_f32_16x16x32_bf16 v[112:115], a[176:179], v[184:187], v[112:115]
    s_waitcnt vmcnt(11)
    ds_read_b64_tr_b16 v[176:177], v244 offset:16384
    v_exp_f32_e64 v205, v205 clamp
    v_mfma_f32_16x16x32_bf16 v[116:119], a[180:183], v[184:187], v[116:119]
    ds_read_b64_tr_b16 v[178:179], v244 offset:18432
    v_mul_f32 v206, 0x3fb8aa3b, v94
    v_cvt_pk_bf16_f32 v89, v90, v91
    v_mfma_f32_16x16x32_bf16 v[120:123], a[184:187], v[184:187], v[120:123]
    buffer_load_dwordx4 v255, s[44:47], s64 offen offset:3072  lds
    v_add_f32 v92, v92, v204
    v_mfma_f32_16x16x32_bf16 v[124:127], a[188:191], v[184:187], v[124:127]
    v_max_f32 v93, s68, v93
    v_mfma_f32_16x16x32_bf16 v[128:131], a[176:179], v[188:191], v[128:131]
    ds_read_b64_tr_b16 v[180:181], v245 offset:16384
    v_exp_f32_e64 v206, v206 clamp
    v_mfma_f32_16x16x32_bf16 v[132:135], a[180:183], v[188:191], v[132:135]
    ds_read_b64_tr_b16 v[182:183], v245 offset:18432
    v_mul_f32 v207, 0x3fb8aa3b, v95
    v_mfma_f32_16x16x32_bf16 v[136:139], a[184:187], v[188:191], v[136:139]
    v_add_f32 v93, v93, v205
    v_max_f32 v94, s68, v94
    v_mfma_f32_16x16x32_bf16 v[140:143], a[188:191], v[188:191], v[140:143]
    v_exp_f32_e64 v207, v207 clamp
    s_waitcnt lgkmcnt(4)
    v_mfma_f32_16x16x32_bf16 v[144:147], a[176:179], v[192:195], v[144:147]
    ds_read_b64_tr_b16 v[184:185], v246 offset:16384
    v_mul_f32 v200, 0x3fb8aa3b, v96
    v_mfma_f32_16x16x32_bf16 v[148:151], a[180:183], v[192:195], v[148:151]
    ds_read_b64_tr_b16 v[186:187], v246 offset:18432
    v_cvt_pk_bf16_f32 v90, v92, v93
    v_mfma_f32_16x16x32_bf16 v[152:155], a[184:187], v[192:195], v[152:155]
    s_add_u32 m0, s7, 147456
    s_add_u32 s64, s10, 1771776
    buffer_load_dwordx4 v252, s[44:47], s64 offen offset:0  lds
    v_add_f32 v94, v94, v206
    v_mfma_f32_16x16x32_bf16 v[156:159], a[188:191], v[192:195], v[156:159]
    v_max_f32 v95, s68, v95
    v_exp_f32_e64 v200, v200 clamp
    v_mfma_f32_16x16x32_bf16 v[160:163], a[176:179], v[196:199], v[160:163]
    ds_read_b64_tr_b16 v[188:189], v247 offset:16384
    v_mul_f32 v201, 0x3fb8aa3b, v97
    v_mfma_f32_16x16x32_bf16 v[164:167], a[180:183], v[196:199], v[164:167]
    ds_read_b64_tr_b16 v[190:191], v247 offset:18432
    v_add_f32 v95, v95, v207
    v_mfma_f32_16x16x32_bf16 v[168:171], a[184:187], v[196:199], v[168:171]
    buffer_load_dwordx4 v253, s[44:47], s64 offen offset:1024  lds
    v_max_f32 v96, s68, v96
    v_mfma_f32_16x16x32_bf16 v[172:175], a[188:191], v[196:199], v[172:175]
    v_exp_f32_e64 v201, v201 clamp
    s_mov_b32 s71, 0
L_epc_a:
    v_readfirstlane_b32 s86, v209
    s_add_u32 s71, s71, 1
    s_nop 1
    s_cmp_lg_u32 s86, 0
    s_cbranch_scc1 L_epc_a_ok
    s_sleep 8
    buffer_load_dword v209, v208, s[60:63], 0 offen sc1
    s_waitcnt vmcnt(0)
    s_cmp_lt_u32 s71, 0x20000
    s_cbranch_scc1 L_epc_a
L_epc_a_ok:
    s_waitcnt lgkmcnt(4)
    v_mfma_f32_16x16x32_bf16 v[112:115], a[192:195], v[176:179], v[112:115]
    s_waitcnt vmcnt(10)
    ds_read_b64_tr_b16 v[192:193], v244 offset:32768
    v_mul_f32 v202, 0x3fb8aa3b, v98
    v_cvt_pk_bf16_f32 v91, v94, v95
    v_mfma_f32_16x16x32_bf16 v[116:119], a[196:199], v[176:179], v[116:119]
    ds_read_b64_tr_b16 v[194:195], v244 offset:34816
    v_add_f32 v96, v96, v200
    v_mfma_f32_16x16x32_bf16 v[120:123], a[200:203], v[176:179], v[120:123]
    buffer_load_dwordx4 v254, s[44:47], s64 offen offset:2048  lds
    v_max_f32 v97, s68, v97
    v_mfma_f32_16x16x32_bf16 v[124:127], a[204:207], v[176:179], v[124:127]
    buffer_load_dwordx4 v255, s[44:47], s64 offen offset:3072  lds
    v_exp_f32_e64 v202, v202 clamp
    v_mfma_f32_16x16x32_bf16 v[128:131], a[192:195], v[180:183], v[128:131]
    ds_read_b64_tr_b16 v[196:197], v245 offset:32768
    v_mul_f32 v203, 0x3fb8aa3b, v99
    v_mfma_f32_16x16x32_bf16 v[132:135], a[196:199], v[180:183], v[132:135]
    ds_read_b64_tr_b16 v[198:199], v245 offset:34816
    ds_write_b128 v4, v[88:91] offset:5120
    v_add_f32 v97, v97, v201
    v_mfma_f32_16x16x32_bf16 v[136:139], a[200:203], v[180:183], v[136:139]
    v_max_f32 v98, s68, v98
    v_mfma_f32_16x16x32_bf16 v[140:143], a[204:207], v[180:183], v[140:143]
    v_exp_f32_e64 v203, v203 clamp
    s_waitcnt lgkmcnt(5)
    v_mfma_f32_16x16x32_bf16 v[144:147], a[192:195], v[184:187], v[144:147]
    ds_read_b64_tr_b16 v[176:177], v246 offset:32768
    v_mul_f32 v204, 0x3fb8aa3b, v100
    v_mfma_f32_16x16x32_bf16 v[148:151], a[196:199], v[184:187], v[148:151]
    ds_read_b64_tr_b16 v[178:179], v246 offset:34816
    v_cvt_pk_bf16_f32 v96, v96, v97
    v_add_f32 v98, v98, v202
    v_mfma_f32_16x16x32_bf16 v[152:155], a[200:203], v[184:187], v[152:155]
    s_add_u32 m0, s7, 81920
    s_add_u32 s64, s10, 1882368
    buffer_load_dwordx4 v252, s[44:47], s64 offen offset:0  lds
    v_max_f32 v99, s68, v99
    v_mfma_f32_16x16x32_bf16 v[156:159], a[204:207], v[184:187], v[156:159]
    v_exp_f32_e64 v204, v204 clamp
    v_mfma_f32_16x16x32_bf16 v[160:163], a[192:195], v[188:191], v[160:163]
    ds_read_b64_tr_b16 v[180:181], v247 offset:32768
    v_mul_f32 v205, 0x3fb8aa3b, v101
    v_mfma_f32_16x16x32_bf16 v[164:167], a[196:199], v[188:191], v[164:167]
    ds_read_b64_tr_b16 v[182:183], v247 offset:34816
    v_add_f32 v99, v99, v203
    v_mfma_f32_16x16x32_bf16 v[168:171], a[200:203], v[188:191], v[168:171]
    buffer_load_dwordx4 v253, s[44:47], s64 offen offset:1024  lds
    v_max_f32 v100, s68, v100
    v_exp_f32_e64 v205, v205 clamp
    v_mfma_f32_16x16x32_bf16 v[172:175], a[204:207], v[188:191], v[172:175]
    v_mul_f32 v206, 0x3fb8aa3b, v102
    s_waitcnt lgkmcnt(5)
    v_mfma_f32_16x16x32_bf16 v[112:115], a[208:211], v[192:195], v[112:115]
    s_waitcnt vmcnt(10)
    ds_read_b64_tr_b16 v[184:185], v244 offset:49152
    v_cvt_pk_bf16_f32 v97, v98, v99
    v_mfma_f32_16x16x32_bf16 v[116:119], a[212:215], v[192:195], v[116:119]
    ds_read_b64_tr_b16 v[186:187], v244 offset:51200
    v_add_f32 v100, v100, v204
    v_mfma_f32_16x16x32_bf16 v[120:123], a[216:219], v[192:195], v[120:123]
    buffer_load_dwordx4 v254, s[44:47], s64 offen offset:2048  lds
    v_max_f32 v101, s68, v101
    v_mfma_f32_16x16x32_bf16 v[124:127], a[220:223], v[192:195], v[124:127]
    v_exp_f32_e64 v206, v206 clamp
    v_mul_f32 v207, 0x3fb8aa3b, v103
    v_mfma_f32_16x16x32_bf16 v[128:131], a[208:211], v[196:199], v[128:131]
    ds_read_b64_tr_b16 v[188:189], v245 offset:49152
    v_add_f32 v101, v101, v205
    v_mfma_f32_16x16x32_bf16 v[132:135], a[212:215], v[196:199], v[132:135]
    ds_read_b64_tr_b16 v[190:191], v245 offset:51200
    v_max_f32 v102, s68, v102
    v_mfma_f32_16x16x32_bf16 v[136:139], a[216:219], v[196:199], v[136:139]
    buffer_load_dwordx4 v255, s[44:47], s64 offen offset:3072  lds
    v_exp_f32_e64 v207, v207 clamp
    v_mfma_f32_16x16x32_bf16 v[140:143], a[220:223], v[196:199], v[140:143]
    v_mul_f32 v200, 0x3fb8aa3b, v104
    s_waitcnt lgkmcnt(4)
    v_mfma_f32_16x16x32_bf16 v[144:147], a[208:211], v[176:179], v[144:147]
    ds_read_b64_tr_b16 v[192:193], v246 offset:49152
    v_cvt_pk_bf16_f32 v98, v100, v101
    v_add_f32 v102, v102, v206
    v_mfma_f32_16x16x32_bf16 v[148:151], a[212:215], v[176:179], v[148:151]
    ds_read_b64_tr_b16 v[194:195], v246 offset:51200
    v_max_f32 v103, s68, v103
    v_mfma_f32_16x16x32_bf16 v[152:155], a[216:219], v[176:179], v[152:155]
    s_add_u32 m0, s7, 98304
    s_add_u32 s64, s66, 0
    buffer_load_dwordx4 v236, s[44:47], s64 offen offset:0  lds
    v_exp_f32_e64 v200, v200 clamp
    v_mfma_f32_16x16x32_bf16 v[156:159], a[220:223], v[176:179], v[156:159]
    buffer_load_dwordx4 v237, s[44:47], s64 offen offset:1024  lds
    v_mul_f32 v201, 0x3fb8aa3b, v105
    v_mfma_f32_16x16x32_bf16 v[160:163], a[208:211], v[180:183], v[160:163]
    ds_read_b64_tr_b16 v[196:197], v247 offset:49152
    v_add_f32 v103, v103, v207
    v_mfma_f32_16x16x32_bf16 v[164:167], a[212:215], v[180:183], v[164:167]
    ds_read_b64_tr_b16 v[198:199], v247 offset:51200
    v_max_f32 v104, s68, v104
    v_exp_f32_e64 v201, v201 clamp
    v_mfma_f32_16x16x32_bf16 v[168:171], a[216:219], v[180:183], v[168:171]
    buffer_load_dwordx4 v238, s[44:47], s64 offen offset:2048  lds
    v_mul_f32 v202, 0x3fb8aa3b, v106
    v_mfma_f32_16x16x32_bf16 v[172:175], a[220:223], v[180:183], v[172:175]
    v_cvt_pk_bf16_f32 v99, v102, v103
    s_waitcnt lgkmcnt(4)
    v_mfma_f32_16x16x32_bf16 v[112:115], a[224:227], v[184:187], v[112:115]
    s_waitcnt vmcnt(11)
    ds_read_b64_tr_b16 v[176:177], v248 offset:0
    v_add_f32 v104, v104, v200
    v_mfma_f32_16x16x32_bf16 v[116:119], a[228:231], v[184:187], v[116:119]
    ds_read_b64_tr_b16 v[178:179], v248 offset:2048
    v_max_f32 v105, s68, v105
    v_exp_f32_e64 v202, v202 clamp
    v_mfma_f32_16x16x32_bf16 v[120:123], a[232:235], v[184:187], v[120:123]
    buffer_load_dwordx4 v239, s[44:47], s64 offen offset:3072  lds
    v_mul_f32 v203, 0x3fb8aa3b, v107
    v_mfma_f32_16x16x32_bf16 v[124:127], a[236:239], v[184:187], v[124:127]
    ds_write_b128 v4, v[96:99] offset:6144
    v_mfma_f32_16x16x32_bf16 v[128:131], a[224:227], v[188:191], v[128:131]
    ds_read_b64_tr_b16 v[180:181], v249 offset:0
    v_add_f32 v105, v105, v201
    v_mfma_f32_16x16x32_bf16 v[132:135], a[228:231], v[188:191], v[132:135]
    ds_read_b64_tr_b16 v[182:183], v249 offset:2048
    v_max_f32 v106, s68, v106
    v_mfma_f32_16x16x32_bf16 v[136:139], a[232:235], v[188:191], v[136:139]
    v_exp_f32_e64 v203, v203 clamp
    v_mul_f32 v204, 0x3fb8aa3b, v108
    v_mfma_f32_16x16x32_bf16 v[140:143], a[236:239], v[188:191], v[140:143]
    v_cvt_pk_bf16_f32 v104, v104, v105
    s_waitcnt lgkmcnt(5)
    v_mfma_f32_16x16x32_bf16 v[144:147], a[224:227], v[192:195], v[144:147]
    ds_read_b64_tr_b16 v[184:185], v250 offset:0
    v_add_f32 v106, v106, v202
    v_mfma_f32_16x16x32_bf16 v[148:151], a[228:231], v[192:195], v[148:151]
    ds_read_b64_tr_b16 v[186:187], v250 offset:2048
    v_max_f32 v107, s68, v107
    v_mfma_f32_16x16x32_bf16 v[152:155], a[232:235], v[192:195], v[152:155]
    s_add_u32 m0, s7, 114688
    s_add_u32 s64, s66, 221184
    buffer_load_dwordx4 v236, s[44:47], s64 offen offset:0  lds
    v_exp_f32_e64 v204, v204 clamp
    v_mfma_f32_16x16x32_bf16 v[156:159], a[236:239], v[192:195], v[156:159]
    v_mul_f32 v205, 0x3fb8aa3b, v109
    v_add_f32 v107, v107, v203
    v_mfma_f32_16x16x32_bf16 v[160:163], a[224:227], v[196:199], v[160:163]
    ds_read_b64_tr_b16 v[188:189], v251 offset:0
    v_max_f32 v108, s68, v108
    v_mfma_f32_16x16x32_bf16 v[164:167], a[228:231], v[196:199], v[164:167]
    ds_read_b64_tr_b16 v[190:191], v251 offset:2048
    v_exp_f32_e64 v205, v205 clamp
    v_mfma_f32_16x16x32_bf16 v[168:171], a[232:235], v[196:199], v[168:171]
    buffer_load_dwordx4 v237, s[44:47], s64 offen offset:1024  lds
    v_mul_f32 v206, 0x3fb8aa3b, v110
    v_mfma_f32_16x16x32_bf16 v[172:175], a[236:239], v[196:199], v[172:175]
    v_cvt_pk_bf16_f32 v105, v106, v107
    s_waitcnt lgkmcnt(4)
    v_mfma_f32_16x16x32_bf16 v[112:115], a[240:243], v[176:179], v[112:115]
    s_waitcnt vmcnt(10)
    ds_read_b64_tr_b16 v[192:193], v248 offset:16384
    v_add_f32 v108, v108, v204
    v_max_f32 v109, s68, v109
    v_mfma_f32_16x16x32_bf16 v[116:119], a[244:247], v[176:179], v[116:119]
    ds_read_b64_tr_b16 v[194:195], v248 offset:18432
    v_exp_f32_e64 v206, v206 clamp
    v_mfma_f32_16x16x32_bf16 v[120:123], a[248:251], v[176:179], v[120:123]
    buffer_load_dwordx4 v238, s[44:47], s64 offen offset:2048  lds
    v_mul_f32 v207, 0x3fb8aa3b, v111
    v_mfma_f32_16x16x32_bf16 v[124:127], a[252:255], v[176:179], v[124:127]
    buffer_load_dwordx4 v239, s[44:47], s64 offen offset:3072  lds
    v_add_f32 v109, v109, v205
    v_mfma_f32_16x16x32_bf16 v[128:131], a[240:243], v[180:183], v[128:131]
    ds_read_b64_tr_b16 v[196:197], v249 offset:16384
    v_max_f32 v110, s68, v110
    v_mfma_f32_16x16x32_bf16 v[132:135], a[244:247], v[180:183], v[132:135]
    ds_read_b64_tr_b16 v[198:199], v249 offset:18432
    v_exp_f32_e64 v207, v207 clamp
    v_cvt_pk_bf16_f32 v106, v108, v109
    v_mfma_f32_16x16x32_bf16 v[136:139], a[248:251], v[180:183], v[136:139]
    v_add_f32 v110, v110, v206
    v_mfma_f32_16x16x32_bf16 v[140:143], a[252:255], v[180:183], v[140:143]
    v_max_f32 v111, s68, v111
    s_waitcnt lgkmcnt(4)
    v_mfma_f32_16x16x32_bf16 v[144:147], a[240:243], v[184:187], v[144:147]
    ds_read_b64_tr_b16 v[176:177], v250 offset:16384
    v_add_f32 v111, v111, v207
    v_mfma_f32_16x16x32_bf16 v[148:151], a[244:247], v[184:187], v[148:151]
    ds_read_b64_tr_b16 v[178:179], v250 offset:18432
    v_cvt_pk_bf16_f32 v107, v110, v111
    ds_write_b128 v4, v[104:107] offset:7168
    v_mfma_f32_16x16x32_bf16 v[152:155], a[248:251], v[184:187], v[152:155]
    s_add_u32 m0, s7, 131072
    s_add_u32 s64, s66, 442368
    buffer_load_dwordx4 v236, s[44:47], s64 offen offset:0  lds
    v_mfma_f32_16x16x32_bf16 v[156:159], a[252:255], v[184:187], v[156:159]
    v_mfma_f32_16x16x32_bf16 v[160:163], a[240:243], v[188:191], v[160:163]
    ds_read_b64_tr_b16 v[180:181], v251 offset:16384
    v_mfma_f32_16x16x32_bf16 v[164:167], a[244:247], v[188:191], v[164:167]
    ds_read_b64_tr_b16 v[182:183], v251 offset:18432
    v_mfma_f32_16x16x32_bf16 v[168:171], a[248:251], v[188:191], v[168:171]
    buffer_load_dwordx4 v237, s[44:47], s64 offen offset:1024  lds
    v_mfma_f32_16x16x32_bf16 v[172:175], a[252:255], v[188:191], v[172:175]
    s_waitcnt lgkmcnt(5)
    v_mfma_f32_16x16x32_bf16 v[112:115], v[16:19], v[192:195], v[112:115]
    s_waitcnt vmcnt(10)
    ds_read_b64_tr_b16 v[184:185], v244 offset:16384
    v_mfma_f32_16x16x32_bf16 v[116:119], v[20:23], v[192:195], v[116:119]
    ds_read_b64_tr_b16 v[186:187], v244 offset:18432
    v_mfma_f32_16x16x32_bf16 v[120:123], v[24:27], v[192:195], v[120:123]
    buffer_load_dwordx4 v238, s[44:47], s64 offen offset:2048  lds
    v_mfma_f32_16x16x32_bf16 v[124:127], v[28:31], v[192:195], v[124:127]
    v_mfma_f32_16x16x32_bf16 v[128:131], v[16:19], v[196:199], v[128:131]
    ds_read_b64_tr_b16 v[188:189], v245 offset:16384
    v_mfma_f32_16x16x32_bf16 v[132:135], v[20:23], v[196:199], v[132:135]
    ds_read_b64_tr_b16 v[190:191], v245 offset:18432
    v_mfma_f32_16x16x32_bf16 v[136:139], v[24:27], v[196:199], v[136:139]
    buffer_load_dwordx4 v239, s[44:47], s64 offen offset:3072  lds
    v_mfma_f32_16x16x32_bf16 v[140:143], v[28:31], v[196:199], v[140:143]
    s_waitcnt lgkmcnt(4)
    v_mfma_f32_16x16x32_bf16 v[144:147], v[16:19], v[176:179], v[144:147]
    ds_read_b64_tr_b16 v[192:193], v246 offset:16384
    v_mfma_f32_16x16x32_bf16 v[148:151], v[20:23], v[176:179], v[148:151]
    ds_read_b64_tr_b16 v[194:195], v246 offset:18432
    v_mfma_f32_16x16x32_bf16 v[152:155], v[24:27], v[176:179], v[152:155]
    s_add_u32 m0, s7, 147456
    s_add_u32 s64, s66, 663552
    buffer_load_dwordx4 v236, s[44:47], s64 offen offset:0  lds
    v_mfma_f32_16x16x32_bf16 v[156:159], v[28:31], v[176:179], v[156:159]
    buffer_load_dwordx4 v237, s[44:47], s64 offen offset:1024  lds
    v_mfma_f32_16x16x32_bf16 v[160:163], v[16:19], v[180:183], v[160:163]
    ds_read_b64_tr_b16 v[196:197], v247 offset:16384
    v_mfma_f32_16x16x32_bf16 v[164:167], v[20:23], v[180:183], v[164:167]
    ds_read_b64_tr_b16 v[198:199], v247 offset:18432
    v_mfma_f32_16x16x32_bf16 v[168:171], v[24:27], v[180:183], v[168:171]
    buffer_load_dwordx4 v238, s[44:47], s64 offen offset:2048  lds
    v_mfma_f32_16x16x32_bf16 v[172:175], v[28:31], v[180:183], v[172:175]
    s_waitcnt lgkmcnt(4)
    v_mfma_f32_16x16x32_bf16 v[112:115], v[32:35], v[184:187], v[112:115]
    s_waitcnt vmcnt(11)
    ds_read_b64_tr_b16 v[176:177], v8 offset:32768
    v_mfma_f32_16x16x32_bf16 v[116:119], v[36:39], v[184:187], v[116:119]
    ds_read_b64_tr_b16 v[178:179], v8 offset:33792
    v_mfma_f32_16x16x32_bf16 v[120:123], v[40:43], v[184:187], v[120:123]
    buffer_load_dwordx4 v239, s[44:47], s64 offen offset:3072  lds
    v_mfma_f32_16x16x32_bf16 v[124:127], v[44:47], v[184:187], v[124:127]
    v_mfma_f32_16x16x32_bf16 v[128:131], v[32:35], v[188:191], v[128:131]
    ds_read_b64_tr_b16 v[180:181], v9 offset:32768
    v_mfma_f32_16x16x32_bf16 v[132:135], v[36:39], v[188:191], v[132:135]
    ds_read_b64_tr_b16 v[182:183], v9 offset:33792
    v_mfma_f32_16x16x32_bf16 v[136:139], v[40:43], v[188:191], v[136:139]
    v_mfma_f32_16x16x32_bf16 v[140:143], v[44:47], v[188:191], v[140:143]
    s_waitcnt lgkmcnt(4)
    v_mfma_f32_16x16x32_bf16 v[144:147], v[32:35], v[192:195], v[144:147]
    ds_read_b64_tr_b16 v[184:185], v8 offset:34816
    v_mfma_f32_16x16x32_bf16 v[148:151], v[36:39], v[192:195], v[148:151]
    ds_read_b64_tr_b16 v[186:187], v8 offset:35840
    v_mfma_f32_16x16x32_bf16 v[152:155], v[40:43], v[192:195], v[152:155]
    s_add_u32 m0, s7, 81920
    s_add_u32 s64, s66, 884736
    buffer_load_dwordx4 v236, s[44:47], s64 offen offset:0  lds
    v_mfma_f32_16x16x32_bf16 v[156:159], v[44:47], v[192:195], v[156:159]
    v_mfma_f32_16x16x32_bf16 v[160:163], v[32:35], v[196:199], v[160:163]
    ds_read_b64_tr_b16 v[188:189], v9 offset:34816
    v_mfma_f32_16x16x32_bf16 v[164:167], v[36:39], v[196:199], v[164:167]
    ds_read_b64_tr_b16 v[190:191], v9 offset:35840
    v_mfma_f32_16x16x32_bf16 v[168:171], v[40:43], v[196:199], v[168:171]
    buffer_load_dwordx4 v237, s[44:47], s64 offen offset:1024  lds
    v_mfma_f32_16x16x32_bf16 v[172:175], v[44:47], v[196:199], v[172:175]
    s_cmp_eq_u32 s3, 1
    s_cselect_b32 s9, 0, s68
    v_mov_b32 v216, s9
    v_mov_b32 v217, s9
    v_mov_b32 v218, s9
    v_mov_b32 v219, s9
    s_cmp_eq_u32 s3, 2
    s_cbranch_scc1 L_lq
    s_waitcnt lgkmcnt(4)
    v_mfma_f32_16x16x32_bf16 v[48:51], a[0:3], v[176:179], v[216:219]
    s_waitcnt vmcnt(10)
    ds_read_b64_tr_b16 v[192:193], v8 offset:49152
    v_mfma_f32_16x16x32_bf16 v[52:55], a[4:7], v[176:179], v[216:219]
    ds_read_b64_tr_b16 v[194:195], v8 offset:50176
    v_mfma_f32_16x16x32_bf16 v[56:59], a[8:11], v[176:179], v[216:219]
    buffer_load_dwordx4 v238, s[44:47], s64 offen offset:2048  lds
    v_mfma_f32_16x16x32_bf16 v[60:63], a[12:15], v[176:179], v[216:219]
    buffer_load_dwordx4 v239, s[44:47], s64 offen offset:3072  lds
    v_mfma_f32_16x16x32_bf16 v[64:67], a[0:3], v[180:183], v[216:219]
    ds_read_b64_tr_b16 v[196:197], v9 offset:49152
    v_mfma_f32_16x16x32_bf16 v[68:71], a[4:7], v[180:183], v[216:219]
    ds_read_b64_tr_b16 v[198:199], v9 offset:50176
    v_mfma_f32_16x16x32_bf16 v[72:75], a[8:11], v[180:183], v[216:219]
    v_mfma_f32_16x16x32_bf16 v[76:79], a[12:15], v[180:183], v[216:219]
    s_waitcnt lgkmcnt(4)
    v_mfma_f32_16x16x32_bf16 v[48:51], a[16:19], v[184:187], v[48:51]
    ds_read_b64_tr_b16 v[176:177], v8 offset:51200
    v_mfma_f32_16x16x32_bf16 v[52:55], a[20:23], v[184:187], v[52:55]
    ds_read_b64_tr_b16 v[178:179], v8 offset:52224
    v_cvt_pk_bf16_f32 v112, v112, v113
    v_mfma_f32_16x16x32_bf16 v[56:59], a[24:27], v[184:187], v[56:59]
    s_add_u32 m0, s7, 98304
    s_add_u32 s64, s66, 1105920
    buffer_load_dwordx4 v236, s[44:47], s64 offen offset:0  lds
    v_mfma_f32_16x16x32_bf16 v[60:63], a[28:31], v[184:187], v[60:63]
    v_mfma_f32_16x16x32_bf16 v[64:67], a[16:19], v[188:191], v[64:67]
    ds_read_b64_tr_b16 v[180:181], v9 offset:51200
    v_mfma_f32_16x16x32_bf16 v[68:71], a[20:23], v[188:191], v[68:71]
    ds_read_b64_tr_b16 v[182:183], v9 offset:52224
    v_cvt_pk_bf16_f32 v113, v114, v115
    v_mfma_f32_16x16x32_bf16 v[72:75], a[24:27], v[188:191], v[72:75]
    buffer_load_dwordx4 v237, s[44:47], s64 offen offset:1024  lds
    v_mfma_f32_16x16x32_bf16 v[76:79], a[28:31], v[188:191], v[76:79]
    s_waitcnt lgkmcnt(4)
    v_mfma_f32_16x16x32_bf16 v[48:51], a[32:35], v[192:195], v[48:51]
    s_waitcnt vmcnt(10)
    ds_read_b64_tr_b16 v[184:185], v10 offset:0
    v_cvt_pk_bf16_f32 v114, v116, v117
    v_mfma_f32_16x16x32_bf16 v[52:55], a[36:39], v[192:195], v[52:55]
    ds_read_b64_tr_b16 v[186:187], v10 offset:1024
    v_mfma_f32_16x16x32_bf16 v[56:59], a[40:43], v[192:195], v[56:59]
    buffer_load_dwordx4 v238, s[44:47], s64 offen offset:2048  lds
    v_mfma_f32_16x16x32_bf16 v[60:63], a[44:47], v[192:195], v[60:63]
    v_cvt_pk_bf16_f32 v115, v118, v119
    v_mfma_f32_16x16x32_bf16 v[64:67], a[32:35], v[196:199], v[64:67]
    ds_read_b64_tr_b16 v[188:189], v11 offset:0
    v_mfma_f32_16x16x32_bf16 v[68:71], a[36:39], v[196:199], v[68:71]
    ds_read_b64_tr_b16 v[190:191], v11 offset:1024
    ds_write_b128 v4, v[112:115] offset:36864
    v_mfma_f32_16x16x32_bf16 v[72:75], a[40:43], v[196:199], v[72:75]
    buffer_load_dwordx4 v239, s[44:47], s64 offen offset:3072  lds
    v_mfma_f32_16x16x32_bf16 v[76:79], a[44:47], v[196:199], v[76:79]
    s_waitcnt lgkmcnt(5)
    v_mfma_f32_16x16x32_bf16 v[48:51], a[48:51], v[176:179], v[48:51]
    ds_read_b64_tr_b16 v[192:193], v10 offset:2048
    v_cvt_pk_bf16_f32 v120, v120, v121
    v_mfma_f32_16x16x32_bf16 v[52:55], a[52:55], v[176:179], v[52:55]
    ds_read_b64_tr_b16 v[194:195], v10 offset:3072
    v_mfma_f32_16x16x32_bf16 v[56:59], a[56:59], v[176:179], v[56:59]
    s_add_u32 m0, s7, 114688
    s_add_u32 s64, s66, 1327104
    buffer_load_dwordx4 v236, s[44:47], s64 offen offset:0  lds
    v_mfma_f32_16x16x32_bf16 v[60:63], a[60:63], v[176:179], v[60:63]
    buffer_load_dwordx4 v237, s[44:47], s64 offen offset:1024  lds
    v_cvt_pk_bf16_f32 v121, v122, v123
    v_mfma_f32_16x16x32_bf16 v[64:67], a[48:51], v[180:183], v[64:67]
    ds_read_b64_tr_b16 v[196:197], v11 offset:2048
    v_mfma_f32_16x16x32_bf16 v[68:71], a[52:55], v[180:183], v[68:71]
    ds_read_b64_tr_b16 v[198:199], v11 offset:3072
    v_mfma_f32_16x16x32_bf16 v[72:75], a[56:59], v[180:183], v[72:75]
    buffer_load_dwordx4 v238, s[44:47], s64 offen offset:2048  lds
    v_cvt_pk_bf16_f32 v122, v124, v125
    v_mfma_f32_16x16x32_bf16 v[76:79], a[60:63], v[180:183], v[76:79]
    s_waitcnt lgkmcnt(5)
    v_mfma_f32_16x16x32_bf16 v[48:51], a[64:67], v[184:187], v[48:51]
    s_waitcnt vmcnt(11)
    ds_read_b64_tr_b16 v[176:177], v10 offset:16384
    v_mfma_f32_16x16x32_bf16 v[52:55], a[68:71], v[184:187], v[52:55]
    ds_read_b64_tr_b16 v[178:179], v10 offset:17408
    v_cvt_pk_bf16_f32 v123, v126, v127
    v_mfma_f32_16x16x32_bf16 v[56:59], a[72:75], v[184:187], v[56:59]
    buffer_load_dwordx4 v239, s[44:47], s64 offen offset:3072  lds
    v_mfma_f32_16x16x32_bf16 v[60:63], a[76:79], v[184:187], v[60:63]
    v_mfma_f32_16x16x32_bf16 v[64:67], a[64:67], v[188:191], v[64:67]
    ds_read_b64_tr_b16 v[180:181], v11 offset:16384
    ds_write_b128 v4, v[120:123] offset:37888
    v_mfma_f32_16x16x32_bf16 v[68:71], a[68:71], v[188:191], v[68:71]
    ds_read_b64_tr_b16 v[182:183], v11 offset:17408
    v_mfma_f32_16x16x32_bf16 v[72:75], a[72:75], v[188:191], v[72:75]
    v_cvt_pk_bf16_f32 v128, v128, v129
    v_mfma_f32_16x16x32_bf16 v[76:79], a[76:79], v[188:191], v[76:79]
    s_waitcnt lgkmcnt(5)
    v_mfma_f32_16x16x32_bf16 v[48:51], a[80:83], v[192:195], v[48:51]
    ds_read_b64_tr_b16 v[184:185], v10 offset:18432
    v_mfma_f32_16x16x32_bf16 v[52:55], a[84:87], v[192:195], v[52:55]
    ds_read_b64_tr_b16 v[186:187], v10 offset:19456
    v_cvt_pk_bf16_f32 v129, v130, v131
    v_mfma_f32_16x16x32_bf16 v[56:59], a[88:91], v[192:195], v[56:59]
    s_add_u32 m0, s7, 131072
    s_add_u32 s64, s66, 1548288
    buffer_load_dwordx4 v236, s[44:47], s64 offen offset:0  lds
    v_mfma_f32_16x16x32_bf16 v[60:63], a[92:95], v[192:195], v[60:63]
    v_mfma_f32_16x16x32_bf16 v[64:67], a[80:83], v[196:199], v[64:67]
    ds_read_b64_tr_b16 v[188:189], v11 offset:18432
    v_cvt_pk_bf16_f32 v130, v132, v133
    v_mfma_f32_16x16x32_bf16 v[68:71], a[84:87], v[196:199], v[68:71]
    ds_read_b64_tr_b16 v[190:191], v11 offset:19456
    v_mfma_f32_16x16x32_bf16 v[72:75], a[88:91], v[196:199], v[72:75]
    buffer_load_dwordx4 v237, s[44:47], s64 offen offset:1024  lds
    v_mfma_f32_16x16x32_bf16 v[76:79], a[92:95], v[196:199], v[76:79]
    s_waitcnt lgkmcnt(4)
    v_mfma_f32_16x16x32_bf16 v[48:51], a[96:99], v[176:179], v[48:51]
    s_waitcnt vmcnt(10)
    ds_read_b64_tr_b16 v[192:193], v8 offset:16384
    v_cvt_pk_bf16_f32 v131, v134, v135
    v_mfma_f32_16x16x32_bf16 v[52:55], a[100:103], v[176:179], v[52:55]
    ds_read_b64_tr_b16 v[194:195], v8 offset:17408
    v_mfma_f32_16x16x32_bf16 v[56:59], a[104:107], v[176:179], v[56:59]
    buffer_load_dwordx4 v238, s[44:47], s64 offen offset:2048  lds
    ds_write_b128 v4, v[128:131] offset:38912
    v_mfma_f32_16x16x32_bf16 v[60:63], a[108:111], v[176:179], v[60:63]
    buffer_load_dwordx4 v239, s[44:47], s64 offen offset:3072  lds
    v_mfma_f32_16x16x32_bf16 v[64:67], a[96:99], v[180:183], v[64:67]
    ds_read_b64_tr_b16 v[196:197], v9 offset:16384
    v_cvt_pk_bf16_f32 v136, v136, v137
    v_mfma_f32_16x16x32_bf16 v[68:71], a[100:103], v[180:183], v[68:71]
    ds_read_b64_tr_b16 v[198:199], v9 offset:17408
    v_mfma_f32_16x16x32_bf16 v[72:75], a[104:107], v[180:183], v[72:75]
    v_mfma_f32_16x16x32_bf16 v[76:79], a[108:111], v[180:183], v[76:79]
    v_cvt_pk_bf16_f32 v137, v138, v139
    s_waitcnt lgkmcnt(5)
    v_mfma_f32_16x16x32_bf16 v[48:51], a[112:115], v[184:187], v[48:51]
    ds_read_b64_tr_b16 v[176:177], v8 offset:18432
    v_mfma_f32_16x16x32_bf16 v[52:55], a[116:119], v[184:187], v[52:55]
    ds_read_b64_tr_b16 v[178:179], v8 offset:19456
    v_mfma_f32_16x16x32_bf16 v[56:59], a[120:123], v[184:187], v[56:59]
    s_add_u32 m0, s7, 147456
    s_add_u32 s64, s66, 1769472
    buffer_load_dwordx4 v236, s[44:47], s64 offen offset:0  lds
    v_cvt_pk_bf16_f32 v138, v140, v141
    v_mfma_f32_16x16x32_bf16 v[60:63], a[124:127], v[184:187], v[60:63]
    v_mfma_f32_16x16x32_bf16 v[64:67], a[112:115], v[188:191], v[64:67]
    ds_read_b64_tr_b16 v[180:181], v9 offset:18432
    v_mfma_f32_16x16x32_bf16 v[68:71], a[116:119], v[188:191], v[68:71]
    ds_read_b64_tr_b16 v[182:183], v9 offset:19456
    v_mfma_f32_16x16x32_bf16 v[72:75], a[120:123], v[188:191], v[72:75]
    buffer_load_dwordx4 v237, s[44:47], s64 offen offset:1024  lds
    v_cvt_pk_bf16_f32 v139, v142, v143
    v_mfma_f32_16x16x32_bf16 v[76:79], a[124:127], v[188:191], v[76:79]
    s_waitcnt lgkmcnt(4)
    v_mfma_f32_16x16x32_bf16 v[48:51], a[128:131], v[192:195], v[48:51]
    s_waitcnt vmcnt(10)
    ds_read_b64_tr_b16 v[184:185], v8 offset:32768
    ds_write_b128 v4, v[136:139] offset:39936
    v_mfma_f32_16x16x32_bf16 v[52:55], a[132:135], v[192:195], v[52:55]
    ds_read_b64_tr_b16 v[186:187], v8 offset:33792
    v_mfma_f32_16x16x32_bf16 v[56:59], a[136:139], v[192:195], v[56:59]
    buffer_load_dwordx4 v238, s[44:47], s64 offen offset:2048  lds
    v_cvt_pk_bf16_f32 v144, v144, v145
    v_mfma_f32_16x16x32_bf16 v[60:63], a[140:143], v[192:195], v[60:63]
    v_mfma_f32_16x16x32_bf16 v[64:67], a[128:131], v[196:199], v[64:67]
    ds_read_b64_tr_b16 v[188:189], v9 offset:32768
    v_mfma_f32_16x16x32_bf16 v[68:71], a[132:135], v[196:199], v[68:71]
    ds_read_b64_tr_b16 v[190:191], v9 offset:33792
    v_cvt_pk_bf16_f32 v145, v146, v147
    v_mfma_f32_16x16x32_bf16 v[72:75], a[136:139], v[196:199], v[72:75]
    buffer_load_dwordx4 v239, s[44:47], s64 offen offset:3072  lds
    v_mfma_f32_16x16x32_bf16 v[76:79], a[140:143], v[196:199], v[76:79]
    s_waitcnt lgkmcnt(5)
    v_mfma_f32_16x16x32_bf16 v[48:51], a[144:147], v[176:179], v[48:51]
    ds_read_b64_tr_b16 v[192:193], v8 offset:34816
    v_mfma_f32_16x16x32_bf16 v[52:55], a[148:151], v[176:179], v[52:55]
    ds_read_b64_tr_b16 v[194:195], v8 offset:35840
    v_cvt_pk_bf16_f32 v146, v148, v149
    v_mfma_f32_16x16x32_bf16 v[56:59], a[152:155], v[176:179], v[56:59]
    s_add_u32 m0, s7, 81920
    s_add_u32 s64, s10, 0
    buffer_load_dwordx4 v252, s[44:47], s64 offen offset:0  lds
    v_mfma_f32_16x16x32_bf16 v[60:63], a[156:159], v[176:179], v[60:63]
    buffer_load_dwordx4 v253, s[44:47], s64 offen offset:1024  lds
    v_mfma_f32_16x16x32_bf16 v[64:67], a[144:147], v[180:183], v[64:67]
    ds_read_b64_tr_b16 v[196:197], v9 offset:34816
    v_cvt_pk_bf16_f32 v147, v150, v151
    v_mfma_f32_16x16x32_bf16 v[68:71], a[148:151], v[180:183], v[68:71]
    ds_read_b64_tr_b16 v[198:199], v9 offset:35840
    v_mfma_f32_16x16x32_bf16 v[72:75], a[152:155], v[180:183], v[72:75]
    buffer_load_dwordx4 v254, s[44:47], s64 offen offset:2048  lds
    ds_write_b128 v4, v[144:147] offset:40960
    v_mfma_f32_16x16x32_bf16 v[76:79], a[156:159], v[180:183], v[76:79]
    s_waitcnt lgkmcnt(5)
    v_mfma_f32_16x16x32_bf16 v[48:51], a[160:163], v[184:187], v[48:51]
    s_waitcnt vmcnt(11)
    ds_read_b64_tr_b16 v[176:177], v8 offset:49152
    v_cvt_pk_bf16_f32 v152, v152, v153
    v_mfma_f32_16x16x32_bf16 v[52:55], a[164:167], v[184:187], v[52:55]
    ds_read_b64_tr_b16 v[178:179], v8 offset:50176
    v_mfma_f32_16x16x32_bf16 v[56:59], a[168:171], v[184:187], v[56:59]
    buffer_load_dwordx4 v255, s[44:47], s64 offen offset:3072  lds
    v_mfma_f32_16x16x32_bf16 v[60:63], a[172:175], v[184:187], v[60:63]
    v_mfma_f32_16x16x32_bf16 v[64:67], a[160:163], v[188:191], v[64:67]
    ds_read_b64_tr_b16 v[180:181], v9 offset:49152
    v_cvt_pk_bf16_f32 v153, v154, v155
    v_mfma_f32_16x16x32_bf16 v[68:71], a[164:167], v[188:191], v[68:71]
    ds_read_b64_tr_b16 v[182:183], v9 offset:50176
    v_mfma_f32_16x16x32_bf16 v[72:75], a[168:171], v[188:191], v[72:75]
    v_mfma_f32_16x16x32_bf16 v[76:79], a[172:175], v[188:191], v[76:79]
    v_cvt_pk_bf16_f32 v154, v156, v157
    s_waitcnt lgkmcnt(5)
    v_mfma_f32_16x16x32_bf16 v[48:51], a[176:179], v[192:195], v[48:51]
    ds_read_b64_tr_b16 v[184:185], v8 offset:51200
    v_mfma_f32_16x16x32_bf16 v[52:55], a[180:183], v[192:195], v[52:55]
    ds_read_b64_tr_b16 v[186:187], v8 offset:52224
    v_mfma_f32_16x16x32_bf16 v[56:59], a[184:187], v[192:195], v[56:59]
    s_add_u32 m0, s7, 98304
    s_add_u32 s64, s10, 110592
    buffer_load_dwordx4 v252, s[44:47], s64 offen offset:0  lds
    v_cvt_pk_bf16_f32 v155, v158, v159
    v_mfma_f32_16x16x32_bf16 v[60:63], a[188:191], v[192:195], v[60:63]
    v_mfma_f32_16x16x32_bf16 v[64:67], a[176:179], v[196:199], v[64:67]
    ds_read_b64_tr_b16 v[188:189], v9 offset:51200
    ds_write_b128 v4, v[152:155] offset:41984
    v_mfma_f32_16x16x32_bf16 v[68:71], a[180:183], v[196:199], v[68:71]
    ds_read_b64_tr_b16 v[190:191], v9 offset:52224
    v_mfma_f32_16x16x32_bf16 v[72:75], a[184:187], v[196:199], v[72:75]
    buffer_load_dwordx4 v253, s[44:47], s64 offen offset:1024  lds
    v_cvt_pk_bf16_f32 v160, v160, v161
    v_mfma_f32_16x16x32_bf16 v[76:79], a[188:191], v[196:199], v[76:79]
    s_waitcnt lgkmcnt(5)
    v_mfma_f32_16x16x32_bf16 v[48:51], a[192:195], v[176:179], v[48:51]
    s_waitcnt vmcnt(10)
    ds_read_b64_tr_b16 v[192:193], v10 offset:0
    v_mfma_f32_16x16x32_bf16 v[52:55], a[196:199], v[176:179], v[52:55]
    ds_read_b64_tr_b16 v[194:195], v10 offset:1024
    v_mfma_f32_16x16x32_bf16 v[56:59], a[200:203], v[176:179], v[56:59]
    buffer_load_dwordx4 v254, s[44:47], s64 offen offset:2048  lds
    v_cvt_pk_bf16_f32 v161, v162, v163
    v_mfma_f32_16x16x32_bf16 v[60:63], a[204:207], v[176:179], v[60:63]
    buffer_load_dwordx4 v255, s[44:47], s64 offen offset:3072  lds
    v_mfma_f32_16x16x32_bf16 v[64:67], a[192:195], v[180:183], v[64:67]
    ds_read_b64_tr_b16 v[196:197], v11 offset:0
    v_mfma_f32_16x16x32_bf16 v[68:71], a[196:199], v[180:183], v[68:71]
    ds_read_b64_tr_b16 v[198:199], v11 offset:1024
    v_cvt_pk_bf16_f32 v162, v164, v165
    v_mfma_f32_16x16x32_bf16 v[72:75], a[200:203], v[180:183], v[72:75]
    v_mfma_f32_16x16x32_bf16 v[76:79], a[204:207], v[180:183], v[76:79]
    s_waitcnt lgkmcnt(4)
    v_mfma_f32_16x16x32_bf16 v[48:51], a[208:211], v[184:187], v[48:51]
    ds_read_b64_tr_b16 v[176:177], v10 offset:2048
    v_cvt_pk_bf16_f32 v163, v166, v167
    v_mfma_f32_16x16x32_bf16 v[52:55], a[212:215], v[184:187], v[52:55]
    ds_read_b64_tr_b16 v[178:179], v10 offset:3072
    v_mfma_f32_16x16x32_bf16 v[56:59], a[216:219], v[184:187], v[56:59]
    s_add_u32 m0, s7, 114688
    s_add_u32 s64, s10, 221184
    buffer_load_dwordx4 v252, s[44:47], s64 offen offset:0  lds
    ds_write_b128 v4, v[160:163] offset:43008
    v_mfma_f32_16x16x32_bf16 v[60:63], a[220:223], v[184:187], v[60:63]
    v_mfma_f32_16x16x32_bf16 v[64:67], a[208:211], v[188:191], v[64:67]
    ds_read_b64_tr_b16 v[180:181], v11 offset:2048
    v_mfma_f32_16x16x32_bf16 v[68:71], a[212:215], v[188:191], v[68:71]
    ds_read_b64_tr_b16 v[182:183], v11 offset:3072
    v_cvt_pk_bf16_f32 v168, v168, v169
    v_mfma_f32_16x16x32_bf16 v[72:75], a[216:219], v[188:191], v[72:75]
    buffer_load_dwordx4 v253, s[44:47], s64 offen offset:1024  lds
    v_mfma_f32_16x16x32_bf16 v[76:79], a[220:223], v[188:191], v[76:79]
    s_waitcnt lgkmcnt(5)
    v_mfma_f32_16x16x32_bf16 v[48:51], a[224:227], v[192:195], v[48:51]
    s_waitcnt vmcnt(10)
    ds_read_b64_tr_b16 v[184:185], v10 offset:16384
    v_cvt_pk_bf16_f32 v169, v170, v171
    v_mfma_f32_16x16x32_bf16 v[52:55], a[228:231], v[192:195], v[52:55]
    ds_read_b64_tr_b16 v[186:187], v10 offset:17408
    v_mfma_f32_16x16x32_bf16 v[56:59], a[232:235], v[192:195], v[56:59]
    buffer_load_dwordx4 v254, s[44:47], s64 offen offset:2048  lds
    v_mfma_f32_16x16x32_bf16 v[60:63], a[236:239], v[192:195], v[60:63]
    v_cvt_pk_bf16_f32 v170, v172, v173
    v_mfma_f32_16x16x32_bf16 v[64:67], a[224:227], v[196:199], v[64:67]
    ds_read_b64_tr_b16 v[188:189], v11 offset:16384
    v_mfma_f32_16x16x32_bf16 v[68:71], a[228:231], v[196:199], v[68:71]
    ds_read_b64_tr_b16 v[190:191], v11 offset:17408
    v_mfma_f32_16x16x32_bf16 v[72:75], a[232:235], v[196:199], v[72:75]
    buffer_load_dwordx4 v255, s[44:47], s64 offen offset:3072  lds
    v_cvt_pk_bf16_f32 v171, v174, v175
    v_mfma_f32_16x16x32_bf16 v[76:79], a[236:239], v[196:199], v[76:79]
    s_waitcnt lgkmcnt(4)
    v_mfma_f32_16x16x32_bf16 v[48:51], a[240:243], v[176:179], v[48:51]
    ds_read_b64_tr_b16 v[192:193], v10 offset:18432
    ds_write_b128 v4, v[168:171] offset:44032
    v_mfma_f32_16x16x32_bf16 v[52:55], a[244:247], v[176:179], v[52:55]
    ds_read_b64_tr_b16 v[194:195], v10 offset:19456
    v_mfma_f32_16x16x32_bf16 v[56:59], a[248:251], v[176:179], v[56:59]
    s_add_u32 m0, s7, 131072
    s_add_u32 s64, s10, 331776
    buffer_load_dwordx4 v252, s[44:47], s64 offen offset:0  lds
    v_mfma_f32_16x16x32_bf16 v[60:63], a[252:255], v[176:179], v[60:63]
    buffer_load_dwordx4 v253, s[44:47], s64 offen offset:1024  lds
    v_mfma_f32_16x16x32_bf16 v[64:67], a[240:243], v[180:183], v[64:67]
    ds_read_b64_tr_b16 v[196:197], v11 offset:18432
    v_mfma_f32_16x16x32_bf16 v[68:71], a[244:247], v[180:183], v[68:71]
    ds_read_b64_tr_b16 v[198:199], v11 offset:19456
    v_mfma_f32_16x16x32_bf16 v[72:75], a[248:251], v[180:183], v[72:75]
    buffer_load_dwordx4 v254, s[44:47], s64 offen offset:2048  lds
    v_mfma_f32_16x16x32_bf16 v[76:79], a[252:255], v[180:183], v[76:79]
    s_waitcnt lgkmcnt(5)
    v_mfma_f32_16x16x32_bf16 v[48:51], v[16:19], v[184:187], v[48:51]
    s_waitcnt vmcnt(11)
    ds_read_b64_tr_b16 v[176:177], v244 offset:16384
    v_mfma_f32_16x16x32_bf16 v[52:55], v[20:23], v[184:187], v[52:55]
    ds_read_b64_tr_b16 v[178:179], v244 offset:18432
    v_mfma_f32_16x16x32_bf16 v[56:59], v[24:27], v[184:187], v[56:59]
    buffer_load_dwordx4 v255, s[44:47], s64 offen offset:3072  lds
    v_mfma_f32_16x16x32_bf16 v[60:63], v[28:31], v[184:187], v[60:63]
    v_mfma_f32_16x16x32_bf16 v[64:67], v[16:19], v[188:191], v[64:67]
    ds_read_b64_tr_b16 v[180:181], v245 offset:16384
    v_mfma_f32_16x16x32_bf16 v[68:71], v[20:23], v[188:191], v[68:71]
    ds_read_b64_tr_b16 v[182:183], v245 offset:18432
    v_mfma_f32_16x16x32_bf16 v[72:75], v[24:27], v[188:191], v[72:75]
    v_mfma_f32_16x16x32_bf16 v[76:79], v[28:31], v[188:191], v[76:79]
    s_waitcnt lgkmcnt(4)
    v_mfma_f32_16x16x32_bf16 v[48:51], v[32:35], v[192:195], v[48:51]
    ds_read_b64_tr_b16 v[184:185], v246 offset:16384
    v_mfma_f32_16x16x32_bf16 v[52:55], v[36:39], v[192:195], v[52:55]
    ds_read_b64_tr_b16 v[186:187], v246 offset:18432
    v_mfma_f32_16x16x32_bf16 v[56:59], v[40:43], v[192:195], v[56:59]
    s_add_u32 m0, s7, 147456
    s_add_u32 s64, s10, 442368
    buffer_load_dwordx4 v252, s[44:47], s64 offen offset:0  lds
    v_mfma_f32_16x16x32_bf16 v[60:63], v[44:47], v[192:195], v[60:63]
    v_mfma_f32_16x16x32_bf16 v[64:67], v[32:35], v[196:199], v[64:67]
    ds_read_b64_tr_b16 v[188:189], v247 offset:16384
    v_mfma_f32_16x16x32_bf16 v[68:71], v[36:39], v[196:199], v[68:71]
    ds_read_b64_tr_b16 v[190:191], v247 offset:18432
    v_mfma_f32_16x16x32_bf16 v[72:75], v[40:43], v[196:199], v[72:75]
    buffer_load_dwordx4 v253, s[44:47], s64 offen offset:1024  lds
    v_mfma_f32_16x16x32_bf16 v[76:79], v[44:47], v[196:199], v[76:79]
    s_branch L_ldone
L_lq:
    s_waitcnt lgkmcnt(4)
    v_mfma_f32_16x16x32_bf16 v[48:51], v[176:179], a[0:3], v[216:219]
    s_waitcnt vmcnt(10)
    ds_read_b64_tr_b16 v[192:193], v8 offset:49152
    v_mfma_f32_16x16x32_bf16 v[52:55], v[176:179], a[4:7], v[216:219]
    ds_read_b64_tr_b16 v[194:195], v8 offset:50176
    v_mfma_f32_16x16x32_bf16 v[56:59], v[176:179], a[8:11], v[216:219]
    buffer_load_dwordx4 v238, s[44:47], s64 offen offset:2048  lds
    v_mfma_f32_16x16x32_bf16 v[60:63], v[176:179], a[12:15], v[216:219]
    buffer_load_dwordx4 v239, s[44:47], s64 offen offset:3072  lds
    v_mfma_f32_16x16x32_bf16 v[64:67], v[180:183], a[0:3], v[216:219]
    ds_read_b64_tr_b16 v[196:197], v9 offset:49152
    v_mfma_f32_16x16x32_bf16 v[68:71], v[180:183], a[4:7], v[216:219]
    ds_read_b64_tr_b16 v[198:199], v9 offset:50176
    v_mfma_f32_16x16x32_bf16 v[72:75], v[180:183], a[8:11], v[216:219]
    v_mfma_f32_16x16x32_bf16 v[76:79], v[180:183], a[12:15], v[216:219]
    s_waitcnt lgkmcnt(4)
    v_mfma_f32_16x16x32_bf16 v[48:51], v[184:187], a[16:19], v[48:51]
    ds_read_b64_tr_b16 v[176:177], v8 offset:51200
    v_mfma_f32_16x16x32_bf16 v[52:55], v[184:187], a[20:23], v[52:55]
    ds_read_b64_tr_b16 v[178:179], v8 offset:52224
    v_cvt_pk_bf16_f32 v112, v112, v113
    v_mfma_f32_16x16x32_bf16 v[56:59], v[184:187], a[24:27], v[56:59]
    s_add_u32 m0, s7, 98304
    s_add_u32 s64, s66, 1105920
    buffer_load_dwordx4 v236, s[44:47], s64 offen offset:0  lds
    v_mfma_f32_16x16x32_bf16 v[60:63], v[184:187], a[28:31], v[60:63]
    v_mfma_f32_16x16x32_bf16 v[64:67], v[188:191], a[16:19], v[64:67]
    ds_read_b64_tr_b16 v[180:181], v9 offset:51200
    v_mfma_f32_16x16x32_bf16 v[68:71], v[188:191], a[20:23], v[68:71]
    ds_read_b64_tr_b16 v[182:183], v9 offset:52224
    v_cvt_pk_bf16_f32 v113, v114, v115
    v_mfma_f32_16x16x32_bf16 v[72:75], v[188:191], a[24:27], v[72:75]
    buffer_load_dwordx4 v237, s[44:47], s64 offen offset:1024  lds
    v_mfma_f32_16x16x32_bf16 v[76:79], v[188:191], a[28:31], v[76:79]
    s_waitcnt lgkmcnt(4)
    v_mfma_f32_16x16x32_bf16 v[48:51], v[192:195], a[32:35], v[48:51]
    s_waitcnt vmcnt(10)
    ds_read_b64_tr_b16 v[184:185], v10 offset:0
    v_cvt_pk_bf16_f32 v114, v116, v117
    v_mfma_f32_16x16x32_bf16 v[52:55], v[192:195], a[36:39], v[52:55]
    ds_read_b64_tr_b16 v[186:187], v10 offset:1024
    v_mfma_f32_16x16x32_bf16 v[56:59], v[192:195], a[40:43], v[56:59]
    buffer_load_dwordx4 v238, s[44:47], s64 offen offset:2048  lds
    v_mfma_f32_16x16x32_bf16 v[60:63], v[192:195], a[44:47], v[60:63]
    v_cvt_pk_bf16_f32 v115, v118, v119
    v_mfma_f32_16x16x32_bf16 v[64:67], v[196:199], a[32:35], v[64:67]
    ds_read_b64_tr_b16 v[188:189], v11 offset:0
    v_mfma_f32_16x16x32_bf16 v[68:71], v[196:199], a[36:39], v[68:71]
    ds_read_b64_tr_b16 v[190:191], v11 offset:1024
    ds_write_b128 v4, v[112:115] offset:36864
    v_mfma_f32_16x16x32_bf16 v[72:75], v[196:199], a[40:43], v[72:75]
    buffer_load_dwordx4 v239, s[44:47], s64 offen offset:3072  lds
    v_mfma_f32_16x16x32_bf16 v[76:79], v[196:199], a[44:47], v[76:79]
    s_waitcnt lgkmcnt(5)
    v_mfma_f32_16x16x32_bf16 v[48:51], v[176:179], a[48:51], v[48:51]
    ds_read_b64_tr_b16 v[192:193], v10 offset:2048
    v_cvt_pk_bf16_f32 v120, v120, v121
    v_mfma_f32_16x16x32_bf16 v[52:55], v[176:179], a[52:55], v[52:55]
    ds_read_b64_tr_b16 v[194:195], v10 offset:3072
    v_mfma_f32_16x16x32_bf16 v[56:59], v[176:179], a[56:59], v[56:59]
    s_add_u32 m0, s7, 114688
    s_add_u32 s64, s66, 1327104
    buffer_load_dwordx4 v236, s[44:47], s64 offen offset:0  lds
    v_mfma_f32_16x16x32_bf16 v[60:63], v[176:179], a[60:63], v[60:63]
    buffer_load_dwordx4 v237, s[44:47], s64 offen offset:1024  lds
    v_cvt_pk_bf16_f32 v121, v122, v123
    v_mfma_f32_16x16x32_bf16 v[64:67], v[180:183], a[48:51], v[64:67]
    ds_read_b64_tr_b16 v[196:197], v11 offset:2048
    v_mfma_f32_16x16x32_bf16 v[68:71], v[180:183], a[52:55], v[68:71]
    ds_read_b64_tr_b16 v[198:199], v11 offset:3072
    v_mfma_f32_16x16x32_bf16 v[72:75], v[180:183], a[56:59], v[72:75]
    buffer_load_dwordx4 v238, s[44:47], s64 offen offset:2048  lds
    v_cvt_pk_bf16_f32 v122, v124, v125
    v_mfma_f32_16x16x32_bf16 v[76:79], v[180:183], a[60:63], v[76:79]
    s_waitcnt lgkmcnt(5)
    v_mfma_f32_16x16x32_bf16 v[48:51], v[184:187], a[64:67], v[48:51]
    s_waitcnt vmcnt(11)
    ds_read_b64_tr_b16 v[176:177], v10 offset:16384
    v_mfma_f32_16x16x32_bf16 v[52:55], v[184:187], a[68:71], v[52:55]
    ds_read_b64_tr_b16 v[178:179], v10 offset:17408
    v_cvt_pk_bf16_f32 v123, v126, v127
    v_mfma_f32_16x16x32_bf16 v[56:59], v[184:187], a[72:75], v[56:59]
    buffer_load_dwordx4 v239, s[44:47], s64 offen offset:3072  lds
    v_mfma_f32_16x16x32_bf16 v[60:63], v[184:187], a[76:79], v[60:63]
    v_mfma_f32_16x16x32_bf16 v[64:67], v[188:191], a[64:67], v[64:67]
    ds_read_b64_tr_b16 v[180:181], v11 offset:16384
    ds_write_b128 v4, v[120:123] offset:37888
    v_mfma_f32_16x16x32_bf16 v[68:71], v[188:191], a[68:71], v[68:71]
    ds_read_b64_tr_b16 v[182:183], v11 offset:17408
    v_mfma_f32_16x16x32_bf16 v[72:75], v[188:191], a[72:75], v[72:75]
    v_cvt_pk_bf16_f32 v128, v128, v129
    v_mfma_f32_16x16x32_bf16 v[76:79], v[188:191], a[76:79], v[76:79]
    s_waitcnt lgkmcnt(5)
    v_mfma_f32_16x16x32_bf16 v[48:51], v[192:195], a[80:83], v[48:51]
    ds_read_b64_tr_b16 v[184:185], v10 offset:18432
    v_mfma_f32_16x16x32_bf16 v[52:55], v[192:195], a[84:87], v[52:55]
    ds_read_b64_tr_b16 v[186:187], v10 offset:19456
    v_cvt_pk_bf16_f32 v129, v130, v131
    v_mfma_f32_16x16x32_bf16 v[56:59], v[192:195], a[88:91], v[56:59]
    s_add_u32 m0, s7, 131072
    s_add_u32 s64, s66, 1548288
    buffer_load_dwordx4 v236, s[44:47], s64 offen offset:0  lds
    v_mfma_f32_16x16x32_bf16 v[60:63], v[192:195], a[92:95], v[60:63]
    v_mfma_f32_16x16x32_bf16 v[64:67], v[196:199], a[80:83], v[64:67]
    ds_read_b64_tr_b16 v[188:189], v11 offset:18432
    v_cvt_pk_bf16_f32 v130, v132, v133
    v_mfma_f32_16x16x32_bf16 v[68:71], v[196:199], a[84:87], v[68:71]
    ds_read_b64_tr_b16 v[190:191], v11 offset:19456
    v_mfma_f32_16x16x32_bf16 v[72:75], v[196:199], a[88:91], v[72:75]
    buffer_load_dwordx4 v237, s[44:47], s64 offen offset:1024  lds
    v_mfma_f32_16x16x32_bf16 v[76:79], v[196:199], a[92:95], v[76:79]
    s_waitcnt lgkmcnt(4)
    v_mfma_f32_16x16x32_bf16 v[48:51], v[176:179], a[96:99], v[48:51]
    s_waitcnt vmcnt(10)
    ds_read_b64_tr_b16 v[192:193], v8 offset:16384
    v_cvt_pk_bf16_f32 v131, v134, v135
    v_mfma_f32_16x16x32_bf16 v[52:55], v[176:179], a[100:103], v[52:55]
    ds_read_b64_tr_b16 v[194:195], v8 offset:17408
    v_mfma_f32_16x16x32_bf16 v[56:59], v[176:179], a[104:107], v[56:59]
    buffer_load_dwordx4 v238, s[44:47], s64 offen offset:2048  lds
    ds_write_b128 v4, v[128:131] offset:38912
    v_mfma_f32_16x16x32_bf16 v[60:63], v[176:179], a[108:111], v[60:63]
    buffer_load_dwordx4 v239, s[44:47], s64 offen offset:3072  lds
    v_mfma_f32_16x16x32_bf16 v[64:67], v[180:183], a[96:99], v[64:67]
    ds_read_b64_tr_b16 v[196:197], v9 offset:16384
    v_cvt_pk_bf16_f32 v136, v136, v137
    v_mfma_f32_16x16x32_bf16 v[68:71], v[180:183], a[100:103], v[68:71]
    ds_read_b64_tr_b16 v[198:199], v9 offset:17408
    v_mfma_f32_16x16x32_bf16 v[72:75], v[180:183], a[104:107], v[72:75]
    v_mfma_f32_16x16x32_bf16 v[76:79], v[180:183], a[108:111], v[76:79]
    v_cvt_pk_bf16_f32 v137, v138, v139
    s_waitcnt lgkmcnt(5)
    v_mfma_f32_16x16x32_bf16 v[48:51], v[184:187], a[112:115], v[48:51]
    ds_read_b64_tr_b16 v[176:177], v8 offset:18432
    v_mfma_f32_16x16x32_bf16 v[52:55], v[184:187], a[116:119], v[52:55]
    ds_read_b64_tr_b16 v[178:179], v8 offset:19456
    v_mfma_f32_16x16x32_bf16 v[56:59], v[184:187], a[120:123], v[56:59]
    s_add_u32 m0, s7, 147456
    s_add_u32 s64, s66, 1769472
    buffer_load_dwordx4 v236, s[44:47], s64 offen offset:0  lds
    v_cvt_pk_bf16_f32 v138, v140, v141
    v_mfma_f32_16x16x32_bf16 v[60:63], v[184:187], a[124:127], v[60:63]
    v_mfma_f32_16x16x32_bf16 v[64:67], v[188:191], a[112:115], v[64:67]
    ds_read_b64_tr_b16 v[180:181], v9 offset:18432
    v_mfma_f32_16x16x32_bf16 v[68:71], v[188:191], a[116:119], v[68:71]
    ds_read_b64_tr_b16 v[182:183], v9 offset:19456
    v_mfma_f32_16x16x32_bf16 v[72:75], v[188:191], a[120:123], v[72:75]
    buffer_load_dwordx4 v237, s[44:47], s64 offen offset:1024  lds
    v_cvt_pk_bf16_f32 v139, v142, v143
    v_mfma_f32_16x16x32_bf16 v[76:79], v[188:191], a[124:127], v[76:79]
    s_waitcnt lgkmcnt(4)
    v_mfma_f32_16x16x32_bf16 v[48:51], v[192:195], a[128:131], v[48:51]
    s_waitcnt vmcnt(10)
    ds_read_b64_tr_b16 v[184:185], v8 offset:32768
    ds_write_b128 v4, v[136:139] offset:39936
    v_mfma_f32_16x16x32_bf16 v[52:55], v[192:195], a[132:135], v[52:55]
    ds_read_b64_tr_b16 v[186:187], v8 offset:33792
    v_mfma_f32_16x16x32_bf16 v[56:59], v[192:195], a[136:139], v[56:59]
    buffer_load_dwordx4 v238, s[44:47], s64 offen offset:2048  lds
    v_cvt_pk_bf16_f32 v144, v144, v145
    v_mfma_f32_16x16x32_bf16 v[60:63], v[192:195], a[140:143], v[60:63]
    v_mfma_f32_16x16x32_bf16 v[64:67], v[196:199], a[128:131], v[64:67]
    ds_read_b64_tr_b16 v[188:189], v9 offset:32768
    v_mfma_f32_16x16x32_bf16 v[68:71], v[196:199], a[132:135], v[68:71]
    ds_read_b64_tr_b16 v[190:191], v9 offset:33792
    v_cvt_pk_bf16_f32 v145, v146, v147
    v_mfma_f32_16x16x32_bf16 v[72:75], v[196:199], a[136:139], v[72:75]
    buffer_load_dwordx4 v239, s[44:47], s64 offen offset:3072  lds
    v_mfma_f32_16x16x32_bf16 v[76:79], v[196:199], a[140:143], v[76:79]
    s_waitcnt lgkmcnt(5)
    v_mfma_f32_16x16x32_bf16 v[48:51], v[176:179], a[144:147], v[48:51]
    ds_read_b64_tr_b16 v[192:193], v8 offset:34816
    v_mfma_f32_16x16x32_bf16 v[52:55], v[176:179], a[148:151], v[52:55]
    ds_read_b64_tr_b16 v[194:195], v8 offset:35840
    v_cvt_pk_bf16_f32 v146, v148, v149
    v_mfma_f32_16x16x32_bf16 v[56:59], v[176:179], a[152:155], v[56:59]
    s_add_u32 m0, s7, 81920
    s_add_u32 s64, s10, 0
    buffer_load_dwordx4 v252, s[44:47], s64 offen offset:0  lds
    v_mfma_f32_16x16x32_bf16 v[60:63], v[176:179], a[156:159], v[60:63]
    buffer_load_dwordx4 v253, s[44:47], s64 offen offset:1024  lds
    v_mfma_f32_16x16x32_bf16 v[64:67], v[180:183], a[144:147], v[64:67]
    ds_read_b64_tr_b16 v[196:197], v9 offset:34816
    v_cvt_pk_bf16_f32 v147, v150, v151
    v_mfma_f32_16x16x32_bf16 v[68:71], v[180:183], a[148:151], v[68:71]
    ds_read_b64_tr_b16 v[198:199], v9 offset:35840
    v_mfma_f32_16x16x32_bf16 v[72:75], v[180:183], a[152:155], v[72:75]
    buffer_load_dwordx4 v254, s[44:47], s64 offen offset:2048  lds
    ds_write_b128 v4, v[144:147] offset:40960
    v_mfma_f32_16x16x32_bf16 v[76:79], v[180:183], a[156:159], v[76:79]
    s_waitcnt lgkmcnt(5)
    v_mfma_f32_16x16x32_bf16 v[48:51], v[184:187], a[160:163], v[48:51]
    s_waitcnt vmcnt(11)
    ds_read_b64_tr_b16 v[176:177], v8 offset:49152
    v_cvt_pk_bf16_f32 v152, v152, v153
    v_mfma_f32_16x16x32_bf16 v[52:55], v[184:187], a[164:167], v[52:55]
    ds_read_b64_tr_b16 v[178:179], v8 offset:50176
    v_mfma_f32_16x16x32_bf16 v[56:59], v[184:187], a[168:171], v[56:59]
    buffer_load_dwordx4 v255, s[44:47], s64 offen offset:3072  lds
    v_mfma_f32_16x16x32_bf16 v[60:63], v[184:187], a[172:175], v[60:63]
    v_mfma_f32_16x16x32_bf16 v[64:67], v[188:191], a[160:163], v[64:67]
    ds_read_b64_tr_b16 v[180:181], v9 offset:49152
    v_cvt_pk_bf16_f32 v153, v154, v155
    v_mfma_f32_16x16x32_bf16 v[68:71], v[188:191], a[164:167], v[68:71]
    ds_read_b64_tr_b16 v[182:183], v9 offset:50176
    v_mfma_f32_16x16x32_bf16 v[72:75], v[188:191], a[168:171], v[72:75]
    v_mfma_f32_16x16x32_bf16 v[76:79], v[188:191], a[172:175], v[76:79]
    v_cvt_pk_bf16_f32 v154, v156, v157
    s_waitcnt lgkmcnt(5)
    v_mfma_f32_16x16x32_bf16 v[48:51], v[192:195], a[176:179], v[48:51]
    ds_read_b64_tr_b16 v[184:185], v8 offset:51200
    v_mfma_f32_16x16x32_bf16 v[52:55], v[192:195], a[180:183], v[52:55]
    ds_read_b64_tr_b16 v[186:187], v8 offset:52224
    v_mfma_f32_16x16x32_bf16 v[56:59], v[192:195], a[184:187], v[56:59]
    s_add_u32 m0, s7, 98304
    s_add_u32 s64, s10, 110592
    buffer_load_dwordx4 v252, s[44:47], s64 offen offset:0  lds
    v_cvt_pk_bf16_f32 v155, v158, v159
    v_mfma_f32_16x16x32_bf16 v[60:63], v[192:195], a[188:191], v[60:63]
    v_mfma_f32_16x16x32_bf16 v[64:67], v[196:199], a[176:179], v[64:67]
    ds_read_b64_tr_b16 v[188:189], v9 offset:51200
    ds_write_b128 v4, v[152:155] offset:41984
    v_mfma_f32_16x16x32_bf16 v[68:71], v[196:199], a[180:183], v[68:71]
    ds_read_b64_tr_b16 v[190:191], v9 offset:52224
    v_mfma_f32_16x16x32_bf16 v[72:75], v[196:199], a[184:187], v[72:75]
    buffer_load_dwordx4 v253, s[44:47], s64 offen offset:1024  lds
    v_cvt_pk_bf16_f32 v160, v160, v161
    v_mfma_f32_16x16x32_bf16 v[76:79], v[196:199], a[188:191], v[76:79]
    s_waitcnt lgkmcnt(5)
    v_mfma_f32_16x16x32_bf16 v[48:51], v[176:179], a[192:195], v[48:51]
    s_waitcnt vmcnt(10)
    ds_read_b64_tr_b16 v[192:193], v10 offset:0
    v_mfma_f32_16x16x32_bf16 v[52:55], v[176:179], a[196:199], v[52:55]
    ds_read_b64_tr_b16 v[194:195], v10 offset:1024
    v_mfma_f32_16x16x32_bf16 v[56:59], v[176:179], a[200:203], v[56:59]
    buffer_load_dwordx4 v254, s[44:47], s64 offen offset:2048  lds
    v_cvt_pk_bf16_f32 v161, v162, v163
    v_mfma_f32_16x16x32_bf16 v[60:63], v[176:179], a[204:207], v[60:63]
    buffer_load_dwordx4 v255, s[44:47], s64 offen offset:3072  lds
    v_mfma_f32_16x16x32_bf16 v[64:67], v[180:183], a[192:195], v[64:67]
    ds_read_b64_tr_b16 v[196:197], v11 offset:0
    v_mfma_f32_16x16x32_bf16 v[68:71], v[180:183], a[196:199], v[68:71]
    ds_read_b64_tr_b16 v[198:199], v11 offset:1024
    v_cvt_pk_bf16_f32 v162, v164, v165
    v_mfma_f32_16x16x32_bf16 v[72:75], v[180:183], a[200:203], v[72:75]
    v_mfma_f32_16x16x32_bf16 v[76:79], v[180:183], a[204:207], v[76:79]
    s_waitcnt lgkmcnt(4)
    v_mfma_f32_16x16x32_bf16 v[48:51], v[184:187], a[208:211], v[48:51]
    ds_read_b64_tr_b16 v[176:177], v10 offset:2048
    v_cvt_pk_bf16_f32 v163, v166, v167
    v_mfma_f32_16x16x32_bf16 v[52:55], v[184:187], a[212:215], v[52:55]
    ds_read_b64_tr_b16 v[178:179], v10 offset:3072
    v_mfma_f32_16x16x32_bf16 v[56:59], v[184:187], a[216:219], v[56:59]
    s_add_u32 m0, s7, 114688
    s_add_u32 s64, s10, 221184
    buffer_load_dwordx4 v252, s[44:47], s64 offen offset:0  lds
    ds_write_b128 v4, v[160:163] offset:43008
    v_mfma_f32_16x16x32_bf16 v[60:63], v[184:187], a[220:223], v[60:63]
    v_mfma_f32_16x16x32_bf16 v[64:67], v[188:191], a[208:211], v[64:67]
    ds_read_b64_tr_b16 v[180:181], v11 offset:2048
    v_mfma_f32_16x16x32_bf16 v[68:71], v[188:191], a[212:215], v[68:71]
    ds_read_b64_tr_b16 v[182:183], v11 offset:3072
    v_cvt_pk_bf16_f32 v168, v168, v169
    v_mfma_f32_16x16x32_bf16 v[72:75], v[188:191], a[216:219], v[72:75]
    buffer_load_dwordx4 v253, s[44:47], s64 offen offset:1024  lds
    v_mfma_f32_16x16x32_bf16 v[76:79], v[188:191], a[220:223], v[76:79]
    s_waitcnt lgkmcnt(5)
    v_mfma_f32_16x16x32_bf16 v[48:51], v[192:195], a[224:227], v[48:51]
    s_waitcnt vmcnt(10)
    ds_read_b64_tr_b16 v[184:185], v10 offset:16384
    v_cvt_pk_bf16_f32 v169, v170, v171
    v_mfma_f32_16x16x32_bf16 v[52:55], v[192:195], a[228:231], v[52:55]
    ds_read_b64_tr_b16 v[186:187], v10 offset:17408
    v_mfma_f32_16x16x32_bf16 v[56:59], v[192:195], a[232:235], v[56:59]
    buffer_load_dwordx4 v254, s[44:47], s64 offen offset:2048  lds
    v_mfma_f32_16x16x32_bf16 v[60:63], v[192:195], a[236:239], v[60:63]
    v_cvt_pk_bf16_f32 v170, v172, v173
    v_mfma_f32_16x16x32_bf16 v[64:67], v[196:199], a[224:227], v[64:67]
    ds_read_b64_tr_b16 v[188:189], v11 offset:16384
    v_mfma_f32_16x16x32_bf16 v[68:71], v[196:199], a[228:231], v[68:71]
    ds_read_b64_tr_b16 v[190:191], v11 offset:17408
    v_mfma_f32_16x16x32_bf16 v[72:75], v[196:199], a[232:235], v[72:75]
    buffer_load_dwordx4 v255, s[44:47], s64 offen offset:3072  lds
    v_cvt_pk_bf16_f32 v171, v174, v175
    v_mfma_f32_16x16x32_bf16 v[76:79], v[196:199], a[236:239], v[76:79]
    s_waitcnt lgkmcnt(4)
    v_mfma_f32_16x16x32_bf16 v[48:51], v[176:179], a[240:243], v[48:51]
    ds_read_b64_tr_b16 v[192:193], v10 offset:18432
    ds_write_b128 v4, v[168:171] offset:44032
    v_mfma_f32_16x16x32_bf16 v[52:55], v[176:179], a[244:247], v[52:55]
    ds_read_b64_tr_b16 v[194:195], v10 offset:19456
    v_mfma_f32_16x16x32_bf16 v[56:59], v[176:179], a[248:251], v[56:59]
    s_add_u32 m0, s7, 131072
    s_add_u32 s64, s10, 331776
    buffer_load_dwordx4 v252, s[44:47], s64 offen offset:0  lds
    v_mfma_f32_16x16x32_bf16 v[60:63], v[176:179], a[252:255], v[60:63]
    buffer_load_dwordx4 v253, s[44:47], s64 offen offset:1024  lds
    v_mfma_f32_16x16x32_bf16 v[64:67], v[180:183], a[240:243], v[64:67]
    ds_read_b64_tr_b16 v[196:197], v11 offset:18432
    v_mfma_f32_16x16x32_bf16 v[68:71], v[180:183], a[244:247], v[68:71]
    ds_read_b64_tr_b16 v[198:199], v11 offset:19456
    v_mfma_f32_16x16x32_bf16 v[72:75], v[180:183], a[248:251], v[72:75]
    buffer_load_dwordx4 v254, s[44:47], s64 offen offset:2048  lds
    v_mfma_f32_16x16x32_bf16 v[76:79], v[180:183], a[252:255], v[76:79]
    s_waitcnt lgkmcnt(5)
    v_mfma_f32_16x16x32_bf16 v[48:51], v[184:187], v[16:19], v[48:51]
    s_waitcnt vmcnt(11)
    ds_read_b64_tr_b16 v[176:177], v244 offset:16384
    v_mfma_f32_16x16x32_bf16 v[52:55], v[184:187], v[20:23], v[52:55]
    ds_read_b64_tr_b16 v[178:179], v244 offset:18432
    v_mfma_f32_16x16x32_bf16 v[56:59], v[184:187], v[24:27], v[56:59]
    buffer_load_dwordx4 v255, s[44:47], s64 offen offset:3072  lds
    v_mfma_f32_16x16x32_bf16 v[60:63], v[184:187], v[28:31], v[60:63]
    v_mfma_f32_16x16x32_bf16 v[64:67], v[188:191], v[16:19], v[64:67]
    ds_read_b64_tr_b16 v[180:181], v245 offset:16384
    v_mfma_f32_16x16x32_bf16 v[68:71], v[188:191], v[20:23], v[68:71]
    ds_read_b64_tr_b16 v[182:183], v245 offset:18432
    v_mfma_f32_16x16x32_bf16 v[72:75], v[188:191], v[24:27], v[72:75]
    v_mfma_f32_16x16x32_bf16 v[76:79], v[188:191], v[28:31], v[76:79]
    s_waitcnt lgkmcnt(4)
    v_mfma_f32_16x16x32_bf16 v[48:51], v[192:195], v[32:35], v[48:51]
    ds_read_b64_tr_b16 v[184:185], v246 offset:16384
    v_mfma_f32_16x16x32_bf16 v[52:55], v[192:195], v[36:39], v[52:55]
    ds_read_b64_tr_b16 v[186:187], v246 offset:18432
    v_mfma_f32_16x16x32_bf16 v[56:59], v[192:195], v[40:43], v[56:59]
    s_add_u32 m0, s7, 147456
    s_add_u32 s64, s10, 442368
    buffer_load_dwordx4 v252, s[44:47], s64 offen offset:0  lds
    v_mfma_f32_16x16x32_bf16 v[60:63], v[192:195], v[44:47], v[60:63]
    v_mfma_f32_16x16x32_bf16 v[64:67], v[196:199], v[32:35], v[64:67]
    ds_read_b64_tr_b16 v[188:189], v247 offset:16384
    v_mfma_f32_16x16x32_bf16 v[68:71], v[196:199], v[36:39], v[68:71]
    ds_read_b64_tr_b16 v[190:191], v247 offset:18432
    v_mfma_f32_16x16x32_bf16 v[72:75], v[196:199], v[40:43], v[72:75]
    buffer_load_dwordx4 v253, s[44:47], s64 offen offset:1024  lds
    v_mfma_f32_16x16x32_bf16 v[76:79], v[196:199], v[44:47], v[76:79]
L_ldone:
    s_nop 7
    s_nop 3
    s_cmp_eq_u32 s3, 1
    s_cbranch_scc1 L_lv
    v_mul_f32 v200, 0x3fb8aa3b, v48
    v_exp_f32_e64 v200, v200 clamp
    v_mul_f32 v201, 0x3fb8aa3b, v49
    v_max_f32 v48, s68, v48
    v_exp_f32_e64 v201, v201 clamp
    v_mul_f32 v202, 0x3fb8aa3b, v50
    v_add_f32 v48, v48, v200
    v_max_f32 v49, s68, v49
    v_exp_f32_e64 v202, v202 clamp
    v_mul_f32 v203, 0x3fb8aa3b, v51
    v_add_f32 v49, v49, v201
    v_max_f32 v50, s68, v50
    v_exp_f32_e64 v203, v203 clamp
    v_mul_f32 v204, 0x3fb8aa3b, v52
    v_add_f32 v50, v50, v202
    v_max_f32 v51, s68, v51
    v_exp_f32_e64 v204, v204 clamp
    v_mul_f32 v205, 0x3fb8aa3b, v53
    v_add_f32 v51, v51, v203
    v_max_f32 v52, s68, v52
    v_exp_f32_e64 v205, v205 clamp
    v_mul_f32 v206, 0x3fb8aa3b, v54
    v_add_f32 v52, v52, v204
    v_max_f32 v53, s68, v53
    v_exp_f32_e64 v206, v206 clamp
    v_mul_f32 v207, 0x3fb8aa3b, v55
    v_add_f32 v53, v53, v205
    v_max_f32 v54, s68, v54
    v_exp_f32_e64 v207, v207 clamp
    v_mul_f32 v200, 0x3fb8aa3b, v56
    v_add_f32 v54, v54, v206
    v_max_f32 v55, s68, v55
    v_exp_f32_e64 v200, v200 clamp
    v_mul_f32 v201, 0x3fb8aa3b, v57
    v_add_f32 v55, v55, v207
    v_max_f32 v56, s68, v56
    v_exp_f32_e64 v201, v201 clamp
    v_mul_f32 v202, 0x3fb8aa3b, v58
    v_add_f32 v56, v56, v200
    v_max_f32 v57, s68, v57
    v_exp_f32_e64 v202, v202 clamp
    v_mul_f32 v203, 0x3fb8aa3b, v59
    v_add_f32 v57, v57, v201
    v_max_f32 v58, s68, v58
    v_exp_f32_e64 v203, v203 clamp
    v_mul_f32 v204, 0x3fb8aa3b, v60
    v_add_f32 v58, v58, v202
    v_max_f32 v59, s68, v59
    v_exp_f32_e64 v204, v204 clamp
    v_mul_f32 v205, 0x3fb8aa3b, v61
    v_add_f32 v59, v59, v203
    v_max_f32 v60, s68, v60
    v_exp_f32_e64 v205, v205 clamp
    v_mul_f32 v206, 0x3fb8aa3b, v62
    v_add_f32 v60, v60, v204
    v_max_f32 v61, s68, v61
    v_exp_f32_e64 v206, v206 clamp
    v_mul_f32 v207, 0x3fb8aa3b, v63
    v_add_f32 v61, v61, v205
    v_max_f32 v62, s68, v62
    v_exp_f32_e64 v207, v207 clamp
    v_mul_f32 v200, 0x3fb8aa3b, v64
    v_add_f32 v62, v62, v206
    v_max_f32 v63, s68, v63
    v_exp_f32_e64 v200, v200 clamp
    v_mul_f32 v201, 0x3fb8aa3b, v65
    v_add_f32 v63, v63, v207
    v_max_f32 v64, s68, v64
    v_exp_f32_e64 v201, v201 clamp
    v_mul_f32 v202, 0x3fb8aa3b, v66
    v_add_f32 v64, v64, v200
    v_max_f32 v65, s68, v65
    v_exp_f32_e64 v202, v202 clamp
    v_mul_f32 v203, 0x3fb8aa3b, v67
    v_add_f32 v65, v65, v201
    v_max_f32 v66, s68, v66
    v_exp_f32_e64 v203, v203 clamp
    v_mul_f32 v204, 0x3fb8aa3b, v68
    v_add_f32 v66, v66, v202
    v_max_f32 v67, s68, v67
    v_exp_f32_e64 v204, v204 clamp
    v_mul_f32 v205, 0x3fb8aa3b, v69
    v_add_f32 v67, v67, v203
    v_max_f32 v68, s68, v68
    v_exp_f32_e64 v205, v205 clamp
    v_mul_f32 v206, 0x3fb8aa3b, v70
    v_add_f32 v68, v68, v204
    v_max_f32 v69, s68, v69
    v_exp_f32_e64 v206, v206 clamp
    v_mul_f32 v207, 0x3fb8aa3b, v71
    v_add_f32 v69, v69, v205
    v_max_f32 v70, s68, v70
    v_exp_f32_e64 v207, v207 clamp
    v_mul_f32 v200, 0x3fb8aa3b, v72
    v_add_f32 v70, v70, v206
    v_max_f32 v71, s68, v71
    v_exp_f32_e64 v200, v200 clamp
    v_mul_f32 v201, 0x3fb8aa3b, v73
    v_add_f32 v71, v71, v207
    v_max_f32 v72, s68, v72
    v_exp_f32_e64 v201, v201 clamp
    v_mul_f32 v202, 0x3fb8aa3b, v74
    v_add_f32 v72, v72, v200
    v_max_f32 v73, s68, v73
    v_exp_f32_e64 v202, v202 clamp
    v_mul_f32 v203, 0x3fb8aa3b, v75
    v_add_f32 v73, v73, v201
    v_max_f32 v74, s68, v74
    v_exp_f32_e64 v203, v203 clamp
    v_mul_f32 v204, 0x3fb8aa3b, v76
    v_add_f32 v74, v74, v202
    v_max_f32 v75, s68, v75
    v_exp_f32_e64 v204, v204 clamp
    v_mul_f32 v205, 0x3fb8aa3b, v77
    v_add_f32 v75, v75, v203
    v_max_f32 v76, s68, v76
    v_exp_f32_e64 v205, v205 clamp
    v_mul_f32 v206, 0x3fb8aa3b, v78
    v_add_f32 v76, v76, v204
    v_max_f32 v77, s68, v77
    v_exp_f32_e64 v206, v206 clamp
    v_mul_f32 v207, 0x3fb8aa3b, v79
    v_add_f32 v77, v77, v205
    v_max_f32 v78, s68, v78
    v_exp_f32_e64 v207, v207 clamp
    v_add_f32 v78, v78, v206
    v_max_f32 v79, s68, v79
    v_add_f32 v79, v79, v207
L_lv:
    s_nop 7
    s_nop 3
    v_cvt_pk_bf16_f32 v216, v48, v49
    v_cvt_pk_bf16_f32 v217, v50, v51
    v_cvt_pk_bf16_f32 v218, v52, v53
    v_cvt_pk_bf16_f32 v219, v54, v55
    v_cvt_pk_bf16_f32 v220, v56, v57
    v_cvt_pk_bf16_f32 v221, v58, v59
    v_cvt_pk_bf16_f32 v222, v60, v61
    v_cvt_pk_bf16_f32 v223, v62, v63
    v_cvt_pk_bf16_f32 v224, v64, v65
    v_cvt_pk_bf16_f32 v225, v66, v67
    v_cvt_pk_bf16_f32 v226, v68, v69
    v_cvt_pk_bf16_f32 v227, v70, v71
    v_cvt_pk_bf16_f32 v228, v72, v73
    v_cvt_pk_bf16_f32 v229, v74, v75
    v_cvt_pk_bf16_f32 v230, v76, v77
    v_cvt_pk_bf16_f32 v231, v78, v79
    s_lshl_b32 s9, s80, 11
    v_add_u32 v201, s9, v2
    s_cmp_lt_u32 s3, 2
    s_cselect_b64 exec, -1, 0
    ds_write_b128 v5, v[216:219] offset:0
    ds_write_b128 v5, v[220:223] offset:1024
    ds_write_b128 v5, v[224:227] offset:2048
    ds_write_b128 v5, v[228:231] offset:3072
    s_mov_b64 exec, -1
    s_waitcnt lgkmcnt(0)
    s_barrier
    ds_read_b128 v[48:51], v201 offset:0
    ds_read_b128 v[88:91], v201 offset:36864
    ds_read_b128 v[56:59], v201 offset:2048
    ds_read_b128 v[96:99], v201 offset:38912
    ds_read_b128 v[64:67], v201 offset:4096
    ds_read_b128 v[104:107], v201 offset:40960
    ds_read_b128 v[72:75], v201 offset:6144
    ds_read_b128 v[112:115], v201 offset:43008
    ds_read_b128 v[80:83], v201 offset:8192
    ds_read_b128 v[120:123], v201 offset:45056
    ds_read_b128 v[52:55], v201 offset:1024
    ds_read_b128 v[92:95], v201 offset:37888
    ds_read_b128 v[60:63], v201 offset:3072
    ds_read_b128 v[100:103], v201 offset:39936
    ds_read_b128 v[68:71], v201 offset:5120
    ds_read_b128 v[108:111], v201 offset:41984
    ds_read_b128 v[76:79], v201 offset:7168
    ds_read_b128 v[116:119], v201 offset:44032
    ds_read_b128 v[84:87], v201 offset:9216
    ds_read_b128 v[124:127], v201 offset:46080
    v_mov_b32 v208, s14
    v_mov_b32 v209, s14
    v_mov_b32 v210, s14
    v_mov_b32 v211, s14
    s_waitcnt lgkmcnt(10)
    v_mfma_f32_16x16x32_bf16 v[128:131], v[48:51], v[88:91], 0
    v_mfma_f32_16x16x32_bf16 v[132:135], v[56:59], v[88:91], 0
    v_mfma_f32_16x16x32_bf16 v[136:139], v[48:51], v[96:99], 0
    v_mfma_f32_16x16x32_bf16 v[140:143], v[56:59], v[96:99], 0
    v_mfma_f32_16x16x32_bf16 v[144:147], v[64:67], v[104:107], 0
    v_mfma_f32_16x16x32_bf16 v[148:151], v[72:75], v[104:107], 0
    v_mfma_f32_16x16x32_bf16 v[152:155], v[64:67], v[112:115], 0
    v_mfma_f32_16x16x32_bf16 v[156:159], v[72:75], v[112:115], 0
    v_mfma_f32_16x16x32_bf16 v[160:163], v[64:67], v[96:99], 0
    v_mfma_f32_16x16x32_bf16 v[164:167], v[56:59], v[104:107], 0
    v_mfma_f32_16x16x32_bf16 v[168:171], v[80:83], v[112:115], 0
    v_mfma_f32_16x16x32_bf16 v[172:175], v[72:75], v[120:123], 0
    s_waitcnt lgkmcnt(0)
    v_mfma_f32_16x16x32_bf16 v[128:131], v[52:55], v[92:95], v[128:131]
    v_mfma_f32_16x16x32_bf16 v[132:135], v[60:63], v[92:95], v[132:135]
    v_mfma_f32_16x16x32_bf16 v[136:139], v[52:55], v[100:103], v[136:139]
    v_mfma_f32_16x16x32_bf16 v[140:143], v[60:63], v[100:103], v[140:143]
    v_mfma_f32_16x16x32_bf16 v[144:147], v[68:71], v[108:111], v[144:147]
    v_mfma_f32_16x16x32_bf16 v[148:151], v[76:79], v[108:111], v[148:151]
    v_mfma_f32_16x16x32_bf16 v[152:155], v[68:71], v[116:119], v[152:155]
    v_mfma_f32_16x16x32_bf16 v[156:159], v[76:79], v[116:119], v[156:159]
    v_mfma_f32_16x16x32_bf16 v[160:163], v[68:71], v[100:103], v[160:163]
    v_mfma_f32_16x16x32_bf16 v[164:167], v[60:63], v[108:111], v[164:167]
    v_mfma_f32_16x16x32_bf16 v[168:171], v[84:87], v[116:119], v[168:171]
    v_mfma_f32_16x16x32_bf16 v[172:175], v[76:79], v[124:127], v[172:175]
    v_cvt_pk_bf16_f32 v128, v128, v129
    v_cvt_pk_bf16_f32 v129, v130, v131
    v_cvt_pk_bf16_f32 v130, v132, v133
    v_cvt_pk_bf16_f32 v132, v134, v135
    v_cvt_pk_bf16_f32 v133, v136, v137
    v_cvt_pk_bf16_f32 v134, v138, v139
    v_mov_b32 v131, s86
    s_add_u32 s70, s81, 0
    buffer_store_dwordx4 v[128:131], v2, s[52:55], s70 offen offset:0 sc1
    v_cvt_pk_bf16_f32 v136, v140, v141
    v_cvt_pk_bf16_f32 v137, v142, v143
    v_cvt_pk_bf16_f32 v138, v144, v145
    v_mov_b32 v135, s86
    buffer_store_dwordx4 v[132:135], v2, s[52:55], s70 offen offset:1024 sc1
    v_cvt_pk_bf16_f32 v140, v146, v147
    v_cvt_pk_bf16_f32 v141, v148, v149
    v_cvt_pk_bf16_f32 v142, v150, v151
    v_mov_b32 v139, s86
    buffer_store_dwordx4 v[136:139], v2, s[52:55], s70 offen offset:2048 sc1
    v_cvt_pk_bf16_f32 v144, v152, v153
    v_cvt_pk_bf16_f32 v145, v154, v155
    v_cvt_pk_bf16_f32 v146, v156, v157
    v_mov_b32 v143, s86
    buffer_store_dwordx4 v[140:143], v2, s[52:55], s70 offen offset:3072 sc1
    v_cvt_pk_bf16_f32 v148, v158, v159
    v_cvt_pk_bf16_f32 v149, v160, v161
    v_cvt_pk_bf16_f32 v150, v162, v163
    v_mov_b32 v147, s86
    s_add_u32 s70, s81, 4096
    buffer_store_dwordx4 v[144:147], v2, s[52:55], s70 offen offset:0 sc1
    v_cvt_pk_bf16_f32 v152, v164, v165
    v_cvt_pk_bf16_f32 v153, v166, v167
    v_cvt_pk_bf16_f32 v154, v168, v169
    v_mov_b32 v151, s86
    buffer_store_dwordx4 v[148:151], v2, s[52:55], s70 offen offset:1024 sc1
    v_cvt_pk_bf16_f32 v156, v170, v171
    v_cvt_pk_bf16_f32 v157, v172, v173
    v_cvt_pk_bf16_f32 v158, v174, v175
    v_mov_b32 v155, s86
    buffer_store_dwordx4 v[152:155], v2, s[52:55], s70 offen offset:2048 sc1
    v_mov_b32 v159, s86
    buffer_store_dwordx4 v[156:159], v2, s[52:55], s70 offen offset:3072 sc1
    v_mfma_f32_16x16x32_bf16 v[128:131], v[80:83], v[120:123], 0
    v_mfma_f32_16x16x32_bf16 v[132:135], v[80:83], v[208:211], 0
    v_mfma_f32_16x16x32_bf16 v[136:139], v[48:51], v[208:211], 0
    v_mfma_f32_16x16x32_bf16 v[140:143], v[56:59], v[208:211], 0
    v_mfma_f32_16x16x32_bf16 v[144:147], v[64:67], v[208:211], 0
    v_mfma_f32_16x16x32_bf16 v[148:151], v[72:75], v[208:211], 0
    v_mfma_f32_16x16x32_bf16 v[128:131], v[84:87], v[124:127], v[128:131]
    v_mfma_f32_16x16x32_bf16 v[132:135], v[84:87], v[208:211], v[132:135]
    v_mfma_f32_16x16x32_bf16 v[136:139], v[52:55], v[208:211], v[136:139]
    v_mfma_f32_16x16x32_bf16 v[140:143], v[60:63], v[208:211], v[140:143]
    v_mfma_f32_16x16x32_bf16 v[144:147], v[68:71], v[208:211], v[144:147]
    v_mfma_f32_16x16x32_bf16 v[148:151], v[76:79], v[208:211], v[148:151]
    s_nop 2
    v_cvt_pk_bf16_f32 v128, v128, v129
    v_cvt_pk_bf16_f32 v129, v130, v131
    v_cvt_pk_bf16_f32 v130, v132, v133
    v_cvt_pk_bf16_f32 v132, v134, v135
    v_cvt_pk_bf16_f32 v133, v136, v137
    v_cvt_pk_bf16_f32 v134, v138, v139
    v_mov_b32 v131, s86
    s_add_u32 s70, s81, 8192
    buffer_store_dwordx4 v[128:131], v2, s[52:55], s70 offen offset:0 sc1
    v_cvt_pk_bf16_f32 v136, v140, v141
    v_cvt_pk_bf16_f32 v137, v142, v143
    v_cvt_pk_bf16_f32 v138, v144, v145
    v_mov_b32 v135, s86
    buffer_store_dwordx4 v[132:135], v2, s[52:55], s70 offen offset:1024 sc1
    v_cvt_pk_bf16_f32 v140, v146, v147
    v_cvt_pk_bf16_f32 v141, v148, v149
    v_cvt_pk_bf16_f32 v142, v150, v151
    v_mov_b32 v139, s86
    buffer_store_dwordx4 v[136:139], v2, s[52:55], s70 offen offset:2048 sc1
    v_mov_b32 v143, s86
    buffer_store_dwordx4 v[140:143], v2, s[52:55], s70 offen offset:3072 sc1
    v_mfma_f32_16x16x32_bf16 v[112:115], v[176:179], a[0:3], v[232:235]
    s_waitcnt vmcnt(22)
    ds_read_b64_tr_b16 v[192:193], v244 offset:32768
    v_mfma_f32_16x16x32_bf16 v[116:119], v[176:179], a[4:7], v[232:235]
    ds_read_b64_tr_b16 v[194:195], v244 offset:34816
    v_mfma_f32_16x16x32_bf16 v[120:123], v[176:179], a[8:11], v[232:235]
    buffer_load_dwordx4 v254, s[44:47], s64 offen offset:2048  lds
    v_mfma_f32_16x16x32_bf16 v[124:127], v[176:179], a[12:15], v[232:235]
    buffer_load_dwordx4 v255, s[44:47], s64 offen offset:3072  lds
    v_mfma_f32_16x16x32_bf16 v[128:131], v[180:183], a[0:3], v[232:235]
    ds_read_b64_tr_b16 v[196:197], v245 offset:32768
    v_mfma_f32_16x16x32_bf16 v[132:135], v[180:183], a[4:7], v[232:235]
    ds_read_b64_tr_b16 v[198:199], v245 offset:34816
    v_mfma_f32_16x16x32_bf16 v[136:139], v[180:183], a[8:11], v[232:235]
    s_add_u32 m0, s7, 81920
    s_add_u32 s64, s10, 552960
    buffer_load_dwordx4 v252, s[44:47], s64 offen offset:0  lds
    v_mfma_f32_16x16x32_bf16 v[140:143], v[180:183], a[12:15], v[232:235]
    v_mfma_f32_16x16x32_bf16 v[144:147], v[184:187], a[0:3], v[232:235]
    ds_read_b64_tr_b16 v[176:177], v246 offset:32768
    v_mfma_f32_16x16x32_bf16 v[148:151], v[184:187], a[4:7], v[232:235]
    ds_read_b64_tr_b16 v[178:179], v246 offset:34816
    v_mfma_f32_16x16x32_bf16 v[152:155], v[184:187], a[8:11], v[232:235]
    buffer_load_dwordx4 v253, s[44:47], s64 offen offset:1024  lds
    v_mfma_f32_16x16x32_bf16 v[156:159], v[184:187], a[12:15], v[232:235]
    v_mfma_f32_16x16x32_bf16 v[160:163], v[188:191], a[0:3], v[232:235]
    ds_read_b64_tr_b16 v[180:181], v247 offset:32768
    v_mfma_f32_16x16x32_bf16 v[164:167], v[188:191], a[4:7], v[232:235]
    ds_read_b64_tr_b16 v[182:183], v247 offset:34816
    v_mfma_f32_16x16x32_bf16 v[168:171], v[188:191], a[8:11], v[232:235]
    buffer_load_dwordx4 v254, s[44:47], s64 offen offset:2048  lds
    v_mfma_f32_16x16x32_bf16 v[172:175], v[188:191], a[12:15], v[232:235]
    s_waitcnt lgkmcnt(4)
    v_mfma_f32_16x16x32_bf16 v[112:115], v[192:195], a[16:19], v[112:115]
    s_waitcnt vmcnt(23)
    ds_read_b64_tr_b16 v[184:185], v244 offset:49152
    v_mfma_f32_16x16x32_bf16 v[116:119], v[192:195], a[20:23], v[116:119]
    ds_read_b64_tr_b16 v[186:187], v244 offset:51200
    v_mfma_f32_16x16x32_bf16 v[120:123], v[192:195], a[24:27], v[120:123]
    buffer_load_dwordx4 v255, s[44:47], s64 offen offset:3072  lds
    v_mfma_f32_16x16x32_bf16 v[124:127], v[192:195], a[28:31], v[124:127]
    v_mfma_f32_16x16x32_bf16 v[128:131], v[196:199], a[16:19], v[128:131]
    ds_read_b64_tr_b16 v[188:189], v245 offset:49152
    v_mfma_f32_16x16x32_bf16 v[132:135], v[196:199], a[20:23], v[132:135]
    ds_read_b64_tr_b16 v[190:191], v245 offset:51200
    v_mfma_f32_16x16x32_bf16 v[136:139], v[196:199], a[24:27], v[136:139]
    v_mfma_f32_16x16x32_bf16 v[140:143], v[196:199], a[28:31], v[140:143]
    s_waitcnt lgkmcnt(4)
    v_mfma_f32_16x16x32_bf16 v[144:147], v[176:179], a[16:19], v[144:147]
    ds_read_b64_tr_b16 v[192:193], v246 offset:49152
    v_mfma_f32_16x16x32_bf16 v[148:151], v[176:179], a[20:23], v[148:151]
    ds_read_b64_tr_b16 v[194:195], v246 offset:51200
    v_mfma_f32_16x16x32_bf16 v[152:155], v[176:179], a[24:27], v[152:155]
    s_add_u32 m0, s7, 98304
    s_add_u32 s64, s10, 663552
    buffer_load_dwordx4 v252, s[44:47], s64 offen offset:0  lds
    v_mfma_f32_16x16x32_bf16 v[156:159], v[176:179], a[28:31], v[156:159]
    buffer_load_dwordx4 v253, s[44:47], s64 offen offset:1024  lds
    v_mfma_f32_16x16x32_bf16 v[160:163], v[180:183], a[16:19], v[160:163]
    ds_read_b64_tr_b16 v[196:197], v247 offset:49152
    v_mfma_f32_16x16x32_bf16 v[164:167], v[180:183], a[20:23], v[164:167]
    ds_read_b64_tr_b16 v[198:199], v247 offset:51200
    v_mfma_f32_16x16x32_bf16 v[168:171], v[180:183], a[24:27], v[168:171]
    buffer_load_dwordx4 v254, s[44:47], s64 offen offset:2048  lds
    v_mfma_f32_16x16x32_bf16 v[172:175], v[180:183], a[28:31], v[172:175]
    s_waitcnt lgkmcnt(4)
    v_mfma_f32_16x16x32_bf16 v[112:115], v[184:187], a[32:35], v[112:115]
    s_waitcnt vmcnt(23)
    ds_read_b64_tr_b16 v[176:177], v248 offset:0
    v_mfma_f32_16x16x32_bf16 v[116:119], v[184:187], a[36:39], v[116:119]
    ds_read_b64_tr_b16 v[178:179], v248 offset:2048
    v_mfma_f32_16x16x32_bf16 v[120:123], v[184:187], a[40:43], v[120:123]
    buffer_load_dwordx4 v255, s[44:47], s64 offen offset:3072  lds
    v_mfma_f32_16x16x32_bf16 v[124:127], v[184:187], a[44:47], v[124:127]
    v_mfma_f32_16x16x32_bf16 v[128:131], v[188:191], a[32:35], v[128:131]
    ds_read_b64_tr_b16 v[180:181], v249 offset:0
    v_mfma_f32_16x16x32_bf16 v[132:135], v[188:191], a[36:39], v[132:135]
    ds_read_b64_tr_b16 v[182:183], v249 offset:2048
    v_mfma_f32_16x16x32_bf16 v[136:139], v[188:191], a[40:43], v[136:139]
    v_mfma_f32_16x16x32_bf16 v[140:143], v[188:191], a[44:47], v[140:143]
    s_waitcnt lgkmcnt(4)
    v_mfma_f32_16x16x32_bf16 v[144:147], v[192:195], a[32:35], v[144:147]
    ds_read_b64_tr_b16 v[184:185], v250 offset:0
    v_mfma_f32_16x16x32_bf16 v[148:151], v[192:195], a[36:39], v[148:151]
    ds_read_b64_tr_b16 v[186:187], v250 offset:2048
    v_mfma_f32_16x16x32_bf16 v[152:155], v[192:195], a[40:43], v[152:155]
    s_add_u32 m0, s7, 114688
    s_add_u32 s64, s10, 774144
    buffer_load_dwordx4 v252, s[44:47], s64 offen offset:0  lds
    v_mfma_f32_16x16x32_bf16 v[156:159], v[192:195], a[44:47], v[156:159]
    v_mfma_f32_16x16x32_bf16 v[160:163], v[196:199], a[32:35], v[160:163]
    ds_read_b64_tr_b16 v[188:189], v251 offset:0
    v_mfma_f32_16x16x32_bf16 v[164:167], v[196:199], a[36:39], v[164:167]
    ds_read_b64_tr_b16 v[190:191], v251 offset:2048
    v_mfma_f32_16x16x32_bf16 v[168:171], v[196:199], a[40:43], v[168:171]
    buffer_load_dwordx4 v253, s[44:47], s64 offen offset:1024  lds
    v_mfma_f32_16x16x32_bf16 v[172:175], v[196:199], a[44:47], v[172:175]
    s_waitcnt lgkmcnt(4)
    v_mfma_f32_16x16x32_bf16 v[112:115], v[176:179], a[48:51], v[112:115]
    s_waitcnt vmcnt(10)
    ds_read_b64_tr_b16 v[192:193], v248 offset:16384
    v_mfma_f32_16x16x32_bf16 v[116:119], v[176:179], a[52:55], v[116:119]
    ds_read_b64_tr_b16 v[194:195], v248 offset:18432
    v_mfma_f32_16x16x32_bf16 v[120:123], v[176:179], a[56:59], v[120:123]
    buffer_load_dwordx4 v254, s[44:47], s64 offen offset:2048  lds
    v_mfma_f32_16x16x32_bf16 v[124:127], v[176:179], a[60:63], v[124:127]
    buffer_load_dwordx4 v255, s[44:47], s64 offen offset:3072  lds
    v_mfma_f32_16x16x32_bf16 v[128:131], v[180:183], a[48:51], v[128:131]
    ds_read_b64_tr_b16 v[196:197], v249 offset:16384
    v_mfma_f32_16x16x32_bf16 v[132:135], v[180:183], a[52:55], v[132:135]
    ds_read_b64_tr_b16 v[198:199], v249 offset:18432
    v_mfma_f32_16x16x32_bf16 v[136:139], v[180:183], a[56:59], v[136:139]
    v_mfma_f32_16x16x32_bf16 v[140:143], v[180:183], a[60:63], v[140:143]
    s_waitcnt lgkmcnt(4)
    v_mfma_f32_16x16x32_bf16 v[144:147], v[184:187], a[48:51], v[144:147]
    ds_read_b64_tr_b16 v[176:177], v250 offset:16384
    v_mfma_f32_16x16x32_bf16 v[148:151], v[184:187], a[52:55], v[148:151]
    ds_read_b64_tr_b16 v[178:179], v250 offset:18432
    v_mfma_f32_16x16x32_bf16 v[152:155], v[184:187], a[56:59], v[152:155]
    s_add_u32 m0, s7, 131072
    s_add_u32 s64, s10, 884736
    buffer_load_dwordx4 v252, s[44:47], s64 offen offset:0  lds
    v_mfma_f32_16x16x32_bf16 v[156:159], v[184:187], a[60:63], v[156:159]
    v_mfma_f32_16x16x32_bf16 v[160:163], v[188:191], a[48:51], v[160:163]
    ds_read_b64_tr_b16 v[180:181], v251 offset:16384
    v_mfma_f32_16x16x32_bf16 v[164:167], v[188:191], a[52:55], v[164:167]
    ds_read_b64_tr_b16 v[182:183], v251 offset:18432
    v_mfma_f32_16x16x32_bf16 v[168:171], v[188:191], a[56:59], v[168:171]
    buffer_load_dwordx4 v253, s[44:47], s64 offen offset:1024  lds
    v_mfma_f32_16x16x32_bf16 v[172:175], v[188:191], a[60:63], v[172:175]
    s_waitcnt lgkmcnt(4)
    v_mfma_f32_16x16x32_bf16 v[112:115], v[192:195], a[64:67], v[112:115]
    s_waitcnt vmcnt(10)
    ds_read_b64_tr_b16 v[184:185], v244 offset:16384
    v_mfma_f32_16x16x32_bf16 v[116:119], v[192:195], a[68:71], v[116:119]
    ds_read_b64_tr_b16 v[186:187], v244 offset:18432
    v_mfma_f32_16x16x32_bf16 v[120:123], v[192:195], a[72:75], v[120:123]
    buffer_load_dwordx4 v254, s[44:47], s64 offen offset:2048  lds
    v_mfma_f32_16x16x32_bf16 v[124:127], v[192:195], a[76:79], v[124:127]
    v_mfma_f32_16x16x32_bf16 v[128:131], v[196:199], a[64:67], v[128:131]
    ds_read_b64_tr_b16 v[188:189], v245 offset:16384
    v_mfma_f32_16x16x32_bf16 v[132:135], v[196:199], a[68:71], v[132:135]
    ds_read_b64_tr_b16 v[190:191], v245 offset:18432
    v_mfma_f32_16x16x32_bf16 v[136:139], v[196:199], a[72:75], v[136:139]
    buffer_load_dwordx4 v255, s[44:47], s64 offen offset:3072  lds
    v_mfma_f32_16x16x32_bf16 v[140:143], v[196:199], a[76:79], v[140:143]
    s_waitcnt lgkmcnt(4)
    v_mfma_f32_16x16x32_bf16 v[144:147], v[176:179], a[64:67], v[144:147]
    ds_read_b64_tr_b16 v[192:193], v246 offset:16384
    v_mfma_f32_16x16x32_bf16 v[148:151], v[176:179], a[68:71], v[148:151]
    ds_read_b64_tr_b16 v[194:195], v246 offset:18432
    v_mfma_f32_16x16x32_bf16 v[152:155], v[176:179], a[72:75], v[152:155]
    s_add_u32 m0, s7, 147456
    s_add_u32 s64, s10, 995328
    buffer_load_dwordx4 v252, s[44:47], s64 offen offset:0  lds
    v_mfma_f32_16x16x32_bf16 v[156:159], v[176:179], a[76:79], v[156:159]
    buffer_load_dwordx4 v253, s[44:47], s64 offen offset:1024  lds
    v_mfma_f32_16x16x32_bf16 v[160:163], v[180:183], a[64:67], v[160:163]
    ds_read_b64_tr_b16 v[196:197], v247 offset:16384
    v_mfma_f32_16x16x32_bf16 v[164:167], v[180:183], a[68:71], v[164:167]
    ds_read_b64_tr_b16 v[198:199], v247 offset:18432
    v_mfma_f32_16x16x32_bf16 v[168:171], v[180:183], a[72:75], v[168:171]
    buffer_load_dwordx4 v254, s[44:47], s64 offen offset:2048  lds
    v_mfma_f32_16x16x32_bf16 v[172:175], v[180:183], a[76:79], v[172:175]
    s_waitcnt lgkmcnt(4)
    v_mfma_f32_16x16x32_bf16 v[112:115], v[184:187], a[80:83], v[112:115]
    s_waitcnt vmcnt(11)
    ds_read_b64_tr_b16 v[176:177], v244 offset:32768
    v_mfma_f32_16x16x32_bf16 v[116:119], v[184:187], a[84:87], v[116:119]
    ds_read_b64_tr_b16 v[178:179], v244 offset:34816
    v_mfma_f32_16x16x32_bf16 v[120:123], v[184:187], a[88:91], v[120:123]
    buffer_load_dwordx4 v255, s[44:47], s64 offen offset:3072  lds
    v_mfma_f32_16x16x32_bf16 v[124:127], v[184:187], a[92:95], v[124:127]
    v_mfma_f32_16x16x32_bf16 v[128:131], v[188:191], a[80:83], v[128:131]
    ds_read_b64_tr_b16 v[180:181], v245 offset:32768
    v_mfma_f32_16x16x32_bf16 v[132:135], v[188:191], a[84:87], v[132:135]
    ds_read_b64_tr_b16 v[182:183], v245 offset:34816
    v_mfma_f32_16x16x32_bf16 v[136:139], v[188:191], a[88:91], v[136:139]
    v_mfma_f32_16x16x32_bf16 v[140:143], v[188:191], a[92:95], v[140:143]
    s_waitcnt lgkmcnt(4)
    v_mfma_f32_16x16x32_bf16 v[144:147], v[192:195], a[80:83], v[144:147]
    ds_read_b64_tr_b16 v[184:185], v246 offset:32768
    v_mfma_f32_16x16x32_bf16 v[148:151], v[192:195], a[84:87], v[148:151]
    ds_read_b64_tr_b16 v[186:187], v246 offset:34816
    v_mfma_f32_16x16x32_bf16 v[152:155], v[192:195], a[88:91], v[152:155]
    s_add_u32 m0, s7, 81920
    s_add_u32 s64, s10, 1105920
    buffer_load_dwordx4 v252, s[44:47], s64 offen offset:0  lds
    v_mfma_f32_16x16x32_bf16 v[156:159], v[192:195], a[92:95], v[156:159]
    v_mfma_f32_16x16x32_bf16 v[160:163], v[196:199], a[80:83], v[160:163]
    ds_read_b64_tr_b16 v[188:189], v247 offset:32768
    v_mfma_f32_16x16x32_bf16 v[164:167], v[196:199], a[84:87], v[164:167]
    ds_read_b64_tr_b16 v[190:191], v247 offset:34816
    v_mfma_f32_16x16x32_bf16 v[168:171], v[196:199], a[88:91], v[168:171]
    buffer_load_dwordx4 v253, s[44:47], s64 offen offset:1024  lds
    v_mfma_f32_16x16x32_bf16 v[172:175], v[196:199], a[92:95], v[172:175]
    s_waitcnt lgkmcnt(4)
    v_mfma_f32_16x16x32_bf16 v[112:115], v[176:179], a[96:99], v[112:115]
    s_waitcnt vmcnt(10)
    ds_read_b64_tr_b16 v[192:193], v244 offset:49152
    v_lshrrev_b32 v212, 5, v1
    v_mul_u32_u24 v212, 196608, v212
    v_mfma_f32_16x16x32_bf16 v[116:119], v[176:179], a[100:103], v[116:119]
    ds_read_b64_tr_b16 v[194:195], v244 offset:51200
    v_and_b32 v213, 31, v1
    v_lshlrev_b32 v213, 4, v213
    v_mfma_f32_16x16x32_bf16 v[120:123], v[176:179], a[104:107], v[120:123]
    buffer_load_dwordx4 v254, s[44:47], s64 offen offset:2048  lds
    v_add_u32 v212, v212, v213
    s_add_u32 s70, s89, 0
    v_mfma_f32_16x16x32_bf16 v[124:127], v[176:179], a[108:111], v[124:127]
    buffer_load_dwordx4 v255, s[44:47], s64 offen offset:3072  lds
    buffer_load_dwordx4 v[48:51], v212, s[52:55], s70 offen  sc1
    s_add_u32 s70, s89, 12288
    buffer_load_dwordx4 v[52:55], v212, s[52:55], s70 offen  sc1
    v_mfma_f32_16x16x32_bf16 v[128:131], v[180:183], a[96:99], v[128:131]
    ds_read_b64_tr_b16 v[196:197], v245 offset:49152
    s_add_u32 s70, s89, 24576
    buffer_load_dwordx4 v[56:59], v212, s[52:55], s70 offen  sc1
    v_mfma_f32_16x16x32_bf16 v[132:135], v[180:183], a[100:103], v[132:135]
    ds_read_b64_tr_b16 v[198:199], v245 offset:51200
    s_add_u32 s70, s89, 36864
    buffer_load_dwordx4 v[60:63], v212, s[52:55], s70 offen  sc1
    v_mfma_f32_16x16x32_bf16 v[136:139], v[180:183], a[104:107], v[136:139]
    s_add_u32 s70, s89, 49152
    buffer_load_dwordx4 v[64:67], v212, s[52:55], s70 offen  sc1
    s_add_u32 s70, s89, 61440
    v_mfma_f32_16x16x32_bf16 v[140:143], v[180:183], a[108:111], v[140:143]
    buffer_load_dwordx4 v[68:71], v212, s[52:55], s70 offen  sc1
    s_add_u32 s70, s89, 73728
    s_waitcnt lgkmcnt(4)
    v_mfma_f32_16x16x32_bf16 v[144:147], v[184:187], a[96:99], v[144:147]
    ds_read_b64_tr_b16 v[176:177], v246 offset:49152
    buffer_load_dwordx4 v[72:75], v212, s[52:55], s70 offen  sc1
    s_add_u32 s70, s89, 86016
    v_mfma_f32_16x16x32_bf16 v[148:151], v[184:187], a[100:103], v[148:151]
    ds_read_b64_tr_b16 v[178:179], v246 offset:51200
    buffer_load_dwordx4 v[76:79], v212, s[52:55], s70 offen  sc1
    s_add_u32 s70, s89, 98304
    buffer_load_dwordx4 v[80:83], v212, s[52:55], s70 offen  sc1
    v_mfma_f32_16x16x32_bf16 v[152:155], v[184:187], a[104:107], v[152:155]
    s_add_u32 m0, s7, 98304
    s_add_u32 s64, s10, 1216512
    buffer_load_dwordx4 v252, s[44:47], s64 offen offset:0  lds
    s_add_u32 s70, s89, 110592
    buffer_load_dwordx4 v[84:87], v212, s[52:55], s70 offen  sc1
    v_mfma_f32_16x16x32_bf16 v[156:159], v[184:187], a[108:111], v[156:159]
    s_add_u32 s70, s89, 122880
    buffer_load_dwordx4 v[88:91], v212, s[52:55], s70 offen  sc1
    v_mfma_f32_16x16x32_bf16 v[160:163], v[188:191], a[96:99], v[160:163]
    ds_read_b64_tr_b16 v[180:181], v247 offset:49152
    s_add_u32 s70, s89, 135168
    buffer_load_dwordx4 v[92:95], v212, s[52:55], s70 offen  sc1
    s_add_u32 s70, s89, 147456
    v_mfma_f32_16x16x32_bf16 v[164:167], v[188:191], a[100:103], v[164:167]
    ds_read_b64_tr_b16 v[182:183], v247 offset:51200
    buffer_load_dwordx4 v[96:99], v212, s[52:55], s70 offen  sc1
    s_add_u32 s70, s89, 159744
    v_mfma_f32_16x16x32_bf16 v[168:171], v[188:191], a[104:107], v[168:171]
    buffer_load_dwordx4 v253, s[44:47], s64 offen offset:1024  lds
    buffer_load_dwordx4 v[100:103], v212, s[52:55], s70 offen  sc1
    s_add_u32 s70, s89, 172032
    v_mfma_f32_16x16x32_bf16 v[172:175], v[188:191], a[108:111], v[172:175]
    buffer_load_dwordx4 v[104:107], v212, s[52:55], s70 offen  sc1
    s_add_u32 s70, s89, 184320
    buffer_load_dwordx4 v[108:111], v212, s[52:55], s70 offen  sc1
    s_waitcnt lgkmcnt(4)
    v_mfma_f32_16x16x32_bf16 v[112:115], v[192:195], a[112:115], v[112:115]
    s_waitcnt vmcnt(26)
    ds_read_b64_tr_b16 v[184:185], v248 offset:0
    v_mfma_f32_16x16x32_bf16 v[116:119], v[192:195], a[116:119], v[116:119]
    ds_read_b64_tr_b16 v[186:187], v248 offset:2048
    v_mfma_f32_16x16x32_bf16 v[120:123], v[192:195], a[120:123], v[120:123]
    buffer_load_dwordx4 v254, s[44:47], s64 offen offset:2048  lds
    v_mfma_f32_16x16x32_bf16 v[124:127], v[192:195], a[124:127], v[124:127]
    v_mfma_f32_16x16x32_bf16 v[128:131], v[196:199], a[112:115], v[128:131]
    ds_read_b64_tr_b16 v[188:189], v249 offset:0
    v_mfma_f32_16x16x32_bf16 v[132:135], v[196:199], a[116:119], v[132:135]
    ds_read_b64_tr_b16 v[190:191], v249 offset:2048
    v_mfma_f32_16x16x32_bf16 v[136:139], v[196:199], a[120:123], v[136:139]
    buffer_load_dwordx4 v255, s[44:47], s64 offen offset:3072  lds
    v_mfma_f32_16x16x32_bf16 v[140:143], v[196:199], a[124:127], v[140:143]
    s_waitcnt lgkmcnt(4)
    v_mfma_f32_16x16x32_bf16 v[144:147], v[176:179], a[112:115], v[144:147]
    ds_read_b64_tr_b16 v[192:193], v250 offset:0
    v_mfma_f32_16x16x32_bf16 v[148:151], v[176:179], a[116:119], v[148:151]
    ds_read_b64_tr_b16 v[194:195], v250 offset:2048
    v_mfma_f32_16x16x32_bf16 v[152:155], v[176:179], a[120:123], v[152:155]
    s_add_u32 m0, s7, 114688
    s_add_u32 s64, s10, 1327104
    buffer_load_dwordx4 v252, s[44:47], s64 offen offset:0  lds
    v_mfma_f32_16x16x32_bf16 v[156:159], v[176:179], a[124:127], v[156:159]
    buffer_load_dwordx4 v253, s[44:47], s64 offen offset:1024  lds
    v_mfma_f32_16x16x32_bf16 v[160:163], v[180:183], a[112:115], v[160:163]
    ds_read_b64_tr_b16 v[196:197], v251 offset:0
    v_mfma_f32_16x16x32_bf16 v[164:167], v[180:183], a[116:119], v[164:167]
    ds_read_b64_tr_b16 v[198:199], v251 offset:2048
    v_mfma_f32_16x16x32_bf16 v[168:171], v[180:183], a[120:123], v[168:171]
    buffer_load_dwordx4 v254, s[44:47], s64 offen offset:2048  lds
    v_mfma_f32_16x16x32_bf16 v[172:175], v[180:183], a[124:127], v[172:175]
    s_waitcnt lgkmcnt(4)
    v_mfma_f32_16x16x32_bf16 v[112:115], v[184:187], a[128:131], v[112:115]
    s_waitcnt vmcnt(27)
    ds_read_b64_tr_b16 v[176:177], v248 offset:16384
    v_mfma_f32_16x16x32_bf16 v[116:119], v[184:187], a[132:135], v[116:119]
    ds_read_b64_tr_b16 v[178:179], v248 offset:18432
    v_mfma_f32_16x16x32_bf16 v[120:123], v[184:187], a[136:139], v[120:123]
    buffer_load_dwordx4 v255, s[44:47], s64 offen offset:3072  lds
    v_mfma_f32_16x16x32_bf16 v[124:127], v[184:187], a[140:143], v[124:127]
    v_mfma_f32_16x16x32_bf16 v[128:131], v[188:191], a[128:131], v[128:131]
    ds_read_b64_tr_b16 v[180:181], v249 offset:16384
    v_mfma_f32_16x16x32_bf16 v[132:135], v[188:191], a[132:135], v[132:135]
    ds_read_b64_tr_b16 v[182:183], v249 offset:18432
    v_mfma_f32_16x16x32_bf16 v[136:139], v[188:191], a[136:139], v[136:139]
    v_mfma_f32_16x16x32_bf16 v[140:143], v[188:191], a[140:143], v[140:143]
    s_waitcnt lgkmcnt(4)
    v_mfma_f32_16x16x32_bf16 v[144:147], v[192:195], a[128:131], v[144:147]
    ds_read_b64_tr_b16 v[184:185], v250 offset:16384
    v_mfma_f32_16x16x32_bf16 v[148:151], v[192:195], a[132:135], v[148:151]
    ds_read_b64_tr_b16 v[186:187], v250 offset:18432
    v_mfma_f32_16x16x32_bf16 v[152:155], v[192:195], a[136:139], v[152:155]
    s_add_u32 m0, s7, 131072
    s_add_u32 s64, s10, 1437696
    buffer_load_dwordx4 v252, s[44:47], s64 offen offset:0  lds
    v_mfma_f32_16x16x32_bf16 v[156:159], v[192:195], a[140:143], v[156:159]
    v_mfma_f32_16x16x32_bf16 v[160:163], v[196:199], a[128:131], v[160:163]
    ds_read_b64_tr_b16 v[188:189], v251 offset:16384
    v_mfma_f32_16x16x32_bf16 v[164:167], v[196:199], a[132:135], v[164:167]
    ds_read_b64_tr_b16 v[190:191], v251 offset:18432
    v_mfma_f32_16x16x32_bf16 v[168:171], v[196:199], a[136:139], v[168:171]
    buffer_load_dwordx4 v253, s[44:47], s64 offen offset:1024  lds
    v_mfma_f32_16x16x32_bf16 v[172:175], v[196:199], a[140:143], v[172:175]
    s_waitcnt lgkmcnt(4)
    v_mfma_f32_16x16x32_bf16 v[112:115], v[176:179], a[144:147], v[112:115]
    s_waitcnt vmcnt(26)
    ds_read_b64_tr_b16 v[192:193], v244 offset:16384
    v_mfma_f32_16x16x32_bf16 v[116:119], v[176:179], a[148:151], v[116:119]
    ds_read_b64_tr_b16 v[194:195], v244 offset:18432
    v_mfma_f32_16x16x32_bf16 v[120:123], v[176:179], a[152:155], v[120:123]
    buffer_load_dwordx4 v254, s[44:47], s64 offen offset:2048  lds
    v_mfma_f32_16x16x32_bf16 v[124:127], v[176:179], a[156:159], v[124:127]
    buffer_load_dwordx4 v255, s[44:47], s64 offen offset:3072  lds
    v_mfma_f32_16x16x32_bf16 v[128:131], v[180:183], a[144:147], v[128:131]
    ds_read_b64_tr_b16 v[196:197], v245 offset:16384
    v_mfma_f32_16x16x32_bf16 v[132:135], v[180:183], a[148:151], v[132:135]
    ds_read_b64_tr_b16 v[198:199], v245 offset:18432
    v_mfma_f32_16x16x32_bf16 v[136:139], v[180:183], a[152:155], v[136:139]
    v_mfma_f32_16x16x32_bf16 v[140:143], v[180:183], a[156:159], v[140:143]
    s_waitcnt lgkmcnt(4)
    v_mfma_f32_16x16x32_bf16 v[144:147], v[184:187], a[144:147], v[144:147]
    ds_read_b64_tr_b16 v[176:177], v246 offset:16384
    v_mfma_f32_16x16x32_bf16 v[148:151], v[184:187], a[148:151], v[148:151]
    ds_read_b64_tr_b16 v[178:179], v246 offset:18432
    v_mfma_f32_16x16x32_bf16 v[152:155], v[184:187], a[152:155], v[152:155]
    s_add_u32 m0, s7, 147456
    s_add_u32 s64, s10, 1548288
    buffer_load_dwordx4 v252, s[44:47], s64 offen offset:0  lds
    v_mfma_f32_16x16x32_bf16 v[156:159], v[184:187], a[156:159], v[156:159]
    v_mfma_f32_16x16x32_bf16 v[160:163], v[188:191], a[144:147], v[160:163]
    ds_read_b64_tr_b16 v[180:181], v247 offset:16384
    v_mfma_f32_16x16x32_bf16 v[164:167], v[188:191], a[148:151], v[164:167]
    ds_read_b64_tr_b16 v[182:183], v247 offset:18432
    v_mfma_f32_16x16x32_bf16 v[168:171], v[188:191], a[152:155], v[168:171]
    buffer_load_dwordx4 v253, s[44:47], s64 offen offset:1024  lds
    v_mfma_f32_16x16x32_bf16 v[172:175], v[188:191], a[156:159], v[172:175]
    s_waitcnt vmcnt(12)
    s_mov_b32 s71, 0
L_tc_l2:
    v_mov_b32 v208, s86
    v_mov_b32 v209, s86
    v_min3_u32 v208, v208, v51, v55
    v_max3_u32 v209, v209, v51, v55
    v_min3_u32 v208, v208, v59, v63
    v_max3_u32 v209, v209, v59, v63
    v_min3_u32 v208, v208, v67, v71
    v_max3_u32 v209, v209, v67, v71
    v_min3_u32 v208, v208, v75, v79
    v_max3_u32 v209, v209, v75, v79
    v_min3_u32 v208, v208, v83, v87
    v_max3_u32 v209, v209, v83, v87
    v_min3_u32 v208, v208, v91, v95
    v_max3_u32 v209, v209, v91, v95
    v_min3_u32 v208, v208, v99, v103
    v_max3_u32 v209, v209, v99, v103
    v_min3_u32 v208, v208, v107, v111
    v_max3_u32 v209, v209, v107, v111
    v_cmp_eq_u32 vcc, v208, v209
    s_add_u32 s71, s71, 1
    s_nop 2
    s_cmp_eq_u64 vcc, -1
    s_cbranch_scc1 L_tc_l2_ok
    s_sleep 4
    s_add_u32 s70, s89, 0
    buffer_load_dwordx4 v[48:51], v212, s[52:55], s70 offen  sc1
    s_add_u32 s70, s89, 12288
    buffer_load_dwordx4 v[52:55], v212, s[52:55], s70 offen  sc1
    s_add_u32 s70, s89, 24576
    buffer_load_dwordx4 v[56:59], v212, s[52:55], s70 offen  sc1
    s_add_u32 s70, s89, 36864
    buffer_load_dwordx4 v[60:63], v212, s[52:55], s70 offen  sc1
    s_add_u32 s70, s89, 49152
    buffer_load_dwordx4 v[64:67], v212, s[52:55], s70 offen  sc1
    s_add_u32 s70, s89, 61440
    buffer_load_dwordx4 v[68:71], v212, s[52:55], s70 offen  sc1
    s_add_u32 s70, s89, 73728
    buffer_load_dwordx4 v[72:75], v212, s[52:55], s70 offen  sc1
    s_add_u32 s70, s89, 86016
    buffer_load_dwordx4 v[76:79], v212, s[52:55], s70 offen  sc1
    s_add_u32 s70, s89, 98304
    buffer_load_dwordx4 v[80:83], v212, s[52:55], s70 offen  sc1
    s_add_u32 s70, s89, 110592
    buffer_load_dwordx4 v[84:87], v212, s[52:55], s70 offen  sc1
    s_add_u32 s70, s89, 122880
    buffer_load_dwordx4 v[88:91], v212, s[52:55], s70 offen  sc1
    s_add_u32 s70, s89, 135168
    buffer_load_dwordx4 v[92:95], v212, s[52:55], s70 offen  sc1
    s_add_u32 s70, s89, 147456
    buffer_load_dwordx4 v[96:99], v212, s[52:55], s70 offen  sc1
    s_add_u32 s70, s89, 159744
    buffer_load_dwordx4 v[100:103], v212, s[52:55], s70 offen  sc1
    s_add_u32 s70, s89, 172032
    buffer_load_dwordx4 v[104:107], v212, s[52:55], s70 offen  sc1
    s_add_u32 s70, s89, 184320
    buffer_load_dwordx4 v[108:111], v212, s[52:55], s70 offen  sc1
    s_waitcnt vmcnt(0)
    s_cmp_lt_u32 s71, 0x8000
    s_cbranch_scc1 L_tc_l2
L_tc_l2_ok:
    v_lshlrev_b32 v200, 16, v48
    v_and_b32 v201, s13, v48
    v_lshlrev_b32 v202, 16, v49
    v_and_b32 v203, s13, v49
    v_lshlrev_b32 v204, 16, v50
    v_and_b32 v205, s13, v50
    v_dot2c_f32_bf16 v200, s84, v52
    v_dot2c_f32_bf16 v201, s85, v52
    v_dot2c_f32_bf16 v202, s84, v53
    v_dot2c_f32_bf16 v203, s85, v53
    v_dot2c_f32_bf16 v204, s84, v54
    v_dot2c_f32_bf16 v205, s85, v54
    v_dot2c_f32_bf16 v200, s84, v56
    v_dot2c_f32_bf16 v201, s85, v56
    v_dot2c_f32_bf16 v202, s84, v57
    v_dot2c_f32_bf16 v203, s85, v57
    v_dot2c_f32_bf16 v204, s84, v58
    v_dot2c_f32_bf16 v205, s85, v58
    v_dot2c_f32_bf16 v200, s84, v60
    v_dot2c_f32_bf16 v201, s85, v60
    v_dot2c_f32_bf16 v202, s84, v61
    v_dot2c_f32_bf16 v203, s85, v61
    v_dot2c_f32_bf16 v204, s84, v62
    v_dot2c_f32_bf16 v205, s85, v62
    v_dot2c_f32_bf16 v200, s84, v64
    v_dot2c_f32_bf16 v201, s85, v64
    v_dot2c_f32_bf16 v202, s84, v65
    v_dot2c_f32_bf16 v203, s85, v65
    v_dot2c_f32_bf16 v204, s84, v66
    v_dot2c_f32_bf16 v205, s85, v66
    v_dot2c_f32_bf16 v200, s84, v68
    v_dot2c_f32_bf16 v201, s85, v68
    v_dot2c_f32_bf16 v202, s84, v69
    v_dot2c_f32_bf16 v203, s85, v69
    v_dot2c_f32_bf16 v204, s84, v70
    v_dot2c_f32_bf16 v205, s85, v70
    v_dot2c_f32_bf16 v200, s84, v72
    v_dot2c_f32_bf16 v201, s85, v72
    v_dot2c_f32_bf16 v202, s84, v73
    v_dot2c_f32_bf16 v203, s85, v73
    v_dot2c_f32_bf16 v204, s84, v74
    v_dot2c_f32_bf16 v205, s85, v74
    v_dot2c_f32_bf16 v200, s84, v76
    v_dot2c_f32_bf16 v201, s85, v76
    v_dot2c_f32_bf16 v202, s84, v77
    v_dot2c_f32_bf16 v203, s85, v77
    v_dot2c_f32_bf16 v204, s84, v78
    v_dot2c_f32_bf16 v205, s85, v78
    v_dot2c_f32_bf16 v200, s84, v80
    v_dot2c_f32_bf16 v201, s85, v80
    v_dot2c_f32_bf16 v202, s84, v81
    v_dot2c_f32_bf16 v203, s85, v81
    v_dot2c_f32_bf16 v204, s84, v82
    v_dot2c_f32_bf16 v205, s85, v82
    v_dot2c_f32_bf16 v200, s84, v84
    v_dot2c_f32_bf16 v201, s85, v84
    v_dot2c_f32_bf16 v202, s84, v85
    v_dot2c_f32_bf16 v203, s85, v85
    v_dot2c_f32_bf16 v204, s84, v86
    v_dot2c_f32_bf16 v205, s85, v86
    v_dot2c_f32_bf16 v200, s84, v88
    v_dot2c_f32_bf16 v201, s85, v88
    v_dot2c_f32_bf16 v202, s84, v89
    v_dot2c_f32_bf16 v203, s85, v89
    v_dot2c_f32_bf16 v204, s84, v90
    v_dot2c_f32_bf16 v205, s85, v90
    v_dot2c_f32_bf16 v200, s84, v92
    v_dot2c_f32_bf16 v201, s85, v92
    v_dot2c_f32_bf16 v202, s84, v93
    v_dot2c_f32_bf16 v203, s85, v93
    v_dot2c_f32_bf16 v204, s84, v94
    v_dot2c_f32_bf16 v205, s85, v94
    v_dot2c_f32_bf16 v200, s84, v96
    v_dot2c_f32_bf16 v201, s85, v96
    v_dot2c_f32_bf16 v202, s84, v97
    v_dot2c_f32_bf16 v203, s85, v97
    v_dot2c_f32_bf16 v204, s84, v98
    v_dot2c_f32_bf16 v205, s85, v98
    v_dot2c_f32_bf16 v200, s84, v100
    v_dot2c_f32_bf16 v201, s85, v100
    v_dot2c_f32_bf16 v202, s84, v101
    v_dot2c_f32_bf16 v203, s85, v101
    v_dot2c_f32_bf16 v204, s84, v102
    v_dot2c_f32_bf16 v205, s85, v102
    v_dot2c_f32_bf16 v200, s84, v104
    v_dot2c_f32_bf16 v201, s85, v104
    v_dot2c_f32_bf16 v202, s84, v105
    v_dot2c_f32_bf16 v203, s85, v105
    v_dot2c_f32_bf16 v204, s84, v106
    v_dot2c_f32_bf16 v205, s85, v106
    v_dot2c_f32_bf16 v200, s84, v108
    v_dot2c_f32_bf16 v201, s85, v108
    v_dot2c_f32_bf16 v202, s84, v109
    v_dot2c_f32_bf16 v203, s85, v109
    v_dot2c_f32_bf16 v204, s84, v110
    v_dot2c_f32_bf16 v205, s85, v110
    v_mov_b32 v56, v200
    v_mov_b32 v57, v201
    v_mov_b32 v58, v202
    v_mov_b32 v59, v203
    v_mov_b32 v60, v204
    v_mov_b32 v61, v205
    v_permlane32_swap_b32 v56, v200
    v_permlane32_swap_b32 v57, v201
    v_permlane32_swap_b32 v58, v202
    v_permlane32_swap_b32 v59, v203
    v_permlane32_swap_b32 v60, v204
    v_permlane32_swap_b32 v61, v205
    v_add_f32 v200, v56, v200
    v_add_f32 v201, v57, v201
    v_add_f32 v202, v58, v202
    v_add_f32 v203, v59, v203
    v_add_f32 v204, v60, v204
    v_add_f32 v205, v61, v205
    v_cvt_pk_bf16_f32 v48, v200, v201
    v_cvt_pk_bf16_f32 v49, v202, v203
    v_cvt_pk_bf16_f32 v50, v204, v205
    s_mov_b64 exec, 0xffffffff
    buffer_store_dwordx4 v[48:51], v213, s[52:55], s90 offen sc1
    s_mov_b64 exec, -1
    s_waitcnt lgkmcnt(4)
    v_mfma_f32_16x16x32_bf16 v[112:115], v[192:195], a[160:163], v[112:115]
    s_waitcnt vmcnt(11)
    ds_read_b64_tr_b16 v[184:185], v244 offset:32768
    v_mfma_f32_16x16x32_bf16 v[116:119], v[192:195], a[164:167], v[116:119]
    ds_read_b64_tr_b16 v[186:187], v244 offset:34816
    v_mfma_f32_16x16x32_bf16 v[120:123], v[192:195], a[168:171], v[120:123]
    buffer_load_dwordx4 v254, s[44:47], s64 offen offset:2048  lds
    v_mfma_f32_16x16x32_bf16 v[124:127], v[192:195], a[172:175], v[124:127]
    v_mfma_f32_16x16x32_bf16 v[128:131], v[196:199], a[160:163], v[128:131]
    ds_read_b64_tr_b16 v[188:189], v245 offset:32768
    v_mfma_f32_16x16x32_bf16 v[132:135], v[196:199], a[164:167], v[132:135]
    ds_read_b64_tr_b16 v[190:191], v245 offset:34816
    v_mfma_f32_16x16x32_bf16 v[136:139], v[196:199], a[168:171], v[136:139]
    buffer_load_dwordx4 v255, s[44:47], s64 offen offset:3072  lds
    v_mfma_f32_16x16x32_bf16 v[140:143], v[196:199], a[172:175], v[140:143]
    s_waitcnt lgkmcnt(4)
    v_mfma_f32_16x16x32_bf16 v[144:147], v[176:179], a[160:163], v[144:147]
    ds_read_b64_tr_b16 v[192:193], v246 offset:32768
    v_mfma_f32_16x16x32_bf16 v[148:151], v[176:179], a[164:167], v[148:151]
    ds_read_b64_tr_b16 v[194:195], v246 offset:34816
    v_mfma_f32_16x16x32_bf16 v[152:155], v[176:179], a[168:171], v[152:155]
    s_add_u32 m0, s7, 81920
    s_add_u32 s64, s10, 1658880
    buffer_load_dwordx4 v252, s[44:47], s64 offen offset:0  lds
    v_mfma_f32_16x16x32_bf16 v[156:159], v[176:179], a[172:175], v[156:159]
    buffer_load_dwordx4 v253, s[44:47], s64 offen offset:1024  lds
    v_mfma_f32_16x16x32_bf16 v[160:163], v[180:183], a[160:163], v[160:163]
    ds_read_b64_tr_b16 v[196:197], v247 offset:32768
    v_mfma_f32_16x16x32_bf16 v[164:167], v[180:183], a[164:167], v[164:167]
    ds_read_b64_tr_b16 v[198:199], v247 offset:34816
    v_mfma_f32_16x16x32_bf16 v[168:171], v[180:183], a[168:171], v[168:171]
    buffer_load_dwordx4 v254, s[44:47], s64 offen offset:2048  lds
    v_mfma_f32_16x16x32_bf16 v[172:175], v[180:183], a[172:175], v[172:175]
    s_waitcnt lgkmcnt(4)
    v_mfma_f32_16x16x32_bf16 v[112:115], v[184:187], a[176:179], v[112:115]
    s_waitcnt vmcnt(12)
    ds_read_b64_tr_b16 v[176:177], v244 offset:49152
    v_mfma_f32_16x16x32_bf16 v[116:119], v[184:187], a[180:183], v[116:119]
    ds_read_b64_tr_b16 v[178:179], v244 offset:51200
    v_mfma_f32_16x16x32_bf16 v[120:123], v[184:187], a[184:187], v[120:123]
    buffer_load_dwordx4 v255, s[44:47], s64 offen offset:3072  lds
    v_mfma_f32_16x16x32_bf16 v[124:127], v[184:187], a[188:191], v[124:127]
    v_mfma_f32_16x16x32_bf16 v[128:131], v[188:191], a[176:179], v[128:131]
    ds_read_b64_tr_b16 v[180:181], v245 offset:49152
    v_mfma_f32_16x16x32_bf16 v[132:135], v[188:191], a[180:183], v[132:135]
    ds_read_b64_tr_b16 v[182:183], v245 offset:51200
    v_mfma_f32_16x16x32_bf16 v[136:139], v[188:191], a[184:187], v[136:139]
    v_mfma_f32_16x16x32_bf16 v[140:143], v[188:191], a[188:191], v[140:143]
    s_waitcnt lgkmcnt(4)
    v_mfma_f32_16x16x32_bf16 v[144:147], v[192:195], a[176:179], v[144:147]
    ds_read_b64_tr_b16 v[184:185], v246 offset:49152
    v_mfma_f32_16x16x32_bf16 v[148:151], v[192:195], a[180:183], v[148:151]
    ds_read_b64_tr_b16 v[186:187], v246 offset:51200
    v_mfma_f32_16x16x32_bf16 v[152:155], v[192:195], a[184:187], v[152:155]
    s_add_u32 m0, s7, 98304
    s_add_u32 s64, s10, 1769472
    buffer_load_dwordx4 v252, s[44:47], s64 offen offset:0  lds
    v_mfma_f32_16x16x32_bf16 v[156:159], v[192:195], a[188:191], v[156:159]
    v_mfma_f32_16x16x32_bf16 v[160:163], v[196:199], a[176:179], v[160:163]
    ds_read_b64_tr_b16 v[188:189], v247 offset:49152
    v_mfma_f32_16x16x32_bf16 v[164:167], v[196:199], a[180:183], v[164:167]
    ds_read_b64_tr_b16 v[190:191], v247 offset:51200
    v_mfma_f32_16x16x32_bf16 v[168:171], v[196:199], a[184:187], v[168:171]
    buffer_load_dwordx4 v253, s[44:47], s64 offen offset:1024  lds
    v_mfma_f32_16x16x32_bf16 v[172:175], v[196:199], a[188:191], v[172:175]
    s_waitcnt lgkmcnt(4)
    v_mfma_f32_16x16x32_bf16 v[112:115], v[176:179], a[192:195], v[112:115]
    s_waitcnt vmcnt(11)
    ds_read_b64_tr_b16 v[192:193], v248 offset:0
    v_mfma_f32_16x16x32_bf16 v[116:119], v[176:179], a[196:199], v[116:119]
    ds_read_b64_tr_b16 v[194:195], v248 offset:2048
    v_mfma_f32_16x16x32_bf16 v[120:123], v[176:179], a[200:203], v[120:123]
    buffer_load_dwordx4 v254, s[44:47], s64 offen offset:2048  lds
    v_mfma_f32_16x16x32_bf16 v[124:127], v[176:179], a[204:207], v[124:127]
    buffer_load_dwordx4 v255, s[44:47], s64 offen offset:3072  lds
    v_mfma_f32_16x16x32_bf16 v[128:131], v[180:183], a[192:195], v[128:131]
    ds_read_b64_tr_b16 v[196:197], v249 offset:0
    v_mfma_f32_16x16x32_bf16 v[132:135], v[180:183], a[196:199], v[132:135]
    ds_read_b64_tr_b16 v[198:199], v249 offset:2048
    v_mfma_f32_16x16x32_bf16 v[136:139], v[180:183], a[200:203], v[136:139]
    v_mfma_f32_16x16x32_bf16 v[140:143], v[180:183], a[204:207], v[140:143]
    s_waitcnt lgkmcnt(4)
    v_mfma_f32_16x16x32_bf16 v[144:147], v[184:187], a[192:195], v[144:147]
    ds_read_b64_tr_b16 v[176:177], v250 offset:0
    v_mfma_f32_16x16x32_bf16 v[148:151], v[184:187], a[196:199], v[148:151]
    ds_read_b64_tr_b16 v[178:179], v250 offset:2048
    v_mfma_f32_16x16x32_bf16 v[152:155], v[184:187], a[200:203], v[152:155]
    s_add_u32 m0, s7, 114688
    s_add_u32 s64, s10, 1880064
    buffer_load_dwordx4 v252, s[44:47], s64 offen offset:0  lds
    v_mfma_f32_16x16x32_bf16 v[156:159], v[184:187], a[204:207], v[156:159]
    v_mfma_f32_16x16x32_bf16 v[160:163], v[188:191], a[192:195], v[160:163]
    ds_read_b64_tr_b16 v[180:181], v251 offset:0
    v_mfma_f32_16x16x32_bf16 v[164:167], v[188:191], a[196:199], v[164:167]
    ds_read_b64_tr_b16 v[182:183], v251 offset:2048
    v_mfma_f32_16x16x32_bf16 v[168:171], v[188:191], a[200:203], v[168:171]
    buffer_load_dwordx4 v253, s[44:47], s64 offen offset:1024  lds
    v_mfma_f32_16x16x32_bf16 v[172:175], v[188:191], a[204:207], v[172:175]
    s_barrier
    s_cmp_eq_u32 s3, 2
    s_cselect_b64 exec, -1, 0
    ds_write_b128 v5, v[216:219] offset:0
    ds_write_b128 v5, v[220:223] offset:1024
    ds_write_b128 v5, v[224:227] offset:2048
    ds_write_b128 v5, v[228:231] offset:3072
    s_mov_b64 exec, -1
    s_waitcnt lgkmcnt(8)
    v_mfma_f32_16x16x32_bf16 v[112:115], v[192:195], a[208:211], v[112:115]
    s_waitcnt vmcnt(10)
    ds_read_b64_tr_b16 v[184:185], v248 offset:16384
    v_mfma_f32_16x16x32_bf16 v[116:119], v[192:195], a[212:215], v[116:119]
    ds_read_b64_tr_b16 v[186:187], v248 offset:18432
    v_mfma_f32_16x16x32_bf16 v[120:123], v[192:195], a[216:219], v[120:123]
    buffer_load_dwordx4 v254, s[44:47], s64 offen offset:2048  lds
    v_mfma_f32_16x16x32_bf16 v[124:127], v[192:195], a[220:223], v[124:127]
    v_mfma_f32_16x16x32_bf16 v[128:131], v[196:199], a[208:211], v[128:131]
    ds_read_b64_tr_b16 v[188:189], v249 offset:16384
    v_mfma_f32_16x16x32_bf16 v[132:135], v[196:199], a[212:215], v[132:135]
    ds_read_b64_tr_b16 v[190:191], v249 offset:18432
    v_mfma_f32_16x16x32_bf16 v[136:139], v[196:199], a[216:219], v[136:139]
    buffer_load_dwordx4 v255, s[44:47], s64 offen offset:3072  lds
    v_mfma_f32_16x16x32_bf16 v[140:143], v[196:199], a[220:223], v[140:143]
    s_waitcnt lgkmcnt(8)
    v_mfma_f32_16x16x32_bf16 v[144:147], v[176:179], a[208:211], v[144:147]
    ds_read_b64_tr_b16 v[192:193], v250 offset:16384
    v_mfma_f32_16x16x32_bf16 v[148:151], v[176:179], a[212:215], v[148:151]
    ds_read_b64_tr_b16 v[194:195], v250 offset:18432
    v_mfma_f32_16x16x32_bf16 v[152:155], v[176:179], a[216:219], v[152:155]
    s_add_u32 m0, s7, 49152
    s_add_u32 s64, s74, 0
    buffer_load_dwordx4 v12, s[48:51], s64 offen offset:0  lds
    v_mfma_f32_16x16x32_bf16 v[156:159], v[176:179], a[220:223], v[156:159]
    buffer_load_dwordx4 v13, s[48:51], s64 offen offset:1024  lds
    v_mfma_f32_16x16x32_bf16 v[160:163], v[180:183], a[208:211], v[160:163]
    ds_read_b64_tr_b16 v[196:197], v251 offset:16384
    v_mfma_f32_16x16x32_bf16 v[164:167], v[180:183], a[212:215], v[164:167]
    ds_read_b64_tr_b16 v[198:199], v251 offset:18432
    v_mfma_f32_16x16x32_bf16 v[168:171], v[180:183], a[216:219], v[168:171]
    buffer_load_dwordx4 v14, s[48:51], s64 offen offset:2048  lds
    v_mfma_f32_16x16x32_bf16 v[172:175], v[180:183], a[220:223], v[172:175]
    s_waitcnt lgkmcnt(4)
    v_mfma_f32_16x16x32_bf16 v[112:115], v[184:187], a[224:227], v[112:115]
    s_waitcnt vmcnt(11)
    ds_read_b64_tr_b16 v[176:177], v244 offset:16384
    v_mfma_f32_16x16x32_bf16 v[116:119], v[184:187], a[228:231], v[116:119]
    ds_read_b64_tr_b16 v[178:179], v244 offset:18432
    v_mfma_f32_16x16x32_bf16 v[120:123], v[184:187], a[232:235], v[120:123]
    buffer_load_dwordx4 v15, s[48:51], s64 offen offset:3072  lds
    v_mfma_f32_16x16x32_bf16 v[124:127], v[184:187], a[236:239], v[124:127]
    v_mfma_f32_16x16x32_bf16 v[128:131], v[188:191], a[224:227], v[128:131]
    ds_read_b64_tr_b16 v[180:181], v245 offset:16384
    v_mfma_f32_16x16x32_bf16 v[132:135], v[188:191], a[228:231], v[132:135]
    ds_read_b64_tr_b16 v[182:183], v245 offset:18432
    v_mfma_f32_16x16x32_bf16 v[136:139], v[188:191], a[232:235], v[136:139]
    s_add_u32 m0, s7, 65536
    s_add_u32 s64, s76, 0
    buffer_load_dwordx4 v12, s[48:51], s64 offen offset:0  lds
    v_mfma_f32_16x16x32_bf16 v[140:143], v[188:191], a[236:239], v[140:143]
    s_waitcnt lgkmcnt(4)
    v_mfma_f32_16x16x32_bf16 v[144:147], v[192:195], a[224:227], v[144:147]
    ds_read_b64_tr_b16 v[184:185], v246 offset:16384
    v_mfma_f32_16x16x32_bf16 v[148:151], v[192:195], a[228:231], v[148:151]
    ds_read_b64_tr_b16 v[186:187], v246 offset:18432
    v_mfma_f32_16x16x32_bf16 v[152:155], v[192:195], a[232:235], v[152:155]
    buffer_load_dwordx4 v13, s[48:51], s64 offen offset:1024  lds
    v_mfma_f32_16x16x32_bf16 v[156:159], v[192:195], a[236:239], v[156:159]
    v_mfma_f32_16x16x32_bf16 v[160:163], v[196:199], a[224:227], v[160:163]
    ds_read_b64_tr_b16 v[188:189], v247 offset:16384
    v_mfma_f32_16x16x32_bf16 v[164:167], v[196:199], a[228:231], v[164:167]
    ds_read_b64_tr_b16 v[190:191], v247 offset:18432
    v_mfma_f32_16x16x32_bf16 v[168:171], v[196:199], a[232:235], v[168:171]
    buffer_load_dwordx4 v14, s[48:51], s64 offen offset:2048  lds
    v_mfma_f32_16x16x32_bf16 v[172:175], v[196:199], a[236:239], v[172:175]
    s_waitcnt lgkmcnt(4)
    v_mfma_f32_16x16x32_bf16 v[112:115], v[176:179], a[240:243], v[112:115]
    s_waitcnt vmcnt(11)
    ds_read_b64_tr_b16 v[192:193], v244 offset:32768
    v_mfma_f32_16x16x32_bf16 v[116:119], v[176:179], a[244:247], v[116:119]
    ds_read_b64_tr_b16 v[194:195], v244 offset:34816
    v_mfma_f32_16x16x32_bf16 v[120:123], v[176:179], a[248:251], v[120:123]
    buffer_load_dwordx4 v15, s[48:51], s64 offen offset:3072  lds
    v_mfma_f32_16x16x32_bf16 v[124:127], v[176:179], a[252:255], v[124:127]
    s_add_u32 m0, s7, 131072
    s_add_u32 s64, s74, 147456
    buffer_load_dwordx4 v12, s[48:51], s64 offen offset:0  lds
    v_mfma_f32_16x16x32_bf16 v[128:131], v[180:183], a[240:243], v[128:131]
    ds_read_b64_tr_b16 v[196:197], v245 offset:32768
    v_mfma_f32_16x16x32_bf16 v[132:135], v[180:183], a[244:247], v[132:135]
    ds_read_b64_tr_b16 v[198:199], v245 offset:34816
    v_mfma_f32_16x16x32_bf16 v[136:139], v[180:183], a[248:251], v[136:139]
    buffer_load_dwordx4 v13, s[48:51], s64 offen offset:1024  lds
    v_mfma_f32_16x16x32_bf16 v[140:143], v[180:183], a[252:255], v[140:143]
    s_waitcnt lgkmcnt(4)
    v_mfma_f32_16x16x32_bf16 v[144:147], v[184:187], a[240:243], v[144:147]
    ds_read_b64_tr_b16 v[176:177], v246 offset:32768
    v_mfma_f32_16x16x32_bf16 v[148:151], v[184:187], a[244:247], v[148:151]
    ds_read_b64_tr_b16 v[178:179], v246 offset:34816
    v_mfma_f32_16x16x32_bf16 v[152:155], v[184:187], a[248:251], v[152:155]
    buffer_load_dwordx4 v14, s[48:51], s64 offen offset:2048  lds
    v_mfma_f32_16x16x32_bf16 v[156:159], v[184:187], a[252:255], v[156:159]
    v_mfma_f32_16x16x32_bf16 v[160:163], v[188:191], a[240:243], v[160:163]
    ds_read_b64_tr_b16 v[180:181], v247 offset:32768
    v_mfma_f32_16x16x32_bf16 v[164:167], v[188:191], a[244:247], v[164:167]
    ds_read_b64_tr_b16 v[182:183], v247 offset:34816
    v_mfma_f32_16x16x32_bf16 v[168:171], v[188:191], a[248:251], v[168:171]
    buffer_load_dwordx4 v15, s[48:51], s64 offen offset:3072  lds
    v_mfma_f32_16x16x32_bf16 v[172:175], v[188:191], a[252:255], v[172:175]
    s_waitcnt lgkmcnt(4)
    v_mfma_f32_16x16x32_bf16 v[112:115], v[192:195], v[16:19], v[112:115]
    s_waitcnt vmcnt(12)
    ds_read_b64_tr_b16 v[184:185], v244 offset:49152
    v_mfma_f32_16x16x32_bf16 v[116:119], v[192:195], v[20:23], v[116:119]
    ds_read_b64_tr_b16 v[186:187], v244 offset:51200
    v_mfma_f32_16x16x32_bf16 v[120:123], v[192:195], v[24:27], v[120:123]
    s_add_u32 m0, s7, 147456
    s_add_u32 s64, s76, 147456
    buffer_load_dwordx4 v12, s[48:51], s64 offen offset:0  lds
    v_mfma_f32_16x16x32_bf16 v[124:127], v[192:195], v[28:31], v[124:127]
    v_mfma_f32_16x16x32_bf16 v[128:131], v[196:199], v[16:19], v[128:131]
    ds_read_b64_tr_b16 v[188:189], v245 offset:49152
    v_mfma_f32_16x16x32_bf16 v[132:135], v[196:199], v[20:23], v[132:135]
    ds_read_b64_tr_b16 v[190:191], v245 offset:51200
    v_mfma_f32_16x16x32_bf16 v[136:139], v[196:199], v[24:27], v[136:139]
    buffer_load_dwordx4 v13, s[48:51], s64 offen offset:1024  lds
    v_mfma_f32_16x16x32_bf16 v[140:143], v[196:199], v[28:31], v[140:143]
    s_waitcnt lgkmcnt(4)
    v_mfma_f32_16x16x32_bf16 v[144:147], v[176:179], v[16:19], v[144:147]
    ds_read_b64_tr_b16 v[192:193], v246 offset:49152
    v_mfma_f32_16x16x32_bf16 v[148:151], v[176:179], v[20:23], v[148:151]
    ds_read_b64_tr_b16 v[194:195], v246 offset:51200
    v_mfma_f32_16x16x32_bf16 v[152:155], v[176:179], v[24:27], v[152:155]
    buffer_load_dwordx4 v14, s[48:51], s64 offen offset:2048  lds
    v_mfma_f32_16x16x32_bf16 v[156:159], v[176:179], v[28:31], v[156:159]
    buffer_load_dwordx4 v15, s[48:51], s64 offen offset:3072  lds
    v_mfma_f32_16x16x32_bf16 v[160:163], v[180:183], v[16:19], v[160:163]
    ds_read_b64_tr_b16 v[196:197], v247 offset:49152
    v_mfma_f32_16x16x32_bf16 v[164:167], v[180:183], v[20:23], v[164:167]
    ds_read_b64_tr_b16 v[198:199], v247 offset:51200
    v_mfma_f32_16x16x32_bf16 v[168:171], v[180:183], v[24:27], v[168:171]
    s_add_u32 m0, s7, 81920
    s_add_u32 s64, s74, 294912
    buffer_load_dwordx4 v12, s[48:51], s64 offen offset:0  lds
    v_mfma_f32_16x16x32_bf16 v[172:175], v[180:183], v[28:31], v[172:175]
    s_waitcnt lgkmcnt(4)
    v_mfma_f32_16x16x32_bf16 v[112:115], v[184:187], v[32:35], v[112:115]
    v_mfma_f32_16x16x32_bf16 v[116:119], v[184:187], v[36:39], v[116:119]
    v_mfma_f32_16x16x32_bf16 v[120:123], v[184:187], v[40:43], v[120:123]
    buffer_load_dwordx4 v13, s[48:51], s64 offen offset:1024  lds
    v_mfma_f32_16x16x32_bf16 v[124:127], v[184:187], v[44:47], v[124:127]
    v_mfma_f32_16x16x32_bf16 v[128:131], v[188:191], v[32:35], v[128:131]
    v_mfma_f32_16x16x32_bf16 v[132:135], v[188:191], v[36:39], v[132:135]
    v_mfma_f32_16x16x32_bf16 v[136:139], v[188:191], v[40:43], v[136:139]
    buffer_load_dwordx4 v14, s[48:51], s64 offen offset:2048  lds
    v_mfma_f32_16x16x32_bf16 v[140:143], v[188:191], v[44:47], v[140:143]
    s_waitcnt lgkmcnt(0)
    v_mfma_f32_16x16x32_bf16 v[144:147], v[192:195], v[32:35], v[144:147]
    v_mfma_f32_16x16x32_bf16 v[148:151], v[192:195], v[36:39], v[148:151]
    v_mfma_f32_16x16x32_bf16 v[152:155], v[192:195], v[40:43], v[152:155]
    buffer_load_dwordx4 v15, s[48:51], s64 offen offset:3072  lds
    v_mfma_f32_16x16x32_bf16 v[156:159], v[192:195], v[44:47], v[156:159]
    v_mfma_f32_16x16x32_bf16 v[160:163], v[196:199], v[32:35], v[160:163]
    v_mfma_f32_16x16x32_bf16 v[164:167], v[196:199], v[36:39], v[164:167]
    v_mfma_f32_16x16x32_bf16 v[168:171], v[196:199], v[40:43], v[168:171]
    s_add_u32 m0, s7, 98304
    s_add_u32 s64, s76, 294912
    buffer_load_dwordx4 v12, s[48:51], s64 offen offset:0  lds
    v_mfma_f32_16x16x32_bf16 v[172:175], v[196:199], v[44:47], v[172:175]
    s_add_u32 s70, s82, 0
    buffer_load_dwordx4 v[48:51], v2, s[52:55], s70 offen offset:0 sc1
    buffer_load_dwordx4 v[52:55], v2, s[52:55], s70 offen offset:1024 sc1
    buffer_load_dwordx4 v[56:59], v2, s[52:55], s70 offen offset:2048 sc1
    buffer_load_dwordx4 v[60:63], v2, s[52:55], s70 offen offset:3072 sc1
    s_add_u32 s70, s82, 4096
    buffer_load_dwordx4 v[64:67], v2, s[52:55], s70 offen offset:0 sc1
    buffer_load_dwordx4 v[68:71], v2, s[52:55], s70 offen offset:1024 sc1
    buffer_load_dwordx4 v[72:75], v2, s[52:55], s70 offen offset:2048 sc1
    buffer_load_dwordx4 v[76:79], v2, s[52:55], s70 offen offset:3072 sc1
    s_add_u32 s70, s82, 8192
    buffer_load_dwordx4 v[80:83], v2, s[52:55], s70 offen offset:0 sc1
    buffer_load_dwordx4 v[84:87], v2, s[52:55], s70 offen offset:1024 sc1
    buffer_load_dwordx4 v[88:91], v2, s[52:55], s70 offen offset:2048 sc1
    buffer_load_dwordx4 v[92:95], v2, s[52:55], s70 offen offset:3072 sc1
    v_mul_f32 v200, 0x3fb8aa3b, v112
    v_exp_f32_e64 v200, v200 clamp
    v_mul_f32 v201, 0x3fb8aa3b, v113
    v_max_f32 v112, s68, v112
    v_exp_f32_e64 v201, v201 clamp
    v_mul_f32 v202, 0x3fb8aa3b, v114
    v_add_f32 v112, v112, v200
    v_max_f32 v113, s68, v113
    v_exp_f32_e64 v202, v202 clamp
    v_mul_f32 v203, 0x3fb8aa3b, v115
    v_add_f32 v113, v113, v201
    v_max_f32 v114, s68, v114
    v_exp_f32_e64 v203, v203 clamp
    v_mul_f32 v204, 0x3fb8aa3b, v116
    v_cvt_pk_bf16_f32 v112, v112, v113
    v_add_f32 v114, v114, v202
    buffer_load_dwordx4 v13, s[48:51], s64 offen offset:1024  lds
    v_max_f32 v115, s68, v115
    v_exp_f32_e64 v204, v204 clamp
    v_mul_f32 v205, 0x3fb8aa3b, v117
    v_add_f32 v115, v115, v203
    v_max_f32 v116, s68, v116
    v_exp_f32_e64 v205, v205 clamp
    v_mul_f32 v206, 0x3fb8aa3b, v118
    v_cvt_pk_bf16_f32 v113, v114, v115
    v_add_f32 v116, v116, v204
    v_max_f32 v117, s68, v117
    v_exp_f32_e64 v206, v206 clamp
    v_mul_f32 v207, 0x3fb8aa3b, v119
    v_add_f32 v117, v117, v205
    v_max_f32 v118, s68, v118
    v_exp_f32_e64 v207, v207 clamp
    v_mul_f32 v200, 0x3fb8aa3b, v120
    buffer_load_dwordx4 v14, s[48:51], s64 offen offset:2048  lds
    v_cvt_pk_bf16_f32 v114, v116, v117
    v_add_f32 v118, v118, v206
    v_max_f32 v119, s68, v119
    v_exp_f32_e64 v200, v200 clamp
    v_mul_f32 v201, 0x3fb8aa3b, v121
    v_add_f32 v119, v119, v207
    v_max_f32 v120, s68, v120
    v_exp_f32_e64 v201, v201 clamp
    v_mul_f32 v202, 0x3fb8aa3b, v122
    v_cvt_pk_bf16_f32 v115, v118, v119
    v_add_f32 v120, v120, v200
    v_max_f32 v121, s68, v121
    v_exp_f32_e64 v202, v202 clamp
    v_mul_f32 v203, 0x3fb8aa3b, v123
    ds_write_b128 v4, v[112:115] offset:0
    v_add_f32 v121, v121, v201
    buffer_load_dwordx4 v15, s[48:51], s64 offen offset:3072  lds
    v_max_f32 v122, s68, v122
    v_exp_f32_e64 v203, v203 clamp
    v_mul_f32 v204, 0x3fb8aa3b, v124
    v_cvt_pk_bf16_f32 v120, v120, v121
    v_add_f32 v122, v122, v202
    v_max_f32 v123, s68, v123
    v_exp_f32_e64 v204, v204 clamp
    v_mul_f32 v205, 0x3fb8aa3b, v125
    v_add_f32 v123, v123, v203
    v_max_f32 v124, s68, v124
    v_exp_f32_e64 v205, v205 clamp
    v_mul_f32 v206, 0x3fb8aa3b, v126
    v_cvt_pk_bf16_f32 v121, v122, v123
    v_add_f32 v124, v124, v204
    v_max_f32 v125, s68, v125
    v_exp_f32_e64 v206, v206 clamp
    v_mul_f32 v207, 0x3fb8aa3b, v127
    v_add_f32 v125, v125, v205
    v_max_f32 v126, s68, v126
    v_exp_f32_e64 v207, v207 clamp
    v_mul_f32 v200, 0x3fb8aa3b, v128
    v_cvt_pk_bf16_f32 v122, v124, v125
    v_add_f32 v126, v126, v206
    v_max_f32 v127, s68, v127
    v_exp_f32_e64 v200, v200 clamp
    v_mul_f32 v201, 0x3fb8aa3b, v129
    v_add_f32 v127, v127, v207
    v_max_f32 v128, s68, v128
    v_exp_f32_e64 v201, v201 clamp
    v_mul_f32 v202, 0x3fb8aa3b, v130
    v_cvt_pk_bf16_f32 v123, v126, v127
    v_add_f32 v128, v128, v200
    v_max_f32 v129, s68, v129
    v_exp_f32_e64 v202, v202 clamp
    v_mul_f32 v203, 0x3fb8aa3b, v131
    ds_write_b128 v4, v[120:123] offset:1024
    v_add_f32 v129, v129, v201
    v_max_f32 v130, s68, v130
    v_exp_f32_e64 v203, v203 clamp
    v_mul_f32 v204, 0x3fb8aa3b, v132
    v_cvt_pk_bf16_f32 v128, v128, v129
    v_add_f32 v130, v130, v202
    v_max_f32 v131, s68, v131
    v_exp_f32_e64 v204, v204 clamp
    v_mul_f32 v205, 0x3fb8aa3b, v133
    v_add_f32 v131, v131, v203
    v_max_f32 v132, s68, v132
    v_exp_f32_e64 v205, v205 clamp
    v_mul_f32 v206, 0x3fb8aa3b, v134
    v_cvt_pk_bf16_f32 v129, v130, v131
    v_add_f32 v132, v132, v204
    v_max_f32 v133, s68, v133
    v_exp_f32_e64 v206, v206 clamp
    v_mul_f32 v207, 0x3fb8aa3b, v135
    v_add_f32 v133, v133, v205
    v_max_f32 v134, s68, v134
    v_exp_f32_e64 v207, v207 clamp
    v_mul_f32 v200, 0x3fb8aa3b, v136
    v_cvt_pk_bf16_f32 v130, v132, v133
    v_add_f32 v134, v134, v206
    v_max_f32 v135, s68, v135
    v_exp_f32_e64 v200, v200 clamp
    v_mul_f32 v201, 0x3fb8aa3b, v137
    v_add_f32 v135, v135, v207
    v_max_f32 v136, s68, v136
    v_exp_f32_e64 v201, v201 clamp
    v_mul_f32 v202, 0x3fb8aa3b, v138
    v_cvt_pk_bf16_f32 v131, v134, v135
    v_add_f32 v136, v136, v200
    v_max_f32 v137, s68, v137
    v_exp_f32_e64 v202, v202 clamp
    v_mul_f32 v203, 0x3fb8aa3b, v139
    ds_write_b128 v4, v[128:131] offset:2048
    v_add_f32 v137, v137, v201
    v_max_f32 v138, s68, v138
    v_exp_f32_e64 v203, v203 clamp
    v_mul_f32 v204, 0x3fb8aa3b, v140
    v_cvt_pk_bf16_f32 v136, v136, v137
    v_add_f32 v138, v138, v202
    v_max_f32 v139, s68, v139
    v_exp_f32_e64 v204, v204 clamp
    v_mul_f32 v205, 0x3fb8aa3b, v141
    v_add_f32 v139, v139, v203
    v_max_f32 v140, s68, v140
    v_exp_f32_e64 v205, v205 clamp
    v_mul_f32 v206, 0x3fb8aa3b, v142
    v_cvt_pk_bf16_f32 v137, v138, v139
    v_add_f32 v140, v140, v204
    v_max_f32 v141, s68, v141
    v_exp_f32_e64 v206, v206 clamp
    v_mul_f32 v207, 0x3fb8aa3b, v143
    v_add_f32 v141, v141, v205
    v_max_f32 v142, s68, v142
    v_exp_f32_e64 v207, v207 clamp
    v_mul_f32 v200, 0x3fb8aa3b, v144
    v_cvt_pk_bf16_f32 v138, v140, v141
    v_add_f32 v142, v142, v206
    v_max_f32 v143, s68, v143
    v_exp_f32_e64 v200, v200 clamp
    v_mul_f32 v201, 0x3fb8aa3b, v145
    v_add_f32 v143, v143, v207
    v_max_f32 v144, s68, v144
    v_exp_f32_e64 v201, v201 clamp
    v_mul_f32 v202, 0x3fb8aa3b, v146
    v_cvt_pk_bf16_f32 v139, v142, v143
    v_add_f32 v144, v144, v200
    v_max_f32 v145, s68, v145
    v_exp_f32_e64 v202, v202 clamp
    v_mul_f32 v203, 0x3fb8aa3b, v147
    ds_write_b128 v4, v[136:139] offset:3072
    v_add_f32 v145, v145, v201
    v_max_f32 v146, s68, v146
    v_exp_f32_e64 v203, v203 clamp
    v_mul_f32 v204, 0x3fb8aa3b, v148
    v_cvt_pk_bf16_f32 v144, v144, v145
    v_add_f32 v146, v146, v202
    v_max_f32 v147, s68, v147
    v_exp_f32_e64 v204, v204 clamp
    v_mul_f32 v205, 0x3fb8aa3b, v149
    v_add_f32 v147, v147, v203
    v_max_f32 v148, s68, v148
    v_exp_f32_e64 v205, v205 clamp
    v_mul_f32 v206, 0x3fb8aa3b, v150
    v_cvt_pk_bf16_f32 v145, v146, v147
    v_add_f32 v148, v148, v204
    v_max_f32 v149, s68, v149
    v_exp_f32_e64 v206, v206 clamp
    v_mul_f32 v207, 0x3fb8aa3b, v151
    v_add_f32 v149, v149, v205
    v_max_f32 v150, s68, v150
    v_exp_f32_e64 v207, v207 clamp
    v_mul_f32 v200, 0x3fb8aa3b, v152
    v_cvt_pk_bf16_f32 v146, v148, v149
    v_add_f32 v150, v150, v206
    v_max_f32 v151, s68, v151
    v_exp_f32_e64 v200, v200 clamp
    v_mul_f32 v201, 0x3fb8aa3b, v153
    v_add_f32 v151, v151, v207
    v_max_f32 v152, s68, v152
    v_exp_f32_e64 v201, v201 clamp
    v_mul_f32 v202, 0x3fb8aa3b, v154
    v_cvt_pk_bf16_f32 v147, v150, v151
    v_add_f32 v152, v152, v200
    v_max_f32 v153, s68, v153
    v_exp_f32_e64 v202, v202 clamp
    v_mul_f32 v203, 0x3fb8aa3b, v155
    ds_write_b128 v4, v[144:147] offset:4096
    v_add_f32 v153, v153, v201
    v_max_f32 v154, s68, v154
    v_exp_f32_e64 v203, v203 clamp
    v_mul_f32 v204, 0x3fb8aa3b, v156
    v_cvt_pk_bf16_f32 v152, v152, v153
    v_add_f32 v154, v154, v202
    v_max_f32 v155, s68, v155
    v_exp_f32_e64 v204, v204 clamp
    v_mul_f32 v205, 0x3fb8aa3b, v157
    v_add_f32 v155, v155, v203
    v_max_f32 v156, s68, v156
    v_exp_f32_e64 v205, v205 clamp
    v_mul_f32 v206, 0x3fb8aa3b, v158
    v_cvt_pk_bf16_f32 v153, v154, v155
    v_add_f32 v156, v156, v204
    v_max_f32 v157, s68, v157
    v_exp_f32_e64 v206, v206 clamp
    v_mul_f32 v207, 0x3fb8aa3b, v159
    v_add_f32 v157, v157, v205
    v_max_f32 v158, s68, v158
    v_exp_f32_e64 v207, v207 clamp
    v_mul_f32 v200, 0x3fb8aa3b, v160
    v_cvt_pk_bf16_f32 v154, v156, v157
    v_add_f32 v158, v158, v206
    v_max_f32 v159, s68, v159
    v_exp_f32_e64 v200, v200 clamp
    v_mul_f32 v201, 0x3fb8aa3b, v161
    v_add_f32 v159, v159, v207
    v_max_f32 v160, s68, v160
    v_exp_f32_e64 v201, v201 clamp
    v_mul_f32 v202, 0x3fb8aa3b, v162
    v_cvt_pk_bf16_f32 v155, v158, v159
    v_add_f32 v160, v160, v200
    v_max_f32 v161, s68, v161
    v_exp_f32_e64 v202, v202 clamp
    v_mul_f32 v203, 0x3fb8aa3b, v163
    ds_write_b128 v4, v[152:155] offset:5120
    v_add_f32 v161, v161, v201
    v_max_f32 v162, s68, v162
    v_exp_f32_e64 v203, v203 clamp
    v_mul_f32 v204, 0x3fb8aa3b, v164
    v_cvt_pk_bf16_f32 v160, v160, v161
    v_add_f32 v162, v162, v202
    v_max_f32 v163, s68, v163
    v_exp_f32_e64 v204, v204 clamp
    v_mul_f32 v205, 0x3fb8aa3b, v165
    v_add_f32 v163, v163, v203
    v_max_f32 v164, s68, v164
    v_exp_f32_e64 v205, v205 clamp
    v_mul_f32 v206, 0x3fb8aa3b, v166
    v_cvt_pk_bf16_f32 v161, v162, v163
    v_add_f32 v164, v164, v204
    v_max_f32 v165, s68, v165
    v_exp_f32_e64 v206, v206 clamp
    v_mul_f32 v207, 0x3fb8aa3b, v167
    v_add_f32 v165, v165, v205
    v_max_f32 v166, s68, v166
    v_exp_f32_e64 v207, v207 clamp
    v_mul_f32 v200, 0x3fb8aa3b, v168
    v_cvt_pk_bf16_f32 v162, v164, v165
    v_add_f32 v166, v166, v206
    v_max_f32 v167, s68, v167
    v_exp_f32_e64 v200, v200 clamp
    v_mul_f32 v201, 0x3fb8aa3b, v169
    v_add_f32 v167, v167, v207
    v_max_f32 v168, s68, v168
    v_exp_f32_e64 v201, v201 clamp
    v_mul_f32 v202, 0x3fb8aa3b, v170
    v_cvt_pk_bf16_f32 v163, v166, v167
    v_add_f32 v168, v168, v200
    v_max_f32 v169, s68, v169
    v_exp_f32_e64 v202, v202 clamp
    v_mul_f32 v203, 0x3fb8aa3b, v171
    ds_write_b128 v4, v[160:163] offset:6144
    v_add_f32 v169, v169, v201
    v_max_f32 v170, s68, v170
    v_exp_f32_e64 v203, v203 clamp
    v_mul_f32 v204, 0x3fb8aa3b, v172
    v_cvt_pk_bf16_f32 v168, v168, v169
    v_add_f32 v170, v170, v202
    v_max_f32 v171, s68, v171
    v_exp_f32_e64 v204, v204 clamp
    v_mul_f32 v205, 0x3fb8aa3b, v173
    v_add_f32 v171, v171, v203
    v_max_f32 v172, s68, v172
    v_exp_f32_e64 v205, v205 clamp
    v_mul_f32 v206, 0x3fb8aa3b, v174
    v_cvt_pk_bf16_f32 v169, v170, v171
    v_add_f32 v172, v172, v204
    v_max_f32 v173, s68, v173
    v_exp_f32_e64 v206, v206 clamp
    v_mul_f32 v207, 0x3fb8aa3b, v175
    v_add_f32 v173, v173, v205
    v_max_f32 v174, s68, v174
    v_exp_f32_e64 v207, v207 clamp
    v_cvt_pk_bf16_f32 v170, v172, v173
    v_add_f32 v174, v174, v206
    v_max_f32 v175, s68, v175
    v_add_f32 v175, v175, v207
    v_cvt_pk_bf16_f32 v171, v174, v175
    ds_write_b128 v4, v[168:171] offset:7168
    s_lshl_b32 s9, s3, 5
    v_subrev_u32 v6, s7, v240
    v_xor_b32 v6, s9, v6
    v_add_u32 v7, 0x10000, v6
    v_add_u32 v8, 0x20000, v6
    s_and_b32 s9, s3, 1
    s_lshl_b32 s9, s9, 3
    s_sub_u32 s9, 18, s9
    v_lshrrev_b32 v200, 4, v1
    v_lshlrev_b32 v200, 2, v200
    v_add_u32 v200, s9, v200
    v_and_b32 v201, 15, v1
    v_add_u32 v201, s9, v201
    v_mul_u32_u24 v200, 57, v200
    v_mul_u32_u24 v201, 57, v201
    s_waitcnt lgkmcnt(0)
    s_barrier
    s_lshl_b32 s9, s80, 11
    v_add_u32 v202, s9, v2
    ds_read_b64 a[0:1], v202 offset:0
    ds_read_b64 a[4:5], v202 offset:8
    ds_read_b64 a[8:9], v202 offset:1024
    ds_read_b64 a[12:13], v202 offset:1032
    ds_read_b64 a[2:3], v202 offset:2048
    ds_read_b64 a[6:7], v202 offset:2056
    ds_read_b64 a[10:11], v202 offset:3072
    ds_read_b64 a[14:15], v202 offset:3080
    ds_read_b64 a[16:17], v202 offset:4096
    ds_read_b64 a[20:21], v202 offset:4104
    ds_read_b64 a[24:25], v202 offset:5120
    ds_read_b64 a[28:29], v202 offset:5128
    ds_read_b64 a[18:19], v202 offset:6144
    ds_read_b64 a[22:23], v202 offset:6152
    ds_read_b64 a[26:27], v202 offset:7168
    ds_read_b64 a[30:31], v202 offset:7176
    ds_read_b64 a[32:33], v202 offset:8192
    ds_read_b64 a[36:37], v202 offset:8200
    ds_read_b64 a[40:41], v202 offset:9216
    ds_read_b64 a[44:45], v202 offset:9224
    v_add_u32 v16, 0, v200
    v_add_u32 v17, 114, v200
    v_add_u32 v26, 0, v201
    v_add_u32 v18, 912, v200
    v_add_u32 v19, 1026, v200
    v_add_u32 v27, 912, v201
    v_add_u32 v20, 1824, v200
    v_add_u32 v21, 1938, v200
    v_add_u32 v28, 1824, v201
    v_add_u32 v22, 2736, v200
    v_add_u32 v23, 2850, v200
    v_add_u32 v29, 2736, v201
    v_add_u32 v24, 3648, v200
    v_add_u32 v25, 3762, v200
    v_add_u32 v30, 3648, v201
    v_lshrrev_b32 v16, 10, v16
    v_lshrrev_b32 v17, 10, v17
    v_lshrrev_b32 v18, 10, v18
    v_lshrrev_b32 v19, 10, v19
    v_lshrrev_b32 v20, 10, v20
    v_lshrrev_b32 v21, 10, v21
    v_lshrrev_b32 v22, 10, v22
    v_lshrrev_b32 v23, 10, v23
    v_lshrrev_b32 v24, 10, v24
    v_lshrrev_b32 v25, 10, v25
    v_lshrrev_b32 v26, 10, v26
    v_lshrrev_b32 v27, 10, v27
    v_lshrrev_b32 v28, 10, v28
    v_lshrrev_b32 v29, 10, v29
    v_lshrrev_b32 v30, 10, v30
    v_accvgpr_write_b32 a34, 0
    v_accvgpr_write_b32 a35, 0
    v_accvgpr_write_b32 a38, 0
    v_accvgpr_write_b32 a39, 0
    v_accvgpr_write_b32 a42, 0
    v_accvgpr_write_b32 a43, 0
    v_accvgpr_write_b32 a46, 0
    v_accvgpr_write_b32 a47, 0
    s_lshr_b32 s9, s80, 1
    s_lshl_b32 s9, s9, 12
    s_and_b32 s15, s80, 1
    s_lshl_b32 s72, s15, 3
    s_add_u32 s72, s72, s9
    v_add_u32 v4, s72, v2
    s_mul_i32 s72, s15, 4088
    s_add_u32 s72, s72, s9
    s_add_u32 s72, s72, 8
    v_add_u32 v5, s72, v2
    s_bitcmp0_b32 s3, 0
    s_cselect_b64 s[72:73], -1, 0
    s_mov_b32 s73, -1
    s_cselect_b64 s[84:85], 0, -1
    s_mov_b32 s84, -1
    s_waitcnt vmcnt(3)
    s_mov_b32 s71, 0
L_tc_kf:
    v_mov_b32 v208, s86
    v_mov_b32 v209, s86
    v_min3_u32 v208, v208, v51, v55
    v_max3_u32 v209, v209, v51, v55
    v_min3_u32 v208, v208, v59, v63
    v_max3_u32 v209, v209, v59, v63
    v_min3_u32 v208, v208, v67, v71
    v_max3_u32 v209, v209, v67, v71
    v_min3_u32 v208, v208, v75, v79
    v_max3_u32 v209, v209, v75, v79
    v_min3_u32 v208, v208, v83, v87
    v_max3_u32 v209, v209, v83, v87
    v_min3_u32 v208, v208, v91, v95
    v_max3_u32 v209, v209, v91, v95
    v_cmp_eq_u32 vcc, v208, v209
    s_add_u32 s71, s71, 1
    s_nop 2
    s_cmp_eq_u64 vcc, -1
    s_cbranch_scc1 L_tc_kf_ok
    s_sleep 4
    s_add_u32 s70, s82, 0
    buffer_load_dwordx4 v[48:51], v2, s[52:55], s70 offen offset:0 sc1
    buffer_load_dwordx4 v[52:55], v2, s[52:55], s70 offen offset:1024 sc1
    buffer_load_dwordx4 v[56:59], v2, s[52:55], s70 offen offset:2048 sc1
    buffer_load_dwordx4 v[60:63], v2, s[52:55], s70 offen offset:3072 sc1
    s_add_u32 s70, s82, 4096
    buffer_load_dwordx4 v[64:67], v2, s[52:55], s70 offen offset:0 sc1
    buffer_load_dwordx4 v[68:71], v2, s[52:55], s70 offen offset:1024 sc1
    buffer_load_dwordx4 v[72:75], v2, s[52:55], s70 offen offset:2048 sc1
    buffer_load_dwordx4 v[76:79], v2, s[52:55], s70 offen offset:3072 sc1
    s_add_u32 s70, s82, 8192
    buffer_load_dwordx4 v[80:83], v2, s[52:55], s70 offen offset:0 sc1
    buffer_load_dwordx4 v[84:87], v2, s[52:55], s70 offen offset:1024 sc1
    buffer_load_dwordx4 v[88:91], v2, s[52:55], s70 offen offset:2048 sc1
    buffer_load_dwordx4 v[92:95], v2, s[52:55], s70 offen offset:3072 sc1
    s_waitcnt vmcnt(0)
    s_cmp_lt_u32 s71, 0x8000
    s_cbranch_scc1 L_tc_kf
L_tc_kf_ok:
    s_waitcnt lgkmcnt(0)
    s_barrier
    v_cmp_eq_u32 s[88:89], v16, v26
    v_cmp_eq_u32 s[90:91], v17, v26
    v_cmp_eq_u32 s[92:93], v18, v26
    v_cmp_eq_u32 s[94:95], v19, v26
    v_cndmask_b32 v32, 0, v48, s[88:89]
    v_cndmask_b32 v36, 0, v85, s[88:89]
    v_cndmask_b32 v33, 0, v49, s[90:91]
    v_cndmask_b32 v37, 0, v86, s[90:91]
    v_cndmask_b32 v34, 0, v50, s[92:93]
    v_cndmask_b32 v38, 0, v88, s[92:93]
    v_cndmask_b32 v35, 0, v52, s[94:95]
    v_cndmask_b32 v39, 0, v89, s[94:95]
    s_nop 0
    v_mfma_f32_16x16x32_bf16 v[112:115], v[32:35], a[0:3], 0
    v_cmp_eq_u32 s[88:89], v16, v27
    v_cmp_eq_u32 s[90:91], v17, v27
    v_mfma_f32_16x16x32_bf16 v[116:119], v[32:35], a[4:7], 0
    v_cmp_eq_u32 s[92:93], v18, v27
    v_cmp_eq_u32 s[94:95], v19, v27
    v_mfma_f32_16x16x32_bf16 v[120:123], v[32:35], a[8:11], 0
    v_cndmask_b32 v40, 0, v53, s[88:89]
    v_cndmask_b32 v44, 0, v85, s[88:89]
    v_mfma_f32_16x16x32_bf16 v[124:127], v[32:35], a[12:15], 0
    v_cndmask_b32 v41, 0, v54, s[90:91]
    v_cndmask_b32 v45, 0, v86, s[90:91]
    v_mfma_f32_16x16x32_bf16 v[128:131], v[36:39], a[0:3], v[232:235]
    v_cndmask_b32 v42, 0, v56, s[92:93]
    v_cndmask_b32 v46, 0, v88, s[92:93]
    v_mfma_f32_16x16x32_bf16 v[132:135], v[36:39], a[4:7], v[232:235]
    v_cndmask_b32 v43, 0, v57, s[94:95]
    v_cndmask_b32 v47, 0, v89, s[94:95]
    v_mfma_f32_16x16x32_bf16 v[136:139], v[36:39], a[8:11], v[232:235]
    v_mfma_f32_16x16x32_bf16 v[140:143], v[36:39], a[12:15], v[232:235]
    v_mfma_f32_16x16x32_bf16 v[144:147], v[40:43], a[0:3], 0
    v_cmp_eq_u32 s[88:89], v20, v27
    v_cmp_eq_u32 s[90:91], v21, v27
    v_mov_b32 v34, 0
    v_mov_b32 v38, 0
    v_mfma_f32_16x16x32_bf16 v[148:151], v[40:43], a[4:7], 0
    v_mov_b32 v35, 0
    v_mov_b32 v39, 0
    v_cndmask_b32 v32, 0, v69, s[88:89]
    v_cndmask_b32 v36, 0, v90, s[88:89]
    v_mfma_f32_16x16x32_bf16 v[152:155], v[40:43], a[8:11], 0
    v_cndmask_b32 v33, 0, v70, s[90:91]
    v_cndmask_b32 v37, 0, v92, s[90:91]
    v_rcp_f32 v128, v128
    v_rcp_f32 v130, v130
    v_mfma_f32_16x16x32_bf16 v[156:159], v[40:43], a[12:15], 0
    v_rcp_f32 v132, v132
    v_rcp_f32 v134, v134
    v_rcp_f32 v136, v136
    v_rcp_f32 v138, v138
    v_mfma_f32_16x16x32_bf16 v[160:163], v[44:47], a[0:3], v[232:235]
    v_rcp_f32 v140, v140
    v_rcp_f32 v142, v142
    v_mul_f32 v112, v112, v128
    v_mul_f32 v113, v113, v128
    v_mfma_f32_16x16x32_bf16 v[164:167], v[44:47], a[4:7], v[232:235]
    v_mul_f32 v114, v114, v130
    v_mul_f32 v115, v115, v130
    v_mul_f32 v116, v116, v132
    v_mul_f32 v117, v117, v132
    v_mfma_f32_16x16x32_bf16 v[168:171], v[44:47], a[8:11], v[232:235]
    v_mul_f32 v118, v118, v134
    v_mul_f32 v119, v119, v134
    v_mfma_f32_16x16x32_bf16 v[172:175], v[44:47], a[12:15], v[232:235]
    v_mfma_f32_16x16x32_bf16 v[144:147], v[32:35], a[16:19], v[144:147]
    v_mov_b32 v40, 0
    v_mov_b32 v44, 0
    v_mov_b32 v41, 0
    v_mov_b32 v45, 0
    v_mfma_f32_16x16x32_bf16 v[148:151], v[32:35], a[20:23], v[148:151]
    v_cmp_eq_u32 s[92:93], v18, v28
    v_cmp_eq_u32 s[94:95], v19, v28
    s_nop 0
    v_cndmask_b32 v42, 0, v72, s[92:93]
    v_cndmask_b32 v46, 0, v88, s[92:93]
    v_mfma_f32_16x16x32_bf16 v[152:155], v[32:35], a[24:27], v[152:155]
    v_cndmask_b32 v43, 0, v73, s[94:95]
    v_cndmask_b32 v47, 0, v89, s[94:95]
    v_mul_f32 v120, v120, v136
    v_mul_f32 v121, v121, v136
    v_mfma_f32_16x16x32_bf16 v[156:159], v[32:35], a[28:31], v[156:159]
    v_mul_f32 v122, v122, v138
    v_mul_f32 v123, v123, v138
    v_mul_f32 v124, v124, v140
    v_mul_f32 v125, v125, v140
    v_mfma_f32_16x16x32_bf16 v[160:163], v[36:39], a[16:19], v[160:163]
    v_mul_f32 v126, v126, v142
    v_mul_f32 v127, v127, v142
    v_cvt_pk_bf16_f32 v128, v112, v113
    v_cvt_pk_bf16_f32 v129, v114, v115
    v_mfma_f32_16x16x32_bf16 v[164:167], v[36:39], a[20:23], v[164:167]
    v_cvt_pk_bf16_f32 v130, v116, v117
    v_cvt_pk_bf16_f32 v131, v118, v119
    v_cvt_pk_bf16_f32 v132, v120, v121
    v_cvt_pk_bf16_f32 v133, v122, v123
    v_mfma_f32_16x16x32_bf16 v[168:171], v[36:39], a[24:27], v[168:171]
    v_cvt_pk_bf16_f32 v134, v124, v125
    v_cvt_pk_bf16_f32 v135, v126, v127
    s_mov_b64 exec, s[72:73]
    ds_write_b64 v4, v[128:129] offset:0
    ds_write_b64 v4, v[130:131] offset:1024
    ds_write_b64 v4, v[132:133] offset:2048
    ds_write_b64 v4, v[134:135] offset:3072
    s_mov_b64 exec, -1
    v_mfma_f32_16x16x32_bf16 v[172:175], v[36:39], a[28:31], v[172:175]
    v_mfma_f32_16x16x32_bf16 v[112:115], v[40:43], a[0:3], 0
    v_cmp_eq_u32 s[88:89], v20, v28
    v_cmp_eq_u32 s[90:91], v21, v28
    v_cmp_eq_u32 s[92:93], v22, v28
    v_cmp_eq_u32 s[94:95], v23, v28
    v_mfma_f32_16x16x32_bf16 v[116:119], v[40:43], a[4:7], 0
    v_cndmask_b32 v32, 0, v58, s[88:89]
    v_cndmask_b32 v36, 0, v90, s[88:89]
    v_cndmask_b32 v33, 0, v60, s[90:91]
    v_cndmask_b32 v37, 0, v92, s[90:91]
    v_mfma_f32_16x16x32_bf16 v[120:123], v[40:43], a[8:11], 0
    v_cndmask_b32 v34, 0, v61, s[92:93]
    v_cndmask_b32 v38, 0, v93, s[92:93]
    v_cndmask_b32 v35, 0, v62, s[94:95]
    v_cndmask_b32 v39, 0, v94, s[94:95]
    v_mfma_f32_16x16x32_bf16 v[124:127], v[40:43], a[12:15], 0
    v_rcp_f32 v160, v160
    v_rcp_f32 v162, v162
    v_rcp_f32 v164, v164
    v_rcp_f32 v166, v166
    v_mfma_f32_16x16x32_bf16 v[128:131], v[44:47], a[0:3], v[232:235]
    v_rcp_f32 v168, v168
    v_rcp_f32 v170, v170
    v_rcp_f32 v172, v172
    v_rcp_f32 v174, v174
    v_mfma_f32_16x16x32_bf16 v[132:135], v[44:47], a[4:7], v[232:235]
    v_mul_f32 v144, v144, v160
    v_mul_f32 v145, v145, v160
    v_mul_f32 v146, v146, v162
    v_mul_f32 v147, v147, v162
    v_mfma_f32_16x16x32_bf16 v[136:139], v[44:47], a[8:11], v[232:235]
    v_mul_f32 v148, v148, v164
    v_mul_f32 v149, v149, v164
    v_mul_f32 v150, v150, v166
    v_mul_f32 v151, v151, v166
    v_mfma_f32_16x16x32_bf16 v[140:143], v[44:47], a[12:15], v[232:235]
    v_mfma_f32_16x16x32_bf16 v[112:115], v[32:35], a[16:19], v[112:115]
    v_cmp_eq_u32 s[88:89], v20, v29
    v_cmp_eq_u32 s[90:91], v21, v29
    v_cmp_eq_u32 s[92:93], v22, v29
    v_cmp_eq_u32 s[94:95], v23, v29
    v_mfma_f32_16x16x32_bf16 v[116:119], v[32:35], a[20:23], v[116:119]
    v_cndmask_b32 v40, 0, v64, s[88:89]
    v_cndmask_b32 v44, 0, v90, s[88:89]
    v_cndmask_b32 v41, 0, v65, s[90:91]
    v_cndmask_b32 v45, 0, v92, s[90:91]
    v_mfma_f32_16x16x32_bf16 v[120:123], v[32:35], a[24:27], v[120:123]
    v_cndmask_b32 v42, 0, v66, s[92:93]
    v_cndmask_b32 v46, 0, v93, s[92:93]
    v_cndmask_b32 v43, 0, v68, s[94:95]
    v_cndmask_b32 v47, 0, v94, s[94:95]
    v_mfma_f32_16x16x32_bf16 v[124:127], v[32:35], a[28:31], v[124:127]
    v_mul_f32 v152, v152, v168
    v_mul_f32 v153, v153, v168
    v_mul_f32 v154, v154, v170
    v_mul_f32 v155, v155, v170
    v_mfma_f32_16x16x32_bf16 v[128:131], v[36:39], a[16:19], v[128:131]
    v_mul_f32 v156, v156, v172
    v_mul_f32 v157, v157, v172
    v_mul_f32 v158, v158, v174
    v_mul_f32 v159, v159, v174
    v_mfma_f32_16x16x32_bf16 v[132:135], v[36:39], a[20:23], v[132:135]
    v_cvt_pk_bf16_f32 v160, v144, v145
    v_cvt_pk_bf16_f32 v161, v146, v147
    v_cvt_pk_bf16_f32 v162, v148, v149
    v_cvt_pk_bf16_f32 v163, v150, v151
    v_mfma_f32_16x16x32_bf16 v[136:139], v[36:39], a[24:27], v[136:139]
    v_cvt_pk_bf16_f32 v164, v152, v153
    v_cvt_pk_bf16_f32 v165, v154, v155
    v_cvt_pk_bf16_f32 v166, v156, v157
    v_cvt_pk_bf16_f32 v167, v158, v159
    v_mfma_f32_16x16x32_bf16 v[140:143], v[36:39], a[28:31], v[140:143]
    ds_write_b64 v5, v[160:161] offset:0
    ds_write_b64 v5, v[162:163] offset:1024
    ds_write_b64 v5, v[164:165] offset:2048
    ds_write_b64 v5, v[166:167] offset:3072
    v_mfma_f32_16x16x32_bf16 v[144:147], v[40:43], a[16:19], 0
    v_cmp_eq_u32 s[88:89], v24, v29
    v_cmp_eq_u32 s[90:91], v25, v29
    v_mov_b32 v34, 0
    v_mov_b32 v38, 0
    v_mfma_f32_16x16x32_bf16 v[148:151], v[40:43], a[20:23], 0
    v_mov_b32 v35, 0
    v_mov_b32 v39, 0
    v_cndmask_b32 v32, 0, v74, s[88:89]
    v_cndmask_b32 v36, 0, v82, s[88:89]
    v_mfma_f32_16x16x32_bf16 v[152:155], v[40:43], a[24:27], 0
    v_cndmask_b32 v33, 0, v76, s[90:91]
    v_cndmask_b32 v37, 0, v84, s[90:91]
    v_rcp_f32 v128, v128
    v_rcp_f32 v130, v130
    v_mfma_f32_16x16x32_bf16 v[156:159], v[40:43], a[28:31], 0
    v_rcp_f32 v132, v132
    v_rcp_f32 v134, v134
    v_rcp_f32 v136, v136
    v_rcp_f32 v138, v138
    v_mfma_f32_16x16x32_bf16 v[160:163], v[44:47], a[16:19], v[232:235]
    v_rcp_f32 v140, v140
    v_rcp_f32 v142, v142
    v_mul_f32 v112, v112, v128
    v_mul_f32 v113, v113, v128
    v_mfma_f32_16x16x32_bf16 v[164:167], v[44:47], a[20:23], v[232:235]
    v_mul_f32 v114, v114, v130
    v_mul_f32 v115, v115, v130
    v_mul_f32 v116, v116, v132
    v_mul_f32 v117, v117, v132
    v_mfma_f32_16x16x32_bf16 v[168:171], v[44:47], a[24:27], v[232:235]
    v_mul_f32 v118, v118, v134
    v_mul_f32 v119, v119, v134
    v_mfma_f32_16x16x32_bf16 v[172:175], v[44:47], a[28:31], v[232:235]
    v_mfma_f32_16x16x32_bf16 v[144:147], v[32:35], a[32:35], v[144:147]
    v_mov_b32 v40, 0
    v_mov_b32 v44, 0
    v_mov_b32 v41, 0
    v_mov_b32 v45, 0
    v_mfma_f32_16x16x32_bf16 v[148:151], v[32:35], a[36:39], v[148:151]
    v_cmp_eq_u32 s[92:93], v22, v30
    v_cmp_eq_u32 s[94:95], v23, v30
    s_nop 0
    v_cndmask_b32 v42, 0, v77, s[92:93]
    v_cndmask_b32 v46, 0, v93, s[92:93]
    v_mfma_f32_16x16x32_bf16 v[152:155], v[32:35], a[40:43], v[152:155]
    v_cndmask_b32 v43, 0, v78, s[94:95]
    v_cndmask_b32 v47, 0, v94, s[94:95]
    v_mul_f32 v120, v120, v136
    v_mul_f32 v121, v121, v136
    v_mfma_f32_16x16x32_bf16 v[156:159], v[32:35], a[44:47], v[156:159]
    v_mul_f32 v122, v122, v138
    v_mul_f32 v123, v123, v138
    v_mul_f32 v124, v124, v140
    v_mul_f32 v125, v125, v140
    v_mfma_f32_16x16x32_bf16 v[160:163], v[36:39], a[32:35], v[160:163]
    v_mul_f32 v126, v126, v142
    v_mul_f32 v127, v127, v142
    v_cvt_pk_bf16_f32 v128, v112, v113
    v_cvt_pk_bf16_f32 v129, v114, v115
    v_mfma_f32_16x16x32_bf16 v[164:167], v[36:39], a[36:39], v[164:167]
    v_cvt_pk_bf16_f32 v130, v116, v117
    v_cvt_pk_bf16_f32 v131, v118, v119
    v_cvt_pk_bf16_f32 v132, v120, v121
    v_cvt_pk_bf16_f32 v133, v122, v123
    v_mfma_f32_16x16x32_bf16 v[168:171], v[36:39], a[40:43], v[168:171]
    v_cvt_pk_bf16_f32 v134, v124, v125
    v_cvt_pk_bf16_f32 v135, v126, v127
    ds_write_b64 v4, v[128:129] offset:4096
    ds_write_b64 v4, v[130:131] offset:5120
    ds_write_b64 v4, v[132:133] offset:6144
    ds_write_b64 v4, v[134:135] offset:7168
    v_mfma_f32_16x16x32_bf16 v[172:175], v[36:39], a[44:47], v[172:175]
    v_mfma_f32_16x16x32_bf16 v[112:115], v[40:43], a[16:19], 0
    v_cmp_eq_u32 s[88:89], v24, v30
    v_cmp_eq_u32 s[90:91], v25, v30
    v_mov_b32 v34, 0
    v_mov_b32 v38, 0
    v_mfma_f32_16x16x32_bf16 v[116:119], v[40:43], a[20:23], 0
    v_mov_b32 v35, 0
    v_mov_b32 v39, 0
    v_cndmask_b32 v32, 0, v80, s[88:89]
    v_cndmask_b32 v36, 0, v82, s[88:89]
    v_mfma_f32_16x16x32_bf16 v[120:123], v[40:43], a[24:27], 0
    v_cndmask_b32 v33, 0, v81, s[90:91]
    v_cndmask_b32 v37, 0, v84, s[90:91]
    v_rcp_f32 v160, v160
    v_rcp_f32 v162, v162
    v_mfma_f32_16x16x32_bf16 v[124:127], v[40:43], a[28:31], 0
    v_rcp_f32 v164, v164
    v_rcp_f32 v166, v166
    v_rcp_f32 v168, v168
    v_rcp_f32 v170, v170
    v_mfma_f32_16x16x32_bf16 v[128:131], v[44:47], a[16:19], v[232:235]
    v_rcp_f32 v172, v172
    v_rcp_f32 v174, v174
    v_mul_f32 v144, v144, v160
    v_mul_f32 v145, v145, v160
    v_mfma_f32_16x16x32_bf16 v[132:135], v[44:47], a[20:23], v[232:235]
    v_mul_f32 v146, v146, v162
    v_mul_f32 v147, v147, v162
    v_mul_f32 v148, v148, v164
    v_mul_f32 v149, v149, v164
    v_mfma_f32_16x16x32_bf16 v[136:139], v[44:47], a[24:27], v[232:235]
    v_mul_f32 v150, v150, v166
    v_mul_f32 v151, v151, v166
    v_mfma_f32_16x16x32_bf16 v[140:143], v[44:47], a[28:31], v[232:235]
    v_mfma_f32_16x16x32_bf16 v[112:115], v[32:35], a[32:35], v[112:115]
    v_mul_f32 v152, v152, v168
    v_mul_f32 v153, v153, v168
    v_mul_f32 v154, v154, v170
    v_mfma_f32_16x16x32_bf16 v[116:119], v[32:35], a[36:39], v[116:119]
    v_mul_f32 v155, v155, v170
    v_mul_f32 v156, v156, v172
    v_mul_f32 v157, v157, v172
    v_mfma_f32_16x16x32_bf16 v[120:123], v[32:35], a[40:43], v[120:123]
    v_mul_f32 v158, v158, v174
    v_mul_f32 v159, v159, v174
    v_cvt_pk_bf16_f32 v160, v144, v145
    v_mfma_f32_16x16x32_bf16 v[124:127], v[32:35], a[44:47], v[124:127]
    v_cvt_pk_bf16_f32 v161, v146, v147
    v_cvt_pk_bf16_f32 v162, v148, v149
    v_cvt_pk_bf16_f32 v163, v150, v151
    v_mfma_f32_16x16x32_bf16 v[128:131], v[36:39], a[32:35], v[128:131]
    v_cvt_pk_bf16_f32 v164, v152, v153
    v_cvt_pk_bf16_f32 v165, v154, v155
    v_cvt_pk_bf16_f32 v166, v156, v157
    v_mfma_f32_16x16x32_bf16 v[132:135], v[36:39], a[36:39], v[132:135]
    v_cvt_pk_bf16_f32 v167, v158, v159
    ds_write_b64 v5, v[160:161] offset:4096
    ds_write_b64 v5, v[162:163] offset:5120
    ds_write_b64 v5, v[164:165] offset:6144
    ds_write_b64 v5, v[166:167] offset:7168
    v_mfma_f32_16x16x32_bf16 v[136:139], v[36:39], a[40:43], v[136:139]
    v_mfma_f32_16x16x32_bf16 v[140:143], v[36:39], a[44:47], v[140:143]
    v_rcp_f32 v128, v128
    v_rcp_f32 v130, v130
    v_rcp_f32 v132, v132
    v_rcp_f32 v134, v134
    s_nop 2
    v_rcp_f32 v136, v136
    v_rcp_f32 v138, v138
    v_rcp_f32 v140, v140
    v_rcp_f32 v142, v142
    v_mul_f32 v112, v112, v128
    v_mul_f32 v113, v113, v128
    v_mul_f32 v114, v114, v130
    v_mul_f32 v115, v115, v130
    v_mul_f32 v116, v116, v132
    v_mul_f32 v117, v117, v132
    v_mul_f32 v118, v118, v134
    v_mul_f32 v119, v119, v134
    v_mul_f32 v120, v120, v136
    v_mul_f32 v121, v121, v136
    v_mul_f32 v122, v122, v138
    v_mul_f32 v123, v123, v138
    v_mul_f32 v124, v124, v140
    v_mul_f32 v125, v125, v140
    v_mul_f32 v126, v126, v142
    v_mul_f32 v127, v127, v142
    v_cvt_pk_bf16_f32 v128, v112, v113
    v_cvt_pk_bf16_f32 v129, v114, v115
    v_cvt_pk_bf16_f32 v130, v116, v117
    v_cvt_pk_bf16_f32 v131, v118, v119
    v_cvt_pk_bf16_f32 v132, v120, v121
    v_cvt_pk_bf16_f32 v133, v122, v123
    v_cvt_pk_bf16_f32 v134, v124, v125
    v_cvt_pk_bf16_f32 v135, v126, v127
    s_mov_b64 exec, s[84:85]
    ds_write_b64 v4, v[128:129] offset:8192
    ds_write_b64 v4, v[130:131] offset:9216
    ds_write_b64 v4, v[132:133] offset:10240
    ds_write_b64 v4, v[134:135] offset:11264
    s_mov_b64 exec, -1
    s_waitcnt lgkmcnt(0)
    s_barrier
    s_mul_i32 s94, s4, 73728
    s_add_u32 s94, s94, s7
    s_add_u32 s94, s94, 37748736
    s_lshl_b32 s95, s4, 6
    s_add_u32 s95, s95, 48267264
    s_mul_i32 s9, s3, 9216
    v_add_u32 v4, s9, v2
    s_mul_i32 s72, s6, 36864
    s_add_u32 s72, s72, s9
    s_add_u32 s72, s72, s94
    s_sub_u32 s72, s72, s7
    s_lshl_b32 s73, s6, 2
    s_add_u32 s73, s73, s3
    s_lshl_b32 s73, s73, 2
    s_add_u32 s73, s73, s95
    v_add_u32 v9, 0x20000, v2
    ds_read_b128 v[48:51], v4 offset:0
    ds_read_b128 v[52:55], v4 offset:1024
    ds_read_b128 v[56:59], v4 offset:2048
    ds_read_b128 v[60:63], v4 offset:3072
    ds_read_b128 v[64:67], v4 offset:4096
    ds_read_b128 v[68:71], v4 offset:5120
    ds_read_b128 v[72:75], v4 offset:6144
    ds_read_b128 v[76:79], v4 offset:7168
    ds_read_b128 v[80:83], v4 offset:8192
    s_waitcnt lgkmcnt(8)
    s_add_u32 s70, s72, 0
    buffer_store_dwordx4 v[48:51], v2, s[52:55], s70 offen offset:0 sc1
    s_waitcnt lgkmcnt(7)
    buffer_store_dwordx4 v[52:55], v2, s[52:55], s70 offen offset:1024 sc1
    s_waitcnt lgkmcnt(6)
    buffer_store_dwordx4 v[56:59], v2, s[52:55], s70 offen offset:2048 sc1
    s_waitcnt lgkmcnt(5)
    buffer_store_dwordx4 v[60:63], v2, s[52:55], s70 offen offset:3072 sc1
    s_waitcnt lgkmcnt(4)
    s_add_u32 s70, s72, 4096
    buffer_store_dwordx4 v[64:67], v2, s[52:55], s70 offen offset:0 sc1
    s_waitcnt lgkmcnt(3)
    buffer_store_dwordx4 v[68:71], v2, s[52:55], s70 offen offset:1024 sc1
    s_waitcnt lgkmcnt(2)
    buffer_store_dwordx4 v[72:75], v2, s[52:55], s70 offen offset:2048 sc1
    s_waitcnt lgkmcnt(1)
    buffer_store_dwordx4 v[76:79], v2, s[52:55], s70 offen offset:3072 sc1
    s_waitcnt lgkmcnt(0)
    s_add_u32 s70, s72, 8192
    buffer_store_dwordx4 v[80:83], v2, s[52:55], s70 offen offset:0 sc1
    v_and_b32 v208, 15, v1
    v_bfe_u32 v209, v1, 4, 1
    v_lshl_add_u32 v208, v209, 4, v208
    v_mul_u32_u24 v208, 1152, v208
    v_lshrrev_b32 v209, 5, v1
    v_lshl_add_u32 v208, v209, 4, v208
    v_lshrrev_b32 v209, 4, v1
    v_lshlrev_b32 v209, 3, v209
    s_mov_b32 s87, 0x40088e99
    s_mov_b32 s92, 0x00003f80
    s_mov_b32 s93, 0x3f800000
    s_mul_i32 s9, s4, 9
    s_add_u32 s9, s9, s69
    s_lshl_b32 s83, s9, 6
    s_add_u32 s83, s83, 48238592
    s_lshl_b32 s80, s9, 2
    s_add_u32 s80, s80, s3
    s_lshl_b32 s80, s80, 14
    s_lshl_b32 s81, s69, 2
    s_add_u32 s81, s81, s3
    s_lshl_b32 s81, s81, 5
    s_mul_i32 s82, s4, 73728
    s_add_u32 s82, s82, s81
    s_mov_b32 s84, 8
    s_and_b32 s85, s3, 1
    s_lshl_b32 s15, s6, 1
    s_add_u32 s85, s85, s15
    s_mul_i32 s9, s4, 9
    s_add_u32 s9, s9, s84
    s_lshl_b32 s91, s9, 6
    s_add_u32 s91, s91, 48238592
    s_lshl_b32 s88, s9, 2
    s_add_u32 s88, s88, s85
    s_lshl_b32 s88, s88, 14
    s_lshl_b32 s89, s84, 2
    s_add_u32 s89, s89, s85
    s_lshl_b32 s89, s89, 5
    s_mul_i32 s90, s4, 73728
    s_add_u32 s90, s90, s89
    s_mov_b32 s56, s30
    s_and_b32 s57, s31, 0xffff
    s_mov_b32 s58, 1152
    s_mov_b32 s59, 0x00020000
    s_mov_b32 s44, s32
    s_and_b32 s45, s33, 0xffff
    s_mov_b32 s46, 2359296
    s_mov_b32 s47, 0x00020000
    s_xor_b32 s9, s6, 1
    s_mul_i32 s78, s9, 36864
    s_add_u32 s78, s78, s94
    s_lshl_b32 s9, s9, 2
    v_and_b32 v210, 3, v1
    v_add_u32 v210, s9, v210
    v_lshlrev_b32 v210, 2, v210
    v_and_b32 v212, 31, v1
    v_min_u32 v212, 5, v212
    v_lshlrev_b32 v212, 2, v212
    s_sub_u32 s9, s91, s83
    v_mov_b32 v213, s9
    v_cmp_gt_u32 vcc, 32, v1
    s_nop 1
    v_cndmask_b32 v213, v213, 0, vcc
    v_add_u32 v212, v212, v213
    s_lshr_b32 s9, s3, 1
    s_lshl_b32 s15, s9, 13
    s_add_u32 s88, s88, s15
    s_mul_i32 s15, s9, 36864
    s_add_u32 s90, s90, s15
    s_lshl_b32 s9, s85, 5
    v_subrev_u32 v236, s7, v240
    v_xor_b32 v236, s9, v236
    v_add_u32 v237, 0x10000, v236
    v_add_u32 v238, 0x20000, v236
    s_waitcnt vmcnt(9)
    s_barrier
    ds_read_b128 a[64:67], v2 offset:0
    ds_read_b128 a[68:71], v2 offset:1024
    ds_read_b64_tr_b16 v[176:177], v6 offset:49152
    ds_read_b128 a[72:75], v2 offset:2048
    ds_read_b128 a[76:79], v2 offset:3072
    ds_read_b64_tr_b16 v[178:179], v6 offset:51200
    ds_read_b128 a[80:83], v2 offset:4096
    ds_read_b128 a[84:87], v2 offset:5120
    ds_read_b64_tr_b16 v[180:181], v6 offset:53248
    ds_read_b128 a[88:91], v2 offset:6144
    ds_read_b128 a[92:95], v2 offset:7168
    ds_read_b64_tr_b16 v[182:183], v6 offset:55296
    ds_read_b128 a[96:99], v2 offset:8192
    ds_read_b128 a[100:103], v2 offset:9216
    ds_read_b64_tr_b16 v[184:185], v6 offset:57344
    ds_read_b128 a[104:107], v2 offset:10240
    ds_read_b128 a[108:111], v2 offset:11264
    ds_read_b64_tr_b16 v[186:187], v6 offset:59392
    ds_read_b128 a[112:115], v2 offset:12288
    ds_read_b128 a[116:119], v2 offset:13312
    ds_read_b64_tr_b16 v[188:189], v6 offset:61440
    ds_read_b128 a[120:123], v2 offset:14336
    ds_read_b128 a[124:127], v2 offset:15360
    ds_read_b64_tr_b16 v[190:191], v6 offset:63488
    s_waitcnt lgkmcnt(12)
    v_mfma_f32_16x16x32_bf16 v[128:131], v[176:179], a[64:67], 0
    ds_read_b128 a[128:131], v2 offset:0
    ds_read_b128 a[132:135], v2 offset:1024
    ds_read_b64_tr_b16 v[192:193], v237 offset:0
    v_mfma_f32_16x16x32_bf16 v[132:135], v[176:179], a[68:71], 0
    ds_read_b128 a[136:139], v2 offset:2048
    ds_read_b128 a[140:143], v2 offset:3072
    ds_read_b64_tr_b16 v[194:195], v237 offset:2048
    v_mfma_f32_16x16x32_bf16 v[136:139], v[176:179], a[72:75], 0
    v_mfma_f32_16x16x32_bf16 v[140:143], v[176:179], a[76:79], 0
    v_mfma_f32_16x16x32_bf16 v[128:131], v[180:183], a[80:83], v[128:131]
    ds_read_b128 a[144:147], v2 offset:4096
    ds_read_b128 a[148:151], v2 offset:5120
    ds_read_b64_tr_b16 v[196:197], v237 offset:4096
    v_mfma_f32_16x16x32_bf16 v[132:135], v[180:183], a[84:87], v[132:135]
    ds_read_b128 a[152:155], v2 offset:6144
    ds_read_b128 a[156:159], v2 offset:7168
    ds_read_b64_tr_b16 v[198:199], v237 offset:6144
    v_mfma_f32_16x16x32_bf16 v[136:139], v[180:183], a[88:91], v[136:139]
    v_mfma_f32_16x16x32_bf16 v[140:143], v[180:183], a[92:95], v[140:143]
    s_waitcnt lgkmcnt(12)
    v_mfma_f32_16x16x32_bf16 v[128:131], v[184:187], a[96:99], v[128:131]
    ds_read_b128 a[64:67], v2 offset:8192
    ds_read_b128 a[68:71], v2 offset:9216
    ds_read_b64_tr_b16 v[176:177], v237 offset:8192
    v_mfma_f32_16x16x32_bf16 v[132:135], v[184:187], a[100:103], v[132:135]
    ds_read_b128 a[72:75], v2 offset:10240
    ds_read_b128 a[76:79], v2 offset:11264
    ds_read_b64_tr_b16 v[178:179], v237 offset:10240
    v_mfma_f32_16x16x32_bf16 v[136:139], v[184:187], a[104:107], v[136:139]
    v_mfma_f32_16x16x32_bf16 v[140:143], v[184:187], a[108:111], v[140:143]
    v_mfma_f32_16x16x32_bf16 v[128:131], v[188:191], a[112:115], v[128:131]
    ds_read_b128 a[80:83], v2 offset:12288
    ds_read_b128 a[84:87], v2 offset:13312
    ds_read_b64_tr_b16 v[180:181], v237 offset:12288
    v_mfma_f32_16x16x32_bf16 v[132:135], v[188:191], a[116:119], v[132:135]
    ds_read_b128 a[88:91], v2 offset:14336
    ds_read_b128 a[92:95], v2 offset:15360
    ds_read_b64_tr_b16 v[182:183], v237 offset:14336
    v_mfma_f32_16x16x32_bf16 v[136:139], v[188:191], a[120:123], v[136:139]
    v_mfma_f32_16x16x32_bf16 v[140:143], v[188:191], a[124:127], v[140:143]
    s_waitcnt lgkmcnt(12)
    v_mfma_f32_16x16x32_bf16 v[144:147], v[192:195], a[128:131], 0
    ds_read_b128 a[96:99], v2 offset:16384
    ds_read_b128 a[100:103], v2 offset:17408
    ds_read_b64_tr_b16 v[184:185], v8 offset:0
    v_mfma_f32_16x16x32_bf16 v[148:151], v[192:195], a[132:135], 0
    ds_read_b128 a[104:107], v2 offset:18432
    ds_read_b128 a[108:111], v2 offset:19456
    ds_read_b64_tr_b16 v[186:187], v8 offset:2048
    v_mfma_f32_16x16x32_bf16 v[152:155], v[192:195], a[136:139], 0
    v_mfma_f32_16x16x32_bf16 v[156:159], v[192:195], a[140:143], 0
    v_mfma_f32_16x16x32_bf16 v[144:147], v[196:199], a[144:147], v[144:147]
    ds_read_b128 a[112:115], v2 offset:20480
    ds_read_b128 a[116:119], v2 offset:21504
    ds_read_b64_tr_b16 v[188:189], v8 offset:4096
    v_mfma_f32_16x16x32_bf16 v[148:151], v[196:199], a[148:151], v[148:151]
    ds_read_b128 a[120:123], v2 offset:22528
    ds_read_b128 a[124:127], v2 offset:23552
    ds_read_b64_tr_b16 v[190:191], v8 offset:6144
    v_mfma_f32_16x16x32_bf16 v[152:155], v[196:199], a[152:155], v[152:155]
    v_mfma_f32_16x16x32_bf16 v[156:159], v[196:199], a[156:159], v[156:159]
    s_waitcnt lgkmcnt(12)
    v_mfma_f32_16x16x32_bf16 v[144:147], v[176:179], a[64:67], v[144:147]
    ds_read_b128 a[128:131], v2 offset:24576
    ds_read_b128 a[132:135], v2 offset:25600
    ds_read_b64_tr_b16 v[192:193], v8 offset:8192
    v_mfma_f32_16x16x32_bf16 v[148:151], v[176:179], a[68:71], v[148:151]
    ds_read_b128 a[136:139], v2 offset:26624
    ds_read_b128 a[140:143], v2 offset:27648
    ds_read_b64_tr_b16 v[194:195], v8 offset:10240
    v_mfma_f32_16x16x32_bf16 v[152:155], v[176:179], a[72:75], v[152:155]
    v_mfma_f32_16x16x32_bf16 v[156:159], v[176:179], a[76:79], v[156:159]
    v_mfma_f32_16x16x32_bf16 v[144:147], v[180:183], a[80:83], v[144:147]
    ds_read_b128 a[144:147], v2 offset:28672
    ds_read_b128 a[148:151], v2 offset:29696
    ds_read_b64_tr_b16 v[196:197], v8 offset:12288
    v_mfma_f32_16x16x32_bf16 v[148:151], v[180:183], a[84:87], v[148:151]
    ds_read_b128 a[152:155], v2 offset:30720
    ds_read_b128 a[156:159], v2 offset:31744
    ds_read_b64_tr_b16 v[198:199], v8 offset:14336
    v_mfma_f32_16x16x32_bf16 v[152:155], v[180:183], a[88:91], v[152:155]
    v_mfma_f32_16x16x32_bf16 v[156:159], v[180:183], a[92:95], v[156:159]
    s_waitcnt lgkmcnt(12)
    v_mfma_f32_16x16x32_bf16 v[128:131], v[184:187], a[96:99], v[128:131]
    ds_read_b128 a[64:67], v2 offset:16384
    ds_read_b128 a[68:71], v2 offset:17408
    ds_read_b64_tr_b16 v[176:177], v238 offset:16384
    v_mfma_f32_16x16x32_bf16 v[132:135], v[184:187], a[100:103], v[132:135]
    ds_read_b128 a[72:75], v2 offset:18432
    ds_read_b128 a[76:79], v2 offset:19456
    ds_read_b64_tr_b16 v[178:179], v238 offset:18432
    v_mfma_f32_16x16x32_bf16 v[136:139], v[184:187], a[104:107], v[136:139]
    v_mfma_f32_16x16x32_bf16 v[140:143], v[184:187], a[108:111], v[140:143]
    v_mfma_f32_16x16x32_bf16 v[128:131], v[188:191], a[112:115], v[128:131]
    ds_read_b128 a[80:83], v2 offset:20480
    ds_read_b128 a[84:87], v2 offset:21504
    ds_read_b64_tr_b16 v[180:181], v238 offset:20480
    v_mfma_f32_16x16x32_bf16 v[132:135], v[188:191], a[116:119], v[132:135]
    ds_read_b128 a[88:91], v2 offset:22528
    ds_read_b128 a[92:95], v2 offset:23552
    ds_read_b64_tr_b16 v[182:183], v238 offset:22528
    v_mfma_f32_16x16x32_bf16 v[136:139], v[188:191], a[120:123], v[136:139]
    v_mfma_f32_16x16x32_bf16 v[140:143], v[188:191], a[124:127], v[140:143]
    s_waitcnt lgkmcnt(12)
    v_mfma_f32_16x16x32_bf16 v[128:131], v[192:195], a[128:131], v[128:131]
    ds_read_b128 a[96:99], v2 offset:24576
    ds_read_b128 a[100:103], v2 offset:25600
    ds_read_b64_tr_b16 v[184:185], v238 offset:24576
    v_mfma_f32_16x16x32_bf16 v[132:135], v[192:195], a[132:135], v[132:135]
    ds_read_b128 a[104:107], v2 offset:26624
    ds_read_b128 a[108:111], v2 offset:27648
    ds_read_b64_tr_b16 v[186:187], v238 offset:26624
    v_mfma_f32_16x16x32_bf16 v[136:139], v[192:195], a[136:139], v[136:139]
    v_mfma_f32_16x16x32_bf16 v[140:143], v[192:195], a[140:143], v[140:143]
    v_mfma_f32_16x16x32_bf16 v[128:131], v[196:199], a[144:147], v[128:131]
    ds_read_b128 a[112:115], v2 offset:28672
    ds_read_b128 a[116:119], v2 offset:29696
    ds_read_b64_tr_b16 v[188:189], v238 offset:28672
    v_mfma_f32_16x16x32_bf16 v[132:135], v[196:199], a[148:151], v[132:135]
    ds_read_b128 a[120:123], v2 offset:30720
    ds_read_b128 a[124:127], v2 offset:31744
    ds_read_b64_tr_b16 v[190:191], v238 offset:30720
    v_mfma_f32_16x16x32_bf16 v[136:139], v[196:199], a[152:155], v[136:139]
    v_mfma_f32_16x16x32_bf16 v[140:143], v[196:199], a[156:159], v[140:143]
    s_waitcnt lgkmcnt(12)
    v_mfma_f32_16x16x32_bf16 v[144:147], v[176:179], a[64:67], v[144:147]
    ds_read_b128 a[128:131], v2 offset:32768
    ds_read_b128 a[132:135], v2 offset:33792
    ds_read_b64_tr_b16 v[192:193], v7 offset:16384
    v_mfma_f32_16x16x32_bf16 v[148:151], v[176:179], a[68:71], v[148:151]
    ds_read_b128 a[136:139], v2 offset:34816
    ds_read_b128 a[140:143], v2 offset:35840
    ds_read_b64_tr_b16 v[194:195], v7 offset:18432
    v_mfma_f32_16x16x32_bf16 v[152:155], v[176:179], a[72:75], v[152:155]
    v_mfma_f32_16x16x32_bf16 v[156:159], v[176:179], a[76:79], v[156:159]
    v_mfma_f32_16x16x32_bf16 v[144:147], v[180:183], a[80:83], v[144:147]
    ds_read_b128 a[144:147], v2 offset:32768
    ds_read_b128 a[148:151], v2 offset:33792
    ds_read_b64_tr_b16 v[196:197], v237 offset:32768
    v_mfma_f32_16x16x32_bf16 v[148:151], v[180:183], a[84:87], v[148:151]
    ds_read_b128 a[152:155], v2 offset:34816
    ds_read_b128 a[156:159], v2 offset:35840
    ds_read_b64_tr_b16 v[198:199], v237 offset:34816
    v_mfma_f32_16x16x32_bf16 v[152:155], v[180:183], a[88:91], v[152:155]
    v_mfma_f32_16x16x32_bf16 v[156:159], v[180:183], a[92:95], v[156:159]
    s_waitcnt lgkmcnt(12)
    v_mfma_f32_16x16x32_bf16 v[144:147], v[184:187], a[96:99], v[144:147]
    v_mfma_f32_16x16x32_bf16 v[148:151], v[184:187], a[100:103], v[148:151]
    v_mfma_f32_16x16x32_bf16 v[152:155], v[184:187], a[104:107], v[152:155]
    v_mfma_f32_16x16x32_bf16 v[156:159], v[184:187], a[108:111], v[156:159]
    v_mfma_f32_16x16x32_bf16 v[144:147], v[188:191], a[112:115], v[144:147]
    v_mfma_f32_16x16x32_bf16 v[148:151], v[188:191], a[116:119], v[148:151]
    v_mfma_f32_16x16x32_bf16 v[152:155], v[188:191], a[120:123], v[152:155]
    v_mfma_f32_16x16x32_bf16 v[156:159], v[188:191], a[124:127], v[156:159]
    s_waitcnt lgkmcnt(0)
    v_mfma_f32_16x16x32_bf16 v[128:131], v[192:195], a[128:131], v[128:131]
    v_mfma_f32_16x16x32_bf16 v[132:135], v[192:195], a[132:135], v[132:135]
    v_mfma_f32_16x16x32_bf16 v[136:139], v[192:195], a[136:139], v[136:139]
    v_mfma_f32_16x16x32_bf16 v[140:143], v[192:195], a[140:143], v[140:143]
    v_mfma_f32_16x16x32_bf16 v[144:147], v[196:199], a[144:147], v[144:147]
    v_mfma_f32_16x16x32_bf16 v[148:151], v[196:199], a[148:151], v[148:151]
    v_mfma_f32_16x16x32_bf16 v[152:155], v[196:199], a[152:155], v[152:155]
    v_mfma_f32_16x16x32_bf16 v[156:159], v[196:199], a[156:159], v[156:159]
    s_waitcnt vmcnt(0)
    v_mov_b32 v214, 0
    v_mov_b32 v215, s86
    s_mov_b64 exec, 1
    buffer_store_dword v215, v214, s[52:55], s73 offen sc1
    s_mov_b64 exec, -1
    buffer_load_dword v211, v210, s[52:55], s95 offen sc1
    buffer_load_dword v213, v212, s[52:55], s83 offen sc1
    s_barrier
    s_add_u32 m0, s7, 114688
    s_add_u32 s64, s75, 0
    buffer_load_dwordx4 v12, s[48:51], s64 offen offset:0  lds
    buffer_load_dwordx4 v13, s[48:51], s64 offen offset:1024  lds
    buffer_load_dwordx4 v14, s[48:51], s64 offen offset:2048  lds
    buffer_load_dwordx4 v15, s[48:51], s64 offen offset:3072  lds
    s_add_u32 m0, s7, 49152
    s_add_u32 s64, s77, 0
    buffer_load_dwordx4 v12, s[48:51], s64 offen offset:0  lds
    buffer_load_dwordx4 v13, s[48:51], s64 offen offset:1024  lds
    buffer_load_dwordx4 v14, s[48:51], s64 offen offset:2048  lds
    buffer_load_dwordx4 v15, s[48:51], s64 offen offset:3072  lds
    s_add_u32 m0, s7, 65536
    s_add_u32 s64, s75, 147456
    buffer_load_dwordx4 v12, s[48:51], s64 offen offset:0  lds
    buffer_load_dwordx4 v13, s[48:51], s64 offen offset:1024  lds
    buffer_load_dwordx4 v14, s[48:51], s64 offen offset:2048  lds
    buffer_load_dwordx4 v15, s[48:51], s64 offen offset:3072  lds
    s_add_u32 m0, s7, 131072
    s_add_u32 s64, s77, 147456
    buffer_load_dwordx4 v12, s[48:51], s64 offen offset:0  lds
    buffer_load_dwordx4 v13, s[48:51], s64 offen offset:1024  lds
    buffer_load_dwordx4 v14, s[48:51], s64 offen offset:2048  lds
    buffer_load_dwordx4 v15, s[48:51], s64 offen offset:3072  lds
    s_add_u32 m0, s7, 147456
    s_add_u32 s64, s75, 294912
    buffer_load_dwordx4 v12, s[48:51], s64 offen offset:0  lds
    buffer_load_dwordx4 v13, s[48:51], s64 offen offset:1024  lds
    buffer_load_dwordx4 v14, s[48:51], s64 offen offset:2048  lds
    buffer_load_dwordx4 v15, s[48:51], s64 offen offset:3072  lds
    s_add_u32 m0, s7, 81920
    s_add_u32 s64, s77, 294912
    buffer_load_dwordx4 v12, s[48:51], s64 offen offset:0  lds
    buffer_load_dwordx4 v13, s[48:51], s64 offen offset:1024  lds
    buffer_load_dwordx4 v14, s[48:51], s64 offen offset:2048  lds
    buffer_load_dwordx4 v15, s[48:51], s64 offen offset:3072  lds
    s_waitcnt vmcnt(25)
    s_mov_b32 s71, 0
L_poll_oa:
    v_cmp_eq_u32 vcc, s86, v211
    s_add_u32 s71, s71, 1
    s_nop 2
    s_cmp_eq_u64 vcc, -1
    s_cbranch_scc1 L_polled_oa
    s_sleep 2
    buffer_load_dword v211, v210, s[52:55], s95 offen sc1
    s_waitcnt vmcnt(0)
    s_cmp_lt_u32 s71, 0x20000
    s_cbranch_scc1 L_poll_oa
L_polled_oa:
    s_add_u32 m0, s7, 98304
    s_add_u32 s64, s78, 0
    buffer_load_dwordx4 v2, s[52:55], s64 offen offset:0 sc1 lds
    buffer_load_dwordx4 v2, s[52:55], s64 offen offset:1024 sc1 lds
    buffer_load_dwordx4 v2, s[52:55], s64 offen offset:2048 sc1 lds
    buffer_load_dwordx4 v2, s[52:55], s64 offen offset:3072 sc1 lds
    s_add_u32 m0, s7, 0
    s_add_u32 s64, s78, 16384
    buffer_load_dwordx4 v2, s[52:55], s64 offen offset:0 sc1 lds
    buffer_load_dwordx4 v2, s[52:55], s64 offen offset:1024 sc1 lds
    buffer_load_dwordx4 v2, s[52:55], s64 offen offset:2048 sc1 lds
    buffer_load_dwordx4 v2, s[52:55], s64 offen offset:3072 sc1 lds
    s_add_u32 m0, s7, 16384
    s_add_u32 s64, s78, 32768
    buffer_load_dwordx4 v2, s[52:55], s64 offen offset:0 sc1 lds
    buffer_load_dwordx4 v2, s[52:55], s64 offen offset:1024 sc1 lds
    buffer_load_dwordx4 v2, s[52:55], s64 offen offset:2048 sc1 lds
    buffer_load_dwordx4 v2, s[52:55], s64 offen offset:3072 sc1 lds
    s_waitcnt vmcnt(36)
    s_mov_b32 s71, 0
L_poll_pa:
    v_cmp_eq_u32 vcc, s86, v213
    s_add_u32 s71, s71, 1
    s_nop 2
    s_cmp_eq_u64 vcc, -1
    s_cbranch_scc1 L_polled_pa
    s_sleep 2
    buffer_load_dword v213, v212, s[52:55], s83 offen sc1
    s_waitcnt vmcnt(0)
    s_cmp_lt_u32 s71, 0x20000
    s_cbranch_scc1 L_poll_pa
L_polled_pa:
    s_add_u32 s70, s82, 0
    buffer_load_dwordx4 v[160:163], v208, s[40:43], s70 offen
    s_add_u32 s70, s82, 36864
    buffer_load_dwordx4 v[164:167], v208, s[40:43], s70 offen
    buffer_load_dwordx2 v[168:169], v209, s[56:59], s81 offen
    buffer_load_dwordx4 v[216:219], v208, s[40:43], s90 offen
    buffer_load_dwordx2 v[170:171], v209, s[56:59], s89 offen
    s_add_u32 s70, s80, 0
    buffer_load_dwordx4 v[16:19], v2, s[52:55], s70 offen sc1
    s_add_u32 s70, s80, 8192
    buffer_load_dwordx4 v[20:23], v2, s[52:55], s70 offen sc1
    s_add_u32 s70, s88, 0
    buffer_load_dwordx4 v[24:27], v2, s[52:55], s70 offen sc1
    s_add_u32 s70, s80, 1024
    buffer_load_dwordx4 v[28:31], v2, s[52:55], s70 offen sc1
    s_add_u32 s70, s80, 9216
    buffer_load_dwordx4 v[32:35], v2, s[52:55], s70 offen sc1
    s_add_u32 s70, s88, 1024
    buffer_load_dwordx4 v[36:39], v2, s[52:55], s70 offen sc1
    s_add_u32 s70, s80, 2048
    buffer_load_dwordx4 v[40:43], v2, s[52:55], s70 offen sc1
    s_add_u32 s70, s80, 10240
    buffer_load_dwordx4 v[44:47], v2, s[52:55], s70 offen sc1
    s_add_u32 s70, s88, 2048
    buffer_load_dwordx4 v[48:51], v2, s[52:55], s70 offen sc1
    s_add_u32 s70, s80, 3072
    buffer_load_dwordx4 v[52:55], v2, s[52:55], s70 offen sc1
    s_add_u32 s70, s80, 11264
    buffer_load_dwordx4 v[56:59], v2, s[52:55], s70 offen sc1
    s_add_u32 s70, s88, 3072
    buffer_load_dwordx4 v[60:63], v2, s[52:55], s70 offen sc1
    s_add_u32 s70, s80, 4096
    buffer_load_dwordx4 v[64:67], v2, s[52:55], s70 offen sc1
    s_add_u32 s70, s80, 12288
    buffer_load_dwordx4 v[68:71], v2, s[52:55], s70 offen sc1
    s_add_u32 s70, s88, 4096
    buffer_load_dwordx4 v[72:75], v2, s[52:55], s70 offen sc1
    s_add_u32 s70, s80, 5120
    buffer_load_dwordx4 v[76:79], v2, s[52:55], s70 offen sc1
    s_add_u32 s70, s80, 13312
    buffer_load_dwordx4 v[80:83], v2, s[52:55], s70 offen sc1
    s_add_u32 s70, s88, 5120
    buffer_load_dwordx4 v[84:87], v2, s[52:55], s70 offen sc1
    s_waitcnt vmcnt(23)
    s_barrier
    ds_read_b128 a[64:67], v3 offset:32768
    ds_read_b128 a[68:71], v3 offset:33792
    ds_read_b64_tr_b16 v[176:177], v7 offset:49152
    ds_read_b128 a[72:75], v3 offset:34816
    ds_read_b128 a[76:79], v3 offset:35840
    ds_read_b64_tr_b16 v[178:179], v7 offset:51200
    ds_read_b128 a[80:83], v3 offset:36864
    ds_read_b128 a[84:87], v3 offset:37888
    ds_read_b64_tr_b16 v[180:181], v7 offset:53248
    ds_read_b128 a[88:91], v3 offset:38912
    ds_read_b128 a[92:95], v3 offset:39936
    ds_read_b64_tr_b16 v[182:183], v7 offset:55296
    ds_read_b128 a[96:99], v3 offset:40960
    ds_read_b128 a[100:103], v3 offset:41984
    ds_read_b64_tr_b16 v[184:185], v7 offset:57344
    ds_read_b128 a[104:107], v3 offset:43008
    ds_read_b128 a[108:111], v3 offset:44032
    ds_read_b64_tr_b16 v[186:187], v7 offset:59392
    ds_read_b128 a[112:115], v3 offset:45056
    ds_read_b128 a[116:119], v3 offset:46080
    ds_read_b64_tr_b16 v[188:189], v7 offset:61440
    ds_read_b128 a[120:123], v3 offset:47104
    ds_read_b128 a[124:127], v3 offset:48128
    ds_read_b64_tr_b16 v[190:191], v7 offset:63488
    s_waitcnt lgkmcnt(12)
    v_mfma_f32_16x16x32_bf16 v[128:131], v[176:179], a[64:67], v[128:131]
    ds_read_b128 a[128:131], v3 offset:32768
    ds_read_b128 a[132:135], v3 offset:33792
    ds_read_b64_tr_b16 v[192:193], v236 offset:49152
    v_mfma_f32_16x16x32_bf16 v[132:135], v[176:179], a[68:71], v[132:135]
    ds_read_b128 a[136:139], v3 offset:34816
    ds_read_b128 a[140:143], v3 offset:35840
    ds_read_b64_tr_b16 v[194:195], v236 offset:51200
    v_mfma_f32_16x16x32_bf16 v[136:139], v[176:179], a[72:75], v[136:139]
    v_mfma_f32_16x16x32_bf16 v[140:143], v[176:179], a[76:79], v[140:143]
    v_mfma_f32_16x16x32_bf16 v[128:131], v[180:183], a[80:83], v[128:131]
    ds_read_b128 a[144:147], v3 offset:36864
    ds_read_b128 a[148:151], v3 offset:37888
    ds_read_b64_tr_b16 v[196:197], v236 offset:53248
    v_mfma_f32_16x16x32_bf16 v[132:135], v[180:183], a[84:87], v[132:135]
    ds_read_b128 a[152:155], v3 offset:38912
    ds_read_b128 a[156:159], v3 offset:39936
    ds_read_b64_tr_b16 v[198:199], v236 offset:55296
    v_mfma_f32_16x16x32_bf16 v[136:139], v[180:183], a[88:91], v[136:139]
    v_mfma_f32_16x16x32_bf16 v[140:143], v[180:183], a[92:95], v[140:143]
    s_waitcnt lgkmcnt(12)
    v_mfma_f32_16x16x32_bf16 v[128:131], v[184:187], a[96:99], v[128:131]
    ds_read_b128 a[64:67], v3 offset:40960
    ds_read_b128 a[68:71], v3 offset:41984
    ds_read_b64_tr_b16 v[176:177], v236 offset:57344
    v_mfma_f32_16x16x32_bf16 v[132:135], v[184:187], a[100:103], v[132:135]
    ds_read_b128 a[72:75], v3 offset:43008
    ds_read_b128 a[76:79], v3 offset:44032
    ds_read_b64_tr_b16 v[178:179], v236 offset:59392
    v_mfma_f32_16x16x32_bf16 v[136:139], v[184:187], a[104:107], v[136:139]
    v_mfma_f32_16x16x32_bf16 v[140:143], v[184:187], a[108:111], v[140:143]
    v_mfma_f32_16x16x32_bf16 v[128:131], v[188:191], a[112:115], v[128:131]
    ds_read_b128 a[80:83], v3 offset:45056
    ds_read_b128 a[84:87], v3 offset:46080
    ds_read_b64_tr_b16 v[180:181], v236 offset:61440
    v_mfma_f32_16x16x32_bf16 v[132:135], v[188:191], a[116:119], v[132:135]
    ds_read_b128 a[88:91], v3 offset:47104
    ds_read_b128 a[92:95], v3 offset:48128
    ds_read_b64_tr_b16 v[182:183], v236 offset:63488
    v_mfma_f32_16x16x32_bf16 v[136:139], v[188:191], a[120:123], v[136:139]
    v_mfma_f32_16x16x32_bf16 v[140:143], v[188:191], a[124:127], v[140:143]
    s_waitcnt lgkmcnt(12)
    v_mfma_f32_16x16x32_bf16 v[144:147], v[192:195], a[128:131], v[144:147]
    ds_read_b128 a[96:99], v2 offset:0
    ds_read_b128 a[100:103], v2 offset:1024
    ds_read_b64_tr_b16 v[184:185], v7 offset:0
    v_mfma_f32_16x16x32_bf16 v[148:151], v[192:195], a[132:135], v[148:151]
    ds_read_b128 a[104:107], v2 offset:2048
    ds_read_b128 a[108:111], v2 offset:3072
    ds_read_b64_tr_b16 v[186:187], v7 offset:2048
    v_mfma_f32_16x16x32_bf16 v[152:155], v[192:195], a[136:139], v[152:155]
    v_mfma_f32_16x16x32_bf16 v[156:159], v[192:195], a[140:143], v[156:159]
    v_mfma_f32_16x16x32_bf16 v[144:147], v[196:199], a[144:147], v[144:147]
    ds_read_b128 a[112:115], v2 offset:4096
    ds_read_b128 a[116:119], v2 offset:5120
    ds_read_b64_tr_b16 v[188:189], v7 offset:4096
    v_mfma_f32_16x16x32_bf16 v[148:151], v[196:199], a[148:151], v[148:151]
    ds_read_b128 a[120:123], v2 offset:6144
    ds_read_b128 a[124:127], v2 offset:7168
    ds_read_b64_tr_b16 v[190:191], v7 offset:6144
    v_mfma_f32_16x16x32_bf16 v[152:155], v[196:199], a[152:155], v[152:155]
    v_mfma_f32_16x16x32_bf16 v[156:159], v[196:199], a[156:159], v[156:159]
    s_waitcnt lgkmcnt(12)
    v_mfma_f32_16x16x32_bf16 v[144:147], v[176:179], a[64:67], v[144:147]
    ds_read_b128 a[128:131], v2 offset:8192
    ds_read_b128 a[132:135], v2 offset:9216
    ds_read_b64_tr_b16 v[192:193], v7 offset:8192
    v_mfma_f32_16x16x32_bf16 v[148:151], v[176:179], a[68:71], v[148:151]
    ds_read_b128 a[136:139], v2 offset:10240
    ds_read_b128 a[140:143], v2 offset:11264
    ds_read_b64_tr_b16 v[194:195], v7 offset:10240
    v_mfma_f32_16x16x32_bf16 v[152:155], v[176:179], a[72:75], v[152:155]
    v_mfma_f32_16x16x32_bf16 v[156:159], v[176:179], a[76:79], v[156:159]
    v_mfma_f32_16x16x32_bf16 v[144:147], v[180:183], a[80:83], v[144:147]
    ds_read_b128 a[144:147], v2 offset:12288
    ds_read_b128 a[148:151], v2 offset:13312
    ds_read_b64_tr_b16 v[196:197], v7 offset:12288
    v_mfma_f32_16x16x32_bf16 v[148:151], v[180:183], a[84:87], v[148:151]
    ds_read_b128 a[152:155], v2 offset:14336
    ds_read_b128 a[156:159], v2 offset:15360
    ds_read_b64_tr_b16 v[198:199], v7 offset:14336
    v_mfma_f32_16x16x32_bf16 v[152:155], v[180:183], a[88:91], v[152:155]
    v_mfma_f32_16x16x32_bf16 v[156:159], v[180:183], a[92:95], v[156:159]
    s_waitcnt lgkmcnt(12)
    v_mfma_f32_16x16x32_bf16 v[128:131], v[184:187], a[96:99], v[128:131]
    ds_read_b128 a[64:67], v2 offset:0
    ds_read_b128 a[68:71], v2 offset:1024
    ds_read_b64_tr_b16 v[176:177], v238 offset:0
    v_mfma_f32_16x16x32_bf16 v[132:135], v[184:187], a[100:103], v[132:135]
    ds_read_b128 a[72:75], v2 offset:2048
    ds_read_b128 a[76:79], v2 offset:3072
    ds_read_b64_tr_b16 v[178:179], v238 offset:2048
    v_mfma_f32_16x16x32_bf16 v[136:139], v[184:187], a[104:107], v[136:139]
    v_mfma_f32_16x16x32_bf16 v[140:143], v[184:187], a[108:111], v[140:143]
    v_mfma_f32_16x16x32_bf16 v[128:131], v[188:191], a[112:115], v[128:131]
    ds_read_b128 a[80:83], v2 offset:4096
    ds_read_b128 a[84:87], v2 offset:5120
    ds_read_b64_tr_b16 v[180:181], v238 offset:4096
    v_mfma_f32_16x16x32_bf16 v[132:135], v[188:191], a[116:119], v[132:135]
    ds_read_b128 a[88:91], v2 offset:6144
    ds_read_b128 a[92:95], v2 offset:7168
    ds_read_b64_tr_b16 v[182:183], v238 offset:6144
    v_mfma_f32_16x16x32_bf16 v[136:139], v[188:191], a[120:123], v[136:139]
    v_mfma_f32_16x16x32_bf16 v[140:143], v[188:191], a[124:127], v[140:143]
    s_waitcnt lgkmcnt(12)
    v_mfma_f32_16x16x32_bf16 v[128:131], v[192:195], a[128:131], v[128:131]
    ds_read_b128 a[96:99], v2 offset:8192
    ds_read_b128 a[100:103], v2 offset:9216
    ds_read_b64_tr_b16 v[184:185], v238 offset:8192
    v_mfma_f32_16x16x32_bf16 v[132:135], v[192:195], a[132:135], v[132:135]
    ds_read_b128 a[104:107], v2 offset:10240
    ds_read_b128 a[108:111], v2 offset:11264
    ds_read_b64_tr_b16 v[186:187], v238 offset:10240
    v_mfma_f32_16x16x32_bf16 v[136:139], v[192:195], a[136:139], v[136:139]
    v_mfma_f32_16x16x32_bf16 v[140:143], v[192:195], a[140:143], v[140:143]
    v_mfma_f32_16x16x32_bf16 v[128:131], v[196:199], a[144:147], v[128:131]
    ds_read_b128 a[112:115], v2 offset:12288
    ds_read_b128 a[116:119], v2 offset:13312
    ds_read_b64_tr_b16 v[188:189], v238 offset:12288
    v_mfma_f32_16x16x32_bf16 v[132:135], v[196:199], a[148:151], v[132:135]
    ds_read_b128 a[120:123], v2 offset:14336
    ds_read_b128 a[124:127], v2 offset:15360
    ds_read_b64_tr_b16 v[190:191], v238 offset:14336
    v_mfma_f32_16x16x32_bf16 v[136:139], v[196:199], a[152:155], v[136:139]
    v_mfma_f32_16x16x32_bf16 v[140:143], v[196:199], a[156:159], v[140:143]
    s_waitcnt lgkmcnt(12)
    v_mfma_f32_16x16x32_bf16 v[144:147], v[176:179], a[64:67], v[144:147]
    ds_read_b128 a[128:131], v2 offset:16384
    ds_read_b128 a[132:135], v2 offset:17408
    ds_read_b64_tr_b16 v[192:193], v8 offset:16384
    v_mfma_f32_16x16x32_bf16 v[148:151], v[176:179], a[68:71], v[148:151]
    ds_read_b128 a[136:139], v2 offset:18432
    ds_read_b128 a[140:143], v2 offset:19456
    ds_read_b64_tr_b16 v[194:195], v8 offset:18432
    v_mfma_f32_16x16x32_bf16 v[152:155], v[176:179], a[72:75], v[152:155]
    v_mfma_f32_16x16x32_bf16 v[156:159], v[176:179], a[76:79], v[156:159]
    v_mfma_f32_16x16x32_bf16 v[144:147], v[180:183], a[80:83], v[144:147]
    ds_read_b128 a[144:147], v2 offset:16384
    ds_read_b128 a[148:151], v2 offset:17408
    ds_read_b64_tr_b16 v[196:197], v237 offset:16384
    v_mfma_f32_16x16x32_bf16 v[148:151], v[180:183], a[84:87], v[148:151]
    ds_read_b128 a[152:155], v2 offset:18432
    ds_read_b128 a[156:159], v2 offset:19456
    ds_read_b64_tr_b16 v[198:199], v237 offset:18432
    v_mfma_f32_16x16x32_bf16 v[152:155], v[180:183], a[88:91], v[152:155]
    v_mfma_f32_16x16x32_bf16 v[156:159], v[180:183], a[92:95], v[156:159]
    s_waitcnt lgkmcnt(12)
    v_mfma_f32_16x16x32_bf16 v[144:147], v[184:187], a[96:99], v[144:147]
    v_mfma_f32_16x16x32_bf16 v[148:151], v[184:187], a[100:103], v[148:151]
    v_mfma_f32_16x16x32_bf16 v[152:155], v[184:187], a[104:107], v[152:155]
    v_mfma_f32_16x16x32_bf16 v[156:159], v[184:187], a[108:111], v[156:159]
    v_mfma_f32_16x16x32_bf16 v[144:147], v[188:191], a[112:115], v[144:147]
    v_mfma_f32_16x16x32_bf16 v[148:151], v[188:191], a[116:119], v[148:151]
    v_mfma_f32_16x16x32_bf16 v[152:155], v[188:191], a[120:123], v[152:155]
    v_mfma_f32_16x16x32_bf16 v[156:159], v[188:191], a[124:127], v[156:159]
    s_waitcnt lgkmcnt(0)
    v_mfma_f32_16x16x32_bf16 v[128:131], v[192:195], a[128:131], v[128:131]
    v_mfma_f32_16x16x32_bf16 v[132:135], v[192:195], a[132:135], v[132:135]
    v_mfma_f32_16x16x32_bf16 v[136:139], v[192:195], a[136:139], v[136:139]
    v_mfma_f32_16x16x32_bf16 v[140:143], v[192:195], a[140:143], v[140:143]
    v_mfma_f32_16x16x32_bf16 v[144:147], v[196:199], a[144:147], v[144:147]
    v_mfma_f32_16x16x32_bf16 v[148:151], v[196:199], a[148:151], v[148:151]
    v_mfma_f32_16x16x32_bf16 v[152:155], v[196:199], a[152:155], v[152:155]
    v_mfma_f32_16x16x32_bf16 v[156:159], v[196:199], a[156:159], v[156:159]
    s_waitcnt vmcnt(15)
    v_lshlrev_b32 v96, 16, v16
    v_and_b32 v97, s13, v16
    v_lshlrev_b32 v98, 16, v17
    v_and_b32 v99, s13, v17
    v_lshlrev_b32 v100, 16, v18
    v_and_b32 v101, s13, v18
    v_lshlrev_b32 v102, 16, v19
    v_and_b32 v103, s13, v19
    v_lshlrev_b32 v104, 16, v20
    v_and_b32 v105, s13, v20
    v_lshlrev_b32 v106, 16, v21
    v_and_b32 v107, s13, v21
    v_lshlrev_b32 v108, 16, v22
    v_and_b32 v109, s13, v22
    v_lshlrev_b32 v110, 16, v23
    v_and_b32 v111, s13, v23
    v_lshlrev_b32 v112, 16, v24
    v_and_b32 v113, s13, v24
    v_lshlrev_b32 v114, 16, v25
    v_and_b32 v115, s13, v25
    v_lshlrev_b32 v116, 16, v26
    v_and_b32 v117, s13, v26
    v_lshlrev_b32 v118, 16, v27
    v_and_b32 v119, s13, v27
    s_waitcnt vmcnt(12)
    v_dot2c_f32_bf16 v96, s92, v28
    v_dot2c_f32_bf16 v97, s93, v28
    v_dot2c_f32_bf16 v98, s92, v29
    v_dot2c_f32_bf16 v99, s93, v29
    v_dot2c_f32_bf16 v100, s92, v30
    v_dot2c_f32_bf16 v101, s93, v30
    v_dot2c_f32_bf16 v102, s92, v31
    v_dot2c_f32_bf16 v103, s93, v31
    v_dot2c_f32_bf16 v104, s92, v32
    v_dot2c_f32_bf16 v105, s93, v32
    v_dot2c_f32_bf16 v106, s92, v33
    v_dot2c_f32_bf16 v107, s93, v33
    v_dot2c_f32_bf16 v108, s92, v34
    v_dot2c_f32_bf16 v109, s93, v34
    v_dot2c_f32_bf16 v110, s92, v35
    v_dot2c_f32_bf16 v111, s93, v35
    v_dot2c_f32_bf16 v112, s92, v36
    v_dot2c_f32_bf16 v113, s93, v36
    v_dot2c_f32_bf16 v114, s92, v37
    v_dot2c_f32_bf16 v115, s93, v37
    v_dot2c_f32_bf16 v116, s92, v38
    v_dot2c_f32_bf16 v117, s93, v38
    v_dot2c_f32_bf16 v118, s92, v39
    v_dot2c_f32_bf16 v119, s93, v39
    s_waitcnt vmcnt(9)
    v_dot2c_f32_bf16 v96, s92, v40
    v_dot2c_f32_bf16 v97, s93, v40
    v_dot2c_f32_bf16 v98, s92, v41
    v_dot2c_f32_bf16 v99, s93, v41
    v_dot2c_f32_bf16 v100, s92, v42
    v_dot2c_f32_bf16 v101, s93, v42
    v_dot2c_f32_bf16 v102, s92, v43
    v_dot2c_f32_bf16 v103, s93, v43
    v_dot2c_f32_bf16 v104, s92, v44
    v_dot2c_f32_bf16 v105, s93, v44
    v_dot2c_f32_bf16 v106, s92, v45
    v_dot2c_f32_bf16 v107, s93, v45
    v_dot2c_f32_bf16 v108, s92, v46
    v_dot2c_f32_bf16 v109, s93, v46
    v_dot2c_f32_bf16 v110, s92, v47
    v_dot2c_f32_bf16 v111, s93, v47
    v_dot2c_f32_bf16 v112, s92, v48
    v_dot2c_f32_bf16 v113, s93, v48
    v_dot2c_f32_bf16 v114, s92, v49
    v_dot2c_f32_bf16 v115, s93, v49
    v_dot2c_f32_bf16 v116, s92, v50
    v_dot2c_f32_bf16 v117, s93, v50
    v_dot2c_f32_bf16 v118, s92, v51
    v_dot2c_f32_bf16 v119, s93, v51
    s_waitcnt vmcnt(6)
    v_dot2c_f32_bf16 v96, s92, v52
    v_dot2c_f32_bf16 v97, s93, v52
    v_dot2c_f32_bf16 v98, s92, v53
    v_dot2c_f32_bf16 v99, s93, v53
    v_dot2c_f32_bf16 v100, s92, v54
    v_dot2c_f32_bf16 v101, s93, v54
    v_dot2c_f32_bf16 v102, s92, v55
    v_dot2c_f32_bf16 v103, s93, v55
    v_dot2c_f32_bf16 v104, s92, v56
    v_dot2c_f32_bf16 v105, s93, v56
    v_dot2c_f32_bf16 v106, s92, v57
    v_dot2c_f32_bf16 v107, s93, v57
    v_dot2c_f32_bf16 v108, s92, v58
    v_dot2c_f32_bf16 v109, s93, v58
    v_dot2c_f32_bf16 v110, s92, v59
    v_dot2c_f32_bf16 v111, s93, v59
    v_dot2c_f32_bf16 v112, s92, v60
    v_dot2c_f32_bf16 v113, s93, v60
    v_dot2c_f32_bf16 v114, s92, v61
    v_dot2c_f32_bf16 v115, s93, v61
    v_dot2c_f32_bf16 v116, s92, v62
    v_dot2c_f32_bf16 v117, s93, v62
    v_dot2c_f32_bf16 v118, s92, v63
    v_dot2c_f32_bf16 v119, s93, v63
    s_waitcnt vmcnt(3)
    v_dot2c_f32_bf16 v96, s92, v64
    v_dot2c_f32_bf16 v97, s93, v64
    v_dot2c_f32_bf16 v98, s92, v65
    v_dot2c_f32_bf16 v99, s93, v65
    v_dot2c_f32_bf16 v100, s92, v66
    v_dot2c_f32_bf16 v101, s93, v66
    v_dot2c_f32_bf16 v102, s92, v67
    v_dot2c_f32_bf16 v103, s93, v67
    v_dot2c_f32_bf16 v104, s92, v68
    v_dot2c_f32_bf16 v105, s93, v68
    v_dot2c_f32_bf16 v106, s92, v69
    v_dot2c_f32_bf16 v107, s93, v69
    v_dot2c_f32_bf16 v108, s92, v70
    v_dot2c_f32_bf16 v109, s93, v70
    v_dot2c_f32_bf16 v110, s92, v71
    v_dot2c_f32_bf16 v111, s93, v71
    v_dot2c_f32_bf16 v112, s92, v72
    v_dot2c_f32_bf16 v113, s93, v72
    v_dot2c_f32_bf16 v114, s92, v73
    v_dot2c_f32_bf16 v115, s93, v73
    v_dot2c_f32_bf16 v116, s92, v74
    v_dot2c_f32_bf16 v117, s93, v74
    v_dot2c_f32_bf16 v118, s92, v75
    v_dot2c_f32_bf16 v119, s93, v75
    s_waitcnt vmcnt(0)
    v_dot2c_f32_bf16 v96, s92, v76
    v_dot2c_f32_bf16 v97, s93, v76
    v_dot2c_f32_bf16 v98, s92, v77
    v_dot2c_f32_bf16 v99, s93, v77
    v_dot2c_f32_bf16 v100, s92, v78
    v_dot2c_f32_bf16 v101, s93, v78
    v_dot2c_f32_bf16 v102, s92, v79
    v_dot2c_f32_bf16 v103, s93, v79
    v_dot2c_f32_bf16 v104, s92, v80
    v_dot2c_f32_bf16 v105, s93, v80
    v_dot2c_f32_bf16 v106, s92, v81
    v_dot2c_f32_bf16 v107, s93, v81
    v_dot2c_f32_bf16 v108, s92, v82
    v_dot2c_f32_bf16 v109, s93, v82
    v_dot2c_f32_bf16 v110, s92, v83
    v_dot2c_f32_bf16 v111, s93, v83
    v_dot2c_f32_bf16 v112, s92, v84
    v_dot2c_f32_bf16 v113, s93, v84
    v_dot2c_f32_bf16 v114, s92, v85
    v_dot2c_f32_bf16 v115, s93, v85
    v_dot2c_f32_bf16 v116, s92, v86
    v_dot2c_f32_bf16 v117, s93, v86
    v_dot2c_f32_bf16 v118, s92, v87
    v_dot2c_f32_bf16 v119, s93, v87
    v_lshlrev_b32 v172, 16, v168
    v_and_b32 v173, s13, v168
    v_lshlrev_b32 v174, 16, v169
    v_and_b32 v175, s13, v169
    v_lshlrev_b32 v220, 16, v170
    v_and_b32 v221, s13, v170
    v_lshlrev_b32 v222, 16, v171
    v_and_b32 v223, s13, v171
    v_fma_f32 v96, v96, s87, v172
    v_fma_f32 v97, v97, s87, v173
    v_fma_f32 v98, v98, s87, v174
    v_fma_f32 v99, v99, s87, v175
    v_fma_f32 v100, v100, s87, v172
    v_fma_f32 v101, v101, s87, v173
    v_fma_f32 v102, v102, s87, v174
    v_fma_f32 v103, v103, s87, v175
    v_mul_f32 v120, 0xbfb8aa3b, v96
    v_mul_f32 v121, 0xbfb8aa3b, v97
    v_mul_f32 v122, 0xbfb8aa3b, v98
    v_mul_f32 v123, 0xbfb8aa3b, v99
    v_mul_f32 v124, 0xbfb8aa3b, v100
    v_mul_f32 v125, 0xbfb8aa3b, v101
    v_mul_f32 v126, 0xbfb8aa3b, v102
    v_mul_f32 v127, 0xbfb8aa3b, v103
    v_exp_f32 v120, v120
    v_exp_f32 v121, v121
    v_exp_f32 v122, v122
    v_exp_f32 v123, v123
    v_exp_f32 v124, v124
    v_exp_f32 v125, v125
    v_exp_f32 v126, v126
    v_exp_f32 v127, v127
    v_mul_f32 v96, v96, v128
    v_mul_f32 v97, v97, v129
    v_mul_f32 v98, v98, v130
    v_mul_f32 v99, v99, v131
    v_mul_f32 v100, v100, v132
    v_mul_f32 v101, v101, v133
    v_mul_f32 v102, v102, v134
    v_mul_f32 v103, v103, v135
    v_add_f32 v120, 1.0, v120
    v_add_f32 v121, 1.0, v121
    v_add_f32 v122, 1.0, v122
    v_add_f32 v123, 1.0, v123
    v_add_f32 v124, 1.0, v124
    v_add_f32 v125, 1.0, v125
    v_add_f32 v126, 1.0, v126
    v_add_f32 v127, 1.0, v127
    v_rcp_f32 v120, v120
    v_rcp_f32 v121, v121
    v_rcp_f32 v122, v122
    v_rcp_f32 v123, v123
    v_rcp_f32 v124, v124
    v_rcp_f32 v125, v125
    v_rcp_f32 v126, v126
    v_rcp_f32 v127, v127
    v_mul_f32 v96, v96, v120
    v_mul_f32 v97, v97, v121
    v_mul_f32 v98, v98, v122
    v_mul_f32 v99, v99, v123
    v_mul_f32 v100, v100, v124
    v_mul_f32 v101, v101, v125
    v_mul_f32 v102, v102, v126
    v_mul_f32 v103, v103, v127
    v_permlane16_swap_b32 v96, v100
    v_permlane16_swap_b32 v97, v101
    v_permlane16_swap_b32 v98, v102
    v_permlane16_swap_b32 v99, v103
    v_dot2c_f32_bf16 v96, s92, v160
    v_dot2c_f32_bf16 v97, s93, v160
    v_dot2c_f32_bf16 v98, s92, v161
    v_dot2c_f32_bf16 v99, s93, v161
    v_dot2c_f32_bf16 v100, s92, v162
    v_dot2c_f32_bf16 v101, s93, v162
    v_dot2c_f32_bf16 v102, s92, v163
    v_dot2c_f32_bf16 v103, s93, v163
    v_cvt_pk_bf16_f32 v160, v96, v97
    v_cvt_pk_bf16_f32 v161, v98, v99
    v_cvt_pk_bf16_f32 v162, v100, v101
    v_cvt_pk_bf16_f32 v163, v102, v103
    s_add_u32 s70, s82, 0
    buffer_store_dwordx4 v[160:163], v208, s[44:47], s70 offen
    v_fma_f32 v104, v104, s87, v172
    v_fma_f32 v105, v105, s87, v173
    v_fma_f32 v106, v106, s87, v174
    v_fma_f32 v107, v107, s87, v175
    v_fma_f32 v108, v108, s87, v172
    v_fma_f32 v109, v109, s87, v173
    v_fma_f32 v110, v110, s87, v174
    v_fma_f32 v111, v111, s87, v175
    v_mul_f32 v120, 0xbfb8aa3b, v104
    v_mul_f32 v121, 0xbfb8aa3b, v105
    v_mul_f32 v122, 0xbfb8aa3b, v106
    v_mul_f32 v123, 0xbfb8aa3b, v107
    v_mul_f32 v124, 0xbfb8aa3b, v108
    v_mul_f32 v125, 0xbfb8aa3b, v109
    v_mul_f32 v126, 0xbfb8aa3b, v110
    v_mul_f32 v127, 0xbfb8aa3b, v111
    v_exp_f32 v120, v120
    v_exp_f32 v121, v121
    v_exp_f32 v122, v122
    v_exp_f32 v123, v123
    v_exp_f32 v124, v124
    v_exp_f32 v125, v125
    v_exp_f32 v126, v126
    v_exp_f32 v127, v127
    v_mul_f32 v104, v104, v136
    v_mul_f32 v105, v105, v137
    v_mul_f32 v106, v106, v138
    v_mul_f32 v107, v107, v139
    v_mul_f32 v108, v108, v140
    v_mul_f32 v109, v109, v141
    v_mul_f32 v110, v110, v142
    v_mul_f32 v111, v111, v143
    v_add_f32 v120, 1.0, v120
    v_add_f32 v121, 1.0, v121
    v_add_f32 v122, 1.0, v122
    v_add_f32 v123, 1.0, v123
    v_add_f32 v124, 1.0, v124
    v_add_f32 v125, 1.0, v125
    v_add_f32 v126, 1.0, v126
    v_add_f32 v127, 1.0, v127
    v_rcp_f32 v120, v120
    v_rcp_f32 v121, v121
    v_rcp_f32 v122, v122
    v_rcp_f32 v123, v123
    v_rcp_f32 v124, v124
    v_rcp_f32 v125, v125
    v_rcp_f32 v126, v126
    v_rcp_f32 v127, v127
    v_mul_f32 v104, v104, v120
    v_mul_f32 v105, v105, v121
    v_mul_f32 v106, v106, v122
    v_mul_f32 v107, v107, v123
    v_mul_f32 v108, v108, v124
    v_mul_f32 v109, v109, v125
    v_mul_f32 v110, v110, v126
    v_mul_f32 v111, v111, v127
    v_permlane16_swap_b32 v104, v108
    v_permlane16_swap_b32 v105, v109
    v_permlane16_swap_b32 v106, v110
    v_permlane16_swap_b32 v107, v111
    v_dot2c_f32_bf16 v104, s92, v164
    v_dot2c_f32_bf16 v105, s93, v164
    v_dot2c_f32_bf16 v106, s92, v165
    v_dot2c_f32_bf16 v107, s93, v165
    v_dot2c_f32_bf16 v108, s92, v166
    v_dot2c_f32_bf16 v109, s93, v166
    v_dot2c_f32_bf16 v110, s92, v167
    v_dot2c_f32_bf16 v111, s93, v167
    v_cvt_pk_bf16_f32 v164, v104, v105
    v_cvt_pk_bf16_f32 v165, v106, v107
    v_cvt_pk_bf16_f32 v166, v108, v109
    v_cvt_pk_bf16_f32 v167, v110, v111
    s_add_u32 s70, s82, 36864
    buffer_store_dwordx4 v[164:167], v208, s[44:47], s70 offen
    s_bitcmp0_b32 s3, 1
    s_cbranch_scc1 L_c8lo
    v_mov_b32 v144, v152
    v_mov_b32 v145, v153
    v_mov_b32 v146, v154
    v_mov_b32 v147, v155
    v_mov_b32 v148, v156
    v_mov_b32 v149, v157
    v_mov_b32 v150, v158
    v_mov_b32 v151, v159
L_c8lo:
    v_fma_f32 v112, v112, s87, v220
    v_fma_f32 v113, v113, s87, v221
    v_fma_f32 v114, v114, s87, v222
    v_fma_f32 v115, v115, s87, v223
    v_fma_f32 v116, v116, s87, v220
    v_fma_f32 v117, v117, s87, v221
    v_fma_f32 v118, v118, s87, v222
    v_fma_f32 v119, v119, s87, v223
    v_mul_f32 v120, 0xbfb8aa3b, v112
    v_mul_f32 v121, 0xbfb8aa3b, v113
    v_mul_f32 v122, 0xbfb8aa3b, v114
    v_mul_f32 v123, 0xbfb8aa3b, v115
    v_mul_f32 v124, 0xbfb8aa3b, v116
    v_mul_f32 v125, 0xbfb8aa3b, v117
    v_mul_f32 v126, 0xbfb8aa3b, v118
    v_mul_f32 v127, 0xbfb8aa3b, v119
    v_exp_f32 v120, v120
    v_exp_f32 v121, v121
    v_exp_f32 v122, v122
    v_exp_f32 v123, v123
    v_exp_f32 v124, v124
    v_exp_f32 v125, v125
    v_exp_f32 v126, v126
    v_exp_f32 v127, v127
    v_mul_f32 v112, v112, v144
    v_mul_f32 v113, v113, v145
    v_mul_f32 v114, v114, v146
    v_mul_f32 v115, v115, v147
    v_mul_f32 v116, v116, v148
    v_mul_f32 v117, v117, v149
    v_mul_f32 v118, v118, v150
    v_mul_f32 v119, v119, v151
    v_add_f32 v120, 1.0, v120
    v_add_f32 v121, 1.0, v121
    v_add_f32 v122, 1.0, v122
    v_add_f32 v123, 1.0, v123
    v_add_f32 v124, 1.0, v124
    v_add_f32 v125, 1.0, v125
    v_add_f32 v126, 1.0, v126
    v_add_f32 v127, 1.0, v127
    v_rcp_f32 v120, v120
    v_rcp_f32 v121, v121
    v_rcp_f32 v122, v122
    v_rcp_f32 v123, v123
    v_rcp_f32 v124, v124
    v_rcp_f32 v125, v125
    v_rcp_f32 v126, v126
    v_rcp_f32 v127, v127
    v_mul_f32 v112, v112, v120
    v_mul_f32 v113, v113, v121
    v_mul_f32 v114, v114, v122
    v_mul_f32 v115, v115, v123
    v_mul_f32 v116, v116, v124
    v_mul_f32 v117, v117, v125
    v_mul_f32 v118, v118, v126
    v_mul_f32 v119, v119, v127
    v_permlane16_swap_b32 v112, v116
    v_permlane16_swap_b32 v113, v117
    v_permlane16_swap_b32 v114, v118
    v_permlane16_swap_b32 v115, v119
    v_dot2c_f32_bf16 v112, s92, v216
    v_dot2c_f32_bf16 v113, s93, v216
    v_dot2c_f32_bf16 v114, s92, v217
    v_dot2c_f32_bf16 v115, s93, v217
    v_dot2c_f32_bf16 v116, s92, v218
    v_dot2c_f32_bf16 v117, s93, v218
    v_dot2c_f32_bf16 v118, s92, v219
    v_dot2c_f32_bf16 v119, s93, v219
    v_cvt_pk_bf16_f32 v216, v112, v113
    v_cvt_pk_bf16_f32 v217, v114, v115
    v_cvt_pk_bf16_f32 v218, v116, v117
    v_cvt_pk_bf16_f32 v219, v118, v119
    s_mov_b32 s70, s90
    buffer_store_dwordx4 v[216:219], v208, s[44:47], s70 offen
L_k1_end:
    s_endpgm
.fill 512, 4, 0xbf800000
.section .rodata,"a"
.p2align 6
.amdhsa_kernel recurrent_scan__linear_attn_block__dense_activation_gelu__prompt_kernel
  .amdhsa_next_free_vgpr 512
  .amdhsa_next_free_sgpr 102
  .amdhsa_accum_offset 256
  .amdhsa_group_segment_fixed_size 0
  .amdhsa_kernarg_size 88
  .amdhsa_user_sgpr_count 2
  .amdhsa_user_sgpr_kernarg_segment_ptr 1
  .amdhsa_system_sgpr_workgroup_id_x 1
.end_amdhsa_kernel
.text
```
